```python
import torch

def _softmax(x, axis=-1):
    return torch.softmax(x, dim=axis)
def _gelu(x):
    return torch.nn.functional.gelu(x, approximate="tanh")
def _silu(x):
    return torch.nn.functional.silu(x)
def _sigmoid(x):
    return torch.sigmoid(x)
def _layernorm(x, axis=-1, eps=1e-5):
    m = x.mean(dim=axis, keepdim=True)
    v = x.var(dim=axis, keepdim=True, unbiased=False)
    return (x - m) / torch.sqrt(v + eps)
def _scatter_add(tgt, idx, src, axis=0):
    return tgt.clone().index_add_(axis, idx, src)
def _segment_sum(src, seg, n):
    out = torch.zeros((n,) + src.shape[1:], dtype=src.dtype)
    return out.index_add_(0, seg, src)
def _pad(x, pw):
    flat = tuple(v for pair in reversed(pw) for v in pair)
    return torch.nn.functional.pad(x, flat)

kernel_name = 'sequential_preLN__linear_kernel_hedgehog__glu_gated_swiglu__prompt'

def setup_inputs():

    _w = (lambda a: (lambda t: t.to(torch.bfloat16) if t.is_floating_point() else t)(torch.as_tensor(a)))
    def _A_setup():
        B, S, D, H = 1, 2048, 1024, 32
        Dh = D // H
        return {
            "x": _w((lambda *s: torch.randn(*s, dtype=torch.bfloat16) * 0.05)(B, S, D)),
            "wqkv": _w((lambda *s: torch.randn(*s, dtype=torch.bfloat16) * 0.2)(D, 3 * D)),
            "w_phi": _w((lambda *s: torch.randn(*s, dtype=torch.bfloat16) * 0.2)(H, Dh, Dh) * (Dh ** -0.5)),
            "wo": _w((lambda *s: torch.randn(*s, dtype=torch.bfloat16) * 0.05)(D, D)),
        }
    _A_in = _A_setup()

    def _B_setup():
        B, S, D, F = 1, 2048, 1024, 3584
        return {
            "x": _w((lambda *s: torch.randn(*s, dtype=torch.bfloat16) * 0.05)(B, S, D)),
            "w1": _w((lambda *s: torch.randn(*s, dtype=torch.bfloat16) * 0.4)(D, F) * (2.0 / D) ** 0.5),
            "w3": _w((lambda *s: torch.randn(*s, dtype=torch.bfloat16) * 0.4)(D, F) * (2.0 / D) ** 0.5),
            "w2": _w((lambda *s: torch.randn(*s, dtype=torch.bfloat16) * 0.4)(F, D) * (2.0 / F) ** 0.5),
        }
    _B_in = _B_setup()

    return {
        "A_x": _A_in["x"],
        "A_wqkv": _A_in["wqkv"],
        "A_w_phi": _A_in["w_phi"],
        "A_wo": _A_in["wo"],
        "B_x": _B_in["x"],
        "B_w1": _B_in["w1"],
        "B_w3": _B_in["w3"],
        "B_w2": _B_in["w2"],
    }

def reference(A_x, A_wqkv, A_w_phi, A_wo, B_x, B_w1, B_w3, B_w2):
    def _A_ref(x, wqkv, w_phi, wo):
        B, S, D = x.shape
        H = 32; Dh = D // H
        qkv = (lambda x, *d: x.permute(*d))((x @ wqkv).reshape(B, S, 3, H, Dh), 2, 0, 3, 1, 4)
        q, k, v = qkv[0], qkv[1], qkv[2]
        pq = torch.einsum("bhsd,hdf->bhsf", q, w_phi)
        pk = torch.einsum("bhsd,hdf->bhsf", k, w_phi)
        phi_q = torch.concatenate([_softmax(pq, axis=-1), _softmax(-pq, axis=-1)], axis=-1)
        phi_k = torch.concatenate([_softmax(pk, axis=-1), _softmax(-pk, axis=-1)], axis=-1)
        kv = torch.einsum("bhsf,bhsd->bhfd", phi_k, v)
        z  = torch.einsum("bhsf->bhf", phi_k)
        num = torch.einsum("bhqf,bhfd->bhqd", phi_q, kv)
        den = torch.einsum("bhqf,bhf->bhq", phi_q, z)[..., None] + 1e-6
        o = num / den
        return (lambda x, *d: x.permute(*d))(o, 0, 2, 1, 3).reshape(B, S, D) @ wo

    def _B_ref(x, w1, w3, w2):
        gate = torch.einsum("bsd,df->bsf", x, w1)
        up = torch.einsum("bsd,df->bsf", x, w3)
        h = _silu(gate) * up
        out = torch.einsum("bsf,fd->bsd", h, w2)
        return out

    x = A_x
    h = x + _A_ref(_layernorm(x, axis=-1), A_wqkv, A_w_phi, A_wo)
    h2 = h + _B_ref(_layernorm(h, axis=-1), B_w1, B_w3, B_w2)
    return h2
```

```asm
; @launch kernel=qkv_kernel grid=(256,1,1) block=(256,1,1) lds=163840
.amdgcn_target "amdgcn-amd-amdhsa--gfx950"
.text
.globl qkv_kernel
.p2align 8
.type qkv_kernel,@function
qkv_kernel:
    s_cmp_ge_u32 s2, 256
    s_cbranch_scc1 L_up_end
    s_load_dwordx4 s[4:7], s[0:1], 0
    s_load_dwordx4 s[56:59], s[0:1], 16
    s_load_dwordx4 s[60:63], s[0:1], 40
    s_load_dwordx4 s[20:23], s[0:1], 72
    s_load_dwordx4 s[52:55], s[0:1], 56
    s_and_b32 s48, s2, 7
    s_lshr_b32 s49, s2, 3
    s_lshr_b32 s26, s48, 2
    s_and_b32 s27, s48, 3
    s_lshr_b32 s50, s49, 2
    s_and_b32 s51, s49, 3
    s_mul_i32 s26, s26, 8
    s_add_u32 s26, s26, s50
    s_mul_i32 s27, s27, 4
    s_add_u32 s27, s27, s51
    v_lshrrev_b32 v1, 6, v0
    v_and_b32 v0, 63, v0
    v_readfirstlane_b32 s28, v1
    v_lshlrev_b32 v1, 4, v0
    v_lshrrev_b32 v24, 3, v0
    v_and_b32 v25, 7, v0
    v_lshrrev_b32 v26, 4, v0
    s_and_b32 s48, s27, 7
    s_cmp_eq_u32 s48, 3
    s_cselect_b32 s30, 3, 1
    s_mul_i32 s30, s26, s30
    s_mul_i32 s48, s27, 1
    s_add_u32 s30, s30, s48
    s_and_b32 s30, s30, 15
    s_lshl_b32 s30, s30, 7
    s_mov_b32 s31, s30
    s_lshl_b32 s29, s26, 2
    s_add_u32 s29, s29, s28
    v_xor_b32 v27, v25, v26
    v_lshlrev_b32 v2, 11, v24
    v_lshl_add_u32 v2, v27, 4, v2
    s_lshl_b32 s48, s29, 16
    v_add_u32 v2, s48, v2
    v_xor_b32 v3, 64, v2
    v_add_u32 v3, 15360, v3
    v_add_u32 v4, 30720, v2
    v_add_u32 v5, 30720, v3
    v_and_b32 v27, 1, v26
    v_lshlrev_b32 v28, 1, v27
    v_xor_b32 v28, v28, v25
    v_mul_u32_u24 v6, 6144, v24
    v_lshl_add_u32 v6, v28, 4, v6
    s_mul_i32 s48, s28, 98304
    s_lshl_b32 s49, s27, 7
    s_add_u32 s48, s48, s49
    v_add_u32 v6, s48, v6
    v_xor_b32 v7, 64, v6
    v_add_u32 v7, 48128, v7
    s_mul_i32 s33, s28, 12288
    s_add_u32 s33, s33, 106496
    s_lshl_b32 s34, s28, 11
    s_waitcnt lgkmcnt(0)
    s_mov_b32 s8, s4
    s_and_b32 s9, s5, 0xffff
    s_mov_b32 s10, 4194304
    s_mov_b32 s11, 0x00020000
    s_mov_b32 s12, s6
    s_and_b32 s13, s7, 0xffff
    s_mov_b32 s14, 6291456
    s_mov_b32 s15, 0x00020000
    s_add_u32 m0, s34, 65536
    s_add_u32 s32, s31, 0
    s_and_b32 s32, s32, 2047
    s_mul_i32 s32, s32, 3072
    s_add_u32 s32, s32, 2048
    buffer_load_dwordx4 v6, s[12:15], s32 offen offset:0 lds
    buffer_load_dwordx4 v7, s[12:15], s32 offen offset:1024 lds
    s_add_u32 m0, s33, 0
    s_nop 0
    buffer_load_dwordx4 v2, s[8:11], s30 offen offset:0 lds
    v_and_b32 v29, 15, v0
    v_lshrrev_b32 v30, 1, v29
    v_xor_b32 v30, v30, v26
    buffer_load_dwordx4 v3, s[8:11], s30 offen offset:1024 lds
    v_lshlrev_b32 v8, 7, v29
    v_lshl_add_u32 v8, v30, 4, v8
    v_add_u32 v8, s33, v8
    buffer_load_dwordx4 v4, s[8:11], s30 offen offset:2048 lds
    v_xor_b32 v9, 64, v8
    v_bfe_u32 v30, v0, 2, 2
    v_lshlrev_b32 v10, 10, v26
    buffer_load_dwordx4 v5, s[8:11], s30 offen offset:3072 lds
    v_lshl_add_u32 v10, v30, 7, v10
    v_and_b32 v31, 3, v0
    v_lshl_add_u32 v10, v31, 3, v10
    s_add_u32 s30, s30, 128
    s_and_b32 s30, s30, 2047
    s_add_u32 m0, s34, 73728
    s_add_u32 s32, s31, 128
    s_and_b32 s32, s32, 2047
    s_mul_i32 s32, s32, 3072
    s_add_u32 s32, s32, 2048
    buffer_load_dwordx4 v6, s[12:15], s32 offen offset:0 lds
    v_lshrrev_b32 v30, 1, v30
    v_lshl_add_u32 v30, v27, 1, v30
    v_xor_b32 v30, s28, v30
    buffer_load_dwordx4 v7, s[12:15], s32 offen offset:1024 lds
    v_lshl_add_u32 v10, v30, 5, v10
    v_add_u32 v10, 65536, v10
    v_xor_b32 v11, 32, v10
    s_add_u32 m0, s33, 4096
    s_nop 0
    buffer_load_dwordx4 v2, s[8:11], s30 offen offset:0 lds
    v_xor_b32 v12, 64, v10
    v_xor_b32 v13, 96, v10
    v_mov_b32 v32, 0x3f803f80
    buffer_load_dwordx4 v3, s[8:11], s30 offen offset:1024 lds
    v_mov_b32 v33, 0x3f803f80
    v_mov_b32 v34, 0x3f803f80
    v_mov_b32 v35, 0x3f803f80
    buffer_load_dwordx4 v4, s[8:11], s30 offen offset:2048 lds
    buffer_load_dwordx4 v5, s[8:11], s30 offen offset:3072 lds
    s_cmp_lt_u32 s28, 2
    s_cbranch_scc0 L_qkv_tl
    s_lshr_b32 s3, s2, 3
    s_mov_b64 s[74:75], s[22:23]
    s_min_u32 s76, s3, 27
    s_cmp_eq_u32 s28, 0
    s_cbranch_scc1 L_qkv_tg
    s_and_b32 s76, s3, 3
    s_mov_b64 s[74:75], s[60:61]
    s_cmp_ge_u32 s3, 4
    s_cselect_b64 s[74:75], s[62:63], s[74:75]
    s_cmp_ge_u32 s3, 8
    s_cselect_b64 s[74:75], s[52:53], s[74:75]
    s_cmp_lt_u32 s3, 12
    s_cbranch_scc1 L_qkv_tg
    s_and_b32 s76, s3, 1
    s_mov_b64 s[74:75], s[54:55]
    s_cmp_lt_u32 s3, 14
    s_cbranch_scc1 L_qkv_tg
    s_mov_b32 s76, 0
    s_mov_b64 s[74:75], s[20:21]
    s_cmp_lt_u32 s3, 15
    s_cbranch_scc0 L_qkv_tl
L_qkv_tg:
    s_lshl_b32 s76, s76, 21
    v_mov_b32 v128, s76
    global_load_dword v16, v128, s[74:75]
L_qkv_tl:
    s_waitcnt vmcnt(10)
    s_barrier
    ds_read_b64_tr_b16 v[60:61], v10 offset:0
    ds_read_b64_tr_b16 v[62:63], v10 offset:512
    ds_read_b64_tr_b16 v[64:65], v11 offset:0
    ds_read_b64_tr_b16 v[66:67], v11 offset:512
    ds_read_b64_tr_b16 v[68:69], v12 offset:0
    ds_read_b64_tr_b16 v[70:71], v12 offset:512
    ds_read_b64_tr_b16 v[72:73], v13 offset:0
    ds_read_b64_tr_b16 v[74:75], v13 offset:512
    ds_read_b64_tr_b16 v[76:77], v10 offset:4096
    ds_read_b64_tr_b16 v[78:79], v10 offset:4608
    ds_read_b64_tr_b16 v[80:81], v11 offset:4096
    ds_read_b64_tr_b16 v[82:83], v11 offset:4608
    ds_read_b64_tr_b16 v[84:85], v12 offset:4096
    ds_read_b64_tr_b16 v[86:87], v12 offset:4608
    s_waitcnt vmcnt(8)
    ds_read_b128 a[0:3], v8 offset:0
    s_waitcnt vmcnt(6)
    ds_read_b128 a[4:7], v8 offset:2048
    s_waitcnt lgkmcnt(1)
    v_mfma_f32_16x16x32_bf16 v[96:99], v[60:63], a[0:3], 0
    s_waitcnt lgkmcnt(0)
    s_add_u32 s30, s30, 128
    s_and_b32 s30, s30, 2047
    v_mfma_f32_16x16x32_bf16 v[100:103], v[60:63], a[4:7], 0
    s_add_u32 m0, s34, 81920
    s_add_u32 s32, s31, 256
    s_and_b32 s32, s32, 2047
    v_mfma_f32_16x16x32_bf16 v[44:47], v[60:63], v[32:35], 0
    s_waitcnt vmcnt(4)
    s_barrier
    s_mul_i32 s32, s32, 3072
    v_mfma_f32_16x16x32_bf16 v[104:107], v[64:67], a[0:3], 0
    s_add_u32 s32, s32, 2048
    ds_read_b64_tr_b16 v[88:89], v13 offset:4096
    v_mfma_f32_16x16x32_bf16 v[108:111], v[64:67], a[4:7], 0
    buffer_load_dwordx4 v6, s[12:15], s32 offen offset:0 lds
    v_mfma_f32_16x16x32_bf16 v[160:163], v[32:35], a[0:3], 0
    buffer_load_dwordx4 v7, s[12:15], s32 offen offset:1024 lds
    v_mfma_f32_16x16x32_bf16 v[168:171], a[0:3], a[0:3], 0
    s_add_u32 m0, s33, 8192
    ds_read_b64_tr_b16 v[90:91], v13 offset:4608
    v_mfma_f32_16x16x32_bf16 v[112:115], v[68:71], a[0:3], 0
    buffer_load_dwordx4 v2, s[8:11], s30 offen offset:0 lds
    ds_read_b128 a[8:11], v9 offset:0
    v_mfma_f32_16x16x32_bf16 v[116:119], v[68:71], a[4:7], 0
    buffer_load_dwordx4 v3, s[8:11], s30 offen offset:1024 lds
    ds_read_b128 a[12:15], v9 offset:2048
    v_mfma_f32_16x16x32_bf16 v[120:123], v[72:75], a[0:3], 0
    buffer_load_dwordx4 v4, s[8:11], s30 offen offset:2048 lds
    ds_read_b64_tr_b16 v[60:61], v10 offset:8192
    v_mfma_f32_16x16x32_bf16 v[124:127], v[72:75], a[4:7], 0
    buffer_load_dwordx4 v5, s[8:11], s30 offen offset:3072 lds
    ds_read_b64_tr_b16 v[62:63], v10 offset:8704
    v_mfma_f32_16x16x32_bf16 v[164:167], v[32:35], a[4:7], 0
    s_add_u32 s30, s30, 128
    s_and_b32 s30, s30, 2047
    s_add_u32 m0, s34, 90112
    v_mfma_f32_16x16x32_bf16 v[172:175], a[4:7], a[4:7], 0
    s_waitcnt lgkmcnt(3)
    s_add_u32 s32, s31, 384
    s_and_b32 s32, s32, 2047
    v_mfma_f32_16x16x32_bf16 v[96:99], v[76:79], a[8:11], v[96:99]
    s_waitcnt lgkmcnt(2)
    s_mul_i32 s32, s32, 3072
    s_add_u32 s32, s32, 2048
    ds_read_b64_tr_b16 v[64:65], v11 offset:8192
    v_mfma_f32_16x16x32_bf16 v[100:103], v[76:79], a[12:15], v[100:103]
    buffer_load_dwordx4 v6, s[12:15], s32 offen offset:0 lds
    ds_read_b64_tr_b16 v[66:67], v11 offset:8704
    v_mfma_f32_16x16x32_bf16 v[44:47], v[76:79], v[32:35], v[44:47]
    buffer_load_dwordx4 v7, s[12:15], s32 offen offset:1024 lds
    ds_read_b64_tr_b16 v[68:69], v12 offset:8192
    v_mfma_f32_16x16x32_bf16 v[104:107], v[80:83], a[8:11], v[104:107]
    s_add_u32 m0, s33, 0
    s_waitcnt vmcnt(10)
    ds_read_b128 a[16:19], v8 offset:4096
    v_mfma_f32_16x16x32_bf16 v[108:111], v[80:83], a[12:15], v[108:111]
    buffer_load_dwordx4 v2, s[8:11], s30 offen offset:0 lds
    ds_read_b64_tr_b16 v[70:71], v12 offset:8704
    v_mfma_f32_16x16x32_bf16 v[160:163], v[32:35], a[8:11], v[160:163]
    buffer_load_dwordx4 v3, s[8:11], s30 offen offset:1024 lds
    v_mfma_f32_16x16x32_bf16 v[168:171], a[8:11], a[8:11], v[168:171]
    buffer_load_dwordx4 v4, s[8:11], s30 offen offset:2048 lds
    ds_read_b64_tr_b16 v[72:73], v13 offset:8192
    v_mfma_f32_16x16x32_bf16 v[112:115], v[84:87], a[8:11], v[112:115]
    buffer_load_dwordx4 v5, s[8:11], s30 offen offset:3072 lds
    ds_read_b64_tr_b16 v[74:75], v13 offset:8704
    v_mfma_f32_16x16x32_bf16 v[116:119], v[84:87], a[12:15], v[116:119]
    s_add_u32 s30, s30, 128
    s_and_b32 s30, s30, 2047
    s_waitcnt vmcnt(12)
    ds_read_b128 a[20:23], v8 offset:6144
    v_mfma_f32_16x16x32_bf16 v[120:123], v[88:91], a[8:11], v[120:123]
    s_add_u32 s36, s22, 0x1a00000
    s_addc_u32 s37, s23, 0
    s_and_b32 s37, s37, 0xffff
    s_mov_b32 s38, 11599872
    s_mov_b32 s39, 0x00020000
    v_mov_b32 v136, -1
    v_mfma_f32_16x16x32_bf16 v[124:127], v[88:91], a[12:15], v[124:127]
    ds_read_b128 a[24:27], v9 offset:4096
    ds_read_b128 a[28:31], v9 offset:6144
    v_mov_b32 v137, -1
    v_mov_b32 v138, -1
    v_mfma_f32_16x16x32_bf16 v[164:167], v[32:35], a[12:15], v[164:167]
    ds_read_b64_tr_b16 v[76:77], v10 offset:12288
    ds_read_b64_tr_b16 v[78:79], v10 offset:12800
    v_mov_b32 v139, -1
    v_mfma_f32_16x16x32_bf16 v[172:175], a[12:15], a[12:15], v[172:175]
    s_waitcnt lgkmcnt(6)
    s_lshl_b32 s74, s2, 2
    s_add_u32 s74, s74, s28
    s_mul_i32 s3, s74, 2560
    v_mfma_f32_16x16x32_bf16 v[96:99], v[60:63], a[16:19], v[96:99]
    s_waitcnt lgkmcnt(4)
    s_add_u32 s3, s3, 8912896
    ds_read_b64_tr_b16 v[80:81], v11 offset:12288
    v_mul_u32_u24 v133, 640, v26
    v_mfma_f32_16x16x32_bf16 v[100:103], v[60:63], a[20:23], v[100:103]
    s_lshl_b32 s74, s74, 11
    s_add_u32 s75, s74, 8781824
    s_add_u32 s76, s74, 9175040
    s_add_u32 s74, s74, 8388608
    s_cmp_lt_u32 s2, 16
    s_cbranch_scc0 L_qkv_i0
    buffer_store_dwordx4 v[136:139], v1, s[36:39], s74 offen offset:0 sc1
    buffer_store_dwordx4 v[136:139], v1, s[36:39], s74 offen offset:1024 sc1
    buffer_store_dwordx4 v[136:139], v1, s[36:39], s75 offen offset:0 sc1
    buffer_store_dwordx4 v[136:139], v1, s[36:39], s75 offen offset:1024 sc1
    buffer_store_dwordx4 v[136:139], v1, s[36:39], s76 offen offset:0 sc1
    buffer_store_dwordx4 v[136:139], v1, s[36:39], s76 offen offset:1024 sc1
    buffer_store_dword v136, v133, s[36:39], s3 offen sc1
L_qkv_i0:
    v_mfma_f32_16x16x32_bf16 v[44:47], v[60:63], v[32:35], v[44:47]
    s_waitcnt vmcnt(10)
    s_barrier
    s_mov_b32 s16, s58
    s_and_b32 s17, s59, 0xffff
    v_mfma_f32_16x16x32_bf16 v[104:107], v[64:67], a[16:19], v[104:107]
    s_mov_b32 s18, 2097152
    s_mov_b32 s19, 0x00020000
    s_mov_b32 s44, s56
    s_and_b32 s45, s57, 0xffff
    v_mfma_f32_16x16x32_bf16 v[108:111], v[64:67], a[20:23], v[108:111]
    s_mov_b32 s46, 65536
    s_mov_b32 s47, 0x00020000
    s_lshl_b32 s74, s27, 4
    s_add_u32 s74, s74, s26
    v_mfma_f32_16x16x32_bf16 v[160:163], v[32:35], a[16:19], v[160:163]
    s_lshl_b32 s74, s74, 2
    s_add_u32 s74, s74, s28
    s_lshl_b32 s74, s74, 11
    ds_read_b64_tr_b16 v[82:83], v11 offset:12800
    v_mfma_f32_16x16x32_bf16 v[168:171], a[16:19], a[16:19], v[168:171]
    buffer_load_dwordx4 v[208:211], v1, s[16:19], s74 offen offset:0
    ds_read_b64_tr_b16 v[84:85], v12 offset:12288
    v_mfma_f32_16x16x32_bf16 v[112:115], v[68:71], a[16:19], v[112:115]
    buffer_load_dwordx4 v[212:215], v1, s[16:19], s74 offen offset:1024
    ds_read_b64_tr_b16 v[86:87], v12 offset:12800
    v_lshrrev_b32 v128, 2, v0
    v_lshlrev_b32 v132, 1, v27
    v_mfma_f32_16x16x32_bf16 v[116:119], v[68:71], a[20:23], v[116:119]
    ds_read_b64_tr_b16 v[88:89], v13 offset:12288
    ds_read_b64_tr_b16 v[90:91], v13 offset:12800
    v_xor_b32 v132, v132, v31
    v_lshlrev_b32 v132, 4, v132
    v_mfma_f32_16x16x32_bf16 v[120:123], v[72:75], a[16:19], v[120:123]
    ds_read_b64_tr_b16 v[60:61], v10 offset:16384
    ds_read_b64_tr_b16 v[62:63], v10 offset:16896
    v_lshl_add_u32 v132, v128, 6, v132
    v_mfma_f32_16x16x32_bf16 v[124:127], v[72:75], a[20:23], v[124:127]
    s_lshl_b32 s48, s28, 10
    s_lshl_b32 s49, s27, 12
    s_add_u32 s49, s49, s48
    s_add_u32 s48, s48, 155648
    v_mfma_f32_16x16x32_bf16 v[164:167], v[32:35], a[20:23], v[164:167]
    s_mov_b32 m0, s48
    s_getpc_b64 s[88:89]
L_qkv_pc:
    s_lshr_b32 s74, s2, 3
    s_lshl_b32 s74, s74, 2
    v_mfma_f32_16x16x32_bf16 v[172:175], a[20:23], a[20:23], v[172:175]
    s_waitcnt lgkmcnt(5)
    s_add_u32 s74, s74, s28
    s_mul_i32 s74, s74, 768
    v_min_u32 v128, 5, v0
    v_lshlrev_b32 v128, 7, v128
    v_add_u32 v128, s74, v128
    v_mfma_f32_16x16x32_bf16 v[96:99], v[76:79], a[24:27], v[96:99]
    buffer_load_dwordx4 v132, s[44:47], s49 offen lds
    ds_read_b64_tr_b16 v[64:65], v11 offset:16384
    v_min_u32 v128, L_code_end-L_qkv_pc-4, v128
    v_mfma_f32_16x16x32_bf16 v[100:103], v[76:79], a[28:31], v[100:103]
    global_load_dword v16, v128, s[88:89]
    ds_read_b64_tr_b16 v[66:67], v11 offset:16896
    v_mfma_f32_16x16x32_bf16 v[44:47], v[76:79], v[32:35], v[44:47]
    s_add_u32 m0, s34, 98304
    s_add_u32 s32, s31, 512
    s_and_b32 s32, s32, 2047
    ds_read_b64_tr_b16 v[68:69], v12 offset:16384
    v_mfma_f32_16x16x32_bf16 v[104:107], v[80:83], a[24:27], v[104:107]
    s_mul_i32 s32, s32, 3072
    s_add_u32 s32, s32, 2048
    ds_read_b64_tr_b16 v[70:71], v12 offset:16896
    v_mfma_f32_16x16x32_bf16 v[108:111], v[80:83], a[28:31], v[108:111]
    buffer_load_dwordx4 v6, s[12:15], s32 offen offset:0 lds
    v_mfma_f32_16x16x32_bf16 v[160:163], v[32:35], a[24:27], v[160:163]
    buffer_load_dwordx4 v7, s[12:15], s32 offen offset:1024 lds
    v_mfma_f32_16x16x32_bf16 v[168:171], a[24:27], a[24:27], v[168:171]
    s_waitcnt lgkmcnt(3)
    s_add_u32 m0, s33, 4096
    s_waitcnt vmcnt(14)
    ds_read_b128 a[32:35], v8 offset:8192
    v_mfma_f32_16x16x32_bf16 v[112:115], v[84:87], a[24:27], v[112:115]
    buffer_load_dwordx4 v2, s[8:11], s30 offen offset:0 lds
    ds_read_b64_tr_b16 v[72:73], v13 offset:16384
    v_mfma_f32_16x16x32_bf16 v[116:119], v[84:87], a[28:31], v[116:119]
    buffer_load_dwordx4 v3, s[8:11], s30 offen offset:1024 lds
    ds_read_b64_tr_b16 v[74:75], v13 offset:16896
    v_mfma_f32_16x16x32_bf16 v[120:123], v[88:91], a[24:27], v[120:123]
    buffer_load_dwordx4 v4, s[8:11], s30 offen offset:2048 lds
    ds_read_b64_tr_b16 v[76:77], v10 offset:20480
    v_mfma_f32_16x16x32_bf16 v[124:127], v[88:91], a[28:31], v[124:127]
    buffer_load_dwordx4 v5, s[8:11], s30 offen offset:3072 lds
    s_waitcnt vmcnt(16)
    ds_read_b128 a[36:39], v8 offset:10240
    v_mfma_f32_16x16x32_bf16 v[164:167], v[32:35], a[28:31], v[164:167]
    s_add_u32 s30, s30, 128
    s_and_b32 s30, s30, 2047
    s_add_u32 m0, s34, 0
    ds_read_b128 a[40:43], v9 offset:8192
    v_mfma_f32_16x16x32_bf16 v[172:175], a[28:31], a[28:31], v[172:175]
    s_waitcnt lgkmcnt(5)
    s_add_u32 s32, s31, 640
    s_and_b32 s32, s32, 2047
    ds_read_b128 a[44:47], v9 offset:10240
    v_mfma_f32_16x16x32_bf16 v[96:99], v[60:63], a[32:35], v[96:99]
    s_waitcnt lgkmcnt(2)
    s_mul_i32 s32, s32, 3072
    s_add_u32 s32, s32, 2048
    ds_read_b64_tr_b16 v[78:79], v10 offset:20992
    v_mfma_f32_16x16x32_bf16 v[100:103], v[60:63], a[36:39], v[100:103]
    buffer_load_dwordx4 v6, s[12:15], s32 offen offset:0 lds
    ds_read_b64_tr_b16 v[80:81], v11 offset:20480
    v_mfma_f32_16x16x32_bf16 v[44:47], v[60:63], v[32:35], v[44:47]
    s_waitcnt vmcnt(15)
    s_barrier
    ds_read_b64_tr_b16 v[82:83], v11 offset:20992
    v_mfma_f32_16x16x32_bf16 v[104:107], v[64:67], a[32:35], v[104:107]
    buffer_load_dwordx4 v7, s[12:15], s32 offen offset:1024 lds
    ds_read_b64_tr_b16 v[84:85], v12 offset:20480
    v_mfma_f32_16x16x32_bf16 v[108:111], v[64:67], a[36:39], v[108:111]
    s_add_u32 m0, s33, 8192
    ds_read_b64_tr_b16 v[86:87], v12 offset:20992
    v_mfma_f32_16x16x32_bf16 v[160:163], v[32:35], a[32:35], v[160:163]
    ds_read_b64_tr_b16 v[88:89], v13 offset:20480
    v_mfma_f32_16x16x32_bf16 v[168:171], a[32:35], a[32:35], v[168:171]
    ds_read_b64_tr_b16 v[90:91], v13 offset:20992
    v_mfma_f32_16x16x32_bf16 v[112:115], v[68:71], a[32:35], v[112:115]
    ds_read_b64_tr_b16 v[60:61], v10 offset:24576
    v_mfma_f32_16x16x32_bf16 v[116:119], v[68:71], a[36:39], v[116:119]
    ds_read_b64_tr_b16 v[62:63], v10 offset:25088
    v_mfma_f32_16x16x32_bf16 v[120:123], v[72:75], a[32:35], v[120:123]
    ds_read_b64_tr_b16 v[64:65], v11 offset:24576
    v_mfma_f32_16x16x32_bf16 v[124:127], v[72:75], a[36:39], v[124:127]
    ds_read_b64_tr_b16 v[66:67], v11 offset:25088
    v_mfma_f32_16x16x32_bf16 v[164:167], v[32:35], a[36:39], v[164:167]
    ds_read_b64_tr_b16 v[68:69], v12 offset:24576
    v_mfma_f32_16x16x32_bf16 v[172:175], a[36:39], a[36:39], v[172:175]
    s_waitcnt lgkmcnt(5)
    s_waitcnt vmcnt(14)
    ds_read_b128 a[48:51], v8 offset:0
    v_mfma_f32_16x16x32_bf16 v[96:99], v[76:79], a[40:43], v[96:99]
    buffer_load_dwordx4 v2, s[8:11], s30 offen offset:0 lds
    v_mfma_f32_16x16x32_bf16 v[100:103], v[76:79], a[44:47], v[100:103]
    buffer_load_dwordx4 v3, s[8:11], s30 offen offset:1024 lds
    v_mfma_f32_16x16x32_bf16 v[44:47], v[76:79], v[32:35], v[44:47]
    buffer_load_dwordx4 v4, s[8:11], s30 offen offset:2048 lds
    ds_read_b64_tr_b16 v[70:71], v12 offset:25088
    v_mfma_f32_16x16x32_bf16 v[104:107], v[80:83], a[40:43], v[104:107]
    buffer_load_dwordx4 v5, s[8:11], s30 offen offset:3072 lds
    v_mfma_f32_16x16x32_bf16 v[108:111], v[80:83], a[44:47], v[108:111]
    s_add_u32 s30, s30, 128
    s_and_b32 s30, s30, 2047
    s_add_u32 m0, s34, 8192
    v_mfma_f32_16x16x32_bf16 v[160:163], v[32:35], a[40:43], v[160:163]
    s_add_u32 s32, s31, 768
    s_and_b32 s32, s32, 2047
    s_mul_i32 s32, s32, 3072
    v_mfma_f32_16x16x32_bf16 v[168:171], a[40:43], a[40:43], v[168:171]
    s_add_u32 s32, s32, 2048
    s_waitcnt vmcnt(16)
    ds_read_b128 a[52:55], v8 offset:2048
    v_mfma_f32_16x16x32_bf16 v[112:115], v[84:87], a[40:43], v[112:115]
    buffer_load_dwordx4 v6, s[12:15], s32 offen offset:0 lds
    ds_read_b64_tr_b16 v[72:73], v13 offset:24576
    v_mfma_f32_16x16x32_bf16 v[116:119], v[84:87], a[44:47], v[116:119]
    buffer_load_dwordx4 v7, s[12:15], s32 offen offset:1024 lds
    ds_read_b64_tr_b16 v[74:75], v13 offset:25088
    v_mfma_f32_16x16x32_bf16 v[120:123], v[88:91], a[40:43], v[120:123]
    s_add_u32 m0, s33, 0
    ds_read_b128 a[56:59], v9 offset:0
    ds_read_b128 a[60:63], v9 offset:2048
    v_mfma_f32_16x16x32_bf16 v[124:127], v[88:91], a[44:47], v[124:127]
    s_add_u32 s40, s22, 0x400000
    s_addc_u32 s41, s23, 0
    s_and_b32 s41, s41, 0xffff
    s_mov_b32 s42, 8388608
    s_mov_b32 s43, 0x00020000
    v_mfma_f32_16x16x32_bf16 v[164:167], v[32:35], a[44:47], v[164:167]
    ds_read_b64_tr_b16 v[76:77], v10 offset:28672
    ds_read_b64_tr_b16 v[78:79], v10 offset:29184
    v_mfma_f32_16x16x32_bf16 v[172:175], a[44:47], a[44:47], v[172:175]
    s_waitcnt lgkmcnt(6)
    ds_read_b64_tr_b16 v[80:81], v11 offset:28672
    v_mfma_f32_16x16x32_bf16 v[96:99], v[60:63], a[48:51], v[96:99]
    ds_read_b64_tr_b16 v[82:83], v11 offset:29184
    v_mfma_f32_16x16x32_bf16 v[100:103], v[60:63], a[52:55], v[100:103]
    ds_read_b64_tr_b16 v[84:85], v12 offset:28672
    v_mfma_f32_16x16x32_bf16 v[44:47], v[60:63], v[32:35], v[44:47]
    s_waitcnt vmcnt(12) lgkmcnt(5)
    s_barrier
    ds_read_b64_tr_b16 v[86:87], v12 offset:29184
    v_mfma_f32_16x16x32_bf16 v[104:107], v[64:67], a[48:51], v[104:107]
    buffer_load_dwordx4 v2, s[8:11], s30 offen offset:0 lds
    v_mfma_f32_16x16x32_bf16 v[108:111], v[64:67], a[52:55], v[108:111]
    buffer_load_dwordx4 v3, s[8:11], s30 offen offset:1024 lds
    v_lshrrev_b32 v17, 2, v0
    v_mfma_f32_16x16x32_bf16 v[160:163], v[32:35], a[48:51], v[160:163]
    buffer_load_dwordx4 v4, s[8:11], s30 offen offset:2048 lds
    v_mfma_f32_16x16x32_bf16 v[168:171], a[48:51], a[48:51], v[168:171]
    buffer_load_dwordx4 v5, s[8:11], s30 offen offset:3072 lds
    ds_read_b64_tr_b16 v[88:89], v13 offset:28672
    v_mfma_f32_16x16x32_bf16 v[112:115], v[68:71], a[48:51], v[112:115]
    s_add_u32 s30, s30, 128
    s_and_b32 s30, s30, 2047
    s_add_u32 m0, s34, 16384
    ds_read_b64_tr_b16 v[90:91], v13 offset:29184
    v_mfma_f32_16x16x32_bf16 v[116:119], v[68:71], a[52:55], v[116:119]
    s_add_u32 s32, s31, 896
    s_and_b32 s32, s32, 2047
    s_mul_i32 s32, s32, 3072
    v_lshlrev_b32 v19, 6, v17
    v_mfma_f32_16x16x32_bf16 v[120:123], v[72:75], a[48:51], v[120:123]
    s_add_u32 s32, s32, 2048
    ds_read_b64_tr_b16 v[60:61], v10 offset:32768
    ds_read_b64_tr_b16 v[62:63], v10 offset:33280
    v_mfma_f32_16x16x32_bf16 v[124:127], v[72:75], a[52:55], v[124:127]
    buffer_load_dwordx4 v6, s[12:15], s32 offen offset:0 lds
    v_mfma_f32_16x16x32_bf16 v[164:167], v[32:35], a[52:55], v[164:167]
    ds_read_b64_tr_b16 v[64:65], v11 offset:32768
    v_lshl_add_u32 v19, v31, 3, v19
    v_mfma_f32_16x16x32_bf16 v[172:175], a[52:55], a[52:55], v[172:175]
    s_waitcnt lgkmcnt(4)
    s_waitcnt vmcnt(15)
    ds_read_b128 a[64:67], v8 offset:4096
    v_mfma_f32_16x16x32_bf16 v[96:99], v[76:79], a[56:59], v[96:99]
    v_lshlrev_b32 v216, 16, v208
    v_and_b32 v217, 0xffff0000, v208
    v_mfma_f32_16x16x32_bf16 v[100:103], v[76:79], a[60:63], v[100:103]
    buffer_load_dwordx4 v7, s[12:15], s32 offen offset:1024 lds
    ds_read_b64_tr_b16 v[66:67], v11 offset:33280
    v_mfma_f32_16x16x32_bf16 v[44:47], v[76:79], v[32:35], v[44:47]
    s_add_u32 m0, s33, 4096
    s_waitcnt vmcnt(14)
    ds_read_b128 a[68:71], v8 offset:6144
    v_mfma_f32_16x16x32_bf16 v[104:107], v[80:83], a[56:59], v[104:107]
    ds_read_b64_tr_b16 v[68:69], v12 offset:32768
    ds_read_b64_tr_b16 v[70:71], v12 offset:33280
    v_lshl_add_u32 v19, v27, 5, v19
    v_mfma_f32_16x16x32_bf16 v[108:111], v[80:83], a[60:63], v[108:111]
    ds_read_b64_tr_b16 v[72:73], v13 offset:32768
    v_lshlrev_b32 v218, 16, v209
    v_mfma_f32_16x16x32_bf16 v[160:163], v[32:35], a[56:59], v[160:163]
    ds_read_b64_tr_b16 v[74:75], v13 offset:33280
    v_and_b32 v219, 0xffff0000, v209
    v_mfma_f32_16x16x32_bf16 v[168:171], a[56:59], a[56:59], v[168:171]
    ds_read_b128 a[72:75], v9 offset:4096
    v_lshlrev_b32 v220, 16, v210
    v_mfma_f32_16x16x32_bf16 v[112:115], v[84:87], a[56:59], v[112:115]
    ds_read_b128 a[76:79], v9 offset:6144
    v_and_b32 v221, 0xffff0000, v210
    v_add_u32 v19, s48, v19
    v_mfma_f32_16x16x32_bf16 v[116:119], v[84:87], a[60:63], v[116:119]
    s_waitcnt lgkmcnt(6)
    ds_read_b64_tr_b16 v[76:77], v10 offset:36864
    v_lshlrev_b32 v222, 16, v211
    v_mfma_f32_16x16x32_bf16 v[120:123], v[88:91], a[56:59], v[120:123]
    ds_read_b64_tr_b16 v[78:79], v10 offset:37376
    v_and_b32 v223, 0xffff0000, v211
    v_mfma_f32_16x16x32_bf16 v[124:127], v[88:91], a[60:63], v[124:127]
    ds_read_b64_tr_b16 v[80:81], v11 offset:36864
    v_lshlrev_b32 v224, 16, v212
    v_mfma_f32_16x16x32_bf16 v[164:167], v[32:35], a[60:63], v[164:167]
    ds_read_b64_tr_b16 v[82:83], v11 offset:37376
    v_xor_b32 v24, 0, v19
    v_mfma_f32_16x16x32_bf16 v[172:175], a[60:63], a[60:63], v[172:175]
    ds_read_b64_tr_b16 v[84:85], v12 offset:36864
    v_and_b32 v225, 0xffff0000, v212
    v_mfma_f32_16x16x32_bf16 v[96:99], v[60:63], a[64:67], v[96:99]
    ds_read_b64_tr_b16 v[86:87], v12 offset:37376
    v_lshlrev_b32 v226, 16, v213
    v_mfma_f32_16x16x32_bf16 v[100:103], v[60:63], a[68:71], v[100:103]
    ds_read_b64_tr_b16 v[88:89], v13 offset:36864
    v_and_b32 v227, 0xffff0000, v213
    v_mfma_f32_16x16x32_bf16 v[44:47], v[60:63], v[32:35], v[44:47]
    s_waitcnt vmcnt(12) lgkmcnt(5)
    s_barrier
    ds_read_b64_tr_b16 v[90:91], v13 offset:37376
    v_mfma_f32_16x16x32_bf16 v[104:107], v[64:67], a[64:67], v[104:107]
    buffer_load_dwordx4 v2, s[8:11], s30 offen offset:0 lds
    v_lshlrev_b32 v228, 16, v214
    v_mfma_f32_16x16x32_bf16 v[108:111], v[64:67], a[68:71], v[108:111]
    buffer_load_dwordx4 v3, s[8:11], s30 offen offset:1024 lds
    v_add_u32 v10, 4294901760, v10
    v_and_b32 v229, 0xffff0000, v214
    v_mfma_f32_16x16x32_bf16 v[160:163], v[32:35], a[64:67], v[160:163]
    buffer_load_dwordx4 v4, s[8:11], s30 offen offset:2048 lds
    v_lshlrev_b32 v230, 16, v215
    v_mfma_f32_16x16x32_bf16 v[168:171], a[64:67], a[64:67], v[168:171]
    buffer_load_dwordx4 v5, s[8:11], s30 offen offset:3072 lds
    v_and_b32 v231, 0xffff0000, v215
    v_mfma_f32_16x16x32_bf16 v[112:115], v[68:71], a[64:67], v[112:115]
    s_add_u32 s30, s30, 128
    s_and_b32 s30, s30, 2047
    s_add_u32 m0, s34, 24576
    ds_read_b64_tr_b16 v[176:177], v24
    v_add_f32 v216, v216, v224
    v_xor_b32 v25, 1024, v19
    v_mfma_f32_16x16x32_bf16 v[116:119], v[68:71], a[68:71], v[116:119]
    s_add_u32 s32, s31, 1024
    s_and_b32 s32, s32, 2047
    s_mul_i32 s32, s32, 3072
    v_mfma_f32_16x16x32_bf16 v[120:123], v[72:75], a[64:67], v[120:123]
    s_add_u32 s32, s32, 2048
    ds_read_b64_tr_b16 v[60:61], v10 offset:0
    ds_read_b64_tr_b16 v[62:63], v10 offset:512
    v_add_u32 v11, 4294901760, v11
    v_add_f32 v217, v217, v225
    v_mfma_f32_16x16x32_bf16 v[124:127], v[72:75], a[68:71], v[124:127]
    buffer_load_dwordx4 v6, s[12:15], s32 offen offset:0 lds
    v_add_f32 v218, v218, v226
    v_mfma_f32_16x16x32_bf16 v[164:167], v[32:35], a[68:71], v[164:167]
    ds_read_b64_tr_b16 v[64:65], v11 offset:0
    v_add_f32 v219, v219, v227
    v_mfma_f32_16x16x32_bf16 v[172:175], a[68:71], a[68:71], v[172:175]
    s_waitcnt vmcnt(15)
    ds_read_b128 a[80:83], v8 offset:8192
    v_add_f32 v220, v220, v228
    v_mfma_f32_16x16x32_bf16 v[96:99], v[76:79], a[72:75], v[96:99]
    s_waitcnt vmcnt(13)
    ds_read_b128 a[84:87], v8 offset:10240
    ds_read_b64_tr_b16 v[66:67], v11 offset:512
    v_add_u32 v12, 4294901760, v12
    v_add_f32 v221, v221, v229
    v_mfma_f32_16x16x32_bf16 v[100:103], v[76:79], a[76:79], v[100:103]
    buffer_load_dwordx4 v7, s[12:15], s32 offen offset:1024 lds
    v_mfma_f32_16x16x32_bf16 v[44:47], v[76:79], v[32:35], v[44:47]
    s_waitcnt lgkmcnt(4)
    s_add_u32 m0, s33, 8192
    ds_read_b64_tr_b16 v[68:69], v12 offset:0
    v_add_f32 v222, v222, v230
    v_mfma_f32_16x16x32_bf16 v[104:107], v[80:83], a[72:75], v[104:107]
    ds_read_b64_tr_b16 v[70:71], v12 offset:512
    ds_read_b64_tr_b16 v[178:179], v25
    v_add_u32 v13, 4294901760, v13
    v_xor_b32 v24, 32, v19
    v_mfma_f32_16x16x32_bf16 v[108:111], v[80:83], a[76:79], v[108:111]
    ds_read_b64_tr_b16 v[72:73], v13 offset:0
    v_add_f32 v223, v223, v231
    v_add_f32 v216, v216, v220
    v_mfma_f32_16x16x32_bf16 v[160:163], v[32:35], a[72:75], v[160:163]
    ds_read_b64_tr_b16 v[74:75], v13 offset:512
    v_add_f32 v217, v217, v221
    v_mfma_f32_16x16x32_bf16 v[168:171], a[72:75], a[72:75], v[168:171]
    ds_read_b128 a[88:91], v9 offset:8192
    v_add_f32 v218, v218, v222
    v_mfma_f32_16x16x32_bf16 v[112:115], v[84:87], a[72:75], v[112:115]
    ds_read_b128 a[92:95], v9 offset:10240
    v_add_f32 v219, v219, v223
    v_mfma_f32_16x16x32_bf16 v[116:119], v[84:87], a[76:79], v[116:119]
    ds_read_b64_tr_b16 v[76:77], v10 offset:4096
    v_add_f32 v216, v216, v218
    v_mfma_f32_16x16x32_bf16 v[120:123], v[88:91], a[72:75], v[120:123]
    ds_read_b64_tr_b16 v[78:79], v10 offset:4608
    v_add_f32 v217, v217, v219
    v_mfma_f32_16x16x32_bf16 v[124:127], v[88:91], a[76:79], v[124:127]
    ds_read_b64_tr_b16 v[180:181], v24
    v_xor_b32 v25, 1056, v19
    v_mfma_f32_16x16x32_bf16 v[164:167], v[32:35], a[76:79], v[164:167]
    ds_read_b64_tr_b16 v[80:81], v11 offset:4096
    v_add_f32 v216, v216, v217
    v_mfma_f32_16x16x32_bf16 v[172:175], a[76:79], a[76:79], v[172:175]
    s_waitcnt lgkmcnt(5)
    ds_read_b64_tr_b16 v[82:83], v11 offset:4608
    v_add_f32_dpp v216, v216, v216 quad_perm:[1,0,3,2] row_mask:0xf bank_mask:0xf
    v_mfma_f32_16x16x32_bf16 v[96:99], v[60:63], a[80:83], v[96:99]
    ds_read_b64_tr_b16 v[84:85], v12 offset:4096
    v_add_f32_dpp v216, v216, v216 quad_perm:[2,3,0,1] row_mask:0xf bank_mask:0xf
    v_mfma_f32_16x16x32_bf16 v[100:103], v[60:63], a[84:87], v[100:103]
    ds_read_b64_tr_b16 v[86:87], v12 offset:4608
    v_add_f32_dpp v216, v216, v216 row_half_mirror row_mask:0xf bank_mask:0xf
    v_mfma_f32_16x16x32_bf16 v[44:47], v[60:63], v[32:35], v[44:47]
    s_waitcnt vmcnt(12) lgkmcnt(5)
    s_barrier
    ds_read_b64_tr_b16 v[182:183], v25
    v_mfma_f32_16x16x32_bf16 v[104:107], v[64:67], a[80:83], v[104:107]
    buffer_load_dwordx4 v2, s[8:11], s30 offen offset:0 lds
    v_add_f32_dpp v216, v216, v216 row_mirror row_mask:0xf bank_mask:0xf
    v_mfma_f32_16x16x32_bf16 v[108:111], v[64:67], a[84:87], v[108:111]
    buffer_load_dwordx4 v3, s[8:11], s30 offen offset:1024 lds
    v_mov_b32 v217, v216
    v_mfma_f32_16x16x32_bf16 v[160:163], v[32:35], a[80:83], v[160:163]
    buffer_load_dwordx4 v4, s[8:11], s30 offen offset:2048 lds
    v_permlane16_swap_b32 v216, v217
    v_mfma_f32_16x16x32_bf16 v[168:171], a[80:83], a[80:83], v[168:171]
    buffer_load_dwordx4 v5, s[8:11], s30 offen offset:3072 lds
    ds_read_b64_tr_b16 v[88:89], v13 offset:4096
    v_xor_b32 v24, 2048, v19
    v_mfma_f32_16x16x32_bf16 v[112:115], v[68:71], a[80:83], v[112:115]
    s_add_u32 s30, s30, 128
    s_and_b32 s30, s30, 2047
    s_add_u32 m0, s34, 32768
    ds_read_b64_tr_b16 v[90:91], v13 offset:4608
    v_mfma_f32_16x16x32_bf16 v[116:119], v[68:71], a[84:87], v[116:119]
    s_add_u32 s32, s31, 1152
    s_and_b32 s32, s32, 2047
    s_mul_i32 s32, s32, 3072
    v_add_f32 v216, v216, v217
    v_mfma_f32_16x16x32_bf16 v[120:123], v[72:75], a[80:83], v[120:123]
    s_add_u32 s32, s32, 2048
    ds_read_b64_tr_b16 v[60:61], v10 offset:8192
    ds_read_b64_tr_b16 v[62:63], v10 offset:8704
    v_mov_b32 v217, v216
    v_mfma_f32_16x16x32_bf16 v[124:127], v[72:75], a[84:87], v[124:127]
    buffer_load_dwordx4 v6, s[12:15], s32 offen offset:0 lds
    v_permlane32_swap_b32 v216, v217
    v_mfma_f32_16x16x32_bf16 v[164:167], v[32:35], a[84:87], v[164:167]
    ds_read_b64_tr_b16 v[64:65], v11 offset:8192
    v_add_f32 v216, v216, v217
    v_mfma_f32_16x16x32_bf16 v[172:175], a[84:87], a[84:87], v[172:175]
    s_waitcnt vmcnt(15)
    ds_read_b128 a[96:99], v8 offset:0
    v_mul_f32 v216, 0x3a800000, v216
    v_mfma_f32_16x16x32_bf16 v[96:99], v[76:79], a[88:91], v[96:99]
    s_waitcnt vmcnt(13)
    ds_read_b128 a[100:103], v8 offset:2048
    ds_read_b64_tr_b16 v[66:67], v11 offset:8704
    v_mfma_f32_16x16x32_bf16 v[100:103], v[76:79], a[92:95], v[100:103]
    buffer_load_dwordx4 v7, s[12:15], s32 offen offset:1024 lds
    ds_read_b64_tr_b16 v[184:185], v24
    v_xor_b32 v25, 3072, v19
    v_mfma_f32_16x16x32_bf16 v[44:47], v[76:79], v[32:35], v[44:47]
    s_waitcnt lgkmcnt(5)
    s_add_u32 m0, s33, 0
    ds_read_b64_tr_b16 v[68:69], v12 offset:8192
    v_cvt_pk_bf16_f32 v43, v216, v216
    v_mfma_f32_16x16x32_bf16 v[104:107], v[80:83], a[88:91], v[104:107]
    s_mov_b32 s4, s20
    s_and_b32 s5, s21, 0xffff
    s_mov_b32 s6, 256
    ds_read_b64_tr_b16 v[70:71], v12 offset:8704
    v_mfma_f32_16x16x32_bf16 v[108:111], v[80:83], a[92:95], v[108:111]
    s_mov_b32 s7, 0x00020000
    s_lshl_b32 s74, s28, 8
    s_add_u32 s74, s74, s2
    v_mfma_f32_16x16x32_bf16 v[160:163], v[32:35], a[88:91], v[160:163]
    s_lshl_b32 s75, s2, 2
    ds_read_b64_tr_b16 v[72:73], v13 offset:8192
    v_mov_b32 v14, 1
    s_cmp_lt_u32 s74, 16
    s_cbranch_scc0 L_qkv_sg
    buffer_store_dword v14, off, s[4:7], s75 offset:128 sc1
L_qkv_sg:
    v_mfma_f32_16x16x32_bf16 v[168:171], a[88:91], a[88:91], v[168:171]
    ds_read_b64_tr_b16 v[74:75], v13 offset:8704
    v_mfma_f32_16x16x32_bf16 v[112:115], v[84:87], a[88:91], v[112:115]
    ds_read_b128 a[104:107], v9 offset:0
    v_mfma_f32_16x16x32_bf16 v[116:119], v[84:87], a[92:95], v[116:119]
    ds_read_b128 a[108:111], v9 offset:2048
    v_mfma_f32_16x16x32_bf16 v[120:123], v[88:91], a[88:91], v[120:123]
    ds_read_b64_tr_b16 v[76:77], v10 offset:12288
    ds_read_b64_tr_b16 v[78:79], v10 offset:12800
    v_mfma_f32_16x16x32_bf16 v[124:127], v[88:91], a[92:95], v[124:127]
    ds_read_b64_tr_b16 v[186:187], v25
    v_xor_b32 v24, 2080, v19
    v_mfma_f32_16x16x32_bf16 v[164:167], v[32:35], a[92:95], v[164:167]
    ds_read_b64_tr_b16 v[80:81], v11 offset:12288
    v_mfma_f32_16x16x32_bf16 v[172:175], a[92:95], a[92:95], v[172:175]
    s_waitcnt lgkmcnt(6)
    ds_read_b64_tr_b16 v[82:83], v11 offset:12800
    v_mfma_f32_16x16x32_bf16 v[96:99], v[60:63], a[96:99], v[96:99]
    ds_read_b64_tr_b16 v[84:85], v12 offset:12288
    v_mfma_f32_16x16x32_bf16 v[100:103], v[60:63], a[100:103], v[100:103]
    ds_read_b64_tr_b16 v[86:87], v12 offset:12800
    v_mfma_f32_16x16x32_bf16 v[44:47], v[60:63], v[32:35], v[44:47]
    s_waitcnt vmcnt(12) lgkmcnt(5)
    s_barrier
    ds_read_b64_tr_b16 v[188:189], v24
    v_mfma_f32_16x16x32_bf16 v[104:107], v[64:67], a[96:99], v[104:107]
    buffer_load_dwordx4 v2, s[8:11], s30 offen offset:0 lds
    v_mfma_f32_16x16x32_bf16 v[108:111], v[64:67], a[100:103], v[108:111]
    buffer_load_dwordx4 v3, s[8:11], s30 offen offset:1024 lds
    v_xor_b32 v25, 3104, v19
    v_mfma_f32_16x16x32_bf16 v[160:163], v[32:35], a[96:99], v[160:163]
    buffer_load_dwordx4 v4, s[8:11], s30 offen offset:2048 lds
    v_mfma_f32_16x16x32_bf16 v[168:171], a[96:99], a[96:99], v[168:171]
    buffer_load_dwordx4 v5, s[8:11], s30 offen offset:3072 lds
    ds_read_b64_tr_b16 v[88:89], v13 offset:12288
    v_mfma_f32_16x16x32_bf16 v[112:115], v[68:71], a[96:99], v[112:115]
    s_add_u32 s30, s30, 128
    s_and_b32 s30, s30, 2047
    s_add_u32 m0, s34, 40960
    ds_read_b64_tr_b16 v[90:91], v13 offset:12800
    v_mfma_f32_16x16x32_bf16 v[116:119], v[68:71], a[100:103], v[116:119]
    s_add_u32 s32, s31, 1280
    s_and_b32 s32, s32, 2047
    s_mul_i32 s32, s32, 3072
    v_mfma_f32_16x16x32_bf16 v[120:123], v[72:75], a[96:99], v[120:123]
    s_add_u32 s32, s32, 2048
    ds_read_b64_tr_b16 v[60:61], v10 offset:16384
    ds_read_b64_tr_b16 v[62:63], v10 offset:16896
    v_mfma_f32_16x16x32_bf16 v[124:127], v[72:75], a[100:103], v[124:127]
    buffer_load_dwordx4 v6, s[12:15], s32 offen offset:0 lds
    v_mfma_f32_16x16x32_bf16 v[164:167], v[32:35], a[100:103], v[164:167]
    ds_read_b64_tr_b16 v[190:191], v25
    s_lshr_b32 s64, s28, 1
    v_mfma_f32_16x16x32_bf16 v[172:175], a[100:103], a[100:103], v[172:175]
    s_waitcnt vmcnt(15)
    ds_read_b128 a[112:115], v8 offset:4096
    v_mfma_f32_16x16x32_bf16 v[96:99], v[76:79], a[104:107], v[96:99]
    s_waitcnt vmcnt(13)
    ds_read_b128 a[116:119], v8 offset:6144
    s_and_b32 s65, s28, 1
    ds_read_b64_tr_b16 v[64:65], v11 offset:16384
    v_mfma_f32_16x16x32_bf16 v[100:103], v[76:79], a[108:111], v[100:103]
    buffer_load_dwordx4 v7, s[12:15], s32 offen offset:1024 lds
    ds_read_b64_tr_b16 v[66:67], v11 offset:16896
    v_mfma_f32_16x16x32_bf16 v[44:47], v[76:79], v[32:35], v[44:47]
    s_waitcnt lgkmcnt(5)
    s_add_u32 m0, s33, 4096
    ds_read_b64_tr_b16 v[68:69], v12 offset:16384
    v_mfma_f32_16x16x32_bf16 v[104:107], v[80:83], a[104:107], v[104:107]
    ds_read_b64_tr_b16 v[70:71], v12 offset:16896
    v_and_b32 v18, 7, v0
    v_mfma_f32_16x16x32_bf16 v[108:111], v[80:83], a[108:111], v[108:111]
    ds_read_b64_tr_b16 v[72:73], v13 offset:16384
    v_mfma_f32_16x16x32_bf16 v[160:163], v[32:35], a[104:107], v[160:163]
    ds_read_b64_tr_b16 v[74:75], v13 offset:16896
    v_mfma_f32_16x16x32_bf16 v[168:171], a[104:107], a[104:107], v[168:171]
    ds_read_b128 a[120:123], v9 offset:4096
    v_xor_b32 v18, v18, v26
    v_mfma_f32_16x16x32_bf16 v[112:115], v[84:87], a[104:107], v[112:115]
    ds_read_b128 a[124:127], v9 offset:6144
    v_mfma_f32_16x16x32_bf16 v[116:119], v[84:87], a[108:111], v[116:119]
    ds_read_b64_tr_b16 v[76:77], v10 offset:20480
    v_mfma_f32_16x16x32_bf16 v[120:123], v[88:91], a[104:107], v[120:123]
    ds_read_b64_tr_b16 v[78:79], v10 offset:20992
    v_mfma_f32_16x16x32_bf16 v[124:127], v[88:91], a[108:111], v[124:127]
    ds_read_b64_tr_b16 v[80:81], v11 offset:20480
    v_lshlrev_b32 v18, 4, v18
    v_mfma_f32_16x16x32_bf16 v[164:167], v[32:35], a[108:111], v[164:167]
    ds_read_b64_tr_b16 v[82:83], v11 offset:20992
    v_mfma_f32_16x16x32_bf16 v[172:175], a[108:111], a[108:111], v[172:175]
    s_waitcnt lgkmcnt(5)
    ds_read_b64_tr_b16 v[84:85], v12 offset:20480
    v_mfma_f32_16x16x32_bf16 v[96:99], v[60:63], a[112:115], v[96:99]
    ds_read_b64_tr_b16 v[86:87], v12 offset:20992
    v_mfma_f32_16x16x32_bf16 v[100:103], v[60:63], a[116:119], v[100:103]
    ds_read_b64_tr_b16 v[88:89], v13 offset:20480
    v_lshl_add_u32 v18, v29, 7, v18
    v_mfma_f32_16x16x32_bf16 v[44:47], v[60:63], v[32:35], v[44:47]
    s_waitcnt vmcnt(12) lgkmcnt(5)
    s_barrier
    ds_read_b64_tr_b16 v[90:91], v13 offset:20992
    v_mfma_f32_16x16x32_bf16 v[104:107], v[64:67], a[112:115], v[104:107]
    buffer_load_dwordx4 v2, s[8:11], s30 offen offset:0 lds
    v_mfma_f32_16x16x32_bf16 v[108:111], v[64:67], a[116:119], v[108:111]
    buffer_load_dwordx4 v3, s[8:11], s30 offen offset:1024 lds
    v_mfma_f32_16x16x32_bf16 v[160:163], v[32:35], a[112:115], v[160:163]
    buffer_load_dwordx4 v4, s[8:11], s30 offen offset:2048 lds
    v_mfma_f32_16x16x32_bf16 v[168:171], a[112:115], a[112:115], v[168:171]
    buffer_load_dwordx4 v5, s[8:11], s30 offen offset:3072 lds
    v_mfma_f32_16x16x32_bf16 v[112:115], v[68:71], a[112:115], v[112:115]
    s_add_u32 s30, s30, 128
    s_and_b32 s30, s30, 2047
    s_add_u32 m0, s34, 49152
    v_mfma_f32_16x16x32_bf16 v[116:119], v[68:71], a[116:119], v[116:119]
    s_add_u32 s32, s31, 1408
    s_and_b32 s32, s32, 2047
    s_mul_i32 s32, s32, 3072
    v_mfma_f32_16x16x32_bf16 v[120:123], v[72:75], a[112:115], v[120:123]
    s_add_u32 s32, s32, 2048
    s_lshl_b32 s76, s28, 12
    ds_read_b64_tr_b16 v[60:61], v10 offset:24576
    v_add_u32 v18, s76, v18
    v_mfma_f32_16x16x32_bf16 v[124:127], v[72:75], a[116:119], v[124:127]
    buffer_load_dwordx4 v6, s[12:15], s32 offen offset:0 lds
    ds_read_b64_tr_b16 v[62:63], v10 offset:25088
    v_mfma_f32_16x16x32_bf16 v[164:167], v[32:35], a[116:119], v[164:167]
    s_lshl_b32 s76, s64, 14
    ds_read_b64_tr_b16 v[64:65], v11 offset:24576
    v_mfma_f32_16x16x32_bf16 v[172:175], a[116:119], a[116:119], v[172:175]
    s_waitcnt vmcnt(15)
    ds_read_b128 a[128:131], v8 offset:8192
    v_mfma_f32_16x16x32_bf16 v[96:99], v[76:79], a[120:123], v[96:99]
    s_waitcnt vmcnt(13)
    ds_read_b128 a[132:135], v8 offset:10240
    s_add_u32 s77, s76, 122880
    ds_read_b64_tr_b16 v[66:67], v11 offset:25088
    v_mfma_f32_16x16x32_bf16 v[100:103], v[76:79], a[124:127], v[100:103]
    buffer_load_dwordx4 v7, s[12:15], s32 offen offset:1024 lds
    v_mfma_f32_16x16x32_bf16 v[44:47], v[76:79], v[32:35], v[44:47]
    s_waitcnt lgkmcnt(5)
    s_add_u32 m0, s33, 8192
    ds_read_b64_tr_b16 v[68:69], v12 offset:24576
    v_mfma_f32_16x16x32_bf16 v[104:107], v[80:83], a[120:123], v[104:107]
    s_sub_u32 s76, 139264, s76
    ds_read_b64_tr_b16 v[70:71], v12 offset:25088
    v_mfma_f32_16x16x32_bf16 v[108:111], v[80:83], a[124:127], v[108:111]
    ds_read_b64_tr_b16 v[72:73], v13 offset:24576
    v_mfma_f32_16x16x32_bf16 v[160:163], v[32:35], a[120:123], v[160:163]
    ds_read_b64_tr_b16 v[74:75], v13 offset:25088
    v_add_u32 v19, s76, v18
    v_mfma_f32_16x16x32_bf16 v[168:171], a[120:123], a[120:123], v[168:171]
    ds_read_b128 a[136:139], v9 offset:8192
    v_mfma_f32_16x16x32_bf16 v[112:115], v[84:87], a[120:123], v[112:115]
    ds_read_b128 a[140:143], v9 offset:10240
    v_mfma_f32_16x16x32_bf16 v[116:119], v[84:87], a[124:127], v[116:119]
    ds_read_b64_tr_b16 v[76:77], v10 offset:28672
    v_mfma_f32_16x16x32_bf16 v[120:123], v[88:91], a[120:123], v[120:123]
    ds_read_b64_tr_b16 v[78:79], v10 offset:29184
    v_add_u32 v18, s77, v18
    v_mfma_f32_16x16x32_bf16 v[124:127], v[88:91], a[124:127], v[124:127]
    ds_read_b64_tr_b16 v[80:81], v11 offset:28672
    v_mfma_f32_16x16x32_bf16 v[164:167], v[32:35], a[124:127], v[164:167]
    ds_read_b64_tr_b16 v[82:83], v11 offset:29184
    v_mfma_f32_16x16x32_bf16 v[172:175], a[124:127], a[124:127], v[172:175]
    s_waitcnt lgkmcnt(5)
    ds_read_b64_tr_b16 v[84:85], v12 offset:28672
    v_mfma_f32_16x16x32_bf16 v[96:99], v[60:63], a[128:131], v[96:99]
    s_lshl_b32 s76, s65, 2
    ds_read_b64_tr_b16 v[86:87], v12 offset:29184
    v_mfma_f32_16x16x32_bf16 v[100:103], v[60:63], a[132:135], v[100:103]
    ds_read_b64_tr_b16 v[88:89], v13 offset:28672
    v_mfma_f32_16x16x32_bf16 v[44:47], v[60:63], v[32:35], v[44:47]
    s_waitcnt vmcnt(12) lgkmcnt(5)
    s_barrier
    ds_read_b64_tr_b16 v[90:91], v13 offset:29184
    v_mfma_f32_16x16x32_bf16 v[104:107], v[64:67], a[128:131], v[104:107]
    buffer_load_dwordx4 v2, s[8:11], s30 offen offset:0 lds
    v_mfma_f32_16x16x32_bf16 v[108:111], v[64:67], a[132:135], v[108:111]
    buffer_load_dwordx4 v3, s[8:11], s30 offen offset:1024 lds
    v_add_u32 v24, s76, v31
    v_mfma_f32_16x16x32_bf16 v[160:163], v[32:35], a[128:131], v[160:163]
    buffer_load_dwordx4 v4, s[8:11], s30 offen offset:2048 lds
    v_mfma_f32_16x16x32_bf16 v[168:171], a[128:131], a[128:131], v[168:171]
    buffer_load_dwordx4 v5, s[8:11], s30 offen offset:3072 lds
    v_mfma_f32_16x16x32_bf16 v[112:115], v[68:71], a[128:131], v[112:115]
    s_add_u32 s30, s30, 128
    s_and_b32 s30, s30, 2047
    s_add_u32 m0, s34, 57344
    v_mfma_f32_16x16x32_bf16 v[116:119], v[68:71], a[132:135], v[116:119]
    s_add_u32 s32, s31, 1536
    s_and_b32 s32, s32, 2047
    s_mul_i32 s32, s32, 3072
    v_and_b32 v25, 7, v17
    v_mfma_f32_16x16x32_bf16 v[120:123], v[72:75], a[128:131], v[120:123]
    s_add_u32 s32, s32, 2048
    ds_read_b64_tr_b16 v[60:61], v10 offset:32768
    ds_read_b64_tr_b16 v[62:63], v10 offset:33280
    v_mfma_f32_16x16x32_bf16 v[124:127], v[72:75], a[132:135], v[124:127]
    buffer_load_dwordx4 v6, s[12:15], s32 offen offset:0 lds
    v_mfma_f32_16x16x32_bf16 v[164:167], v[32:35], a[132:135], v[164:167]
    ds_read_b64_tr_b16 v[64:65], v11 offset:32768
    v_xor_b32 v24, v24, v25
    v_mfma_f32_16x16x32_bf16 v[172:175], a[132:135], a[132:135], v[172:175]
    s_waitcnt vmcnt(15)
    ds_read_b128 a[144:147], v8 offset:0
    v_mfma_f32_16x16x32_bf16 v[96:99], v[76:79], a[136:139], v[96:99]
    s_waitcnt vmcnt(13)
    ds_read_b128 a[148:151], v8 offset:2048
    ds_read_b64_tr_b16 v[66:67], v11 offset:33280
    v_mfma_f32_16x16x32_bf16 v[100:103], v[76:79], a[140:143], v[100:103]
    buffer_load_dwordx4 v7, s[12:15], s32 offen offset:1024 lds
    v_mfma_f32_16x16x32_bf16 v[44:47], v[76:79], v[32:35], v[44:47]
    s_waitcnt lgkmcnt(4)
    s_add_u32 m0, s33, 0
    ds_read_b64_tr_b16 v[68:69], v12 offset:32768
    v_mfma_f32_16x16x32_bf16 v[104:107], v[80:83], a[136:139], v[104:107]
    ds_read_b64_tr_b16 v[70:71], v12 offset:33280
    v_lshlrev_b32 v17, 7, v17
    v_mfma_f32_16x16x32_bf16 v[108:111], v[80:83], a[140:143], v[108:111]
    ds_read_b64_tr_b16 v[72:73], v13 offset:32768
    v_mfma_f32_16x16x32_bf16 v[160:163], v[32:35], a[136:139], v[160:163]
    ds_read_b64_tr_b16 v[74:75], v13 offset:33280
    v_lshl_add_u32 v17, v24, 4, v17
    v_mfma_f32_16x16x32_bf16 v[168:171], a[136:139], a[136:139], v[168:171]
    ds_read_b128 a[152:155], v9 offset:0
    v_mfma_f32_16x16x32_bf16 v[112:115], v[84:87], a[136:139], v[112:115]
    ds_read_b128 a[156:159], v9 offset:2048
    v_mfma_f32_16x16x32_bf16 v[116:119], v[84:87], a[140:143], v[116:119]
    ds_read_b64_tr_b16 v[76:77], v10 offset:36864
    v_mfma_f32_16x16x32_bf16 v[120:123], v[88:91], a[136:139], v[120:123]
    ds_read_b64_tr_b16 v[78:79], v10 offset:37376
    v_mfma_f32_16x16x32_bf16 v[124:127], v[88:91], a[140:143], v[124:127]
    ds_read_b64_tr_b16 v[80:81], v11 offset:36864
    v_add_u32 v17, s77, v17
    v_mfma_f32_16x16x32_bf16 v[164:167], v[32:35], a[140:143], v[164:167]
    ds_read_b64_tr_b16 v[82:83], v11 offset:37376
    v_mfma_f32_16x16x32_bf16 v[172:175], a[140:143], a[140:143], v[172:175]
    s_waitcnt lgkmcnt(5)
    ds_read_b64_tr_b16 v[84:85], v12 offset:36864
    v_mfma_f32_16x16x32_bf16 v[96:99], v[60:63], a[144:147], v[96:99]
    ds_read_b64_tr_b16 v[86:87], v12 offset:37376
    v_mfma_f32_16x16x32_bf16 v[100:103], v[60:63], a[148:151], v[100:103]
    s_lshl_b32 s76, s64, 11
    ds_read_b64_tr_b16 v[88:89], v13 offset:36864
    v_mfma_f32_16x16x32_bf16 v[44:47], v[60:63], v[32:35], v[44:47]
    s_waitcnt vmcnt(12) lgkmcnt(5)
    s_barrier
    ds_read_b64_tr_b16 v[90:91], v13 offset:37376
    v_mfma_f32_16x16x32_bf16 v[104:107], v[64:67], a[144:147], v[104:107]
    buffer_load_dwordx4 v2, s[8:11], s30 offen offset:0 lds
    v_mfma_f32_16x16x32_bf16 v[108:111], v[64:67], a[148:151], v[108:111]
    buffer_load_dwordx4 v3, s[8:11], s30 offen offset:1024 lds
    v_mfma_f32_16x16x32_bf16 v[160:163], v[32:35], a[144:147], v[160:163]
    buffer_load_dwordx4 v4, s[8:11], s30 offen offset:2048 lds
    v_mfma_f32_16x16x32_bf16 v[168:171], a[144:147], a[144:147], v[168:171]
    buffer_load_dwordx4 v5, s[8:11], s30 offen offset:3072 lds
    v_mfma_f32_16x16x32_bf16 v[112:115], v[68:71], a[144:147], v[112:115]
    s_add_u32 s30, s30, 128
    s_and_b32 s30, s30, 2047
    s_add_u32 m0, s34, 65536
    v_mfma_f32_16x16x32_bf16 v[116:119], v[68:71], a[148:151], v[116:119]
    s_add_u32 s32, s31, 1664
    s_and_b32 s32, s32, 2047
    s_mul_i32 s32, s32, 3072
    v_mfma_f32_16x16x32_bf16 v[120:123], v[72:75], a[144:147], v[120:123]
    s_add_u32 s32, s32, 2048
    s_add_u32 s76, s76, 106496
    ds_read_b64_tr_b16 v[60:61], v10 offset:40960
    v_add_u32 v20, s76, v1
    v_mfma_f32_16x16x32_bf16 v[124:127], v[72:75], a[148:151], v[124:127]
    buffer_load_dwordx4 v6, s[12:15], s32 offen offset:0 lds
    ds_read_b64_tr_b16 v[62:63], v10 offset:41472
    v_mfma_f32_16x16x32_bf16 v[164:167], v[32:35], a[148:151], v[164:167]
    s_mul_i32 s76, s28, 5120
    s_add_u32 s76, s76, 106496
    ds_read_b64_tr_b16 v[64:65], v11 offset:40960
    v_mfma_f32_16x16x32_bf16 v[172:175], a[148:151], a[148:151], v[172:175]
    s_waitcnt vmcnt(15)
    ds_read_b128 a[160:163], v8 offset:4096
    v_mfma_f32_16x16x32_bf16 v[96:99], v[76:79], a[152:155], v[96:99]
    s_waitcnt vmcnt(13)
    ds_read_b128 a[164:167], v8 offset:6144
    ds_read_b64_tr_b16 v[66:67], v11 offset:41472
    v_mfma_f32_16x16x32_bf16 v[100:103], v[76:79], a[156:159], v[100:103]
    buffer_load_dwordx4 v7, s[12:15], s32 offen offset:1024 lds
    v_mfma_f32_16x16x32_bf16 v[44:47], v[76:79], v[32:35], v[44:47]
    s_waitcnt lgkmcnt(5)
    s_add_u32 m0, s33, 4096
    ds_read_b64_tr_b16 v[68:69], v12 offset:40960
    v_add_u32 v21, s76, v1
    v_mfma_f32_16x16x32_bf16 v[104:107], v[80:83], a[152:155], v[104:107]
    ds_read_b64_tr_b16 v[70:71], v12 offset:41472
    v_mfma_f32_16x16x32_bf16 v[108:111], v[80:83], a[156:159], v[108:111]
    s_lshl_b32 s76, s28, 6
    ds_read_b64_tr_b16 v[72:73], v13 offset:40960
    v_mfma_f32_16x16x32_bf16 v[160:163], v[32:35], a[152:155], v[160:163]
    ds_read_b64_tr_b16 v[74:75], v13 offset:41472
    v_mfma_f32_16x16x32_bf16 v[168:171], a[152:155], a[152:155], v[168:171]
    s_add_u32 s76, s76, 159744
    ds_read_b128 a[168:171], v9 offset:4096
    v_mfma_f32_16x16x32_bf16 v[112:115], v[84:87], a[152:155], v[112:115]
    ds_read_b128 a[172:175], v9 offset:6144
    v_mfma_f32_16x16x32_bf16 v[116:119], v[84:87], a[156:159], v[116:119]
    ds_read_b64_tr_b16 v[76:77], v10 offset:45056
    v_lshl_add_u32 v22, v26, 4, s76
    v_mfma_f32_16x16x32_bf16 v[120:123], v[88:91], a[152:155], v[120:123]
    ds_read_b64_tr_b16 v[78:79], v10 offset:45568
    v_mfma_f32_16x16x32_bf16 v[124:127], v[88:91], a[156:159], v[124:127]
    ds_read_b64_tr_b16 v[80:81], v11 offset:45056
    v_mfma_f32_16x16x32_bf16 v[164:167], v[32:35], a[156:159], v[164:167]
    ds_read_b64_tr_b16 v[82:83], v11 offset:45568
    v_mfma_f32_16x16x32_bf16 v[172:175], a[156:159], a[156:159], v[172:175]
    s_waitcnt lgkmcnt(5)
    ds_read_b64_tr_b16 v[84:85], v12 offset:45056
    v_mfma_f32_16x16x32_bf16 v[96:99], v[60:63], a[160:163], v[96:99]
    ds_read_b64_tr_b16 v[86:87], v12 offset:45568
    v_lshl_add_u32 v23, v29, 2, s76
    v_mfma_f32_16x16x32_bf16 v[100:103], v[60:63], a[164:167], v[100:103]
    ds_read_b64_tr_b16 v[88:89], v13 offset:45056
    v_mfma_f32_16x16x32_bf16 v[44:47], v[60:63], v[32:35], v[44:47]
    s_waitcnt vmcnt(12) lgkmcnt(5)
    s_barrier
    ds_read_b64_tr_b16 v[90:91], v13 offset:45568
    v_mfma_f32_16x16x32_bf16 v[104:107], v[64:67], a[160:163], v[104:107]
    buffer_load_dwordx4 v2, s[8:11], s30 offen offset:0 lds
    v_mfma_f32_16x16x32_bf16 v[108:111], v[64:67], a[164:167], v[108:111]
    buffer_load_dwordx4 v3, s[8:11], s30 offen offset:1024 lds
    v_mfma_f32_16x16x32_bf16 v[160:163], v[32:35], a[160:163], v[160:163]
    buffer_load_dwordx4 v4, s[8:11], s30 offen offset:2048 lds
    v_mfma_f32_16x16x32_bf16 v[168:171], a[160:163], a[160:163], v[168:171]
    buffer_load_dwordx4 v5, s[8:11], s30 offen offset:3072 lds
    v_mfma_f32_16x16x32_bf16 v[112:115], v[68:71], a[160:163], v[112:115]
    s_add_u32 s30, s30, 128
    s_and_b32 s30, s30, 2047
    s_add_u32 m0, s34, 73728
    v_mfma_f32_16x16x32_bf16 v[116:119], v[68:71], a[164:167], v[116:119]
    s_add_u32 s32, s31, 1792
    s_and_b32 s32, s32, 2047
    s_mul_i32 s32, s32, 3072
    v_mfma_f32_16x16x32_bf16 v[120:123], v[72:75], a[160:163], v[120:123]
    s_add_u32 s32, s32, 2048
    s_lshl_b32 s76, s28, 8
    s_add_u32 s76, s76, 160512
    ds_read_b64_tr_b16 v[60:61], v10 offset:49152
    v_mfma_f32_16x16x32_bf16 v[124:127], v[72:75], a[164:167], v[124:127]
    buffer_load_dwordx4 v6, s[12:15], s32 offen offset:0 lds
    ds_read_b64_tr_b16 v[62:63], v10 offset:49664
    v_lshl_add_u32 v30, v29, 3, s76
    v_mfma_f32_16x16x32_bf16 v[164:167], v[32:35], a[164:167], v[164:167]
    ds_read_b64_tr_b16 v[64:65], v11 offset:49152
    v_mfma_f32_16x16x32_bf16 v[172:175], a[164:167], a[164:167], v[172:175]
    s_waitcnt vmcnt(15)
    ds_read_b128 a[176:179], v8 offset:8192
    v_lshl_add_u32 v28, v26, 5, s76
    v_mfma_f32_16x16x32_bf16 v[96:99], v[76:79], a[168:171], v[96:99]
    s_waitcnt vmcnt(13)
    ds_read_b128 a[180:183], v8 offset:10240
    ds_read_b64_tr_b16 v[66:67], v11 offset:49664
    v_mfma_f32_16x16x32_bf16 v[100:103], v[76:79], a[172:175], v[100:103]
    buffer_load_dwordx4 v7, s[12:15], s32 offen offset:1024 lds
    v_mfma_f32_16x16x32_bf16 v[44:47], v[76:79], v[32:35], v[44:47]
    s_waitcnt lgkmcnt(5)
    s_add_u32 m0, s33, 8192
    ds_read_b64_tr_b16 v[68:69], v12 offset:49152
    v_mfma_f32_16x16x32_bf16 v[104:107], v[80:83], a[168:171], v[104:107]
    s_lshl_b32 s50, s27, 2
    ds_read_b64_tr_b16 v[70:71], v12 offset:49664
    v_mfma_f32_16x16x32_bf16 v[108:111], v[80:83], a[172:175], v[108:111]
    ds_read_b64_tr_b16 v[72:73], v13 offset:49152
    v_mfma_f32_16x16x32_bf16 v[160:163], v[32:35], a[168:171], v[160:163]
    s_add_u32 s50, s50, s28
    ds_read_b64_tr_b16 v[74:75], v13 offset:49664
    v_mfma_f32_16x16x32_bf16 v[168:171], a[168:171], a[168:171], v[168:171]
    ds_read_b128 a[184:187], v9 offset:8192
    v_mfma_f32_16x16x32_bf16 v[112:115], v[84:87], a[168:171], v[112:115]
    s_lshl_b32 s51, s50, 11
    ds_read_b128 a[188:191], v9 offset:10240
    v_mfma_f32_16x16x32_bf16 v[116:119], v[84:87], a[172:175], v[116:119]
    ds_read_b64_tr_b16 v[76:77], v10 offset:53248
    v_mfma_f32_16x16x32_bf16 v[120:123], v[88:91], a[168:171], v[120:123]
    s_lshl_b32 s50, s50, 15
    ds_read_b64_tr_b16 v[78:79], v10 offset:53760
    v_mfma_f32_16x16x32_bf16 v[124:127], v[88:91], a[172:175], v[124:127]
    ds_read_b64_tr_b16 v[80:81], v11 offset:53248
    v_mfma_f32_16x16x32_bf16 v[164:167], v[32:35], a[172:175], v[164:167]
    s_add_u32 s50, s50, 6291456
    ds_read_b64_tr_b16 v[82:83], v11 offset:53760
    v_mfma_f32_16x16x32_bf16 v[172:175], a[172:175], a[172:175], v[172:175]
    s_waitcnt lgkmcnt(5)
    ds_read_b64_tr_b16 v[84:85], v12 offset:53248
    v_mfma_f32_16x16x32_bf16 v[96:99], v[60:63], a[176:179], v[96:99]
    s_add_u32 s51, s51, 8388608
    ds_read_b64_tr_b16 v[86:87], v12 offset:53760
    v_mfma_f32_16x16x32_bf16 v[100:103], v[60:63], a[180:183], v[100:103]
    ds_read_b64_tr_b16 v[88:89], v13 offset:53248
    v_mfma_f32_16x16x32_bf16 v[44:47], v[60:63], v[32:35], v[44:47]
    s_waitcnt vmcnt(12) lgkmcnt(5)
    s_barrier
    s_lshl_b32 s78, s26, 11
    v_mfma_f32_16x16x32_bf16 v[104:107], v[64:67], a[176:179], v[104:107]
    buffer_load_dwordx4 v2, s[8:11], s30 offen offset:0 lds
    v_mfma_f32_16x16x32_bf16 v[108:111], v[64:67], a[180:183], v[108:111]
    buffer_load_dwordx4 v3, s[8:11], s30 offen offset:1024 lds
    v_mfma_f32_16x16x32_bf16 v[160:163], v[32:35], a[176:179], v[160:163]
    buffer_load_dwordx4 v4, s[8:11], s30 offen offset:2048 lds
    v_mfma_f32_16x16x32_bf16 v[168:171], a[176:179], a[176:179], v[168:171]
    buffer_load_dwordx4 v5, s[8:11], s30 offen offset:3072 lds
    ds_read_b64_tr_b16 v[90:91], v13 offset:53760
    v_mfma_f32_16x16x32_bf16 v[112:115], v[68:71], a[176:179], v[112:115]
    s_add_u32 s30, s30, 128
    s_and_b32 s30, s30, 2047
    s_add_u32 m0, s34, 81920
    v_mfma_f32_16x16x32_bf16 v[116:119], v[68:71], a[180:183], v[116:119]
    s_add_u32 s32, s31, 1920
    s_and_b32 s32, s32, 2047
    s_mul_i32 s32, s32, 3072
    v_mfma_f32_16x16x32_bf16 v[120:123], v[72:75], a[176:179], v[120:123]
    s_add_u32 s32, s32, 2048
    s_add_u32 s78, s78, s50
    s_lshl_b32 s79, s26, 7
    ds_read_b64_tr_b16 v[60:61], v10 offset:57344
    v_mfma_f32_16x16x32_bf16 v[124:127], v[72:75], a[180:183], v[124:127]
    buffer_load_dwordx4 v6, s[12:15], s32 offen offset:0 lds
    ds_read_b64_tr_b16 v[62:63], v10 offset:57856
    v_mfma_f32_16x16x32_bf16 v[164:167], v[32:35], a[180:183], v[164:167]
    s_add_u32 s50, s50, s79
    s_add_u32 s79, s79, s51
    ds_read_b64_tr_b16 v[64:65], v11 offset:57344
    v_mfma_f32_16x16x32_bf16 v[172:175], a[180:183], a[180:183], v[172:175]
    s_waitcnt vmcnt(15)
    ds_read_b128 a[192:195], v8 offset:0
    v_mfma_f32_16x16x32_bf16 v[96:99], v[76:79], a[184:187], v[96:99]
    s_waitcnt vmcnt(13)
    ds_read_b128 a[196:199], v8 offset:2048
    ds_read_b64_tr_b16 v[66:67], v11 offset:57856
    v_mfma_f32_16x16x32_bf16 v[100:103], v[76:79], a[188:191], v[100:103]
    buffer_load_dwordx4 v7, s[12:15], s32 offen offset:1024 lds
    v_mfma_f32_16x16x32_bf16 v[44:47], v[76:79], v[32:35], v[44:47]
    s_waitcnt lgkmcnt(5)
    s_add_u32 m0, s33, 0
    ds_read_b64_tr_b16 v[68:69], v12 offset:57344
    v_bfe_u32 v37, v0, 2, 2
    v_mfma_f32_16x16x32_bf16 v[104:107], v[80:83], a[184:187], v[104:107]
    ds_read_b64_tr_b16 v[70:71], v12 offset:57856
    v_mfma_f32_16x16x32_bf16 v[108:111], v[80:83], a[188:191], v[108:111]
    ds_read_b64_tr_b16 v[72:73], v13 offset:57344
    v_cmp_eq_u32 s[52:53], v26, v37
    v_mfma_f32_16x16x32_bf16 v[160:163], v[32:35], a[184:187], v[160:163]
    ds_read_b64_tr_b16 v[74:75], v13 offset:57856
    v_mfma_f32_16x16x32_bf16 v[168:171], a[184:187], a[184:187], v[168:171]
    ds_read_b128 a[200:203], v9 offset:0
    v_mfma_f32_16x16x32_bf16 v[112:115], v[84:87], a[184:187], v[112:115]
    ds_read_b128 a[204:207], v9 offset:2048
    v_mfma_f32_16x16x32_bf16 v[116:119], v[84:87], a[188:191], v[116:119]
    ds_read_b64_tr_b16 v[76:77], v10 offset:61440
    v_and_b32 v36, 1, v0
    v_mfma_f32_16x16x32_bf16 v[120:123], v[88:91], a[184:187], v[120:123]
    ds_read_b64_tr_b16 v[78:79], v10 offset:61952
    v_mfma_f32_16x16x32_bf16 v[124:127], v[88:91], a[188:191], v[124:127]
    ds_read_b64_tr_b16 v[80:81], v11 offset:61440
    v_mfma_f32_16x16x32_bf16 v[164:167], v[32:35], a[188:191], v[164:167]
    ds_read_b64_tr_b16 v[82:83], v11 offset:61952
    v_mfma_f32_16x16x32_bf16 v[172:175], a[188:191], a[188:191], v[172:175]
    s_waitcnt lgkmcnt(5)
    ds_read_b64_tr_b16 v[84:85], v12 offset:61440
    v_lshlrev_b32 v36, 4, v36
    v_mfma_f32_16x16x32_bf16 v[96:99], v[60:63], a[192:195], v[96:99]
    ds_read_b64_tr_b16 v[86:87], v12 offset:61952
    v_mfma_f32_16x16x32_bf16 v[100:103], v[60:63], a[196:199], v[100:103]
    ds_read_b64_tr_b16 v[88:89], v13 offset:61440
    v_mfma_f32_16x16x32_bf16 v[44:47], v[60:63], v[32:35], v[44:47]
    s_waitcnt vmcnt(12) lgkmcnt(5)
    s_barrier
    ds_read_b64_tr_b16 v[90:91], v13 offset:61952
    v_mfma_f32_16x16x32_bf16 v[104:107], v[64:67], a[192:195], v[104:107]
    buffer_load_dwordx4 v2, s[8:11], s30 offen offset:0 lds
    v_mfma_f32_16x16x32_bf16 v[108:111], v[64:67], a[196:199], v[108:111]
    buffer_load_dwordx4 v3, s[8:11], s30 offen offset:1024 lds
    v_add_u32 v10, 65536, v10
    v_mfma_f32_16x16x32_bf16 v[160:163], v[32:35], a[192:195], v[160:163]
    buffer_load_dwordx4 v4, s[8:11], s30 offen offset:2048 lds
    v_mov_b32 v37, 0x3f80
    v_mfma_f32_16x16x32_bf16 v[168:171], a[192:195], a[192:195], v[168:171]
    buffer_load_dwordx4 v5, s[8:11], s30 offen offset:3072 lds
    v_mfma_f32_16x16x32_bf16 v[112:115], v[68:71], a[192:195], v[112:115]
    s_add_u32 s30, s30, 128
    s_and_b32 s30, s30, 2047
    s_add_u32 m0, s34, 90112
    v_mfma_f32_16x16x32_bf16 v[116:119], v[68:71], a[196:199], v[116:119]
    s_add_u32 s32, s31, 0
    s_and_b32 s32, s32, 2047
    s_mul_i32 s32, s32, 3072
    v_mfma_f32_16x16x32_bf16 v[120:123], v[72:75], a[192:195], v[120:123]
    s_add_u32 s32, s32, 4096
    ds_read_b64_tr_b16 v[60:61], v10 offset:0
    ds_read_b64_tr_b16 v[62:63], v10 offset:512
    v_add_u32 v11, 65536, v11
    v_lshlrev_b32 v36, v36, v37
    v_mfma_f32_16x16x32_bf16 v[124:127], v[72:75], a[196:199], v[124:127]
    buffer_load_dwordx4 v6, s[12:15], s32 offen offset:0 lds
    v_mfma_f32_16x16x32_bf16 v[164:167], v[32:35], a[196:199], v[164:167]
    ds_read_b64_tr_b16 v[64:65], v11 offset:0
    v_mfma_f32_16x16x32_bf16 v[172:175], a[196:199], a[196:199], v[172:175]
    s_waitcnt vmcnt(15)
    ds_read_b128 a[208:211], v8 offset:4096
    v_cndmask_b32 v36, 0, v36, s[52:53]
    v_mfma_f32_16x16x32_bf16 v[96:99], v[76:79], a[200:203], v[96:99]
    s_waitcnt vmcnt(13)
    ds_read_b128 a[212:215], v8 offset:6144
    ds_read_b64_tr_b16 v[66:67], v11 offset:512
    v_add_u32 v12, 65536, v12
    v_mfma_f32_16x16x32_bf16 v[100:103], v[76:79], a[204:207], v[100:103]
    buffer_load_dwordx4 v7, s[12:15], s32 offen offset:1024 lds
    v_mfma_f32_16x16x32_bf16 v[44:47], v[76:79], v[32:35], v[44:47]
    s_waitcnt lgkmcnt(4)
    s_add_u32 m0, s34, 98304
    s_add_u32 s32, s31, 128
    ds_read_b64_tr_b16 v[68:69], v12 offset:0
    v_mfma_f32_16x16x32_bf16 v[104:107], v[80:83], a[200:203], v[104:107]
    s_and_b32 s32, s32, 2047
    s_mul_i32 s32, s32, 3072
    s_add_u32 s32, s32, 4096
    ds_read_b64_tr_b16 v[70:71], v12 offset:512
    v_add_u32 v13, 65536, v13
    v_mfma_f32_16x16x32_bf16 v[108:111], v[80:83], a[204:207], v[108:111]
    ds_read_b64_tr_b16 v[72:73], v13 offset:0
    v_bfe_i32 v37, v0, 1, 1
    v_mfma_f32_16x16x32_bf16 v[160:163], v[32:35], a[200:203], v[160:163]
    buffer_load_dwordx4 v6, s[12:15], s32 offen offset:0 lds
    v_mfma_f32_16x16x32_bf16 v[168:171], a[200:203], a[200:203], v[168:171]
    ds_read_b64_tr_b16 v[74:75], v13 offset:512
    v_mfma_f32_16x16x32_bf16 v[112:115], v[84:87], a[200:203], v[112:115]
    ds_read_b128 a[216:219], v9 offset:4096
    v_and_b32 v39, v37, v36
    v_mfma_f32_16x16x32_bf16 v[116:119], v[84:87], a[204:207], v[116:119]
    buffer_load_dwordx4 v7, s[12:15], s32 offen offset:1024 lds
    ds_read_b128 a[220:223], v9 offset:6144
    v_mfma_f32_16x16x32_bf16 v[120:123], v[88:91], a[200:203], v[120:123]
    s_add_u32 m0, s34, 0
    s_add_u32 s32, s31, 256
    s_and_b32 s32, s32, 2047
    ds_read_b64_tr_b16 v[76:77], v10 offset:4096
    v_mfma_f32_16x16x32_bf16 v[124:127], v[88:91], a[204:207], v[124:127]
    s_mul_i32 s32, s32, 3072
    s_add_u32 s32, s32, 4096
    ds_read_b64_tr_b16 v[78:79], v10 offset:4608
    v_mfma_f32_16x16x32_bf16 v[164:167], v[32:35], a[204:207], v[164:167]
    ds_read_b64_tr_b16 v[80:81], v11 offset:4096
    v_xor_b32 v38, v39, v36
    v_mfma_f32_16x16x32_bf16 v[172:175], a[204:207], a[204:207], v[172:175]
    s_waitcnt lgkmcnt(5)
    ds_read_b64_tr_b16 v[82:83], v11 offset:4608
    v_mfma_f32_16x16x32_bf16 v[96:99], v[60:63], a[208:211], v[96:99]
    buffer_load_dwordx4 v6, s[12:15], s32 offen offset:0 lds
    v_mfma_f32_16x16x32_bf16 v[100:103], v[60:63], a[212:215], v[100:103]
    ds_read_b64_tr_b16 v[84:85], v12 offset:4096
    v_mfma_f32_16x16x32_bf16 v[44:47], v[60:63], v[32:35], v[44:47]
    s_waitcnt vmcnt(15) lgkmcnt(4)
    s_barrier
    ds_read_b64_tr_b16 v[86:87], v12 offset:4608
    v_mfma_f32_16x16x32_bf16 v[104:107], v[64:67], a[208:211], v[104:107]
    ds_read_b64_tr_b16 v[88:89], v13 offset:4096
    v_mov_b32 v36, 0
    v_mfma_f32_16x16x32_bf16 v[108:111], v[64:67], a[212:215], v[108:111]
    buffer_load_dwordx4 v7, s[12:15], s32 offen offset:1024 lds
    v_mfma_f32_16x16x32_bf16 v[160:163], v[32:35], a[208:211], v[160:163]
    s_add_u32 m0, s34, 8192
    s_add_u32 s32, s31, 384
    s_and_b32 s32, s32, 2047
    v_mfma_f32_16x16x32_bf16 v[168:171], a[208:211], a[208:211], v[168:171]
    s_mul_i32 s32, s32, 3072
    s_add_u32 s32, s32, 4096
    ds_read_b64_tr_b16 v[90:91], v13 offset:4608
    v_mfma_f32_16x16x32_bf16 v[112:115], v[68:71], a[208:211], v[112:115]
    ds_read_b64_tr_b16 v[60:61], v10 offset:8192
    v_mov_b32 v37, 0
    v_mfma_f32_16x16x32_bf16 v[116:119], v[68:71], a[212:215], v[116:119]
    buffer_load_dwordx4 v6, s[12:15], s32 offen offset:0 lds
    v_mfma_f32_16x16x32_bf16 v[120:123], v[72:75], a[208:211], v[120:123]
    ds_read_b64_tr_b16 v[62:63], v10 offset:8704
    v_mfma_f32_16x16x32_bf16 v[124:127], v[72:75], a[212:215], v[124:127]
    ds_read_b64_tr_b16 v[64:65], v11 offset:8192
    v_mov_b32 v40, 0
    v_mfma_f32_16x16x32_bf16 v[164:167], v[32:35], a[212:215], v[164:167]
    ds_read_b64_tr_b16 v[66:67], v11 offset:8704
    v_mfma_f32_16x16x32_bf16 v[172:175], a[212:215], a[212:215], v[172:175]
    s_waitcnt lgkmcnt(4)
    s_waitcnt vmcnt(15)
    ds_read_b128 a[224:227], v8 offset:8192
    v_mfma_f32_16x16x32_bf16 v[96:99], v[76:79], a[216:219], v[96:99]
    buffer_load_dwordx4 v7, s[12:15], s32 offen offset:1024 lds
    v_mfma_f32_16x16x32_bf16 v[100:103], v[76:79], a[220:223], v[100:103]
    s_add_u32 m0, s34, 16384
    s_add_u32 s32, s31, 512
    s_and_b32 s32, s32, 2047
    v_mfma_f32_16x16x32_bf16 v[44:47], v[76:79], v[32:35], v[44:47]
    s_mul_i32 s32, s32, 3072
    s_add_u32 s32, s32, 4096
    ds_read_b64_tr_b16 v[68:69], v12 offset:8192
    v_mfma_f32_16x16x32_bf16 v[104:107], v[80:83], a[216:219], v[104:107]
    s_waitcnt vmcnt(14)
    ds_read_b128 a[228:231], v8 offset:10240
    ds_read_b64_tr_b16 v[70:71], v12 offset:8704
    v_mov_b32 v41, 0
    v_mfma_f32_16x16x32_bf16 v[108:111], v[80:83], a[220:223], v[108:111]
    ds_read_b64_tr_b16 v[72:73], v13 offset:8192
    v_mfma_f32_16x16x32_bf16 v[160:163], v[32:35], a[216:219], v[160:163]
    ds_read_b64_tr_b16 v[74:75], v13 offset:8704
    v_mfma_f32_16x16x32_bf16 v[168:171], a[216:219], a[216:219], v[168:171]
    buffer_store_dwordx4 v[136:139], v1, s[36:39], s78 offen offset:0 sc1
    v_mfma_f32_16x16x32_bf16 v[112:115], v[84:87], a[216:219], v[112:115]
    ds_read_b128 a[232:235], v9 offset:8192
    v_mfma_f32_16x16x32_bf16 v[116:119], v[84:87], a[220:223], v[116:119]
    ds_read_b128 a[236:239], v9 offset:10240
    v_mfma_f32_16x16x32_bf16 v[120:123], v[88:91], a[216:219], v[120:123]
    ds_read_b64_tr_b16 v[76:77], v10 offset:12288
    ds_read_b64_tr_b16 v[78:79], v10 offset:12800
    v_mfma_f32_16x16x32_bf16 v[124:127], v[88:91], a[220:223], v[124:127]
    ds_read_b64_tr_b16 v[80:81], v11 offset:12288
    v_mfma_f32_16x16x32_bf16 v[164:167], v[32:35], a[220:223], v[164:167]
    ds_read_b64_tr_b16 v[82:83], v11 offset:12800
    v_mfma_f32_16x16x32_bf16 v[172:175], a[220:223], a[220:223], v[172:175]
    s_waitcnt lgkmcnt(6)
    ds_read_b64_tr_b16 v[84:85], v12 offset:12288
    v_mfma_f32_16x16x32_bf16 v[96:99], v[60:63], a[224:227], v[96:99]
    ds_read_b64_tr_b16 v[86:87], v12 offset:12800
    v_mfma_f32_16x16x32_bf16 v[100:103], v[60:63], a[228:231], v[100:103]
    buffer_store_dwordx4 v[136:139], v1, s[36:39], s78 offen offset:1024 sc1
    v_mfma_f32_16x16x32_bf16 v[44:47], v[60:63], v[32:35], v[44:47]
    s_waitcnt vmcnt(14) lgkmcnt(4)
    s_barrier
    ds_read_b64_tr_b16 v[88:89], v13 offset:12288
    v_mfma_f32_16x16x32_bf16 v[104:107], v[64:67], a[224:227], v[104:107]
    ds_read_b64_tr_b16 v[90:91], v13 offset:12800
    v_mfma_f32_16x16x32_bf16 v[108:111], v[64:67], a[228:231], v[108:111]
    ds_read_b64_tr_b16 v[60:61], v10 offset:16384
    v_mfma_f32_16x16x32_bf16 v[160:163], v[32:35], a[224:227], v[160:163]
    ds_read_b64_tr_b16 v[62:63], v10 offset:16896
    v_mfma_f32_16x16x32_bf16 v[168:171], a[224:227], a[224:227], v[168:171]
    v_mfma_f32_16x16x32_bf16 v[112:115], v[68:71], a[224:227], v[112:115]
    ds_read_b64_tr_b16 v[64:65], v11 offset:16384
    v_mfma_f32_16x16x32_bf16 v[116:119], v[68:71], a[228:231], v[116:119]
    ds_read_b64_tr_b16 v[66:67], v11 offset:16896
    v_mfma_f32_16x16x32_bf16 v[120:123], v[72:75], a[224:227], v[120:123]
    ds_read_b64_tr_b16 v[68:69], v12 offset:16384
    v_cmp_eq_u32 s[54:55], 1, v31
    v_mfma_f32_16x16x32_bf16 v[124:127], v[72:75], a[228:231], v[124:127]
    ds_read_b64_tr_b16 v[70:71], v12 offset:16896
    v_mfma_f32_16x16x32_bf16 v[164:167], v[32:35], a[228:231], v[164:167]
    v_mfma_f32_16x16x32_bf16 v[172:175], a[228:231], a[228:231], v[172:175]
    s_waitcnt vmcnt(12)
    ds_read_b128 a[240:243], v8 offset:0
    v_mfma_f32_16x16x32_bf16 v[96:99], v[76:79], a[232:235], v[96:99]
    s_waitcnt vmcnt(10)
    ds_read_b128 a[244:247], v8 offset:2048
    v_cmp_eq_u32 s[98:99], 2, v31
    v_mfma_f32_16x16x32_bf16 v[100:103], v[76:79], a[236:239], v[100:103]
    ds_read_b64_tr_b16 v[72:73], v13 offset:16384
    v_mfma_f32_16x16x32_bf16 v[44:47], v[76:79], v[32:35], v[44:47]
    s_waitcnt lgkmcnt(4)
    ds_read_b64_tr_b16 v[74:75], v13 offset:16896
    v_mfma_f32_16x16x32_bf16 v[104:107], v[80:83], a[232:235], v[104:107]
    ds_read_b128 a[248:251], v9 offset:0
    v_mfma_f32_16x16x32_bf16 v[108:111], v[80:83], a[236:239], v[108:111]
    ds_read_b128 a[252:255], v9 offset:2048
    v_cmp_eq_u32 s[100:101], 3, v31
    v_mfma_f32_16x16x32_bf16 v[160:163], v[32:35], a[232:235], v[160:163]
    ds_read_b64_tr_b16 v[76:77], v10 offset:20480
    v_mfma_f32_16x16x32_bf16 v[168:171], a[232:235], a[232:235], v[168:171]
    ds_read_b64_tr_b16 v[78:79], v10 offset:20992
    v_mfma_f32_16x16x32_bf16 v[112:115], v[84:87], a[232:235], v[112:115]
    ds_read_b64_tr_b16 v[80:81], v11 offset:20480
    v_mfma_f32_16x16x32_bf16 v[116:119], v[84:87], a[236:239], v[116:119]
    ds_read_b64_tr_b16 v[82:83], v11 offset:20992
    v_mfma_f32_16x16x32_bf16 v[120:123], v[88:91], a[232:235], v[120:123]
    ds_read_b64_tr_b16 v[84:85], v12 offset:20480
    v_mfma_f32_16x16x32_bf16 v[124:127], v[88:91], a[236:239], v[124:127]
    ds_read_b64_tr_b16 v[86:87], v12 offset:20992
    v_mfma_f32_16x16x32_bf16 v[164:167], v[32:35], a[236:239], v[164:167]
    v_mfma_f32_16x16x32_bf16 v[172:175], a[236:239], a[236:239], v[172:175]
    s_waitcnt lgkmcnt(4)
    v_mfma_f32_16x16x32_bf16 v[96:99], v[60:63], a[240:243], v[96:99]
    ds_read_b64_tr_b16 v[88:89], v13 offset:20480
    v_mfma_f32_16x16x32_bf16 v[100:103], v[60:63], a[244:247], v[100:103]
    ds_read_b64_tr_b16 v[90:91], v13 offset:20992
    v_mfma_f32_16x16x32_bf16 v[44:47], v[60:63], v[32:35], v[44:47]
    s_waitcnt vmcnt(6) lgkmcnt(3)
    s_barrier
    v_mfma_f32_16x16x32_bf16 v[104:107], v[64:67], a[240:243], v[104:107]
    ds_read_b64_tr_b16 v[60:61], v10 offset:24576
    v_mfma_f32_16x16x32_bf16 v[108:111], v[64:67], a[244:247], v[108:111]
    ds_read_b64_tr_b16 v[62:63], v10 offset:25088
    v_mfma_f32_16x16x32_bf16 v[160:163], v[32:35], a[240:243], v[160:163]
    v_mfma_f32_16x16x32_bf16 v[168:171], a[240:243], a[240:243], v[168:171]
    v_mfma_f32_16x16x32_bf16 v[112:115], v[68:71], a[240:243], v[112:115]
    ds_read_b64_tr_b16 v[64:65], v11 offset:24576
    v_mfma_f32_16x16x32_bf16 v[116:119], v[68:71], a[244:247], v[116:119]
    ds_read_b64_tr_b16 v[66:67], v11 offset:25088
    v_mfma_f32_16x16x32_bf16 v[120:123], v[72:75], a[240:243], v[120:123]
    ds_read_b64_tr_b16 v[68:69], v12 offset:24576
    v_mfma_f32_16x16x32_bf16 v[124:127], v[72:75], a[244:247], v[124:127]
    ds_read_b64_tr_b16 v[70:71], v12 offset:25088
    v_mfma_f32_16x16x32_bf16 v[164:167], v[32:35], a[244:247], v[164:167]
    v_mfma_f32_16x16x32_bf16 v[172:175], a[244:247], a[244:247], v[172:175]
    v_mfma_f32_16x16x32_bf16 v[96:99], v[76:79], a[248:251], v[96:99]
    ds_read_b64_tr_b16 v[72:73], v13 offset:24576
    v_mfma_f32_16x16x32_bf16 v[100:103], v[76:79], a[252:255], v[100:103]
    ds_read_b64_tr_b16 v[74:75], v13 offset:25088
    v_mfma_f32_16x16x32_bf16 v[44:47], v[76:79], v[32:35], v[44:47]
    v_mfma_f32_16x16x32_bf16 v[104:107], v[80:83], a[248:251], v[104:107]
    ds_read_b64_tr_b16 v[76:77], v10 offset:28672
    v_mfma_f32_16x16x32_bf16 v[108:111], v[80:83], a[252:255], v[108:111]
    ds_read_b64_tr_b16 v[78:79], v10 offset:29184
    v_mfma_f32_16x16x32_bf16 v[160:163], v[32:35], a[248:251], v[160:163]
    v_mfma_f32_16x16x32_bf16 v[168:171], a[248:251], a[248:251], v[168:171]
    s_waitcnt lgkmcnt(3)
    v_mfma_f32_16x16x32_bf16 v[112:115], v[84:87], a[248:251], v[112:115]
    buffer_load_dwordx4 v6, s[12:15], s32 offen offset:0 lds
    v_mfma_f32_16x16x32_bf16 v[116:119], v[84:87], a[252:255], v[116:119]
    ds_read_b64_tr_b16 v[80:81], v11 offset:28672
    v_mfma_f32_16x16x32_bf16 v[120:123], v[88:91], a[248:251], v[120:123]
    ds_read_b64_tr_b16 v[82:83], v11 offset:29184
    v_mfma_f32_16x16x32_bf16 v[124:127], v[88:91], a[252:255], v[124:127]
    buffer_load_dwordx4 v7, s[12:15], s32 offen offset:1024 lds
    v_mfma_f32_16x16x32_bf16 v[164:167], v[32:35], a[252:255], v[164:167]
    s_add_u32 m0, s34, 24576
    s_add_u32 s32, s31, 640
    s_and_b32 s32, s32, 2047
    v_mfma_f32_16x16x32_bf16 v[172:175], a[252:255], a[252:255], v[172:175]
    s_mul_i32 s32, s32, 3072
    s_add_u32 s32, s32, 4096
    ds_read_b64_tr_b16 v[84:85], v12 offset:28672
    v_mfma_f32_16x16x32_bf16 v[128:131], a[0:3], v[60:63], 0
    buffer_load_dwordx4 v6, s[12:15], s32 offen offset:0 lds
    v_mfma_f32_16x16x32_bf16 v[132:135], a[4:7], v[60:63], 0
    buffer_load_dwordx4 v7, s[12:15], s32 offen offset:1024 lds
    v_mfma_f32_16x16x32_bf16 v[48:51], v[60:63], v[32:35], 0
    s_add_u32 m0, s34, 32768
    s_add_u32 s32, s31, 768
    s_and_b32 s32, s32, 2047
    ds_read_b64_tr_b16 v[86:87], v12 offset:29184
    v_mfma_f32_16x16x32_bf16 v[136:139], a[0:3], v[64:67], 0
    s_mul_i32 s32, s32, 3072
    s_add_u32 s32, s32, 4096
    ds_read_b64_tr_b16 v[88:89], v13 offset:28672
    v_mfma_f32_16x16x32_bf16 v[140:143], a[4:7], v[64:67], 0
    ds_read_b64_tr_b16 v[90:91], v13 offset:29184
    v_mfma_f32_16x16x32_bf16 v[144:147], a[0:3], v[68:71], 0
    buffer_load_dwordx4 v6, s[12:15], s32 offen offset:0 lds
    v_mfma_f32_16x16x32_bf16 v[148:151], a[4:7], v[68:71], 0
    s_waitcnt lgkmcnt(3)
    ds_read_b64_tr_b16 v[60:61], v10 offset:32768
    v_mfma_f32_16x16x32_bf16 v[152:155], a[0:3], v[72:75], 0
    s_mov_b32 exec_lo, 0x10001
    s_mov_b32 exec_hi, 0x10001
    ds_write_b128 v22, v[44:47] offset:0
    s_mov_b64 exec, -1
    v_mfma_f32_16x16x32_bf16 v[156:159], a[4:7], v[72:75], 0
    ds_read_b64_tr_b16 v[62:63], v10 offset:33280
    v_cndmask_b32 v168, v168, v169, s[54:55]
    v_mfma_f32_16x16x32_bf16 v[128:131], a[8:11], v[76:79], v[128:131]
    buffer_load_dwordx4 v7, s[12:15], s32 offen offset:1024 lds
    v_cndmask_b32 v168, v168, v170, s[98:99]
    v_cndmask_b32 v168, v168, v171, s[100:101]
    v_cndmask_b32 v168, 0, v168, s[52:53]
    v_mfma_f32_16x16x32_bf16 v[132:135], a[12:15], v[76:79], v[132:135]
    s_add_u32 m0, s34, 40960
    s_add_u32 s32, s31, 896
    s_and_b32 s32, s32, 2047
    v_cndmask_b32 v172, v172, v173, s[54:55]
    v_cndmask_b32 v172, v172, v174, s[98:99]
    v_mfma_f32_16x16x32_bf16 v[48:51], v[76:79], v[32:35], v[48:51]
    s_mul_i32 s32, s32, 3072
    s_add_u32 s32, s32, 4096
    ds_read_b64_tr_b16 v[64:65], v11 offset:32768
    v_cndmask_b32 v172, v172, v175, s[100:101]
    v_cndmask_b32 v172, 0, v172, s[52:53]
    v_mfma_f32_16x16x32_bf16 v[136:139], a[8:11], v[80:83], v[136:139]
    buffer_load_dwordx4 v6, s[12:15], s32 offen offset:0 lds
    ds_read_b64_tr_b16 v[66:67], v11 offset:33280
    v_mov_b32 v169, v168
    v_mov_b32 v173, v172
    v_mfma_f32_16x16x32_bf16 v[140:143], a[12:15], v[80:83], v[140:143]
    s_waitcnt lgkmcnt(3)
    ds_read_b64_tr_b16 v[68:69], v12 offset:32768
    ds_read_b64_tr_b16 v[70:71], v12 offset:33280
    v_permlane16_swap_b32 v168, v169
    v_mfma_f32_16x16x32_bf16 v[144:147], a[8:11], v[84:87], v[144:147]
    ds_read_b64_tr_b16 v[72:73], v13 offset:32768
    v_permlane16_swap_b32 v172, v173
    v_mfma_f32_16x16x32_bf16 v[148:151], a[12:15], v[84:87], v[148:151]
    buffer_load_dwordx4 v7, s[12:15], s32 offen offset:1024 lds
    ds_read_b64_tr_b16 v[74:75], v13 offset:33280
    v_add_f32 v168, v168, v169
    v_add_f32 v172, v172, v173
    v_mfma_f32_16x16x32_bf16 v[152:155], a[8:11], v[88:91], v[152:155]
    s_add_u32 m0, s34, 49152
    s_add_u32 s32, s31, 1024
    s_and_b32 s32, s32, 2047
    v_mov_b32 v169, v168
    v_mov_b32 v173, v172
    v_mfma_f32_16x16x32_bf16 v[156:159], a[12:15], v[88:91], v[156:159]
    s_waitcnt lgkmcnt(5)
    s_mul_i32 s32, s32, 3072
    s_add_u32 s32, s32, 4096
    v_permlane32_swap_b32 v168, v169
    v_mfma_f32_16x16x32_bf16 v[128:131], a[16:19], v[60:63], v[128:131]
    buffer_load_dwordx4 v6, s[12:15], s32 offen offset:0 lds
    ds_read_b64_tr_b16 v[76:77], v10 offset:36864
    v_permlane32_swap_b32 v172, v173
    v_mfma_f32_16x16x32_bf16 v[132:135], a[20:23], v[60:63], v[132:135]
    ds_read_b64_tr_b16 v[78:79], v10 offset:37376
    v_add_f32 v168, v168, v169
    v_add_f32 v172, v172, v173
    v_mul_f32 v92, 0x3a800000, v160
    v_mfma_f32_16x16x32_bf16 v[48:51], v[60:63], v[32:35], v[48:51]
    s_waitcnt vmcnt(11) lgkmcnt(3)
    s_barrier
    ds_read_b64_tr_b16 v[80:81], v11 offset:36864
    v_mul_f32 v94, 0x3a800000, v164
    v_mul_f32 v168, 0x3a800000, v168
    v_mfma_f32_16x16x32_bf16 v[136:139], a[16:19], v[64:67], v[136:139]
    buffer_load_dwordx4 v7, s[12:15], s32 offen offset:1024 lds
    ds_read_b64_tr_b16 v[82:83], v11 offset:37376
    v_mul_f32 v172, 0x3a800000, v172
    v_fma_f32 v168, -v92, v92, v168
    v_mfma_f32_16x16x32_bf16 v[140:143], a[20:23], v[64:67], v[140:143]
    s_add_u32 m0, s34, 57344
    s_add_u32 s32, s31, 1152
    s_and_b32 s32, s32, 2047
    ds_read_b64_tr_b16 v[84:85], v12 offset:36864
    v_fma_f32 v172, -v94, v94, v172
    v_max_f32 v168, 0, v168
    v_mfma_f32_16x16x32_bf16 v[144:147], a[16:19], v[68:71], v[144:147]
    s_mul_i32 s32, s32, 3072
    s_add_u32 s32, s32, 4096
    ds_read_b64_tr_b16 v[86:87], v12 offset:37376
    v_max_f32 v172, 0, v172
    v_add_f32 v168, 0x3727c5ac, v168
    v_add_f32 v172, 0x3727c5ac, v172
    v_mfma_f32_16x16x32_bf16 v[148:151], a[20:23], v[68:71], v[148:151]
    s_waitcnt lgkmcnt(5)
    ds_read_b64_tr_b16 v[88:89], v13 offset:36864
    ds_read_b64_tr_b16 v[90:91], v13 offset:37376
    v_add_u32 v10, 4294901760, v10
    v_mfma_f32_16x16x32_bf16 v[152:155], a[16:19], v[72:75], v[152:155]
    buffer_load_dwordx4 v6, s[12:15], s32 offen offset:0 lds
    v_rsq_f32 v93, v168
    v_mfma_f32_16x16x32_bf16 v[156:159], a[20:23], v[72:75], v[156:159]
    s_waitcnt lgkmcnt(5)
    ds_read_b64_tr_b16 v[60:61], v10 offset:0
    v_rsq_f32 v95, v172
    v_lshlrev_b32 v15, 2, v29
    v_mfma_f32_16x16x32_bf16 v[128:131], a[24:27], v[76:79], v[128:131]
    buffer_load_dword v14, v15, s[4:7], 0 offen offset:128 sc1
    ds_read_b64_tr_b16 v[62:63], v10 offset:512
    v_add_u32 v11, 4294901760, v11
    v_mfma_f32_16x16x32_bf16 v[132:135], a[28:31], v[76:79], v[132:135]
    s_waitcnt lgkmcnt(5)
    s_barrier
    ds_read_b64_tr_b16 v[64:65], v11 offset:0
    v_xor_b32 v8, 0, v22
    v_mfma_f32_16x16x32_bf16 v[48:51], v[76:79], v[32:35], v[48:51]
    ds_read_b64_tr_b16 v[66:67], v11 offset:512
    v_add_u32 v12, 4294901760, v12
    v_mfma_f32_16x16x32_bf16 v[136:139], a[24:27], v[80:83], v[136:139]
    ds_read_b64_tr_b16 v[68:69], v12 offset:0
    v_mfma_f32_16x16x32_bf16 v[140:143], a[28:31], v[80:83], v[140:143]
    s_waitcnt lgkmcnt(5)
    ds_read_b64_tr_b16 v[70:71], v12 offset:512
    ds_read_b128 v[192:195], v8 offset:0
    v_xor_b32 v9, 64, v22
    v_add_u32 v13, 4294901760, v13
    v_mfma_f32_16x16x32_bf16 v[144:147], a[24:27], v[84:87], v[144:147]
    buffer_load_dwordx4 v7, s[12:15], s32 offen offset:1024 lds
    ds_read_b128 v[196:199], v9 offset:0
    v_xor_b32 v8, 128, v22
    v_mfma_f32_16x16x32_bf16 v[148:151], a[28:31], v[84:87], v[148:151]
    s_add_u32 m0, s34, 65536
    s_add_u32 s32, s31, 1280
    s_and_b32 s32, s32, 2047
    ds_read_b128 v[200:203], v8 offset:0
    v_xor_b32 v9, 192, v22
    v_mfma_f32_16x16x32_bf16 v[152:155], a[24:27], v[88:91], v[152:155]
    s_mul_i32 s32, s32, 3072
    s_add_u32 s32, s32, 4096
    ds_read_b64_tr_b16 v[72:73], v13 offset:0
    v_mfma_f32_16x16x32_bf16 v[156:159], a[28:31], v[88:91], v[156:159]
    s_waitcnt lgkmcnt(6)
    ds_read_b64_tr_b16 v[74:75], v13 offset:512
    ds_read_b128 v[204:207], v9 offset:0
    v_mfma_f32_16x16x32_bf16 v[128:131], a[32:35], v[60:63], v[128:131]
    buffer_load_dwordx4 v6, s[12:15], s32 offen offset:0 lds
    ds_read_b64_tr_b16 v[76:77], v10 offset:4096
    v_mfma_f32_16x16x32_bf16 v[132:135], a[36:39], v[60:63], v[132:135]
    s_mov_b64 exec, 0xffff
    ds_write_b64 v30, v[92:93] offset:0
    s_mov_b64 exec, -1
    v_mfma_f32_16x16x32_bf16 v[48:51], v[60:63], v[32:35], v[48:51]
    s_mov_b64 exec, 0xffff
    ds_write_b64 v30, v[94:95] offset:128
    s_mov_b64 exec, -1
    v_mul_f32 v93, 0x3fb8aa3b, v93
    v_mfma_f32_16x16x32_bf16 v[136:139], a[32:35], v[64:67], v[136:139]
    buffer_load_dwordx4 v7, s[12:15], s32 offen offset:1024 lds
    ds_read_b64_tr_b16 v[78:79], v10 offset:4608
    v_mul_f32 v95, 0x3fb8aa3b, v95
    v_mfma_f32_16x16x32_bf16 v[140:143], a[36:39], v[64:67], v[140:143]
    s_waitcnt lgkmcnt(6)
    s_add_u32 m0, s34, 73728
    s_add_u32 s32, s31, 1408
    ds_read_b64_tr_b16 v[80:81], v11 offset:4096
    v_mfma_f32_16x16x32_bf16 v[144:147], a[32:35], v[68:71], v[144:147]
    s_and_b32 s32, s32, 2047
    s_mul_i32 s32, s32, 3072
    s_add_u32 s32, s32, 4096
    ds_read_b64_tr_b16 v[82:83], v11 offset:4608
    v_mfma_f32_16x16x32_bf16 v[148:151], a[36:39], v[68:71], v[148:151]
    s_waitcnt lgkmcnt(5)
    v_fma_f32 v96, -v92, v192, v96
    v_fma_f32 v97, -v92, v193, v97
    v_fma_f32 v98, -v92, v194, v98
    v_fma_f32 v99, -v92, v195, v99
    v_cvt_pk_bf16_f32 v160, v96, v97
    v_mfma_f32_16x16x32_bf16 v[152:155], a[32:35], v[72:75], v[152:155]
    buffer_load_dwordx4 v6, s[12:15], s32 offen offset:0 lds
    ds_read_b64_tr_b16 v[84:85], v12 offset:4096
    v_cvt_pk_bf16_f32 v161, v98, v99
    v_mfma_f32_16x16x32_bf16 v[156:159], a[36:39], v[72:75], v[156:159]
    s_waitcnt lgkmcnt(3)
    v_fma_f32 v104, -v92, v196, v104
    v_fma_f32 v105, -v92, v197, v105
    v_fma_f32 v106, -v92, v198, v106
    v_fma_f32 v107, -v92, v199, v107
    v_cvt_pk_bf16_f32 v162, v104, v105
    v_mfma_f32_16x16x32_bf16 v[128:131], a[40:43], v[76:79], v[128:131]
    ds_read_b64_tr_b16 v[86:87], v12 offset:4608
    ds_read_b64_tr_b16 v[88:89], v13 offset:4096
    v_cvt_pk_bf16_f32 v163, v106, v107
    v_mfma_f32_16x16x32_bf16 v[132:135], a[44:47], v[76:79], v[132:135]
    buffer_load_dwordx4 v7, s[12:15], s32 offen offset:1024 lds
    ds_read_b64_tr_b16 v[90:91], v13 offset:4608
    v_mfma_f32_16x16x32_bf16 v[48:51], v[76:79], v[32:35], v[48:51]
    s_waitcnt lgkmcnt(4)
    s_add_u32 m0, s34, 81920
    s_add_u32 s32, s31, 1536
    ds_read_b64_tr_b16 v[60:61], v10 offset:8192
    v_mfma_f32_16x16x32_bf16 v[136:139], a[40:43], v[80:83], v[136:139]
    s_and_b32 s32, s32, 2047
    s_mul_i32 s32, s32, 3072
    s_add_u32 s32, s32, 4096
    ds_read_b64_tr_b16 v[62:63], v10 offset:8704
    v_mfma_f32_16x16x32_bf16 v[140:143], a[44:47], v[80:83], v[140:143]
    s_waitcnt lgkmcnt(4)
    v_fma_f32 v112, -v92, v200, v112
    v_fma_f32 v113, -v92, v201, v113
    v_fma_f32 v114, -v92, v202, v114
    v_fma_f32 v115, -v92, v203, v115
    v_cvt_pk_bf16_f32 v168, v112, v113
    v_mfma_f32_16x16x32_bf16 v[144:147], a[40:43], v[84:87], v[144:147]
    buffer_load_dwordx4 v6, s[12:15], s32 offen offset:0 lds
    ds_read_b64_tr_b16 v[64:65], v11 offset:8192
    v_cvt_pk_bf16_f32 v169, v114, v115
    v_mfma_f32_16x16x32_bf16 v[148:151], a[44:47], v[84:87], v[148:151]
    s_waitcnt lgkmcnt(3)
    v_fma_f32 v120, -v92, v204, v120
    v_fma_f32 v121, -v92, v205, v121
    v_fma_f32 v122, -v92, v206, v122
    v_fma_f32 v123, -v92, v207, v123
    v_cvt_pk_bf16_f32 v170, v120, v121
    v_mfma_f32_16x16x32_bf16 v[152:155], a[40:43], v[88:91], v[152:155]
    ds_read_b64_tr_b16 v[66:67], v11 offset:8704
    ds_read_b64_tr_b16 v[68:69], v12 offset:8192
    v_cvt_pk_bf16_f32 v171, v122, v123
    v_mfma_f32_16x16x32_bf16 v[96:99], v[176:179], v[160:163], 0
    buffer_load_dwordx4 v7, s[12:15], s32 offen offset:1024 lds
    ds_read_b64_tr_b16 v[70:71], v12 offset:8704
    v_mfma_f32_16x16x32_bf16 v[104:107], v[180:183], v[160:163], 0
    s_add_u32 m0, s34, 90112
    s_add_u32 s32, s31, 1664
    s_and_b32 s32, s32, 2047
    ds_read_b64_tr_b16 v[72:73], v13 offset:8192
    v_mfma_f32_16x16x32_bf16 v[112:115], v[184:187], v[168:171], 0
    s_mul_i32 s32, s32, 3072
    s_add_u32 s32, s32, 4096
    ds_read_b64_tr_b16 v[74:75], v13 offset:8704
    v_mfma_f32_16x16x32_bf16 v[120:123], v[188:191], v[168:171], 0
    ds_read_b64_tr_b16 v[76:77], v10 offset:12288
    v_fma_f32 v100, -v94, v192, v100
    v_fma_f32 v101, -v94, v193, v101
    v_fma_f32 v102, -v94, v194, v102
    v_fma_f32 v103, -v94, v195, v103
    v_mfma_f32_16x16x32_bf16 v[156:159], a[44:47], v[88:91], v[156:159]
    s_waitcnt lgkmcnt(7)
    ds_read_b64_tr_b16 v[78:79], v10 offset:12800
    v_cvt_pk_bf16_f32 v164, v100, v101
    v_cvt_pk_bf16_f32 v165, v102, v103
    v_fma_f32 v108, -v94, v196, v108
    v_fma_f32 v109, -v94, v197, v109
    v_mfma_f32_16x16x32_bf16 v[128:131], a[48:51], v[60:63], v[128:131]
    buffer_load_dwordx4 v6, s[12:15], s32 offen offset:0 lds
    v_fma_f32 v110, -v94, v198, v110
    v_fma_f32 v111, -v94, v199, v111
    v_mfma_f32_16x16x32_bf16 v[132:135], a[52:55], v[60:63], v[132:135]
    s_cmp_ge_u32 s28, 2
    s_cselect_b32 s60, s62, s60
    s_cselect_b32 s61, s63, s61
    v_cvt_pk_bf16_f32 v166, v108, v109
    v_cvt_pk_bf16_f32 v167, v110, v111
    v_mfma_f32_16x16x32_bf16 v[48:51], v[60:63], v[32:35], v[48:51]
    s_waitcnt vmcnt(16) lgkmcnt(6)
    s_barrier
    ds_read_b64_tr_b16 v[80:81], v11 offset:12288
    v_fma_f32 v116, -v94, v200, v116
    v_fma_f32 v117, -v94, v201, v117
    v_mfma_f32_16x16x32_bf16 v[136:139], a[48:51], v[64:67], v[136:139]
    buffer_load_dwordx4 v7, s[12:15], s32 offen offset:1024 lds
    ds_read_b64_tr_b16 v[82:83], v11 offset:12800
    v_fma_f32 v118, -v94, v202, v118
    v_fma_f32 v119, -v94, v203, v119
    v_mfma_f32_16x16x32_bf16 v[140:143], a[52:55], v[64:67], v[140:143]
    s_waitcnt lgkmcnt(3)
    s_add_u32 m0, s34, 98304
    s_add_u32 s32, s31, 1792
    s_waitcnt vmcnt(9)
    v_cmp_ne_u32 vcc, 1, v14
    v_cvt_pk_bf16_f32 v172, v116, v117
    v_mfma_f32_16x16x32_bf16 v[144:147], a[48:51], v[68:71], v[144:147]
    s_and_b32 s32, s32, 2047
    s_mul_i32 s32, s32, 3072
    s_add_u32 s32, s32, 4096
    s_cbranch_vccnz L_qkv_slow0
L_qkv_back0:
    v_cvt_pk_bf16_f32 v173, v118, v119
    v_fma_f32 v124, -v94, v204, v124
    v_mfma_f32_16x16x32_bf16 v[148:151], a[52:55], v[68:71], v[148:151]
    buffer_load_dwordx4 v6, s[12:15], s32 offen offset:0 lds
    ds_read_b64_tr_b16 v[84:85], v12 offset:12288
    v_fma_f32 v125, -v94, v205, v125
    v_fma_f32 v126, -v94, v206, v126
    v_mfma_f32_16x16x32_bf16 v[152:155], a[48:51], v[72:75], v[152:155]
    buffer_store_dword v43, off, s[36:39], s79 offset:64 sc1
    ds_read_b64_tr_b16 v[86:87], v12 offset:12800
    v_fma_f32 v127, -v94, v207, v127
    v_cvt_pk_bf16_f32 v174, v124, v125
    v_mfma_f32_16x16x32_bf16 v[156:159], a[52:55], v[72:75], v[156:159]
    s_waitcnt lgkmcnt(3)
    s_mov_b32 s44, s60
    s_and_b32 s45, s61, 0xffff
    ds_read_b64_tr_b16 v[88:89], v13 offset:12288
    v_cvt_pk_bf16_f32 v175, v126, v127
    v_mfma_f32_16x16x32_bf16 v[100:103], v[176:179], v[164:167], 0
    s_mov_b32 s46, 7340032
    ds_read_b64_tr_b16 v[90:91], v13 offset:12800
    v_mfma_f32_16x16x32_bf16 v[108:111], v[180:183], v[164:167], 0
    buffer_load_dwordx4 v7, s[12:15], s32 offen offset:1024 lds
    v_mfma_f32_16x16x32_bf16 v[116:119], v[184:187], v[172:175], 0
    s_add_u32 m0, s34, 0
    s_add_u32 s32, s31, 1920
    s_and_b32 s32, s32, 2047
    v_mfma_f32_16x16x32_bf16 v[128:131], a[56:59], v[76:79], v[128:131]
    s_mul_i32 s32, s32, 3072
    s_add_u32 s32, s32, 4096
    ds_read_b64_tr_b16 v[60:61], v10 offset:16384
    v_mfma_f32_16x16x32_bf16 v[124:127], v[188:191], v[172:175], 0
    ds_read_b64_tr_b16 v[62:63], v10 offset:16896
    v_mfma_f32_16x16x32_bf16 v[132:135], a[60:63], v[76:79], v[132:135]
    buffer_load_dwordx4 v6, s[12:15], s32 offen offset:0 lds
    v_mfma_f32_16x16x32_bf16 v[48:51], v[76:79], v[32:35], v[48:51]
    s_waitcnt lgkmcnt(6)
    s_mov_b32 s47, 0x00020000
    ds_read_b64_tr_b16 v[64:65], v11 offset:16384
    v_mfma_f32_16x16x32_bf16 v[136:139], a[56:59], v[80:83], v[136:139]
    s_lshl_b32 s88, s2, 1
    ds_read_b64_tr_b16 v[66:67], v11 offset:16896
    v_xor_b32 v8, 64, v18
    v_xor_b32 v9, 64, v19
    v_mfma_f32_16x16x32_bf16 v[140:143], a[60:63], v[80:83], v[140:143]
    s_waitcnt lgkmcnt(6)
    ds_read_b128 v[192:195], v28 offset:0
    ds_read_b128 v[196:199], v28 offset:16
    v_max3_f32 v224, v96, v97, v98
    v_max3_f32 v225, -v96, -v97, -v98
    v_mfma_f32_16x16x32_bf16 v[144:147], a[56:59], v[84:87], v[144:147]
    buffer_load_dwordx4 v7, s[12:15], s32 offen offset:1024 lds
    ds_read_b128 v[200:203], v28 offset:128
    v_max3_f32 v226, v112, v113, v114
    v_max3_f32 v227, -v112, -v113, -v114
    v_mfma_f32_16x16x32_bf16 v[148:151], a[60:63], v[84:87], v[148:151]
    s_waitcnt lgkmcnt(5)
    s_add_u32 m0, s34, 8192
    s_add_u32 s32, s31, 0
    ds_read_b128 v[204:207], v28 offset:144
    v_max3_f32 v224, v224, v99, v104
    v_max3_f32 v225, v225, -v99, -v104
    v_mfma_f32_16x16x32_bf16 v[152:155], a[56:59], v[88:91], v[152:155]
    s_and_b32 s32, s32, 2047
    s_mul_i32 s32, s32, 3072
    s_add_u32 s88, s88, s65
    ds_read_b64_tr_b16 v[68:69], v12 offset:16384
    v_max3_f32 v226, v226, v115, v120
    v_max3_f32 v227, v227, -v115, -v120
    v_mfma_f32_16x16x32_bf16 v[156:159], a[60:63], v[88:91], v[156:159]
    s_mul_i32 s88, s88, 9216
    ds_read_b64_tr_b16 v[70:71], v12 offset:16896
    ds_read_b64_tr_b16 v[72:73], v13 offset:16384
    v_max3_f32 v224, v224, v105, v106
    v_max3_f32 v225, v225, -v105, -v106
    v_mfma_f32_16x16x32_bf16 v[128:131], a[64:67], v[60:63], v[128:131]
    ds_read_b64_tr_b16 v[74:75], v13 offset:16896
    ds_read_b64_tr_b16 v[76:77], v10 offset:20480
    v_max3_f32 v226, v226, v121, v122
    v_max3_f32 v227, v227, -v121, -v122
    v_mfma_f32_16x16x32_bf16 v[132:135], a[68:71], v[60:63], v[132:135]
    ds_read_b64_tr_b16 v[78:79], v10 offset:20992
    v_max_f32 v224, v224, v107
    v_min_u32 v42, 35, v0
    v_max_f32 v225, v225, -v107
    v_max_f32 v226, v226, v123
    v_mfma_f32_16x16x32_bf16 v[48:51], v[60:63], v[32:35], v[48:51]
    s_waitcnt lgkmcnt(7)
    ds_read_b64_tr_b16 v[80:81], v11 offset:20480
    ds_read_b64_tr_b16 v[82:83], v11 offset:20992
    v_max_f32 v227, v227, -v123
    v_mfma_f32_16x16x32_bf16 v[136:139], a[64:67], v[64:67], v[136:139]
    ds_read_b64_tr_b16 v[84:85], v12 offset:20480
    v_permlane32_swap_b32 v224, v225
    v_max3_f32 v248, v100, v101, v102
    v_max3_f32 v249, -v100, -v101, -v102
    v_mfma_f32_16x16x32_bf16 v[140:143], a[68:71], v[64:67], v[140:143]
    s_waitcnt lgkmcnt(7)
    ds_read_b64_tr_b16 v[86:87], v12 offset:20992
    v_permlane32_swap_b32 v226, v227
    v_mfma_f32_16x16x32_bf16 v[144:147], a[64:67], v[68:71], v[144:147]
    ds_read_b64_tr_b16 v[88:89], v13 offset:20480
    v_lshlrev_b32 v42, 7, v42
    v_max3_f32 v250, v116, v117, v118
    v_max3_f32 v251, -v116, -v117, -v118
    v_mfma_f32_16x16x32_bf16 v[148:151], a[68:71], v[68:71], v[148:151]
    s_waitcnt lgkmcnt(6)
    ds_read_b64_tr_b16 v[90:91], v13 offset:20992
    v_max_f32 v224, v224, v225
    v_max3_f32 v248, v248, v103, v108
    v_mfma_f32_16x16x32_bf16 v[152:155], a[64:67], v[72:75], v[152:155]
    ds_read_b64_tr_b16 v[60:61], v10 offset:24576
    v_max3_f32 v249, v249, -v103, -v108
    v_max_f32 v226, v226, v227
    v_mfma_f32_16x16x32_bf16 v[156:159], a[68:71], v[72:75], v[156:159]
    s_waitcnt lgkmcnt(5)
    ds_read_b64_tr_b16 v[62:63], v10 offset:25088
    v_max3_f32 v250, v250, v119, v124
    v_max3_f32 v251, v251, -v119, -v124
    v_mfma_f32_16x16x32_bf16 v[128:131], a[72:75], v[76:79], v[128:131]
    ds_read_b64_tr_b16 v[64:65], v11 offset:24576
    v_permlane16_swap_b32 v224, v226
    v_max3_f32 v248, v248, v109, v110
    v_mfma_f32_16x16x32_bf16 v[132:135], a[76:79], v[76:79], v[132:135]
    ds_read_b64_tr_b16 v[66:67], v11 offset:25088
    v_max3_f32 v249, v249, -v109, -v110
    v_max_f32 v224, v224, v226
    v_mfma_f32_16x16x32_bf16 v[48:51], v[76:79], v[32:35], v[48:51]
    ds_read_b64_tr_b16 v[68:69], v12 offset:24576
    v_max3_f32 v250, v250, v125, v126
    v_max3_f32 v251, v251, -v125, -v126
    v_mfma_f32_16x16x32_bf16 v[136:139], a[72:75], v[80:83], v[136:139]
    buffer_load_dword v16, v42, s[44:47], s88 offen
    s_add_u32 s88, s88, 4608
    v_mul_f32 v224, v93, v224
    v_max_f32 v248, v248, v111
    v_mfma_f32_16x16x32_bf16 v[140:143], a[76:79], v[80:83], v[140:143]
    s_waitcnt lgkmcnt(4)
    ds_read_b64_tr_b16 v[70:71], v12 offset:25088
    v_max_f32 v249, v249, -v111
    v_mov_b32 v226, v224
    v_mfma_f32_16x16x32_bf16 v[144:147], a[72:75], v[84:87], v[144:147]
    ds_read_b64_tr_b16 v[72:73], v13 offset:24576
    v_max_f32 v250, v250, v127
    v_max_f32 v251, v251, -v127
    v_mfma_f32_16x16x32_bf16 v[148:151], a[76:79], v[84:87], v[148:151]
    ds_read_b64_tr_b16 v[74:75], v13 offset:25088
    v_permlane16_swap_b32 v224, v226
    s_nop 0
    v_mov_b32 v225, v224
    v_mfma_f32_16x16x32_bf16 v[152:155], a[72:75], v[88:91], v[152:155]
    ds_read_b64_tr_b16 v[76:77], v10 offset:28672
    v_mov_b32 v227, v226
    v_permlane32_swap_b32 v224, v225
    v_mfma_f32_16x16x32_bf16 v[156:159], a[76:79], v[88:91], v[156:159]
    s_waitcnt lgkmcnt(4)
    ds_read_b64_tr_b16 v[78:79], v10 offset:29184
    v_permlane32_swap_b32 v226, v227
    v_mfma_f32_16x16x32_bf16 v[128:131], a[80:83], v[60:63], v[128:131]
    ds_read_b64_tr_b16 v[80:81], v11 offset:28672
    v_permlane32_swap_b32 v248, v249
    v_mfma_f32_16x16x32_bf16 v[132:135], a[84:87], v[60:63], v[132:135]
    ds_read_b64_tr_b16 v[82:83], v11 offset:29184
    v_fma_f32 v208, -v96, v93, -v225
    v_mfma_f32_16x16x32_bf16 v[48:51], v[60:63], v[32:35], v[48:51]
    s_waitcnt lgkmcnt(5)
    s_barrier
    ds_read_b64_tr_b16 v[84:85], v12 offset:28672
    v_fma_f32 v96, v96, v93, -v224
    v_permlane32_swap_b32 v250, v251
    v_mfma_f32_16x16x32_bf16 v[136:139], a[80:83], v[64:67], v[136:139]
    buffer_load_dwordx4 v6, s[12:15], s32 offen offset:0 lds
    v_fma_f32 v209, -v97, v93, -v225
    v_fma_f32 v97, v97, v93, -v224
    v_mfma_f32_16x16x32_bf16 v[140:143], a[84:87], v[64:67], v[140:143]
    ds_read_b64_tr_b16 v[86:87], v12 offset:29184
    v_max_f32 v248, v248, v249
    v_exp_f32 v208, v208
    v_mfma_f32_16x16x32_bf16 v[144:147], a[80:83], v[68:71], v[144:147]
    ds_read_b64_tr_b16 v[88:89], v13 offset:28672
    v_exp_f32 v96, v96
    v_mfma_f32_16x16x32_bf16 v[148:151], a[84:87], v[68:71], v[148:151]
    s_waitcnt lgkmcnt(4)
    ds_read_b64_tr_b16 v[90:91], v13 offset:29184
    v_max_f32 v250, v250, v251
    v_mfma_f32_16x16x32_bf16 v[152:155], a[80:83], v[72:75], v[152:155]
    buffer_load_dwordx4 v7, s[12:15], s32 offen offset:1024 lds
    v_fma_f32 v210, -v98, v93, -v225
    v_fma_f32 v98, v98, v93, -v224
    v_mfma_f32_16x16x32_bf16 v[156:159], a[84:87], v[72:75], v[156:159]
    s_add_u32 m0, s34, 16384
    s_add_u32 s32, s31, 128
    s_and_b32 s32, s32, 2047
    v_permlane16_swap_b32 v248, v250
    v_mfma_f32_16x16x32_bf16 v[128:131], a[88:91], v[76:79], v[128:131]
    s_mul_i32 s32, s32, 3072
    ds_read_b64_tr_b16 v[60:61], v10 offset:32768
    ds_read_b64_tr_b16 v[62:63], v10 offset:33280
    v_exp_f32 v209, v209
    v_mfma_f32_16x16x32_bf16 v[132:135], a[92:95], v[76:79], v[132:135]
    buffer_load_dwordx4 v6, s[12:15], s32 offen offset:0 lds
    v_exp_f32 v97, v97
    v_max_f32 v248, v248, v250
    v_mfma_f32_16x16x32_bf16 v[48:51], v[76:79], v[32:35], v[48:51]
    s_waitcnt lgkmcnt(3)
    ds_read_b64_tr_b16 v[64:65], v11 offset:32768
    ds_read_b64_tr_b16 v[66:67], v11 offset:33280
    v_fma_f32 v211, -v99, v93, -v225
    v_fma_f32 v99, v99, v93, -v224
    v_mfma_f32_16x16x32_bf16 v[136:139], a[88:91], v[80:83], v[136:139]
    ds_read_b64_tr_b16 v[68:69], v12 offset:32768
    v_mul_f32 v248, v95, v248
    v_exp_f32 v210, v210
    v_mfma_f32_16x16x32_bf16 v[140:143], a[92:95], v[80:83], v[140:143]
    buffer_load_dwordx4 v7, s[12:15], s32 offen offset:1024 lds
    ds_read_b64_tr_b16 v[70:71], v12 offset:33280
    v_exp_f32 v98, v98
    v_mfma_f32_16x16x32_bf16 v[144:147], a[88:91], v[84:87], v[144:147]
    s_add_u32 m0, s34, 24576
    s_add_u32 s32, s31, 256
    s_and_b32 s32, s32, 2047
    v_mov_b32 v250, v248
    v_mfma_f32_16x16x32_bf16 v[148:151], a[92:95], v[84:87], v[148:151]
    s_waitcnt lgkmcnt(4)
    s_mul_i32 s32, s32, 3072
    ds_read_b64_tr_b16 v[72:73], v13 offset:32768
    v_fma_f32 v212, -v104, v93, -v225
    v_fma_f32 v104, v104, v93, -v224
    v_mfma_f32_16x16x32_bf16 v[152:155], a[88:91], v[88:91], v[152:155]
    ds_read_b64_tr_b16 v[74:75], v13 offset:33280
    v_permlane16_swap_b32 v248, v250
    v_exp_f32 v211, v211
    v_mfma_f32_16x16x32_bf16 v[156:159], a[92:95], v[88:91], v[156:159]
    ds_read_b64_tr_b16 v[76:77], v10 offset:36864
    v_exp_f32 v99, v99
    v_mfma_f32_16x16x32_bf16 v[128:131], a[96:99], v[60:63], v[128:131]
    ds_read_b64_tr_b16 v[78:79], v10 offset:37376
    v_mov_b32 v249, v248
    v_mfma_f32_16x16x32_bf16 v[132:135], a[100:103], v[60:63], v[132:135]
    ds_read_b64_tr_b16 v[80:81], v11 offset:36864
    v_fma_f32 v213, -v105, v93, -v225
    v_fma_f32 v105, v105, v93, -v224
    v_mfma_f32_16x16x32_bf16 v[48:51], v[60:63], v[32:35], v[48:51]
    s_waitcnt lgkmcnt(5)
    ds_read_b64_tr_b16 v[82:83], v11 offset:37376
    v_mov_b32 v251, v250
    v_exp_f32 v212, v212
    v_mfma_f32_16x16x32_bf16 v[136:139], a[96:99], v[64:67], v[136:139]
    ds_read_b64_tr_b16 v[84:85], v12 offset:36864
    v_exp_f32 v104, v104
    v_mfma_f32_16x16x32_bf16 v[140:143], a[100:103], v[64:67], v[140:143]
    ds_read_b64_tr_b16 v[86:87], v12 offset:37376
    v_permlane32_swap_b32 v248, v249
    v_mfma_f32_16x16x32_bf16 v[144:147], a[96:99], v[68:71], v[144:147]
    ds_read_b64_tr_b16 v[88:89], v13 offset:36864
    v_fma_f32 v214, -v106, v93, -v225
    v_fma_f32 v106, v106, v93, -v224
    v_mfma_f32_16x16x32_bf16 v[148:151], a[100:103], v[68:71], v[148:151]
    s_waitcnt lgkmcnt(5)
    ds_read_b64_tr_b16 v[90:91], v13 offset:37376
    v_permlane32_swap_b32 v250, v251
    v_mfma_f32_16x16x32_bf16 v[152:155], a[96:99], v[72:75], v[152:155]
    ds_read_b64_tr_b16 v[60:61], v10 offset:40960
    v_exp_f32 v213, v213
    v_mfma_f32_16x16x32_bf16 v[156:159], a[100:103], v[72:75], v[156:159]
    ds_read_b64_tr_b16 v[62:63], v10 offset:41472
    v_exp_f32 v105, v105
    v_mfma_f32_16x16x32_bf16 v[128:131], a[104:107], v[76:79], v[128:131]
    ds_read_b64_tr_b16 v[64:65], v11 offset:40960
    v_fma_f32 v215, -v107, v93, -v225
    v_fma_f32 v107, v107, v93, -v224
    v_exp_f32 v214, v214
    v_mfma_f32_16x16x32_bf16 v[132:135], a[108:111], v[76:79], v[132:135]
    ds_read_b64_tr_b16 v[66:67], v11 offset:41472
    v_exp_f32 v106, v106
    v_mfma_f32_16x16x32_bf16 v[48:51], v[76:79], v[32:35], v[48:51]
    s_waitcnt lgkmcnt(5)
    ds_read_b64_tr_b16 v[68:69], v12 offset:40960
    v_fma_f32 v216, -v112, v93, -v227
    v_mfma_f32_16x16x32_bf16 v[136:139], a[104:107], v[80:83], v[136:139]
    ds_read_b64_tr_b16 v[70:71], v12 offset:41472
    v_fma_f32 v112, v112, v93, -v226
    v_exp_f32 v215, v215
    v_mfma_f32_16x16x32_bf16 v[140:143], a[108:111], v[80:83], v[140:143]
    ds_read_b64_tr_b16 v[72:73], v13 offset:40960
    v_exp_f32 v107, v107
    v_mfma_f32_16x16x32_bf16 v[144:147], a[104:107], v[84:87], v[144:147]
    ds_read_b64_tr_b16 v[74:75], v13 offset:41472
    v_fma_f32 v217, -v113, v93, -v227
    v_mfma_f32_16x16x32_bf16 v[148:151], a[108:111], v[84:87], v[148:151]
    s_waitcnt lgkmcnt(5)
    ds_read_b64_tr_b16 v[76:77], v10 offset:45056
    v_fma_f32 v113, v113, v93, -v226
    v_exp_f32 v216, v216
    v_mfma_f32_16x16x32_bf16 v[152:155], a[104:107], v[88:91], v[152:155]
    ds_read_b64_tr_b16 v[78:79], v10 offset:45568
    v_exp_f32 v112, v112
    v_mfma_f32_16x16x32_bf16 v[156:159], a[108:111], v[88:91], v[156:159]
    ds_read_b64_tr_b16 v[80:81], v11 offset:45056
    v_fma_f32 v218, -v114, v93, -v227
    v_fma_f32 v114, v114, v93, -v226
    v_mfma_f32_16x16x32_bf16 v[128:131], a[112:115], v[60:63], v[128:131]
    ds_read_b64_tr_b16 v[82:83], v11 offset:45568
    v_exp_f32 v217, v217
    v_mfma_f32_16x16x32_bf16 v[132:135], a[116:119], v[60:63], v[132:135]
    ds_read_b64_tr_b16 v[84:85], v12 offset:45056
    v_exp_f32 v113, v113
    v_mfma_f32_16x16x32_bf16 v[48:51], v[60:63], v[32:35], v[48:51]
    s_waitcnt vmcnt(18) lgkmcnt(5)
    s_barrier
    ds_read_b64_tr_b16 v[86:87], v12 offset:45568
    v_fma_f32 v219, -v115, v93, -v227
    v_fma_f32 v115, v115, v93, -v226
    v_mfma_f32_16x16x32_bf16 v[136:139], a[112:115], v[64:67], v[136:139]
    ds_read_b64_tr_b16 v[88:89], v13 offset:45056
    v_exp_f32 v218, v218
    v_exp_f32 v114, v114
    v_mfma_f32_16x16x32_bf16 v[140:143], a[116:119], v[64:67], v[140:143]
    ds_read_b64_tr_b16 v[90:91], v13 offset:45568
    v_fma_f32 v220, -v120, v93, -v227
    v_mfma_f32_16x16x32_bf16 v[144:147], a[112:115], v[68:71], v[144:147]
    ds_read_b64_tr_b16 v[60:61], v10 offset:49152
    v_fma_f32 v120, v120, v93, -v226
    v_exp_f32 v219, v219
    v_mfma_f32_16x16x32_bf16 v[148:151], a[116:119], v[68:71], v[148:151]
    ds_read_b64_tr_b16 v[62:63], v10 offset:49664
    v_exp_f32 v115, v115
    v_mfma_f32_16x16x32_bf16 v[152:155], a[112:115], v[72:75], v[152:155]
    ds_read_b64_tr_b16 v[64:65], v11 offset:49152
    v_fma_f32 v221, -v121, v93, -v227
    v_mfma_f32_16x16x32_bf16 v[156:159], a[116:119], v[72:75], v[156:159]
    s_waitcnt lgkmcnt(5)
    ds_read_b64_tr_b16 v[66:67], v11 offset:49664
    v_fma_f32 v121, v121, v93, -v226
    v_exp_f32 v220, v220
    v_mfma_f32_16x16x32_bf16 v[128:131], a[120:123], v[76:79], v[128:131]
    ds_read_b64_tr_b16 v[68:69], v12 offset:49152
    v_exp_f32 v120, v120
    v_mfma_f32_16x16x32_bf16 v[132:135], a[124:127], v[76:79], v[132:135]
    ds_read_b64_tr_b16 v[70:71], v12 offset:49664
    v_fma_f32 v222, -v122, v93, -v227
    v_fma_f32 v122, v122, v93, -v226
    v_mfma_f32_16x16x32_bf16 v[48:51], v[76:79], v[32:35], v[48:51]
    ds_read_b64_tr_b16 v[72:73], v13 offset:49152
    v_exp_f32 v221, v221
    v_mfma_f32_16x16x32_bf16 v[136:139], a[120:123], v[80:83], v[136:139]
    ds_read_b64_tr_b16 v[74:75], v13 offset:49664
    v_exp_f32 v121, v121
    v_mfma_f32_16x16x32_bf16 v[140:143], a[124:127], v[80:83], v[140:143]
    ds_read_b64_tr_b16 v[76:77], v10 offset:53248
    v_fma_f32 v223, -v123, v93, -v227
    v_fma_f32 v123, v123, v93, -v226
    v_mfma_f32_16x16x32_bf16 v[144:147], a[120:123], v[84:87], v[144:147]
    ds_read_b64_tr_b16 v[78:79], v10 offset:53760
    v_exp_f32 v222, v222
    v_mfma_f32_16x16x32_bf16 v[148:151], a[124:127], v[84:87], v[148:151]
    s_waitcnt lgkmcnt(5)
    ds_read_b64_tr_b16 v[80:81], v11 offset:53248
    v_exp_f32 v122, v122
    v_exp_f32 v223, v223
    v_mfma_f32_16x16x32_bf16 v[152:155], a[120:123], v[88:91], v[152:155]
    ds_read_b64_tr_b16 v[82:83], v11 offset:53760
    v_exp_f32 v123, v123
    v_mfma_f32_16x16x32_bf16 v[156:159], a[124:127], v[88:91], v[156:159]
    ds_read_b64_tr_b16 v[84:85], v12 offset:53248
    v_add_f32 v224, v96, v97
    v_mfma_f32_16x16x32_bf16 v[128:131], a[128:131], v[60:63], v[128:131]
    ds_read_b64_tr_b16 v[86:87], v12 offset:53760
    v_add_f32 v228, v98, v99
    v_add_f32 v225, v208, v209
    v_mfma_f32_16x16x32_bf16 v[132:135], a[132:135], v[60:63], v[132:135]
    ds_read_b64_tr_b16 v[88:89], v13 offset:53248
    v_add_f32 v229, v210, v211
    v_add_f32 v226, v112, v113
    v_mfma_f32_16x16x32_bf16 v[48:51], v[60:63], v[32:35], v[48:51]
    ds_read_b64_tr_b16 v[90:91], v13 offset:53760
    v_add_f32 v230, v114, v115
    v_add_f32 v227, v216, v217
    v_add_f32 v231, v218, v219
    v_mfma_f32_16x16x32_bf16 v[136:139], a[128:131], v[64:67], v[136:139]
    ds_read_b64_tr_b16 v[60:61], v10 offset:57344
    v_add_f32 v224, v224, v104
    v_add_f32 v228, v228, v105
    v_mfma_f32_16x16x32_bf16 v[140:143], a[132:135], v[64:67], v[140:143]
    s_waitcnt lgkmcnt(5)
    ds_read_b64_tr_b16 v[62:63], v10 offset:57856
    v_add_f32 v225, v225, v212
    v_add_f32 v229, v229, v213
    v_mfma_f32_16x16x32_bf16 v[144:147], a[128:131], v[68:71], v[144:147]
    ds_read_b64_tr_b16 v[64:65], v11 offset:57344
    v_add_f32 v226, v226, v120
    v_add_f32 v230, v230, v121
    v_mfma_f32_16x16x32_bf16 v[148:151], a[132:135], v[68:71], v[148:151]
    ds_read_b64_tr_b16 v[66:67], v11 offset:57856
    v_add_f32 v227, v227, v220
    v_add_f32 v231, v231, v221
    v_mfma_f32_16x16x32_bf16 v[152:155], a[128:131], v[72:75], v[152:155]
    ds_read_b64_tr_b16 v[68:69], v12 offset:57344
    v_add_f32 v224, v224, v106
    v_add_f32 v228, v228, v107
    v_mfma_f32_16x16x32_bf16 v[156:159], a[132:135], v[72:75], v[156:159]
    ds_read_b64_tr_b16 v[70:71], v12 offset:57856
    v_add_f32 v225, v225, v214
    v_add_f32 v229, v229, v215
    v_add_f32 v226, v226, v122
    v_mfma_f32_16x16x32_bf16 v[128:131], a[136:139], v[76:79], v[128:131]
    ds_read_b64_tr_b16 v[72:73], v13 offset:57344
    v_add_f32 v230, v230, v123
    v_add_f32 v227, v227, v222
    v_mfma_f32_16x16x32_bf16 v[132:135], a[140:143], v[76:79], v[132:135]
    ds_read_b64_tr_b16 v[74:75], v13 offset:57856
    v_add_f32 v231, v231, v223
    v_add_f32 v224, v224, v228
    v_mfma_f32_16x16x32_bf16 v[48:51], v[76:79], v[32:35], v[48:51]
    v_add_f32 v225, v225, v229
    v_add_f32 v226, v226, v230
    v_mfma_f32_16x16x32_bf16 v[136:139], a[136:139], v[80:83], v[136:139]
    ds_read_b64_tr_b16 v[76:77], v10 offset:61440
    v_add_f32 v227, v227, v231
    v_permlane32_swap_b32 v224, v225
    v_mfma_f32_16x16x32_bf16 v[140:143], a[140:143], v[80:83], v[140:143]
    s_waitcnt lgkmcnt(4)
    ds_read_b64_tr_b16 v[78:79], v10 offset:61952
    v_fma_f32 v232, -v100, v95, -v249
    v_mfma_f32_16x16x32_bf16 v[144:147], a[136:139], v[84:87], v[144:147]
    ds_read_b64_tr_b16 v[80:81], v11 offset:61440
    v_fma_f32 v100, v100, v95, -v248
    v_permlane32_swap_b32 v226, v227
    v_mfma_f32_16x16x32_bf16 v[148:151], a[140:143], v[84:87], v[148:151]
    ds_read_b64_tr_b16 v[82:83], v11 offset:61952
    v_fma_f32 v233, -v101, v95, -v249
    v_fma_f32 v101, v101, v95, -v248
    v_mfma_f32_16x16x32_bf16 v[152:155], a[136:139], v[88:91], v[152:155]
    ds_read_b64_tr_b16 v[84:85], v12 offset:61440
    v_add_f32 v224, v224, v225
    v_exp_f32 v232, v232
    v_mfma_f32_16x16x32_bf16 v[156:159], a[140:143], v[88:91], v[156:159]
    ds_read_b64_tr_b16 v[86:87], v12 offset:61952
    v_exp_f32 v100, v100
    v_mfma_f32_16x16x32_bf16 v[128:131], a[144:147], v[60:63], v[128:131]
    ds_read_b64_tr_b16 v[88:89], v13 offset:61440
    v_add_f32 v226, v226, v227
    v_mfma_f32_16x16x32_bf16 v[132:135], a[148:151], v[60:63], v[132:135]
    ds_read_b64_tr_b16 v[90:91], v13 offset:61952
    v_fma_f32 v234, -v102, v95, -v249
    v_fma_f32 v102, v102, v95, -v248
    v_mfma_f32_16x16x32_bf16 v[48:51], v[60:63], v[32:35], v[48:51]
    s_waitcnt vmcnt(14) lgkmcnt(5)
    s_barrier
    v_permlane16_swap_b32 v224, v226
    v_exp_f32 v233, v233
    v_mfma_f32_16x16x32_bf16 v[136:139], a[144:147], v[64:67], v[136:139]
    v_exp_f32 v101, v101
    v_mfma_f32_16x16x32_bf16 v[140:143], a[148:151], v[64:67], v[140:143]
    v_add_u32 v10, 65536, v10
    v_add_f32 v224, v224, v226
    v_mfma_f32_16x16x32_bf16 v[144:147], a[144:147], v[68:71], v[144:147]
    ds_read_b64_tr_b16 v[60:61], v10 offset:0
    v_fma_f32 v235, -v103, v95, -v249
    v_fma_f32 v103, v103, v95, -v248
    v_mfma_f32_16x16x32_bf16 v[148:151], a[148:151], v[68:71], v[148:151]
    ds_read_b64_tr_b16 v[62:63], v10 offset:512
    v_add_u32 v11, 65536, v11
    v_rcp_f32 v224, v224
    v_mfma_f32_16x16x32_bf16 v[152:155], a[144:147], v[72:75], v[152:155]
    ds_read_b64_tr_b16 v[64:65], v11 offset:0
    v_exp_f32 v234, v234
    v_mfma_f32_16x16x32_bf16 v[156:159], a[148:151], v[72:75], v[156:159]
    ds_read_b64_tr_b16 v[66:67], v11 offset:512
    v_add_u32 v12, 65536, v12
    v_exp_f32 v102, v102
    v_mov_b32 v226, v224
    v_mfma_f32_16x16x32_bf16 v[128:131], a[152:155], v[76:79], v[128:131]
    ds_read_b64_tr_b16 v[68:69], v12 offset:0
    v_fma_f32 v236, -v108, v95, -v249
    v_fma_f32 v108, v108, v95, -v248
    v_mfma_f32_16x16x32_bf16 v[132:135], a[156:159], v[76:79], v[132:135]
    ds_read_b64_tr_b16 v[70:71], v12 offset:512
    v_add_u32 v13, 65536, v13
    v_permlane16_swap_b32 v224, v226
    v_mfma_f32_16x16x32_bf16 v[48:51], v[76:79], v[32:35], v[48:51]
    s_waitcnt lgkmcnt(5)
    ds_read_b64_tr_b16 v[72:73], v13 offset:0
    v_exp_f32 v235, v235
    v_mfma_f32_16x16x32_bf16 v[136:139], a[152:155], v[80:83], v[136:139]
    buffer_load_dword v16, v42, s[44:47], s88 offen
    s_add_u32 s88, s88, 4608
    v_exp_f32 v103, v103
    v_mfma_f32_16x16x32_bf16 v[140:143], a[156:159], v[80:83], v[140:143]
    ds_read_b64_tr_b16 v[74:75], v13 offset:512
    v_mov_b32 v225, v224
    v_fma_f32 v237, -v109, v95, -v249
    v_mfma_f32_16x16x32_bf16 v[144:147], a[152:155], v[84:87], v[144:147]
    ds_read_b64_tr_b16 v[76:77], v10 offset:4096
    v_fma_f32 v109, v109, v95, -v248
    v_mov_b32 v227, v226
    v_exp_f32 v236, v236
    v_mfma_f32_16x16x32_bf16 v[148:151], a[156:159], v[84:87], v[148:151]
    ds_read_b64_tr_b16 v[78:79], v10 offset:4608
    v_exp_f32 v108, v108
    v_mfma_f32_16x16x32_bf16 v[152:155], a[152:155], v[88:91], v[152:155]
    ds_read_b64_tr_b16 v[80:81], v11 offset:4096
    v_permlane32_swap_b32 v224, v225
    v_mfma_f32_16x16x32_bf16 v[156:159], a[156:159], v[88:91], v[156:159]
    s_waitcnt lgkmcnt(4)
    ds_read_b64_tr_b16 v[82:83], v11 offset:4608
    v_fma_f32 v238, -v110, v95, -v249
    v_mfma_f32_16x16x32_bf16 v[128:131], a[160:163], v[60:63], v[128:131]
    ds_read_b64_tr_b16 v[84:85], v12 offset:4096
    v_fma_f32 v110, v110, v95, -v248
    v_permlane32_swap_b32 v226, v227
    v_mfma_f32_16x16x32_bf16 v[132:135], a[164:167], v[60:63], v[132:135]
    ds_read_b64_tr_b16 v[86:87], v12 offset:4608
    v_exp_f32 v237, v237
    v_mfma_f32_16x16x32_bf16 v[48:51], v[60:63], v[32:35], v[48:51]
    ds_read_b64_tr_b16 v[88:89], v13 offset:4096
    v_exp_f32 v109, v109
    v_mfma_f32_16x16x32_bf16 v[136:139], a[160:163], v[64:67], v[136:139]
    ds_read_b64_tr_b16 v[90:91], v13 offset:4608
    v_fma_f32 v239, -v111, v95, -v249
    v_fma_f32 v111, v111, v95, -v248
    v_mfma_f32_16x16x32_bf16 v[140:143], a[164:167], v[64:67], v[140:143]
    ds_read_b64_tr_b16 v[60:61], v10 offset:8192
    v_exp_f32 v238, v238
    v_mfma_f32_16x16x32_bf16 v[144:147], a[160:163], v[68:71], v[144:147]
    ds_read_b64_tr_b16 v[62:63], v10 offset:8704
    v_exp_f32 v110, v110
    v_mfma_f32_16x16x32_bf16 v[148:151], a[164:167], v[68:71], v[148:151]
    s_waitcnt lgkmcnt(5)
    ds_read_b64_tr_b16 v[64:65], v11 offset:8192
    v_fma_f32 v240, -v116, v95, -v251
    v_fma_f32 v116, v116, v95, -v250
    v_mfma_f32_16x16x32_bf16 v[152:155], a[160:163], v[72:75], v[152:155]
    ds_read_b64_tr_b16 v[66:67], v11 offset:8704
    v_exp_f32 v239, v239
    v_mfma_f32_16x16x32_bf16 v[156:159], a[164:167], v[72:75], v[156:159]
    ds_read_b64_tr_b16 v[68:69], v12 offset:8192
    v_exp_f32 v111, v111
    v_fma_f32 v241, -v117, v95, -v251
    v_mfma_f32_16x16x32_bf16 v[128:131], a[168:171], v[76:79], v[128:131]
    ds_read_b64_tr_b16 v[70:71], v12 offset:8704
    v_fma_f32 v117, v117, v95, -v250
    v_exp_f32 v240, v240
    v_mfma_f32_16x16x32_bf16 v[132:135], a[172:175], v[76:79], v[132:135]
    ds_read_b64_tr_b16 v[72:73], v13 offset:8192
    v_exp_f32 v116, v116
    v_mfma_f32_16x16x32_bf16 v[48:51], v[76:79], v[32:35], v[48:51]
    ds_read_b64_tr_b16 v[74:75], v13 offset:8704
    v_fma_f32 v242, -v118, v95, -v251
    v_mfma_f32_16x16x32_bf16 v[136:139], a[168:171], v[80:83], v[136:139]
    ds_read_b64_tr_b16 v[76:77], v10 offset:12288
    v_fma_f32 v118, v118, v95, -v250
    v_exp_f32 v241, v241
    v_mfma_f32_16x16x32_bf16 v[140:143], a[172:175], v[80:83], v[140:143]
    s_waitcnt lgkmcnt(5)
    ds_read_b64_tr_b16 v[78:79], v10 offset:12800
    v_exp_f32 v117, v117
    v_mfma_f32_16x16x32_bf16 v[144:147], a[168:171], v[84:87], v[144:147]
    ds_read_b64_tr_b16 v[80:81], v11 offset:12288
    v_fma_f32 v243, -v119, v95, -v251
    v_fma_f32 v119, v119, v95, -v250
    v_mfma_f32_16x16x32_bf16 v[148:151], a[172:175], v[84:87], v[148:151]
    ds_read_b64_tr_b16 v[82:83], v11 offset:12800
    v_exp_f32 v242, v242
    v_mfma_f32_16x16x32_bf16 v[152:155], a[168:171], v[88:91], v[152:155]
    ds_read_b64_tr_b16 v[84:85], v12 offset:12288
    v_exp_f32 v118, v118
    v_mfma_f32_16x16x32_bf16 v[156:159], a[172:175], v[88:91], v[156:159]
    ds_read_b64_tr_b16 v[86:87], v12 offset:12800
    v_fma_f32 v244, -v124, v95, -v251
    v_fma_f32 v124, v124, v95, -v250
    v_mfma_f32_16x16x32_bf16 v[128:131], a[176:179], v[60:63], v[128:131]
    ds_read_b64_tr_b16 v[88:89], v13 offset:12288
    v_exp_f32 v243, v243
    v_mfma_f32_16x16x32_bf16 v[132:135], a[180:183], v[60:63], v[132:135]
    ds_read_b64_tr_b16 v[90:91], v13 offset:12800
    v_exp_f32 v119, v119
    v_mfma_f32_16x16x32_bf16 v[48:51], v[60:63], v[32:35], v[48:51]
    s_waitcnt vmcnt(11) lgkmcnt(5)
    s_barrier
    v_fma_f32 v245, -v125, v95, -v251
    v_fma_f32 v125, v125, v95, -v250
    v_exp_f32 v244, v244
    v_mfma_f32_16x16x32_bf16 v[136:139], a[176:179], v[64:67], v[136:139]
    ds_read_b64_tr_b16 v[60:61], v10 offset:16384
    v_exp_f32 v124, v124
    v_mfma_f32_16x16x32_bf16 v[140:143], a[180:183], v[64:67], v[140:143]
    ds_read_b64_tr_b16 v[62:63], v10 offset:16896
    v_fma_f32 v246, -v126, v95, -v251
    v_mfma_f32_16x16x32_bf16 v[144:147], a[176:179], v[68:71], v[144:147]
    ds_read_b64_tr_b16 v[64:65], v11 offset:16384
    v_fma_f32 v126, v126, v95, -v250
    v_exp_f32 v245, v245
    v_mfma_f32_16x16x32_bf16 v[148:151], a[180:183], v[68:71], v[148:151]
    ds_read_b64_tr_b16 v[66:67], v11 offset:16896
    v_exp_f32 v125, v125
    v_mfma_f32_16x16x32_bf16 v[152:155], a[176:179], v[72:75], v[152:155]
    ds_read_b64_tr_b16 v[68:69], v12 offset:16384
    v_fma_f32 v247, -v127, v95, -v251
    v_mfma_f32_16x16x32_bf16 v[156:159], a[180:183], v[72:75], v[156:159]
    ds_read_b64_tr_b16 v[70:71], v12 offset:16896
    v_fma_f32 v127, v127, v95, -v250
    v_exp_f32 v246, v246
    v_mfma_f32_16x16x32_bf16 v[128:131], a[184:187], v[76:79], v[128:131]
    ds_read_b64_tr_b16 v[72:73], v13 offset:16384
    v_exp_f32 v126, v126
    v_mfma_f32_16x16x32_bf16 v[132:135], a[188:191], v[76:79], v[132:135]
    ds_read_b64_tr_b16 v[74:75], v13 offset:16896
    v_exp_f32 v247, v247
    v_mfma_f32_16x16x32_bf16 v[48:51], v[76:79], v[32:35], v[48:51]
    s_waitcnt lgkmcnt(5)
    v_exp_f32 v127, v127
    v_mfma_f32_16x16x32_bf16 v[136:139], a[184:187], v[80:83], v[136:139]
    ds_read_b64_tr_b16 v[76:77], v10 offset:20480
    v_mul_f32 v96, v96, v224
    v_mul_f32 v97, v97, v224
    v_mfma_f32_16x16x32_bf16 v[140:143], a[188:191], v[80:83], v[140:143]
    ds_read_b64_tr_b16 v[78:79], v10 offset:20992
    v_mul_f32 v98, v98, v224
    v_mul_f32 v99, v99, v224
    v_mfma_f32_16x16x32_bf16 v[144:147], a[184:187], v[84:87], v[144:147]
    s_waitcnt vmcnt(6) lgkmcnt(4)
    s_barrier
    ds_read_b64_tr_b16 v[80:81], v11 offset:20480
    v_mul_f32 v104, v104, v224
    v_mul_f32 v105, v105, v224
    v_mul_f32 v106, v106, v224
    v_mfma_f32_16x16x32_bf16 v[148:151], a[188:191], v[84:87], v[148:151]
    ds_read_b64_tr_b16 v[82:83], v11 offset:20992
    v_mul_f32 v107, v107, v224
    v_cvt_pk_bf16_f32 v96, v96, v97
    v_mfma_f32_16x16x32_bf16 v[152:155], a[184:187], v[88:91], v[152:155]
    ds_read_b64_tr_b16 v[52:53], v10 offset:32768
    v_cvt_pk_bf16_f32 v97, v98, v99
    v_cvt_pk_bf16_f32 v98, v104, v105
    v_mfma_f32_16x16x32_bf16 v[156:159], a[188:191], v[88:91], v[156:159]
    ds_read_b64_tr_b16 v[54:55], v10 offset:33280
    v_cvt_pk_bf16_f32 v99, v106, v107
    v_mfma_f32_16x16x32_bf16 v[128:131], a[192:195], v[60:63], v[128:131]
    ds_write_b128 v18, v[96:99] offset:0
    v_mul_f32 v208, v208, v225
    v_mfma_f32_16x16x32_bf16 v[132:135], a[196:199], v[60:63], v[132:135]
    ds_read_b64_tr_b16 v[84:85], v12 offset:20480
    v_mul_f32 v209, v209, v225
    v_mul_f32 v210, v210, v225
    v_mfma_f32_16x16x32_bf16 v[48:51], v[60:63], v[32:35], v[48:51]
    ds_read_b64_tr_b16 v[86:87], v12 offset:20992
    v_mul_f32 v211, v211, v225
    v_mul_f32 v212, v212, v225
    v_mul_f32 v213, v213, v225
    v_mfma_f32_16x16x32_bf16 v[136:139], a[192:195], v[64:67], v[136:139]
    ds_read_b64_tr_b16 v[88:89], v13 offset:20480
    v_mul_f32 v214, v214, v225
    v_mul_f32 v215, v215, v225
    v_mfma_f32_16x16x32_bf16 v[140:143], a[196:199], v[64:67], v[140:143]
    ds_read_b64_tr_b16 v[90:91], v13 offset:20992
    v_cvt_pk_bf16_f32 v104, v208, v209
    v_cvt_pk_bf16_f32 v105, v210, v211
    v_mfma_f32_16x16x32_bf16 v[144:147], a[192:195], v[68:71], v[144:147]
    ds_read_b64_tr_b16 v[60:61], v10 offset:24576
    v_cvt_pk_bf16_f32 v106, v212, v213
    v_cvt_pk_bf16_f32 v107, v214, v215
    v_mfma_f32_16x16x32_bf16 v[148:151], a[196:199], v[68:71], v[148:151]
    s_waitcnt lgkmcnt(5)
    ds_read_b64_tr_b16 v[62:63], v10 offset:25088
    v_mfma_f32_16x16x32_bf16 v[48:51], v[52:55], v[32:35], v[48:51]
    ds_write_b128 v8, v[104:107] offset:0
    v_add_f32 v248, v100, v101
    v_add_f32 v252, v102, v103
    v_mfma_f32_16x16x32_bf16 v[152:155], a[192:195], v[72:75], v[152:155]
    ds_read_b64_tr_b16 v[64:65], v11 offset:24576
    v_add_f32 v249, v232, v233
    v_add_f32 v253, v234, v235
    v_add_f32 v250, v116, v117
    v_mfma_f32_16x16x32_bf16 v[156:159], a[196:199], v[72:75], v[156:159]
    ds_read_b64_tr_b16 v[66:67], v11 offset:25088
    v_add_f32 v254, v118, v119
    v_add_f32 v251, v240, v241
    v_mfma_f32_16x16x32_bf16 v[128:131], a[200:203], v[76:79], v[128:131]
    ds_read_b64_tr_b16 v[56:57], v10 offset:36864
    v_add_f32 v255, v242, v243
    v_add_f32 v248, v248, v108
    v_lshlrev_b32 v15, 7, v29
    v_mfma_f32_16x16x32_bf16 v[132:135], a[204:207], v[76:79], v[132:135]
    buffer_load_dword v14, v15, s[36:39], s51 offen offset:64 sc1
    v_add_f32 v252, v252, v109
    v_add_f32 v249, v249, v236
    v_mfma_f32_16x16x32_bf16 v[48:51], v[76:79], v[32:35], v[48:51]
    ds_read_b64_tr_b16 v[58:59], v10 offset:37376
    v_add_f32 v253, v253, v237
    v_add_f32 v250, v250, v124
    v_mfma_f32_16x16x32_bf16 v[136:139], a[200:203], v[80:83], v[136:139]
    ds_read_b64_tr_b16 v[68:69], v12 offset:24576
    v_add_f32 v254, v254, v125
    v_add_f32 v251, v251, v244
    v_mfma_f32_16x16x32_bf16 v[140:143], a[204:207], v[80:83], v[140:143]
    s_waitcnt lgkmcnt(4)
    ds_read_b64_tr_b16 v[70:71], v12 offset:25088
    v_add_f32 v255, v255, v245
    v_add_f32 v248, v248, v110
    v_add_f32 v252, v252, v111
    v_mfma_f32_16x16x32_bf16 v[144:147], a[200:203], v[84:87], v[144:147]
    ds_read_b64_tr_b16 v[72:73], v13 offset:24576
    v_add_f32 v249, v249, v238
    v_add_f32 v253, v253, v239
    v_mfma_f32_16x16x32_bf16 v[148:151], a[204:207], v[84:87], v[148:151]
    s_waitcnt lgkmcnt(3)
    ds_read_b64_tr_b16 v[74:75], v13 offset:25088
    v_add_f32 v250, v250, v126
    v_add_f32 v254, v254, v127
    v_mfma_f32_16x16x32_bf16 v[48:51], v[56:59], v[32:35], v[48:51]
    ds_read_b64_tr_b16 v[76:77], v10 offset:28672
    v_add_f32 v251, v251, v246
    v_add_f32 v255, v255, v247
    v_mfma_f32_16x16x32_bf16 v[152:155], a[200:203], v[88:91], v[152:155]
    ds_read_b64_tr_b16 v[78:79], v10 offset:29184
    v_add_f32 v248, v248, v252
    v_add_f32 v249, v249, v253
    v_mfma_f32_16x16x32_bf16 v[156:159], a[204:207], v[88:91], v[156:159]
    ds_read_b64_tr_b16 v[80:81], v11 offset:28672
    v_add_f32 v250, v250, v254
    v_add_f32 v251, v251, v255
    v_mfma_f32_16x16x32_bf16 v[128:131], a[208:211], v[60:63], v[128:131]
    ds_read_b64_tr_b16 v[82:83], v11 offset:29184
    v_add_u32 v10, 4294901760, v10
    v_permlane32_swap_b32 v248, v249
    v_mul_f32 v112, v112, v226
    v_mfma_f32_16x16x32_bf16 v[132:135], a[212:215], v[60:63], v[132:135]
    ds_read_b64_tr_b16 v[52:53], v10 offset:0
    v_mul_f32 v113, v113, v226
    v_permlane32_swap_b32 v250, v251
    v_mfma_f32_16x16x32_bf16 v[48:51], v[60:63], v[32:35], v[48:51]
    ds_read_b64_tr_b16 v[54:55], v10 offset:512
    v_mul_f32 v114, v114, v226
    v_mfma_f32_16x16x32_bf16 v[136:139], a[208:211], v[64:67], v[136:139]
    ds_read_b64_tr_b16 v[84:85], v12 offset:28672
    v_mul_f32 v115, v115, v226
    v_add_f32 v248, v248, v249
    v_mfma_f32_16x16x32_bf16 v[140:143], a[212:215], v[64:67], v[140:143]
    s_waitcnt lgkmcnt(5)
    ds_read_b64_tr_b16 v[86:87], v12 offset:29184
    v_mul_f32 v120, v120, v226
    v_mul_f32 v121, v121, v226
    v_mfma_f32_16x16x32_bf16 v[144:147], a[208:211], v[68:71], v[144:147]
    ds_read_b64_tr_b16 v[88:89], v13 offset:28672
    v_add_f32 v250, v250, v251
    v_mul_f32 v122, v122, v226
    v_mfma_f32_16x16x32_bf16 v[148:151], a[212:215], v[68:71], v[148:151]
    s_waitcnt lgkmcnt(3)
    ds_read_b64_tr_b16 v[90:91], v13 offset:29184
    v_add_u32 v10, 65536, v10
    v_mul_f32 v123, v123, v226
    v_permlane16_swap_b32 v248, v250
    v_mfma_f32_16x16x32_bf16 v[48:51], v[52:55], v[32:35], v[48:51]
    ds_read_b64_tr_b16 v[60:61], v10 offset:32768
    v_cvt_pk_bf16_f32 v112, v112, v113
    v_cvt_pk_bf16_f32 v113, v114, v115
    v_mfma_f32_16x16x32_bf16 v[152:155], a[208:211], v[72:75], v[152:155]
    ds_read_b64_tr_b16 v[62:63], v10 offset:33280
    v_add_f32 v248, v248, v250
    v_cvt_pk_bf16_f32 v114, v120, v121
    v_mfma_f32_16x16x32_bf16 v[156:159], a[212:215], v[72:75], v[156:159]
    ds_read_b64_tr_b16 v[64:65], v11 offset:32768
    v_cvt_pk_bf16_f32 v115, v122, v123
    v_rcp_f32 v248, v248
    v_mfma_f32_16x16x32_bf16 v[128:131], a[216:219], v[76:79], v[128:131]
    ds_write_b128 v19, v[112:115] offset:0
    v_mfma_f32_16x16x32_bf16 v[132:135], a[220:223], v[76:79], v[132:135]
    ds_read_b64_tr_b16 v[66:67], v11 offset:33280
    v_add_u32 v10, 4294901760, v10
    v_mul_f32 v216, v216, v227
    v_mfma_f32_16x16x32_bf16 v[48:51], v[76:79], v[32:35], v[48:51]
    ds_read_b64_tr_b16 v[56:57], v10 offset:4096
    v_mov_b32 v250, v248
    v_mul_f32 v217, v217, v227
    v_mul_f32 v218, v218, v227
    v_mfma_f32_16x16x32_bf16 v[136:139], a[216:219], v[80:83], v[136:139]
    ds_read_b64_tr_b16 v[58:59], v10 offset:4608
    v_permlane16_swap_b32 v248, v250
    v_mfma_f32_16x16x32_bf16 v[140:143], a[220:223], v[80:83], v[140:143]
    s_waitcnt lgkmcnt(5)
    ds_read_b64_tr_b16 v[68:69], v12 offset:32768
    ds_read_b64_tr_b16 v[70:71], v12 offset:33280
    v_mul_f32 v219, v219, v227
    v_mul_f32 v220, v220, v227
    v_mfma_f32_16x16x32_bf16 v[144:147], a[216:219], v[84:87], v[144:147]
    ds_read_b64_tr_b16 v[72:73], v13 offset:32768
    v_mov_b32 v249, v248
    v_mul_f32 v221, v221, v227
    v_mfma_f32_16x16x32_bf16 v[148:151], a[220:223], v[84:87], v[148:151]
    s_waitcnt lgkmcnt(3)
    ds_read_b64_tr_b16 v[74:75], v13 offset:33280
    v_add_u32 v10, 65536, v10
    v_mul_f32 v222, v222, v227
    v_mov_b32 v251, v250
    v_mfma_f32_16x16x32_bf16 v[48:51], v[56:59], v[32:35], v[48:51]
    ds_read_b64_tr_b16 v[76:77], v10 offset:36864
    v_mul_f32 v223, v223, v227
    v_cvt_pk_bf16_f32 v120, v216, v217
    v_mfma_f32_16x16x32_bf16 v[152:155], a[216:219], v[88:91], v[152:155]
    ds_read_b64_tr_b16 v[78:79], v10 offset:37376
    v_permlane32_swap_b32 v248, v249
    v_cvt_pk_bf16_f32 v121, v218, v219
    v_mfma_f32_16x16x32_bf16 v[156:159], a[220:223], v[88:91], v[156:159]
    ds_read_b64_tr_b16 v[80:81], v11 offset:36864
    v_cvt_pk_bf16_f32 v122, v220, v221
    v_permlane32_swap_b32 v250, v251
    v_mfma_f32_16x16x32_bf16 v[128:131], a[224:227], v[60:63], v[128:131]
    ds_read_b64_tr_b16 v[82:83], v11 offset:37376
    v_cvt_pk_bf16_f32 v123, v222, v223
    v_mfma_f32_16x16x32_bf16 v[132:135], a[228:231], v[60:63], v[132:135]
    ds_write_b128 v9, v[120:123] offset:0
    v_mfma_f32_16x16x32_bf16 v[136:139], a[224:227], v[64:67], v[136:139]
    s_mov_b32 exec_lo, 0x10001
    s_mov_b32 exec_hi, 0x10001
    ds_write_b128 v22, v[48:51] offset:256
    s_mov_b64 exec, -1
    v_mfma_f32_16x16x32_bf16 v[140:143], a[228:231], v[64:67], v[140:143]
    s_waitcnt lgkmcnt(5)
    ds_read_b64_tr_b16 v[84:85], v12 offset:36864
    v_mul_f32 v100, v100, v248
    v_mul_f32 v101, v101, v248
    v_mul_f32 v102, v102, v248
    v_mul_f32 v103, v103, v248
    v_mfma_f32_16x16x32_bf16 v[144:147], a[224:227], v[68:71], v[144:147]
    ds_read_b64_tr_b16 v[86:87], v12 offset:37376
    v_mul_f32 v108, v108, v248
    v_mul_f32 v109, v109, v248
    v_mul_f32 v110, v110, v248
    v_mfma_f32_16x16x32_bf16 v[148:151], a[228:231], v[68:71], v[148:151]
    ds_read_b64_tr_b16 v[88:89], v13 offset:36864
    v_mul_f32 v111, v111, v248
    v_cvt_pk_bf16_f32 v100, v100, v101
    v_mfma_f32_16x16x32_bf16 v[152:155], a[224:227], v[72:75], v[152:155]
    ds_read_b64_tr_b16 v[90:91], v13 offset:37376
    v_add_u32 v10, 4294901760, v10
    v_cvt_pk_bf16_f32 v101, v102, v103
    v_cvt_pk_bf16_f32 v102, v108, v109
    v_mfma_f32_16x16x32_bf16 v[156:159], a[228:231], v[72:75], v[156:159]
    s_waitcnt lgkmcnt(5)
    ds_read_b64_tr_b16 v[60:61], v10 offset:0
    v_cvt_pk_bf16_f32 v103, v110, v111
    v_mfma_f32_16x16x32_bf16 v[128:131], a[232:235], v[76:79], v[128:131]
    buffer_load_dwordx4 v6, s[12:15], s32 offen offset:0 lds
    s_waitcnt vmcnt(1)
    v_cmp_eq_u32 vcc, -1, v14
    v_mfma_f32_16x16x32_bf16 v[132:135], a[236:239], v[76:79], v[132:135]
    buffer_load_dwordx4 v7, s[12:15], s32 offen offset:1024 lds
    s_cbranch_vccnz L_qkv_slow3
L_qkv_back3:
    v_mfma_f32_16x16x32_bf16 v[136:139], a[232:235], v[80:83], v[136:139]
    ds_write_b128 v18, v[100:103] offset:2048
    s_waitcnt lgkmcnt(4)
    s_barrier
    v_mul_f32 v232, v232, v249
    v_mfma_f32_16x16x32_bf16 v[140:143], a[236:239], v[80:83], v[140:143]
    s_add_u32 m0, s34, 32768
    s_add_u32 s32, s31, 384
    s_and_b32 s32, s32, 2047
    ds_read_b64_tr_b16 v[62:63], v10 offset:512
    v_xor_b32 v24, 0, v23
    v_add_u32 v11, 4294901760, v11
    v_mfma_f32_16x16x32_bf16 v[144:147], a[232:235], v[84:87], v[144:147]
    s_mul_i32 s32, s32, 3072
    ds_read_b32 v48, v24 offset:256
    ds_read_b64_tr_b16 v[64:65], v11 offset:0
    v_xor_b32 v25, 64, v23
    v_mul_f32 v233, v233, v249
    v_mfma_f32_16x16x32_bf16 v[148:151], a[236:239], v[84:87], v[148:151]
    s_waitcnt lgkmcnt(4)
    ds_read_b32 v49, v25 offset:256
    ds_read_b64_tr_b16 v[66:67], v11 offset:512
    v_xor_b32 v24, 128, v23
    v_add_u32 v12, 4294901760, v12
    v_mfma_f32_16x16x32_bf16 v[152:155], a[232:235], v[88:91], v[152:155]
    buffer_load_dwordx4 v6, s[12:15], s32 offen offset:0 lds
    ds_read_b32 v50, v24 offset:256
    v_xor_b32 v25, 192, v23
    v_mul_f32 v234, v234, v249
    v_mfma_f32_16x16x32_bf16 v[156:159], a[236:239], v[88:91], v[156:159]
    s_waitcnt lgkmcnt(5)
    ds_read_b32 v51, v25 offset:256
    ds_read_b64_tr_b16 v[68:69], v12 offset:0
    v_mul_f32 v235, v235, v249
    v_mul_f32 v236, v236, v249
    v_mfma_f32_16x16x32_bf16 v[128:131], a[240:243], v[60:63], v[128:131]
    buffer_load_dwordx4 v7, s[12:15], s32 offen offset:1024 lds
    ds_read_b64_tr_b16 v[70:71], v12 offset:512
    v_add_u32 v13, 4294901760, v13
    v_mul_f32 v237, v237, v249
    v_mfma_f32_16x16x32_bf16 v[132:135], a[244:247], v[60:63], v[132:135]
    s_waitcnt lgkmcnt(4)
    s_barrier
    s_add_u32 m0, s34, 40960
    ds_read_b64_tr_b16 v[72:73], v13 offset:0
    v_mul_f32 v238, v238, v249
    v_mul_f32 v239, v239, v249
    v_mfma_f32_16x16x32_bf16 v[136:139], a[240:243], v[64:67], v[136:139]
    s_add_u32 s32, s31, 512
    s_and_b32 s32, s32, 2047
    s_mul_i32 s32, s32, 3072
    ds_read_b64_tr_b16 v[74:75], v13 offset:512
    v_cvt_pk_bf16_f32 v108, v232, v233
    v_cvt_pk_bf16_f32 v109, v234, v235
    v_mfma_f32_16x16x32_bf16 v[140:143], a[244:247], v[64:67], v[140:143]
    s_waitcnt lgkmcnt(2)
    ds_read_b64_tr_b16 v[76:77], v10 offset:4096
    ds_read_b64_tr_b16 v[78:79], v10 offset:4608
    v_cvt_pk_bf16_f32 v110, v236, v237
    v_cvt_pk_bf16_f32 v111, v238, v239
    v_mfma_f32_16x16x32_bf16 v[144:147], a[240:243], v[68:71], v[144:147]
    buffer_load_dwordx4 v6, s[12:15], s32 offen offset:0 lds
    ds_read_b64_tr_b16 v[80:81], v11 offset:4096
    v_mfma_f32_16x16x32_bf16 v[148:151], a[244:247], v[68:71], v[148:151]
    s_waitcnt lgkmcnt(3)
    ds_write_b128 v8, v[108:111] offset:2048
    v_mul_f32 v116, v116, v250
    v_mul_f32 v117, v117, v250
    v_mfma_f32_16x16x32_bf16 v[152:155], a[240:243], v[72:75], v[152:155]
    ds_read_b64_tr_b16 v[82:83], v11 offset:4608
    ds_read_b64_tr_b16 v[84:85], v12 offset:4096
    v_mul_f32 v118, v118, v250
    v_mul_f32 v119, v119, v250
    v_mfma_f32_16x16x32_bf16 v[156:159], a[244:247], v[72:75], v[156:159]
    s_waitcnt lgkmcnt(4)
    ds_read_b64_tr_b16 v[86:87], v12 offset:4608
    ds_read_b64_tr_b16 v[88:89], v13 offset:4096
    v_mul_f32 v124, v124, v250
    v_mul_f32 v125, v125, v250
    v_mfma_f32_16x16x32_bf16 v[128:131], a[248:251], v[76:79], v[128:131]
    buffer_load_dwordx4 v7, s[12:15], s32 offen offset:1024 lds
    ds_read_b64_tr_b16 v[90:91], v13 offset:4608
    v_mul_f32 v126, v126, v250
    v_mul_f32 v127, v127, v250
    v_mfma_f32_16x16x32_bf16 v[132:135], a[252:255], v[76:79], v[132:135]
    s_waitcnt lgkmcnt(4)
    s_add_u32 m0, s34, 49152
    s_add_u32 s32, s31, 640
    ds_read_b64_tr_b16 v[60:61], v10 offset:8192
    v_cvt_pk_bf16_f32 v116, v116, v117
    v_cvt_pk_bf16_f32 v117, v118, v119
    v_mfma_f32_16x16x32_bf16 v[136:139], a[248:251], v[80:83], v[136:139]
    s_and_b32 s32, s32, 2047
    s_mul_i32 s32, s32, 3072
    ds_read_b64_tr_b16 v[62:63], v10 offset:8704
    v_cvt_pk_bf16_f32 v118, v124, v125
    v_cvt_pk_bf16_f32 v119, v126, v127
    v_mfma_f32_16x16x32_bf16 v[140:143], a[252:255], v[80:83], v[140:143]
    s_waitcnt lgkmcnt(4)
    ds_write_b128 v19, v[116:119] offset:2048
    v_mul_f32 v240, v240, v251
    v_mul_f32 v241, v241, v251
    v_mfma_f32_16x16x32_bf16 v[144:147], a[248:251], v[84:87], v[144:147]
    buffer_load_dwordx4 v6, s[12:15], s32 offen offset:0 lds
    ds_read_b64_tr_b16 v[64:65], v11 offset:8192
    v_mul_f32 v242, v242, v251
    v_mul_f32 v243, v243, v251
    v_mfma_f32_16x16x32_bf16 v[148:151], a[252:255], v[84:87], v[148:151]
    s_waitcnt lgkmcnt(4)
    ds_read_b64_tr_b16 v[66:67], v11 offset:8704
    ds_read_b64_tr_b16 v[68:69], v12 offset:8192
    v_mul_f32 v244, v244, v251
    v_mul_f32 v245, v245, v251
    v_mfma_f32_16x16x32_bf16 v[152:155], a[248:251], v[88:91], v[152:155]
    buffer_load_dwordx4 v7, s[12:15], s32 offen offset:1024 lds
    ds_read_b64_tr_b16 v[70:71], v12 offset:8704
    v_mul_f32 v246, v246, v251
    v_mul_f32 v247, v247, v251
    v_cvt_pk_bf16_f32 v124, v240, v241
    v_cvt_pk_bf16_f32 v125, v242, v243
    v_cvt_pk_bf16_f32 v126, v244, v245
    v_cvt_pk_bf16_f32 v127, v246, v247
    ds_write_b128 v9, v[124:127] offset:2048
    v_mfma_f32_16x16x32_bf16 v[156:159], a[252:255], v[88:91], v[156:159]
    s_waitcnt lgkmcnt(6)
    s_add_u32 m0, s34, 57344
    s_add_u32 s32, s31, 768
    ds_read_b64_tr_b16 v[72:73], v13 offset:8192
    v_mfma_f32_16x16x32_bf16 v[96:99], v[60:63], a[0:3], 0
    s_and_b32 s32, s32, 2047
    s_mul_i32 s32, s32, 3072
    ds_read_b64_tr_b16 v[74:75], v13 offset:8704
    v_mfma_f32_16x16x32_bf16 v[100:103], v[60:63], a[4:7], 0
    buffer_load_dwordx4 v6, s[12:15], s32 offen offset:0 lds
    ds_read_b64_tr_b16 v[76:77], v10 offset:12288
    v_mfma_f32_16x16x32_bf16 v[44:47], v[60:63], v[32:35], 0
    s_waitcnt lgkmcnt(6)
    ds_read_b64_tr_b16 v[78:79], v10 offset:12800
    ds_read_b64_tr_b16 v[80:81], v11 offset:12288
    v_mfma_f32_16x16x32_bf16 v[104:107], v[64:67], a[0:3], 0
    v_fma_f32 v128, -v192, v48, v128
    v_lshl_add_u32 v42, v26, 4, v15
    v_fma_f32 v129, -v194, v48, v129
    v_fma_f32 v130, -v196, v48, v130
    v_fma_f32 v131, -v198, v48, v131
    v_mul_f32 v128, v128, v193
    v_mul_f32 v129, v129, v195
    v_mul_f32 v130, v130, v197
    v_mfma_f32_16x16x32_bf16 v[108:111], v[64:67], a[4:7], 0
    s_waitcnt lgkmcnt(5)
    ds_read_b64_tr_b16 v[82:83], v11 offset:12800
    ds_read_b64_tr_b16 v[84:85], v12 offset:12288
    v_mul_f32 v131, v131, v199
    v_cvt_pk_bf16_f32 v128, v128, v129
    v_cvt_pk_bf16_f32 v129, v130, v131
    v_fma_f32 v132, -v200, v48, v132
    v_fma_f32 v133, -v202, v48, v133
    v_mfma_f32_16x16x32_bf16 v[112:115], v[68:71], a[0:3], 0
    buffer_load_dwordx4 v7, s[12:15], s32 offen offset:1024 lds
    ds_read_b64_tr_b16 v[86:87], v12 offset:12800
    v_fma_f32 v134, -v204, v48, v134
    v_fma_f32 v135, -v206, v48, v135
    v_mul_f32 v132, v132, v201
    v_mul_f32 v133, v133, v203
    v_mul_f32 v134, v134, v205
    v_mfma_f32_16x16x32_bf16 v[116:119], v[68:71], a[4:7], 0
    s_waitcnt lgkmcnt(6)
    s_add_u32 m0, s34, 65536
    s_add_u32 s32, s31, 896
    ds_read_b64_tr_b16 v[88:89], v13 offset:12288
    v_mul_f32 v135, v135, v207
    v_cvt_pk_bf16_f32 v130, v132, v133
    v_cvt_pk_bf16_f32 v131, v134, v135
    v_xor_b32 v8, 0, v21
    v_mfma_f32_16x16x32_bf16 v[120:123], v[72:75], a[0:3], 0
    ds_write_b128 v8, v[128:131]
    ds_read_b64_tr_b16 v[90:91], v13 offset:12800
    v_fma_f32 v136, -v192, v49, v136
    v_fma_f32 v137, -v194, v49, v137
    v_fma_f32 v138, -v196, v49, v138
    v_fma_f32 v139, -v198, v49, v139
    v_mul_f32 v136, v136, v193
    v_mfma_f32_16x16x32_bf16 v[124:127], v[72:75], a[4:7], 0
    s_waitcnt lgkmcnt(6)
    s_and_b32 s32, s32, 2047
    s_mul_i32 s32, s32, 3072
    v_mul_f32 v137, v137, v195
    v_mul_f32 v138, v138, v197
    v_mul_f32 v139, v139, v199
    v_cvt_pk_bf16_f32 v136, v136, v137
    v_cvt_pk_bf16_f32 v137, v138, v139
    v_fma_f32 v140, -v200, v49, v140
    v_mfma_f32_16x16x32_bf16 v[96:99], v[76:79], a[8:11], v[96:99]
    buffer_load_dwordx4 v6, s[12:15], s32 offen offset:0 lds
    ds_read_b64_tr_b16 v[60:61], v10 offset:16384
    v_fma_f32 v141, -v202, v49, v141
    v_fma_f32 v142, -v204, v49, v142
    v_fma_f32 v143, -v206, v49, v143
    v_mul_f32 v140, v140, v201
    v_mul_f32 v141, v141, v203
    v_mfma_f32_16x16x32_bf16 v[100:103], v[76:79], a[12:15], v[100:103]
    ds_read_b64_tr_b16 v[62:63], v10 offset:16896
    v_lshlrev_b32 v15, 4, v26
    v_mul_f32 v142, v142, v205
    v_mul_f32 v143, v143, v207
    v_cvt_pk_bf16_f32 v138, v140, v141
    v_cvt_pk_bf16_f32 v139, v142, v143
    v_xor_b32 v9, 1024, v21
    v_mfma_f32_16x16x32_bf16 v[44:47], v[76:79], v[32:35], v[44:47]
    s_waitcnt lgkmcnt(5)
    ds_write_b128 v9, v[136:139]
    v_fma_f32 v144, -v192, v50, v144
    v_fma_f32 v145, -v194, v50, v145
    v_fma_f32 v146, -v196, v50, v146
    v_fma_f32 v147, -v198, v50, v147
    v_mul_f32 v144, v144, v193
    v_mfma_f32_16x16x32_bf16 v[104:107], v[80:83], a[8:11], v[104:107]
    buffer_load_dwordx4 v7, s[12:15], s32 offen offset:1024 lds
    ds_read_b64_tr_b16 v[64:65], v11 offset:16384
    v_mul_f32 v145, v145, v195
    v_mul_f32 v146, v146, v197
    v_mul_f32 v147, v147, v199
    v_cvt_pk_bf16_f32 v144, v144, v145
    v_cvt_pk_bf16_f32 v145, v146, v147
    v_mfma_f32_16x16x32_bf16 v[108:111], v[80:83], a[12:15], v[108:111]
    s_add_u32 m0, s34, 73728
    s_add_u32 s32, s31, 1024
    s_and_b32 s32, s32, 2047
    ds_read_b64_tr_b16 v[66:67], v11 offset:16896
    v_fma_f32 v148, -v200, v50, v148
    v_fma_f32 v149, -v202, v50, v149
    v_fma_f32 v150, -v204, v50, v150
    v_fma_f32 v151, -v206, v50, v151
    v_mul_f32 v148, v148, v201
    v_mfma_f32_16x16x32_bf16 v[112:115], v[84:87], a[8:11], v[112:115]
    s_mul_i32 s32, s32, 3072
    ds_read_b64_tr_b16 v[68:69], v12 offset:16384
    ds_read_b64_tr_b16 v[70:71], v12 offset:16896
    v_mul_f32 v149, v149, v203
    v_mul_f32 v150, v150, v205
    v_mul_f32 v151, v151, v207
    v_cvt_pk_bf16_f32 v146, v148, v149
    v_cvt_pk_bf16_f32 v147, v150, v151
    v_mfma_f32_16x16x32_bf16 v[116:119], v[84:87], a[12:15], v[116:119]
    s_waitcnt lgkmcnt(6)
    ds_read_b64_tr_b16 v[72:73], v13 offset:16384
    ds_read_b64_tr_b16 v[74:75], v13 offset:16896
    v_xor_b32 v8, 2048, v21
    v_mfma_f32_16x16x32_bf16 v[120:123], v[88:91], a[8:11], v[120:123]
    buffer_load_dwordx4 v6, s[12:15], s32 offen offset:0 lds
    ds_write_b128 v8, v[144:147]
    v_fma_f32 v152, -v192, v51, v152
    v_fma_f32 v153, -v194, v51, v153
    v_fma_f32 v154, -v196, v51, v154
    v_mfma_f32_16x16x32_bf16 v[124:127], v[88:91], a[12:15], v[124:127]
    s_waitcnt lgkmcnt(7)
    ds_read_b64_tr_b16 v[76:77], v10 offset:20480
    v_fma_f32 v155, -v198, v51, v155
    v_mul_f32 v152, v152, v193
    v_mul_f32 v153, v153, v195
    v_mul_f32 v154, v154, v197
    v_mul_f32 v155, v155, v199
    v_cvt_pk_bf16_f32 v152, v152, v153
    v_cvt_pk_bf16_f32 v153, v154, v155
    v_mfma_f32_16x16x32_bf16 v[96:99], v[60:63], a[16:19], v[96:99]
    ds_read_b64_tr_b16 v[78:79], v10 offset:20992
    v_fma_f32 v156, -v200, v51, v156
    v_fma_f32 v157, -v202, v51, v157
    v_fma_f32 v158, -v204, v51, v158
    v_fma_f32 v159, -v206, v51, v159
    v_mul_f32 v156, v156, v201
    v_mul_f32 v157, v157, v203
    v_mul_f32 v158, v158, v205
    v_mfma_f32_16x16x32_bf16 v[100:103], v[60:63], a[20:23], v[100:103]
    buffer_load_dwordx4 v7, s[12:15], s32 offen offset:1024 lds
    v_mul_f32 v159, v159, v207
    v_cvt_pk_bf16_f32 v154, v156, v157
    v_cvt_pk_bf16_f32 v155, v158, v159
    v_xor_b32 v9, 3072, v21
    v_mfma_f32_16x16x32_bf16 v[44:47], v[60:63], v[32:35], v[44:47]
    s_waitcnt vmcnt(10) lgkmcnt(5)
    s_barrier
    ds_write_b128 v9, v[152:155]
    s_waitcnt lgkmcnt(0)
    s_barrier
    ds_read_b128 v[128:131], v20 offset:0
    v_mfma_f32_16x16x32_bf16 v[104:107], v[64:67], a[16:19], v[104:107]
    s_add_u32 m0, s34, 81920
    s_add_u32 s32, s31, 1152
    s_and_b32 s32, s32, 2047
    ds_read_b128 v[132:135], v20 offset:1024
    ds_read_b64_tr_b16 v[208:209], v17 offset:0
    ds_read_b64_tr_b16 v[210:211], v17 offset:2048
    v_mfma_f32_16x16x32_bf16 v[108:111], v[64:67], a[20:23], v[108:111]
    s_mul_i32 s32, s32, 3072
    ds_read_b64_tr_b16 v[212:213], v17 offset:8
    ds_read_b64_tr_b16 v[214:215], v17 offset:2056
    ds_read_b128 v[136:139], v20 offset:4096
    ds_read_b128 v[140:143], v20 offset:5120
    v_mfma_f32_16x16x32_bf16 v[112:115], v[68:71], a[16:19], v[112:115]
    buffer_load_dwordx4 v6, s[12:15], s32 offen offset:0 lds
    ds_read_b64_tr_b16 v[216:217], v17 offset:4096
    ds_read_b64_tr_b16 v[218:219], v17 offset:6144
    ds_read_b64_tr_b16 v[220:221], v17 offset:4104
    v_mfma_f32_16x16x32_bf16 v[116:119], v[68:71], a[20:23], v[116:119]
    ds_read_b64_tr_b16 v[222:223], v17 offset:6152
    ds_read_b128 v[144:147], v20 offset:8192
    ds_read_b128 v[148:151], v20 offset:9216
    ds_read_b64_tr_b16 v[224:225], v17 offset:8192
    v_mfma_f32_16x16x32_bf16 v[120:123], v[72:75], a[16:19], v[120:123]
    ds_read_b64_tr_b16 v[226:227], v17 offset:10240
    ds_read_b64_tr_b16 v[228:229], v17 offset:8200
    ds_read_b64_tr_b16 v[230:231], v17 offset:10248
    ds_read_b128 v[152:155], v20 offset:12288
    v_mfma_f32_16x16x32_bf16 v[124:127], v[72:75], a[20:23], v[124:127]
    buffer_load_dwordx4 v7, s[12:15], s32 offen offset:1024 lds
    ds_read_b128 v[156:159], v20 offset:13312
    ds_read_b64_tr_b16 v[232:233], v17 offset:12288
    ds_read_b64_tr_b16 v[234:235], v17 offset:14336
    v_mfma_f32_16x16x32_bf16 v[96:99], v[76:79], a[24:27], v[96:99]
    s_add_u32 m0, s34, 90112
    s_add_u32 s32, s31, 1280
    s_and_b32 s32, s32, 2047
    ds_read_b64_tr_b16 v[236:237], v17 offset:12296
    ds_read_b64_tr_b16 v[238:239], v17 offset:14344
    ds_read_b64_tr_b16 v[80:81], v11 offset:20480
    ds_read_b64_tr_b16 v[82:83], v11 offset:20992
    s_waitcnt lgkmcnt(15)
    v_mfma_f32_16x16x32_bf16 v[160:163], v[208:211], v[128:131], 0
    s_mul_i32 s32, s32, 3072
    ds_read_b64_tr_b16 v[84:85], v12 offset:20480
    ds_read_b64_tr_b16 v[86:87], v12 offset:20992
    v_mfma_f32_16x16x32_bf16 v[164:167], v[208:211], v[132:135], 0
    buffer_load_dwordx4 v6, s[12:15], s32 offen offset:0 lds
    ds_read_b64_tr_b16 v[88:89], v13 offset:20480
    v_mfma_f32_16x16x32_bf16 v[240:243], v[208:211], v[32:35], 0
    ds_read_b64_tr_b16 v[90:91], v13 offset:20992
    ds_read_b64_tr_b16 v[60:61], v10 offset:24576
    v_mfma_f32_16x16x32_bf16 v[168:171], v[212:215], v[128:131], 0
    ds_read_b64_tr_b16 v[62:63], v10 offset:25088
    v_mfma_f32_16x16x32_bf16 v[100:103], v[76:79], a[28:31], v[100:103]
    ds_read_b64_tr_b16 v[64:65], v11 offset:24576
    v_mfma_f32_16x16x32_bf16 v[172:175], v[212:215], v[132:135], 0
    ds_read_b64_tr_b16 v[66:67], v11 offset:25088
    v_mfma_f32_16x16x32_bf16 v[244:247], v[212:215], v[32:35], 0
    ds_read_b64_tr_b16 v[68:69], v12 offset:24576
    v_mfma_f32_16x16x32_bf16 v[160:163], v[216:219], v[136:139], v[160:163]
    buffer_load_dwordx4 v7, s[12:15], s32 offen offset:1024 lds
    v_mfma_f32_16x16x32_bf16 v[164:167], v[216:219], v[140:143], v[164:167]
    s_add_u32 m0, s34, 98304
    s_add_u32 s32, s31, 1408
    s_and_b32 s32, s32, 2047
    v_mfma_f32_16x16x32_bf16 v[44:47], v[76:79], v[32:35], v[44:47]
    s_waitcnt lgkmcnt(9)
    s_mul_i32 s32, s32, 3072
    ds_read_b64_tr_b16 v[70:71], v12 offset:25088
    v_mfma_f32_16x16x32_bf16 v[240:243], v[216:219], v[32:35], v[240:243]
    ds_read_b64_tr_b16 v[72:73], v13 offset:24576
    v_mfma_f32_16x16x32_bf16 v[168:171], v[220:223], v[136:139], v[168:171]
    ds_read_b64_tr_b16 v[74:75], v13 offset:25088
    v_mfma_f32_16x16x32_bf16 v[172:175], v[220:223], v[140:143], v[172:175]
    v_mfma_f32_16x16x32_bf16 v[244:247], v[220:223], v[32:35], v[244:247]
    buffer_load_dwordx4 v6, s[12:15], s32 offen offset:0 lds
    v_mfma_f32_16x16x32_bf16 v[104:107], v[80:83], a[24:27], v[104:107]
    ds_read_b64_tr_b16 v[76:77], v10 offset:28672
    v_mfma_f32_16x16x32_bf16 v[160:163], v[224:227], v[144:147], v[160:163]
    ds_read_b64_tr_b16 v[78:79], v10 offset:29184
    v_mfma_f32_16x16x32_bf16 v[164:167], v[224:227], v[148:151], v[164:167]
    v_mfma_f32_16x16x32_bf16 v[240:243], v[224:227], v[32:35], v[240:243]
    v_mfma_f32_16x16x32_bf16 v[168:171], v[228:231], v[144:147], v[168:171]
    v_mfma_f32_16x16x32_bf16 v[108:111], v[80:83], a[28:31], v[108:111]
    s_waitcnt lgkmcnt(12)
    v_mfma_f32_16x16x32_bf16 v[172:175], v[228:231], v[148:151], v[172:175]
    buffer_load_dwordx4 v7, s[12:15], s32 offen offset:1024 lds
    v_mfma_f32_16x16x32_bf16 v[244:247], v[228:231], v[32:35], v[244:247]
    s_add_u32 m0, s34, 0
    s_add_u32 s32, s31, 1536
    s_and_b32 s32, s32, 2047
    v_mfma_f32_16x16x32_bf16 v[160:163], v[232:235], v[152:155], v[160:163]
    s_mul_i32 s32, s32, 3072
    v_mfma_f32_16x16x32_bf16 v[164:167], v[232:235], v[156:159], v[164:167]
    v_mfma_f32_16x16x32_bf16 v[112:115], v[84:87], a[24:27], v[112:115]
    ds_read_b64_tr_b16 v[80:81], v11 offset:28672
    v_mfma_f32_16x16x32_bf16 v[240:243], v[232:235], v[32:35], v[240:243]
    ds_read_b64_tr_b16 v[82:83], v11 offset:29184
    v_mfma_f32_16x16x32_bf16 v[168:171], v[236:239], v[152:155], v[168:171]
    buffer_load_dwordx4 v6, s[12:15], s32 offen offset:0 lds
    v_mfma_f32_16x16x32_bf16 v[172:175], v[236:239], v[156:159], v[172:175]
    v_mfma_f32_16x16x32_bf16 v[244:247], v[236:239], v[32:35], v[244:247]
    v_mfma_f32_16x16x32_bf16 v[116:119], v[84:87], a[28:31], v[116:119]
    s_waitcnt lgkmcnt(10)
    v_mfma_f32_16x16x32_bf16 v[120:123], v[88:91], a[24:27], v[120:123]
    ds_read_b64_tr_b16 v[84:85], v12 offset:28672
    v_mfma_f32_16x16x32_bf16 v[124:127], v[88:91], a[28:31], v[124:127]
    ds_read_b64_tr_b16 v[86:87], v12 offset:29184
    v_cvt_pk_bf16_f32 v208, v160, v161
    v_cvt_pk_bf16_f32 v209, v162, v163
    v_cvt_pk_bf16_f32 v210, v168, v169
    v_cvt_pk_bf16_f32 v211, v170, v171
    v_mfma_f32_16x16x32_bf16 v[96:99], v[60:63], a[32:35], v[96:99]
    buffer_load_dwordx4 v7, s[12:15], s32 offen offset:1024 lds
    buffer_store_dwordx4 v[208:211], v1, s[36:39], s78 offen offset:0 sc1
    v_cvt_pk_bf16_f32 v212, v164, v165
    v_cvt_pk_bf16_f32 v213, v166, v167
    v_cvt_pk_bf16_f32 v214, v172, v173
    v_mfma_f32_16x16x32_bf16 v[100:103], v[60:63], a[36:39], v[100:103]
    s_add_u32 m0, s34, 8192
    s_add_u32 s32, s31, 1664
    s_and_b32 s32, s32, 2047
    v_cvt_pk_bf16_f32 v215, v174, v175
    v_mfma_f32_16x16x32_bf16 v[44:47], v[60:63], v[32:35], v[44:47]
    s_waitcnt lgkmcnt(2)
    buffer_store_dwordx4 v[212:215], v1, s[36:39], s78 offen offset:1024 sc1
    v_cvt_pk_bf16_f32 v216, v240, v241
    v_cvt_pk_bf16_f32 v217, v242, v243
    v_cvt_pk_bf16_f32 v218, v244, v245
    v_cvt_pk_bf16_f32 v219, v246, v247
    v_mfma_f32_16x16x32_bf16 v[104:107], v[64:67], a[32:35], v[104:107]
    buffer_store_dwordx4 v[216:219], v15, s[36:39], s79 offen sc1
    s_lshl_b32 s48, s29, 5
    v_add_u32 v43, s48, v29
    v_mfma_f32_16x16x32_bf16 v[108:111], v[64:67], a[36:39], v[108:111]
    s_mul_i32 s32, s32, 3072
    ds_read_b64_tr_b16 v[88:89], v13 offset:28672
    v_lshlrev_b32 v25, 11, v43
    v_lshl_add_u32 v25, v27, 5, v25
    v_lshrrev_b32 v24, 5, v0
    v_mfma_f32_16x16x32_bf16 v[112:115], v[68:71], a[32:35], v[112:115]
    ds_read_b64_tr_b16 v[90:91], v13 offset:29184
    v_lshl_add_u32 v25, v24, 4, v25
    s_lshl_b32 s48, s27, 7
    s_add_u32 s49, s48, 32768
    v_mfma_f32_16x16x32_bf16 v[116:119], v[68:71], a[36:39], v[116:119]
    buffer_load_dwordx4 v[144:147], v25, s[8:11], s48 offen offset:0
    v_mfma_f32_16x16x32_bf16 v[120:123], v[72:75], a[32:35], v[120:123]
    buffer_load_dwordx4 v[148:151], v25, s[8:11], s48 offen offset:64
    v_mfma_f32_16x16x32_bf16 v[124:127], v[72:75], a[36:39], v[124:127]
    buffer_load_dwordx4 v[152:155], v25, s[8:11], s49 offen offset:0
    v_mfma_f32_16x16x32_bf16 v[96:99], v[76:79], a[40:43], v[96:99]
    buffer_load_dwordx4 v[156:159], v25, s[8:11], s49 offen offset:64
    s_mul_i32 s48, s64, 6144
    s_add_u32 s49, s48, 147456
    v_mfma_f32_16x16x32_bf16 v[100:103], v[76:79], a[44:47], v[100:103]
    s_sub_u32 s48, 153600, s48
    ds_read_b64_tr_b16 v[60:61], v10 offset:32768
    ds_read_b64_tr_b16 v[62:63], v10 offset:33280
    v_add_u32 v18, s49, v1
    v_mfma_f32_16x16x32_bf16 v[44:47], v[76:79], v[32:35], v[44:47]
    ds_read_b64_tr_b16 v[64:65], v11 offset:32768
    ds_read_b64_tr_b16 v[66:67], v11 offset:33280
    v_add_u32 v19, s48, v1
    v_mfma_f32_16x16x32_bf16 v[104:107], v[80:83], a[40:43], v[104:107]
    s_lshl_b32 s48, s65, 10
    ds_read_b64_tr_b16 v[68:69], v12 offset:32768
    v_add_u32 v17, s48, v18
    v_bfe_u32 v24, v0, 3, 1
    v_lshlrev_b32 v20, 4, v31
    v_mfma_f32_16x16x32_bf16 v[108:111], v[80:83], a[44:47], v[108:111]
    s_waitcnt lgkmcnt(5)
    ds_read_b64_tr_b16 v[70:71], v12 offset:33280
    v_lshl_add_u32 v20, v24, 6, v20
    v_bfe_u32 v24, v0, 2, 1
    v_lshl_add_u32 v20, v24, 3, v20
    v_mfma_f32_16x16x32_bf16 v[112:115], v[84:87], a[40:43], v[112:115]
    buffer_load_dwordx4 v6, s[12:15], s32 offen offset:0 lds
    s_lshl_b32 s48, s28, 1
    s_add_u32 s48, s48, 161536
    v_mfma_f32_16x16x32_bf16 v[116:119], v[84:87], a[44:47], v[116:119]
    ds_read_b64_tr_b16 v[72:73], v13 offset:32768
    ds_read_b64_tr_b16 v[74:75], v13 offset:33280
    v_add_u32 v20, s48, v20
    v_mfma_f32_16x16x32_bf16 v[120:123], v[88:91], a[40:43], v[120:123]
    s_lshl_b32 s48, s64, 6
    s_add_u32 s48, s48, 161536
    ds_read_b64_tr_b16 v[76:77], v10 offset:36864
    v_lshl_add_u32 v21, v26, 4, s48
    v_xor_b32 v23, 64, v21
    v_mfma_f32_16x16x32_bf16 v[124:127], v[88:91], a[44:47], v[124:127]
    s_waitcnt lgkmcnt(5)
    s_lshl_b32 s35, s29, 11
    s_add_u32 s35, s35, 8519680
    s_lshl_b32 s25, s27, 7
    s_add_u32 s25, s25, s35
    v_mfma_f32_16x16x32_bf16 v[96:99], v[60:63], a[48:51], v[96:99]
    buffer_load_dwordx4 v7, s[12:15], s32 offen offset:1024 lds
    s_mul_i32 s57, s26, 10240
    s_add_u32 s57, s57, 8912896
    v_mfma_f32_16x16x32_bf16 v[100:103], v[60:63], a[52:55], v[100:103]
    s_add_u32 m0, s34, 16384
    s_add_u32 s32, s31, 1792
    s_and_b32 s32, s32, 2047
    s_mul_i32 s56, s27, 640
    s_add_u32 s56, s56, s57
    v_mfma_f32_16x16x32_bf16 v[44:47], v[60:63], v[32:35], v[44:47]
    s_waitcnt vmcnt(23) lgkmcnt(3)
    s_barrier
    s_mul_i32 s32, s32, 3072
    s_lshl_b32 s24, s29, 16
    s_lshl_b32 s48, s27, 12
    v_mfma_f32_16x16x32_bf16 v[104:107], v[64:67], a[48:51], v[104:107]
    s_add_u32 s48, s48, s24
    s_lshl_b32 s49, s64, 11
    s_add_u32 s48, s48, s49
    s_xor_b32 s49, s48, 2048
    s_lshr_b32 s58, s29, 1
    v_mfma_f32_16x16x32_bf16 v[108:111], v[64:67], a[52:55], v[108:111]
    buffer_load_dwordx4 v6, s[12:15], s32 offen offset:0 lds
    s_lshl_b32 s58, s58, 17
    s_lshl_b32 s59, s27, 13
    v_mfma_f32_16x16x32_bf16 v[112:115], v[68:71], a[48:51], v[112:115]
    s_add_u32 s58, s58, s59
    s_and_b32 s59, s29, 1
    s_lshl_b32 s59, s59, 11
    s_add_u32 s58, s58, s59
    s_add_u32 s58, s58, 4194304
    v_mfma_f32_16x16x32_bf16 v[116:119], v[68:71], a[52:55], v[116:119]
    s_waitcnt lgkmcnt(0)
    s_add_u32 s59, s58, 4096
    ds_read_b64_tr_b16 v[78:79], v10 offset:37376
    v_lshlrev_b32 v43, 2, v43
    s_mov_b32 s53, 24576
    v_mfma_f32_16x16x32_bf16 v[120:123], v[72:75], a[48:51], v[120:123]
    s_mov_b32 s52, s27
    ds_read_b64_tr_b16 v[80:81], v11 offset:36864
    ds_read_b64_tr_b16 v[82:83], v11 offset:37376
    v_mul_u32_u24 v28, 640, v29
    v_mfma_f32_16x16x32_bf16 v[124:127], v[72:75], a[52:55], v[124:127]
    s_waitcnt lgkmcnt(2)
    ds_read_b64_tr_b16 v[84:85], v12 offset:36864
    ds_read_b64_tr_b16 v[86:87], v12 offset:37376
    v_mfma_f32_16x16x32_bf16 v[96:99], v[76:79], a[56:59], v[96:99]
    buffer_load_dwordx4 v7, s[12:15], s32 offen offset:1024 lds
    ds_read_b64_tr_b16 v[88:89], v13 offset:36864
    v_mfma_f32_16x16x32_bf16 v[100:103], v[76:79], a[60:63], v[100:103]
    s_add_u32 m0, s34, 24576
    s_add_u32 s32, s31, 1920
    s_and_b32 s32, s32, 2047
    ds_read_b64_tr_b16 v[90:91], v13 offset:37376
    v_mfma_f32_16x16x32_bf16 v[44:47], v[76:79], v[32:35], v[44:47]
    s_waitcnt lgkmcnt(4)
    s_mul_i32 s32, s32, 3072
    ds_read_b64_tr_b16 v[60:61], v10 offset:40960
    v_mfma_f32_16x16x32_bf16 v[104:107], v[80:83], a[56:59], v[104:107]
    ds_read_b64_tr_b16 v[62:63], v10 offset:41472
    ds_read_b64_tr_b16 v[64:65], v11 offset:40960
    v_mfma_f32_16x16x32_bf16 v[108:111], v[80:83], a[60:63], v[108:111]
    s_waitcnt lgkmcnt(5)
    ds_read_b64_tr_b16 v[66:67], v11 offset:41472
    ds_read_b64_tr_b16 v[68:69], v12 offset:40960
    v_mfma_f32_16x16x32_bf16 v[112:115], v[84:87], a[56:59], v[112:115]
    buffer_load_dwordx4 v6, s[12:15], s32 offen offset:0 lds
    ds_read_b64_tr_b16 v[70:71], v12 offset:41472
    v_mfma_f32_16x16x32_bf16 v[116:119], v[84:87], a[60:63], v[116:119]
    s_waitcnt lgkmcnt(6)
    ds_read_b64_tr_b16 v[72:73], v13 offset:40960
    ds_read_b64_tr_b16 v[74:75], v13 offset:41472
    v_mfma_f32_16x16x32_bf16 v[120:123], v[88:91], a[56:59], v[120:123]
    ds_read_b64_tr_b16 v[76:77], v10 offset:45056
    v_lshrrev_b32 v30, 3, v0
    v_mfma_f32_16x16x32_bf16 v[124:127], v[88:91], a[60:63], v[124:127]
    s_waitcnt lgkmcnt(7)
    v_and_b32 v16, 0x70, v1
    v_lshl_add_u32 v30, v30, 11, v16
    v_mfma_f32_16x16x32_bf16 v[96:99], v[60:63], a[64:67], v[96:99]
    s_add_u32 s89, s50, 16384
    ds_read_b64_tr_b16 v[78:79], v10 offset:45568
    v_lshl_add_u32 v16, v26, 2, v16
    v_mfma_f32_16x16x32_bf16 v[100:103], v[60:63], a[68:71], v[100:103]
    ds_read_b64_tr_b16 v[80:81], v11 offset:45056
    v_mfma_f32_16x16x32_bf16 v[44:47], v[60:63], v[32:35], v[44:47]
    s_waitcnt lgkmcnt(5)
    ds_read_b64_tr_b16 v[82:83], v11 offset:45568
    v_mfma_f32_16x16x32_bf16 v[104:107], v[64:67], a[64:67], v[104:107]
    buffer_load_dwordx4 v7, s[12:15], s32 offen offset:1024 lds
    v_mfma_f32_16x16x32_bf16 v[108:111], v[64:67], a[68:71], v[108:111]
    ds_read_b64_tr_b16 v[84:85], v12 offset:45056
    ds_read_b64_tr_b16 v[86:87], v12 offset:45568
    v_mfma_f32_16x16x32_bf16 v[112:115], v[68:71], a[64:67], v[112:115]
    ds_read_b64_tr_b16 v[88:89], v13 offset:45056
    v_lshrrev_b32 v2, 3, v0
    v_mfma_f32_16x16x32_bf16 v[116:119], v[68:71], a[68:71], v[116:119]
    s_waitcnt lgkmcnt(5)
    ds_read_b64_tr_b16 v[90:91], v13 offset:45568
    v_and_b32 v3, 7, v0
    v_mfma_f32_16x16x32_bf16 v[120:123], v[72:75], a[64:67], v[120:123]
    ds_read_b64_tr_b16 v[60:61], v10 offset:49152
    v_lshlrev_b32 v4, 1, v26
    v_mfma_f32_16x16x32_bf16 v[124:127], v[72:75], a[68:71], v[124:127]
    ds_read_b64_tr_b16 v[62:63], v10 offset:49664
    v_xor_b32 v3, v3, v4
    v_mfma_f32_16x16x32_bf16 v[96:99], v[76:79], a[72:75], v[96:99]
    ds_read_b64_tr_b16 v[64:65], v11 offset:49152
    v_lshlrev_b32 v2, 11, v2
    v_mfma_f32_16x16x32_bf16 v[100:103], v[76:79], a[76:79], v[100:103]
    ds_read_b64_tr_b16 v[66:67], v11 offset:49664
    v_lshl_add_u32 v2, v3, 4, v2
    v_mfma_f32_16x16x32_bf16 v[44:47], v[76:79], v[32:35], v[44:47]
    s_waitcnt lgkmcnt(5)
    ds_read_b64_tr_b16 v[68:69], v12 offset:49152
    v_add_u32 v3, 15360, v2
    v_mfma_f32_16x16x32_bf16 v[104:107], v[80:83], a[72:75], v[104:107]
    ds_read_b64_tr_b16 v[70:71], v12 offset:49664
    v_add_u32 v4, 30720, v2
    v_mfma_f32_16x16x32_bf16 v[108:111], v[80:83], a[76:79], v[108:111]
    ds_read_b64_tr_b16 v[72:73], v13 offset:49152
    v_add_u32 v5, 46080, v2
    v_mfma_f32_16x16x32_bf16 v[112:115], v[84:87], a[72:75], v[112:115]
    s_lshl_b32 s33, s28, 12
    s_lshl_b32 s30, s28, 16
    s_lshl_b32 s31, s27, 7
    v_mfma_f32_16x16x32_bf16 v[116:119], v[84:87], a[76:79], v[116:119]
    s_waitcnt lgkmcnt(4)
    s_add_u32 s30, s30, s31
    s_add_u32 m0, s33, 114688
    ds_read_b64_tr_b16 v[74:75], v13 offset:49664
    v_mfma_f32_16x16x32_bf16 v[120:123], v[88:91], a[72:75], v[120:123]
    s_add_u32 s32, s30, 786432
    ds_read_b64_tr_b16 v[76:77], v10 offset:53248
    v_mfma_f32_16x16x32_bf16 v[124:127], v[88:91], a[76:79], v[124:127]
    buffer_load_dwordx4 v2, s[16:19], s32 offen offset:0 lds
    v_mfma_f32_16x16x32_bf16 v[96:99], v[60:63], a[80:83], v[96:99]
    ds_read_b64_tr_b16 v[78:79], v10 offset:53760
    v_mfma_f32_16x16x32_bf16 v[100:103], v[60:63], a[84:87], v[100:103]
    ds_read_b64_tr_b16 v[80:81], v11 offset:53248
    v_mfma_f32_16x16x32_bf16 v[44:47], v[60:63], v[32:35], v[44:47]
    s_waitcnt vmcnt(24) lgkmcnt(4)
    s_barrier
    ds_read_b64_tr_b16 v[82:83], v11 offset:53760
    v_mfma_f32_16x16x32_bf16 v[104:107], v[64:67], a[80:83], v[104:107]
    ds_read_b64_tr_b16 v[84:85], v12 offset:53248
    v_mfma_f32_16x16x32_bf16 v[108:111], v[64:67], a[84:87], v[108:111]
    ds_read_b64_tr_b16 v[86:87], v12 offset:53760
    v_mfma_f32_16x16x32_bf16 v[112:115], v[68:71], a[80:83], v[112:115]
    buffer_load_dwordx4 v3, s[16:19], s32 offen offset:1024 lds
    v_mfma_f32_16x16x32_bf16 v[116:119], v[68:71], a[84:87], v[116:119]
    s_waitcnt lgkmcnt(4)
    ds_read_b64_tr_b16 v[88:89], v13 offset:53248
    ds_read_b64_tr_b16 v[90:91], v13 offset:53760
    v_mfma_f32_16x16x32_bf16 v[120:123], v[72:75], a[80:83], v[120:123]
    buffer_load_dwordx4 v[232:235], v30, s[36:39], s50 offen sc1
    buffer_load_dwordx4 v[236:239], v30, s[36:39], s89 offen sc1
    buffer_load_dwordx4 v[48:51], v42, s[36:39], s51 offen sc1
    v_mfma_f32_16x16x32_bf16 v[124:127], v[72:75], a[84:87], v[124:127]
    ds_read_b64_tr_b16 v[60:61], v10 offset:57344
    v_mfma_f32_16x16x32_bf16 v[96:99], v[76:79], a[88:91], v[96:99]
    ds_read_b64_tr_b16 v[62:63], v10 offset:57856
    v_mfma_f32_16x16x32_bf16 v[100:103], v[76:79], a[92:95], v[100:103]
    ds_read_b64_tr_b16 v[64:65], v11 offset:57344
    v_mfma_f32_16x16x32_bf16 v[44:47], v[76:79], v[32:35], v[44:47]
    s_waitcnt lgkmcnt(5)
    ds_read_b64_tr_b16 v[66:67], v11 offset:57856
    v_mfma_f32_16x16x32_bf16 v[104:107], v[80:83], a[88:91], v[104:107]
    buffer_load_dwordx4 v4, s[16:19], s32 offen offset:2048 lds
    v_mfma_f32_16x16x32_bf16 v[108:111], v[80:83], a[92:95], v[108:111]
    ds_read_b64_tr_b16 v[68:69], v12 offset:57344
    ds_read_b64_tr_b16 v[70:71], v12 offset:57856
    v_mfma_f32_16x16x32_bf16 v[112:115], v[84:87], a[88:91], v[112:115]
    ds_read_b64_tr_b16 v[72:73], v13 offset:57344
    v_mfma_f32_16x16x32_bf16 v[116:119], v[84:87], a[92:95], v[116:119]
    s_waitcnt lgkmcnt(5)
    ds_read_b64_tr_b16 v[74:75], v13 offset:57856
    v_mfma_f32_16x16x32_bf16 v[120:123], v[88:91], a[88:91], v[120:123]
    ds_read_b64_tr_b16 v[76:77], v10 offset:61440
    v_mfma_f32_16x16x32_bf16 v[124:127], v[88:91], a[92:95], v[124:127]
    ds_read_b64_tr_b16 v[78:79], v10 offset:61952
    v_mfma_f32_16x16x32_bf16 v[96:99], v[60:63], a[96:99], v[96:99]
    buffer_load_dwordx4 v5, s[16:19], s32 offen offset:3072 lds
    v_mfma_f32_16x16x32_bf16 v[100:103], v[60:63], a[100:103], v[100:103]
    s_add_u32 m0, s33, 131072
    s_add_u32 s32, s30, 1572864
    ds_read_b64_tr_b16 v[80:81], v11 offset:61440
    v_mfma_f32_16x16x32_bf16 v[44:47], v[60:63], v[32:35], v[44:47]
    s_waitcnt lgkmcnt(4)
    ds_read_b64_tr_b16 v[82:83], v11 offset:61952
    v_mfma_f32_16x16x32_bf16 v[104:107], v[64:67], a[96:99], v[104:107]
    ds_read_b64_tr_b16 v[84:85], v12 offset:61440
    v_mfma_f32_16x16x32_bf16 v[108:111], v[64:67], a[100:103], v[108:111]
    ds_read_b64_tr_b16 v[86:87], v12 offset:61952
    v_mfma_f32_16x16x32_bf16 v[112:115], v[68:71], a[96:99], v[112:115]
    ds_read_b64_tr_b16 v[88:89], v13 offset:61440
    v_mfma_f32_16x16x32_bf16 v[116:119], v[68:71], a[100:103], v[116:119]
    s_waitcnt lgkmcnt(5)
    ds_read_b64_tr_b16 v[90:91], v13 offset:61952
    v_add_u32 v10, 65536, v10
    v_mfma_f32_16x16x32_bf16 v[120:123], v[72:75], a[96:99], v[120:123]
    buffer_load_dwordx4 v2, s[16:19], s32 offen offset:0 lds
    v_mfma_f32_16x16x32_bf16 v[124:127], v[72:75], a[100:103], v[124:127]
    ds_read_b64_tr_b16 v[60:61], v10 offset:0
    v_mfma_f32_16x16x32_bf16 v[96:99], v[76:79], a[104:107], v[96:99]
    ds_read_b64_tr_b16 v[62:63], v10 offset:512
    v_add_u32 v11, 65536, v11
    v_mfma_f32_16x16x32_bf16 v[100:103], v[76:79], a[108:111], v[100:103]
    ds_read_b64_tr_b16 v[64:65], v11 offset:0
    v_mfma_f32_16x16x32_bf16 v[44:47], v[76:79], v[32:35], v[44:47]
    s_waitcnt lgkmcnt(4)
    ds_read_b64_tr_b16 v[66:67], v11 offset:512
    v_add_u32 v12, 65536, v12
    v_mfma_f32_16x16x32_bf16 v[104:107], v[80:83], a[104:107], v[104:107]
    ds_read_b64_tr_b16 v[68:69], v12 offset:0
    v_mfma_f32_16x16x32_bf16 v[108:111], v[80:83], a[108:111], v[108:111]
    buffer_load_dwordx4 v3, s[16:19], s32 offen offset:1024 lds
    ds_read_b64_tr_b16 v[70:71], v12 offset:512
    v_add_u32 v13, 65536, v13
    v_mfma_f32_16x16x32_bf16 v[112:115], v[84:87], a[104:107], v[112:115]
    ds_read_b64_tr_b16 v[72:73], v13 offset:0
    v_mfma_f32_16x16x32_bf16 v[116:119], v[84:87], a[108:111], v[116:119]
    s_waitcnt lgkmcnt(5)
    ds_read_b64_tr_b16 v[74:75], v13 offset:512
    v_mfma_f32_16x16x32_bf16 v[120:123], v[88:91], a[104:107], v[120:123]
    ds_read_b64_tr_b16 v[76:77], v10 offset:4096
    v_mfma_f32_16x16x32_bf16 v[124:127], v[88:91], a[108:111], v[124:127]
    ds_read_b64_tr_b16 v[78:79], v10 offset:4608
    v_mfma_f32_16x16x32_bf16 v[96:99], v[60:63], a[112:115], v[96:99]
    ds_read_b64_tr_b16 v[80:81], v11 offset:4096
    v_mfma_f32_16x16x32_bf16 v[100:103], v[60:63], a[116:119], v[100:103]
    buffer_load_dwordx4 v4, s[16:19], s32 offen offset:2048 lds
    v_mfma_f32_16x16x32_bf16 v[44:47], v[60:63], v[32:35], v[44:47]
    s_waitcnt vmcnt(29) lgkmcnt(4)
    s_barrier
    ds_read_b64_tr_b16 v[82:83], v11 offset:4608
    v_mfma_f32_16x16x32_bf16 v[104:107], v[64:67], a[112:115], v[104:107]
    ds_read_b64_tr_b16 v[84:85], v12 offset:4096
    v_mfma_f32_16x16x32_bf16 v[108:111], v[64:67], a[116:119], v[108:111]
    ds_read_b64_tr_b16 v[86:87], v12 offset:4608
    v_mfma_f32_16x16x32_bf16 v[112:115], v[68:71], a[112:115], v[112:115]
    ds_read_b64_tr_b16 v[88:89], v13 offset:4096
    v_mfma_f32_16x16x32_bf16 v[116:119], v[68:71], a[116:119], v[116:119]
    s_waitcnt lgkmcnt(4)
    ds_read_b64_tr_b16 v[90:91], v13 offset:4608
    v_mfma_f32_16x16x32_bf16 v[120:123], v[72:75], a[112:115], v[120:123]
    buffer_load_dwordx4 v5, s[16:19], s32 offen offset:3072 lds
    v_mfma_f32_16x16x32_bf16 v[124:127], v[72:75], a[116:119], v[124:127]
    s_add_u32 m0, s33, 32768
    s_add_u32 s32, s30, 0
    ds_read_b64_tr_b16 v[60:61], v10 offset:8192
    v_mfma_f32_16x16x32_bf16 v[96:99], v[76:79], a[120:123], v[96:99]
    s_waitcnt vmcnt(6)
    v_max3_u32 v240, v232, v236, v48
    v_cmp_eq_u32 vcc, -1, v240
    v_mfma_f32_16x16x32_bf16 v[100:103], v[76:79], a[124:127], v[100:103]
    s_cbranch_vccnz L_qkv_slow1
L_qkv_back1:
    v_permlane16_swap_b32 v144, v146
    v_lshlrev_b32 v240, 16, v232
    v_and_b32 v241, 0xffff0000, v232
    v_lshlrev_b32 v242, 16, v233
    v_and_b32 v243, 0xffff0000, v233
    v_mfma_f32_16x16x32_bf16 v[44:47], v[76:79], v[32:35], v[44:47]
    s_waitcnt lgkmcnt(2)
    ds_read_b64_tr_b16 v[62:63], v10 offset:8704
    ds_read_b64_tr_b16 v[64:65], v11 offset:8192
    v_lshlrev_b32 v244, 16, v234
    v_and_b32 v245, 0xffff0000, v234
    v_lshlrev_b32 v246, 16, v235
    v_mfma_f32_16x16x32_bf16 v[104:107], v[80:83], a[120:123], v[104:107]
    buffer_load_dwordx4 v2, s[16:19], s32 offen offset:0 lds
    ds_read_b64_tr_b16 v[66:67], v11 offset:8704
    v_and_b32 v247, 0xffff0000, v235
    v_lshlrev_b32 v248, 16, v236
    v_and_b32 v249, 0xffff0000, v236
    v_mfma_f32_16x16x32_bf16 v[108:111], v[80:83], a[124:127], v[108:111]
    ds_read_b64_tr_b16 v[68:69], v12 offset:8192
    ds_read_b64_tr_b16 v[70:71], v12 offset:8704
    v_lshlrev_b32 v250, 16, v237
    v_and_b32 v251, 0xffff0000, v237
    v_lshlrev_b32 v252, 16, v238
    v_mfma_f32_16x16x32_bf16 v[112:115], v[84:87], a[120:123], v[112:115]
    ds_read_b64_tr_b16 v[72:73], v13 offset:8192
    v_and_b32 v253, 0xffff0000, v238
    v_lshlrev_b32 v254, 16, v239
    v_and_b32 v255, 0xffff0000, v239
    v_add_f32 v240, v240, v248
    v_add_f32 v241, v241, v249
    v_mfma_f32_16x16x32_bf16 v[116:119], v[84:87], a[124:127], v[116:119]
    s_waitcnt lgkmcnt(6)
    ds_read_b64_tr_b16 v[74:75], v13 offset:8704
    v_add_f32 v242, v242, v250
    v_add_f32 v243, v243, v251
    v_add_f32 v244, v244, v252
    v_add_f32 v245, v245, v253
    v_add_f32 v246, v246, v254
    v_mfma_f32_16x16x32_bf16 v[120:123], v[88:91], a[120:123], v[120:123]
    buffer_load_dwordx4 v3, s[16:19], s32 offen offset:1024 lds
    v_add_f32 v247, v247, v255
    v_permlane32_swap_b32 v240, v244
    v_mfma_f32_16x16x32_bf16 v[124:127], v[88:91], a[124:127], v[124:127]
    s_waitcnt lgkmcnt(5)
    ds_read_b64_tr_b16 v[76:77], v10 offset:12288
    v_permlane32_swap_b32 v241, v245
    v_permlane32_swap_b32 v242, v246
    v_mfma_f32_16x16x32_bf16 v[96:99], v[60:63], a[128:131], v[96:99]
    ds_read_b64_tr_b16 v[78:79], v10 offset:12800
    v_permlane32_swap_b32 v243, v247
    v_add_f32 v240, v240, v244
    v_add_f32 v241, v241, v245
    v_add_f32 v242, v242, v246
    v_mfma_f32_16x16x32_bf16 v[100:103], v[60:63], a[132:135], v[100:103]
    ds_read_b64_tr_b16 v[80:81], v11 offset:12288
    v_add_f32 v243, v243, v247
    s_add_u32 s79, s79, 786432
    v_permlane16_swap_b32 v240, v242
    v_mfma_f32_16x16x32_bf16 v[44:47], v[60:63], v[32:35], v[44:47]
    s_waitcnt lgkmcnt(4)
    ds_read_b64_tr_b16 v[82:83], v11 offset:12800
    v_permlane16_swap_b32 v241, v243
    v_add_f32 v240, v240, v242
    v_add_f32 v241, v241, v243
    s_add_u32 s51, s51, 786432
    v_mfma_f32_16x16x32_bf16 v[104:107], v[64:67], a[128:131], v[104:107]
    buffer_load_dwordx4 v4, s[16:19], s32 offen offset:2048 lds
    v_add_f32_dpp v240, v240, v240 row_ror:8 row_mask:0xf bank_mask:0xf
    v_add_f32_dpp v241, v241, v241 row_ror:8 row_mask:0xf bank_mask:0xf
    v_cvt_pk_bf16_f32 v240, v240, v241
    v_mfma_f32_16x16x32_bf16 v[108:111], v[64:67], a[132:135], v[108:111]
    buffer_store_dword v240, v16, s[36:39], s79 offen sc1
    ds_read_b64_tr_b16 v[84:85], v12 offset:12288
    v_mfma_f32_16x16x32_bf16 v[112:115], v[68:71], a[128:131], v[112:115]
    ds_read_b64_tr_b16 v[86:87], v12 offset:12800
    v_permlane16_swap_b32 v145, v147
    v_mfma_f32_16x16x32_bf16 v[116:119], v[68:71], a[132:135], v[116:119]
    s_waitcnt lgkmcnt(4)
    v_permlane16_swap_b32 v148, v150
    v_permlane16_swap_b32 v149, v151
    v_mfma_f32_16x16x32_bf16 v[120:123], v[72:75], a[128:131], v[120:123]
    v_permlane16_swap_b32 v152, v154
    v_permlane16_swap_b32 v153, v155
    v_mfma_f32_16x16x32_bf16 v[124:127], v[72:75], a[132:135], v[124:127]
    v_permlane16_swap_b32 v156, v158
    v_permlane16_swap_b32 v157, v159
    v_mfma_f32_16x16x32_bf16 v[96:99], v[76:79], a[136:139], v[96:99]
    buffer_load_dwordx4 v5, s[16:19], s32 offen offset:3072 lds
    ds_read_b64_tr_b16 v[88:89], v13 offset:12288
    v_mfma_f32_16x16x32_bf16 v[100:103], v[76:79], a[140:143], v[100:103]
    s_add_u32 m0, s33, 49152
    s_add_u32 s32, s30, 262144
    ds_read_b64_tr_b16 v[90:91], v13 offset:12800
    v_lshlrev_b32 v224, 16, v48
    v_mfma_f32_16x16x32_bf16 v[44:47], v[76:79], v[32:35], v[44:47]
    s_waitcnt lgkmcnt(2)
    ds_read_b64_tr_b16 v[60:61], v10 offset:16384
    ds_read_b64_tr_b16 v[62:63], v10 offset:16896
    v_mfma_f32_16x16x32_bf16 v[104:107], v[80:83], a[136:139], v[104:107]
    ds_read_b64_tr_b16 v[64:65], v11 offset:16384
    ds_read_b64_tr_b16 v[66:67], v11 offset:16896
    v_mfma_f32_16x16x32_bf16 v[108:111], v[80:83], a[140:143], v[108:111]
    ds_read_b64_tr_b16 v[68:69], v12 offset:16384
    ds_read_b64_tr_b16 v[70:71], v12 offset:16896
    v_mfma_f32_16x16x32_bf16 v[112:115], v[84:87], a[136:139], v[112:115]
    buffer_load_dwordx4 v2, s[16:19], s32 offen offset:0 lds
    v_and_b32 v225, 0xffff0000, v48
    v_mfma_f32_16x16x32_bf16 v[116:119], v[84:87], a[140:143], v[116:119]
    s_waitcnt lgkmcnt(6)
    ds_read_b64_tr_b16 v[72:73], v13 offset:16384
    ds_read_b64_tr_b16 v[74:75], v13 offset:16896
    v_mfma_f32_16x16x32_bf16 v[120:123], v[88:91], a[136:139], v[120:123]
    ds_read_b64_tr_b16 v[76:77], v10 offset:20480
    v_lshlrev_b32 v226, 16, v49
    v_and_b32 v227, 0xffff0000, v49
    v_mfma_f32_16x16x32_bf16 v[124:127], v[88:91], a[140:143], v[124:127]
    s_waitcnt lgkmcnt(7)
    ds_read_b64_tr_b16 v[78:79], v10 offset:20992
    v_lshlrev_b32 v228, 16, v50
    v_and_b32 v229, 0xffff0000, v50
    v_mfma_f32_16x16x32_bf16 v[96:99], v[60:63], a[144:147], v[96:99]
    ds_read_b64_tr_b16 v[80:81], v11 offset:20480
    v_lshlrev_b32 v230, 16, v51
    v_and_b32 v231, 0xffff0000, v51
    v_mfma_f32_16x16x32_bf16 v[100:103], v[60:63], a[148:151], v[100:103]
    buffer_load_dwordx4 v3, s[16:19], s32 offen offset:1024 lds
    v_add_f32_dpp v224, v224, v224 quad_perm:[1,0,3,2] row_mask:0xf bank_mask:0xf
    v_mfma_f32_16x16x32_bf16 v[44:47], v[60:63], v[32:35], v[44:47]
    s_waitcnt lgkmcnt(5)
    s_barrier
    ds_read_b64_tr_b16 v[82:83], v11 offset:20992
    v_add_f32_dpp v225, v225, v225 quad_perm:[1,0,3,2] row_mask:0xf bank_mask:0xf
    v_mfma_f32_16x16x32_bf16 v[104:107], v[64:67], a[144:147], v[104:107]
    ds_read_b64_tr_b16 v[84:85], v12 offset:20480
    v_add_f32_dpp v226, v226, v226 quad_perm:[1,0,3,2] row_mask:0xf bank_mask:0xf
    v_add_f32_dpp v227, v227, v227 quad_perm:[1,0,3,2] row_mask:0xf bank_mask:0xf
    v_mfma_f32_16x16x32_bf16 v[108:111], v[64:67], a[148:151], v[108:111]
    ds_read_b64_tr_b16 v[86:87], v12 offset:20992
    v_add_f32_dpp v228, v228, v228 quad_perm:[1,0,3,2] row_mask:0xf bank_mask:0xf
    v_add_f32_dpp v229, v229, v229 quad_perm:[1,0,3,2] row_mask:0xf bank_mask:0xf
    v_mfma_f32_16x16x32_bf16 v[112:115], v[68:71], a[144:147], v[112:115]
    ds_read_b64_tr_b16 v[88:89], v13 offset:20480
    v_add_f32_dpp v230, v230, v230 quad_perm:[1,0,3,2] row_mask:0xf bank_mask:0xf
    v_add_f32_dpp v231, v231, v231 quad_perm:[1,0,3,2] row_mask:0xf bank_mask:0xf
    v_mfma_f32_16x16x32_bf16 v[116:119], v[68:71], a[148:151], v[116:119]
    s_waitcnt lgkmcnt(4)
    ds_read_b64_tr_b16 v[90:91], v13 offset:20992
    v_add_f32_dpp v224, v224, v224 quad_perm:[2,3,0,1] row_mask:0xf bank_mask:0xf
    v_add_f32_dpp v225, v225, v225 quad_perm:[2,3,0,1] row_mask:0xf bank_mask:0xf
    v_mfma_f32_16x16x32_bf16 v[120:123], v[72:75], a[144:147], v[120:123]
    buffer_load_dwordx4 v4, s[16:19], s32 offen offset:2048 lds
    v_add_f32_dpp v226, v226, v226 quad_perm:[2,3,0,1] row_mask:0xf bank_mask:0xf
    v_mfma_f32_16x16x32_bf16 v[124:127], v[72:75], a[148:151], v[124:127]
    ds_read_b64_tr_b16 v[60:61], v10 offset:24576
    v_add_f32_dpp v227, v227, v227 quad_perm:[2,3,0,1] row_mask:0xf bank_mask:0xf
    v_add_f32_dpp v228, v228, v228 quad_perm:[2,3,0,1] row_mask:0xf bank_mask:0xf
    v_mfma_f32_16x16x32_bf16 v[96:99], v[76:79], a[152:155], v[96:99]
    ds_read_b64_tr_b16 v[62:63], v10 offset:25088
    v_add_f32_dpp v229, v229, v229 quad_perm:[2,3,0,1] row_mask:0xf bank_mask:0xf
    v_add_f32_dpp v230, v230, v230 quad_perm:[2,3,0,1] row_mask:0xf bank_mask:0xf
    v_mfma_f32_16x16x32_bf16 v[100:103], v[76:79], a[156:159], v[100:103]
    ds_read_b64_tr_b16 v[64:65], v11 offset:24576
    v_add_f32_dpp v231, v231, v231 quad_perm:[2,3,0,1] row_mask:0xf bank_mask:0xf
    v_add_f32_dpp v224, v224, v224 row_half_mirror row_mask:0xf bank_mask:0xf
    v_mfma_f32_16x16x32_bf16 v[44:47], v[76:79], v[32:35], v[44:47]
    s_waitcnt lgkmcnt(4)
    ds_read_b64_tr_b16 v[66:67], v11 offset:25088
    v_add_f32_dpp v225, v225, v225 row_half_mirror row_mask:0xf bank_mask:0xf
    v_add_f32_dpp v226, v226, v226 row_half_mirror row_mask:0xf bank_mask:0xf
    v_mfma_f32_16x16x32_bf16 v[104:107], v[80:83], a[152:155], v[104:107]
    buffer_load_dwordx4 v5, s[16:19], s32 offen offset:3072 lds
    v_add_f32_dpp v227, v227, v227 row_half_mirror row_mask:0xf bank_mask:0xf
    v_mfma_f32_16x16x32_bf16 v[108:111], v[80:83], a[156:159], v[108:111]
    s_add_u32 m0, s33, 65536
    s_add_u32 s32, s30, 1048576
    ds_read_b64_tr_b16 v[68:69], v12 offset:24576
    v_add_f32_dpp v228, v228, v228 row_half_mirror row_mask:0xf bank_mask:0xf
    v_mfma_f32_16x16x32_bf16 v[112:115], v[84:87], a[152:155], v[112:115]
    ds_read_b64_tr_b16 v[70:71], v12 offset:25088
    v_add_f32_dpp v229, v229, v229 row_half_mirror row_mask:0xf bank_mask:0xf
    v_add_f32_dpp v230, v230, v230 row_half_mirror row_mask:0xf bank_mask:0xf
    v_mfma_f32_16x16x32_bf16 v[116:119], v[84:87], a[156:159], v[116:119]
    s_waitcnt lgkmcnt(4)
    ds_read_b64_tr_b16 v[72:73], v13 offset:24576
    ds_read_b64_tr_b16 v[74:75], v13 offset:25088
    v_mfma_f32_16x16x32_bf16 v[120:123], v[88:91], a[152:155], v[120:123]
    ds_read_b64_tr_b16 v[76:77], v10 offset:28672
    v_add_f32_dpp v231, v231, v231 row_half_mirror row_mask:0xf bank_mask:0xf
    v_add_f32_dpp v224, v224, v224 row_mirror row_mask:0xf bank_mask:0xf
    v_mfma_f32_16x16x32_bf16 v[124:127], v[88:91], a[156:159], v[124:127]
    buffer_load_dwordx4 v2, s[16:19], s32 offen offset:0 lds
    v_add_f32_dpp v225, v225, v225 row_mirror row_mask:0xf bank_mask:0xf
    v_mfma_f32_16x16x32_bf16 v[96:99], v[60:63], a[160:163], v[96:99]
    ds_read_b64_tr_b16 v[78:79], v10 offset:29184
    v_add_f32_dpp v226, v226, v226 row_mirror row_mask:0xf bank_mask:0xf
    v_add_f32_dpp v227, v227, v227 row_mirror row_mask:0xf bank_mask:0xf
    v_mfma_f32_16x16x32_bf16 v[100:103], v[60:63], a[164:167], v[100:103]
    ds_read_b64_tr_b16 v[80:81], v11 offset:28672
    v_add_f32_dpp v228, v228, v228 row_mirror row_mask:0xf bank_mask:0xf
    v_add_f32_dpp v229, v229, v229 row_mirror row_mask:0xf bank_mask:0xf
    v_mfma_f32_16x16x32_bf16 v[44:47], v[60:63], v[32:35], v[44:47]
    s_waitcnt lgkmcnt(5)
    ds_read_b64_tr_b16 v[82:83], v11 offset:29184
    v_add_f32_dpp v230, v230, v230 row_mirror row_mask:0xf bank_mask:0xf
    v_add_f32_dpp v231, v231, v231 row_mirror row_mask:0xf bank_mask:0xf
    v_mfma_f32_16x16x32_bf16 v[104:107], v[64:67], a[160:163], v[104:107]
    ds_read_b64_tr_b16 v[84:85], v12 offset:28672
    v_cvt_pk_bf16_f32 v48, v224, v225
    v_cvt_pk_bf16_f32 v49, v226, v227
    v_mfma_f32_16x16x32_bf16 v[108:111], v[64:67], a[164:167], v[108:111]
    buffer_load_dwordx4 v3, s[16:19], s32 offen offset:1024 lds
    ds_read_b64_tr_b16 v[86:87], v12 offset:29184
    v_mfma_f32_16x16x32_bf16 v[112:115], v[68:71], a[160:163], v[112:115]
    ds_read_b64_tr_b16 v[88:89], v13 offset:28672
    v_cvt_pk_bf16_f32 v50, v228, v229
    v_cvt_pk_bf16_f32 v51, v230, v231
    v_mfma_f32_16x16x32_bf16 v[116:119], v[68:71], a[164:167], v[116:119]
    s_waitcnt lgkmcnt(5)
    ds_read_b64_tr_b16 v[90:91], v13 offset:29184
    v_cndmask_b32 v48, v48, v32, s[54:55]
    v_cndmask_b32 v49, v49, v32, s[54:55]
    v_mfma_f32_16x16x32_bf16 v[120:123], v[72:75], a[160:163], v[120:123]
    ds_read_b64_tr_b16 v[60:61], v10 offset:32768
    v_cndmask_b32 v50, v50, v32, s[54:55]
    v_cndmask_b32 v51, v51, v32, s[54:55]
    v_mfma_f32_16x16x32_bf16 v[124:127], v[72:75], a[164:167], v[124:127]
    ds_write_b128 v17, v[48:51] offset:4096
    v_mfma_f32_16x16x32_bf16 v[96:99], v[76:79], a[168:171], v[96:99]
    buffer_load_dwordx4 v4, s[16:19], s32 offen offset:2048 lds
    ds_read_b64_tr_b16 v[62:63], v10 offset:33280
    v_mfma_f32_16x16x32_bf16 v[100:103], v[76:79], a[172:175], v[100:103]
    s_mov_b64 exec, 0xffff
    ds_write_b16 v20, v14
    s_mov_b64 exec, -1
    v_mfma_f32_16x16x32_bf16 v[44:47], v[76:79], v[32:35], v[44:47]
    s_waitcnt lgkmcnt(5)
    ds_read_b64_tr_b16 v[64:65], v11 offset:32768
    ds_read_b64_tr_b16 v[66:67], v11 offset:33280
    v_mfma_f32_16x16x32_bf16 v[104:107], v[80:83], a[168:171], v[104:107]
    ds_read_b64_tr_b16 v[68:69], v12 offset:32768
    v_mfma_f32_16x16x32_bf16 v[108:111], v[80:83], a[172:175], v[108:111]
    ds_read_b64_tr_b16 v[70:71], v12 offset:33280
    v_mfma_f32_16x16x32_bf16 v[112:115], v[84:87], a[168:171], v[112:115]
    buffer_load_dwordx4 v5, s[16:19], s32 offen offset:3072 lds
    v_mfma_f32_16x16x32_bf16 v[116:119], v[84:87], a[172:175], v[116:119]
    s_waitcnt lgkmcnt(5)
    s_add_u32 m0, s33, 81920
    s_add_u32 s32, s30, 1310720
    ds_read_b64_tr_b16 v[72:73], v13 offset:32768
    v_mfma_f32_16x16x32_bf16 v[120:123], v[88:91], a[168:171], v[120:123]
    ds_read_b64_tr_b16 v[74:75], v13 offset:33280
    v_mfma_f32_16x16x32_bf16 v[124:127], v[88:91], a[172:175], v[124:127]
    ds_read_b64_tr_b16 v[76:77], v10 offset:36864
    v_mfma_f32_16x16x32_bf16 v[96:99], v[60:63], a[176:179], v[96:99]
    ds_read_b64_tr_b16 v[78:79], v10 offset:37376
    v_mfma_f32_16x16x32_bf16 v[100:103], v[60:63], a[180:183], v[100:103]
    ds_read_b64_tr_b16 v[80:81], v11 offset:36864
    v_mfma_f32_16x16x32_bf16 v[44:47], v[60:63], v[32:35], v[44:47]
    s_waitcnt lgkmcnt(5)
    s_barrier
    ds_read_b64_tr_b16 v[82:83], v11 offset:37376
    v_mfma_f32_16x16x32_bf16 v[104:107], v[64:67], a[176:179], v[104:107]
    buffer_load_dwordx4 v2, s[16:19], s32 offen offset:0 lds
    v_mfma_f32_16x16x32_bf16 v[108:111], v[64:67], a[180:183], v[108:111]
    ds_read_b64_tr_b16 v[84:85], v12 offset:36864
    ds_read_b64_tr_b16 v[86:87], v12 offset:37376
    v_mfma_f32_16x16x32_bf16 v[112:115], v[68:71], a[176:179], v[112:115]
    ds_read_b64_tr_b16 v[88:89], v13 offset:36864
    v_mfma_f32_16x16x32_bf16 v[116:119], v[68:71], a[180:183], v[116:119]
    s_waitcnt lgkmcnt(5)
    ds_read_b64_tr_b16 v[90:91], v13 offset:37376
    v_add_u32 v10, 4294901760, v10
    v_mfma_f32_16x16x32_bf16 v[120:123], v[72:75], a[176:179], v[120:123]
    ds_read_b64_tr_b16 v[60:61], v10 offset:0
    v_mfma_f32_16x16x32_bf16 v[124:127], v[72:75], a[180:183], v[124:127]
    buffer_load_dwordx4 v[128:131], v1, s[36:39], s51 offen offset:0 sc1
    buffer_load_dwordx4 v[132:135], v1, s[36:39], s51 offen offset:1024 sc1
    v_mfma_f32_16x16x32_bf16 v[96:99], v[76:79], a[184:187], v[96:99]
    ds_read_b64_tr_b16 v[62:63], v10 offset:512
    v_add_u32 v11, 4294901760, v11
    v_mfma_f32_16x16x32_bf16 v[100:103], v[76:79], a[188:191], v[100:103]
    ds_read_b64_tr_b16 v[64:65], v11 offset:0
    v_mfma_f32_16x16x32_bf16 v[44:47], v[76:79], v[32:35], v[44:47]
    s_waitcnt lgkmcnt(4)
    ds_read_b64_tr_b16 v[66:67], v11 offset:512
    v_add_u32 v12, 4294901760, v12
    v_mfma_f32_16x16x32_bf16 v[104:107], v[80:83], a[184:187], v[104:107]
    ds_read_b64_tr_b16 v[68:69], v12 offset:0
    v_mfma_f32_16x16x32_bf16 v[108:111], v[80:83], a[188:191], v[108:111]
    ds_read_b64_tr_b16 v[70:71], v12 offset:512
    v_add_u32 v13, 4294901760, v13
    v_mfma_f32_16x16x32_bf16 v[112:115], v[84:87], a[184:187], v[112:115]
    s_waitcnt lgkmcnt(5)
    s_barrier
    ds_read_b64_tr_b16 v[72:73], v13 offset:0
    v_mfma_f32_16x16x32_bf16 v[116:119], v[84:87], a[188:191], v[116:119]
    buffer_load_dwordx4 v3, s[16:19], s32 offen offset:1024 lds
    ds_read_b64_tr_b16 v[74:75], v13 offset:512
    v_mfma_f32_16x16x32_bf16 v[120:123], v[88:91], a[184:187], v[120:123]
    ds_read_b64_tr_b16 v[76:77], v10 offset:4096
    v_mfma_f32_16x16x32_bf16 v[124:127], v[88:91], a[188:191], v[124:127]
    s_waitcnt lgkmcnt(5)
    ds_read_b64_tr_b16 v[78:79], v10 offset:4608
    v_mfma_f32_16x16x32_bf16 v[96:99], v[60:63], a[192:195], v[96:99]
    ds_read_b64_tr_b16 v[80:81], v11 offset:4096
    v_mfma_f32_16x16x32_bf16 v[100:103], v[60:63], a[196:199], v[100:103]
    ds_read_b64_tr_b16 v[82:83], v11 offset:4608
    v_mfma_f32_16x16x32_bf16 v[44:47], v[60:63], v[32:35], v[44:47]
    ds_read_b64_tr_b16 v[52:53], v10 offset:16384
    v_mfma_f32_16x16x32_bf16 v[104:107], v[64:67], a[192:195], v[104:107]
    buffer_load_dwordx4 v4, s[16:19], s32 offen offset:2048 lds
    ds_read_b64_tr_b16 v[54:55], v10 offset:16896
    v_mfma_f32_16x16x32_bf16 v[108:111], v[64:67], a[196:199], v[108:111]
    s_waitcnt lgkmcnt(5)
    ds_read_b64_tr_b16 v[84:85], v12 offset:4096
    ds_read_b64_tr_b16 v[86:87], v12 offset:4608
    v_mfma_f32_16x16x32_bf16 v[112:115], v[68:71], a[192:195], v[112:115]
    ds_read_b64_tr_b16 v[88:89], v13 offset:4096
    v_mfma_f32_16x16x32_bf16 v[116:119], v[68:71], a[196:199], v[116:119]
    s_waitcnt lgkmcnt(3)
    ds_read_b64_tr_b16 v[90:91], v13 offset:4608
    v_mfma_f32_16x16x32_bf16 v[44:47], v[52:55], v[32:35], v[44:47]
    ds_read_b64_tr_b16 v[60:61], v10 offset:8192
    v_mfma_f32_16x16x32_bf16 v[120:123], v[72:75], a[192:195], v[120:123]
    ds_read_b64_tr_b16 v[62:63], v10 offset:8704
    v_mfma_f32_16x16x32_bf16 v[124:127], v[72:75], a[196:199], v[124:127]
    buffer_load_dwordx4 v5, s[16:19], s32 offen offset:3072 lds
    v_mfma_f32_16x16x32_bf16 v[96:99], v[76:79], a[200:203], v[96:99]
    s_add_u32 m0, s33, 98304
    s_add_u32 s32, s30, 524288
    ds_read_b64_tr_b16 v[64:65], v11 offset:8192
    v_mfma_f32_16x16x32_bf16 v[100:103], v[76:79], a[204:207], v[100:103]
    ds_read_b64_tr_b16 v[66:67], v11 offset:8704
    v_mfma_f32_16x16x32_bf16 v[44:47], v[76:79], v[32:35], v[44:47]
    ds_read_b64_tr_b16 v[56:57], v10 offset:20480
    v_mfma_f32_16x16x32_bf16 v[104:107], v[80:83], a[200:203], v[104:107]
    ds_read_b64_tr_b16 v[58:59], v10 offset:20992
    v_mfma_f32_16x16x32_bf16 v[108:111], v[80:83], a[204:207], v[108:111]
    s_waitcnt lgkmcnt(4)
    ds_read_b64_tr_b16 v[68:69], v12 offset:8192
    ds_read_b64_tr_b16 v[70:71], v12 offset:8704
    v_mfma_f32_16x16x32_bf16 v[112:115], v[84:87], a[200:203], v[112:115]
    buffer_load_dwordx4 v2, s[16:19], s32 offen offset:0 lds
    v_mfma_f32_16x16x32_bf16 v[116:119], v[84:87], a[204:207], v[116:119]
    s_waitcnt lgkmcnt(2)
    ds_read_b64_tr_b16 v[72:73], v13 offset:8192
    ds_read_b64_tr_b16 v[74:75], v13 offset:8704
    v_mfma_f32_16x16x32_bf16 v[44:47], v[56:59], v[32:35], v[44:47]
    ds_read_b64_tr_b16 v[76:77], v10 offset:12288
    v_mfma_f32_16x16x32_bf16 v[120:123], v[88:91], a[200:203], v[120:123]
    ds_read_b64_tr_b16 v[78:79], v10 offset:12800
    v_mfma_f32_16x16x32_bf16 v[124:127], v[88:91], a[204:207], v[124:127]
    ds_read_b64_tr_b16 v[80:81], v11 offset:12288
    v_mfma_f32_16x16x32_bf16 v[96:99], v[60:63], a[208:211], v[96:99]
    ds_read_b64_tr_b16 v[82:83], v11 offset:12800
    v_mfma_f32_16x16x32_bf16 v[100:103], v[60:63], a[212:215], v[100:103]
    buffer_load_dwordx4 v3, s[16:19], s32 offen offset:1024 lds
    v_mfma_f32_16x16x32_bf16 v[44:47], v[60:63], v[32:35], v[44:47]
    ds_read_b64_tr_b16 v[52:53], v10 offset:24576
    v_mfma_f32_16x16x32_bf16 v[104:107], v[64:67], a[208:211], v[104:107]
    ds_read_b64_tr_b16 v[54:55], v10 offset:25088
    v_mfma_f32_16x16x32_bf16 v[108:111], v[64:67], a[212:215], v[108:111]
    s_waitcnt lgkmcnt(4)
    ds_read_b64_tr_b16 v[84:85], v12 offset:12288
    ds_read_b64_tr_b16 v[86:87], v12 offset:12800
    v_mfma_f32_16x16x32_bf16 v[112:115], v[68:71], a[208:211], v[112:115]
    ds_read_b64_tr_b16 v[88:89], v13 offset:12288
    v_mfma_f32_16x16x32_bf16 v[116:119], v[68:71], a[212:215], v[116:119]
    s_waitcnt lgkmcnt(3)
    ds_read_b64_tr_b16 v[90:91], v13 offset:12800
    v_mfma_f32_16x16x32_bf16 v[44:47], v[52:55], v[32:35], v[44:47]
    buffer_load_dwordx4 v4, s[16:19], s32 offen offset:2048 lds
    v_mfma_f32_16x16x32_bf16 v[120:123], v[72:75], a[208:211], v[120:123]
    s_waitcnt vmcnt(6)
    v_max3_u32 v136, v128, v129, v130
    v_max3_u32 v137, v131, v132, v133
    v_max3_u32 v136, v136, v134, v135
    v_max_u32 v136, v136, v137
    v_cmp_eq_u32 vcc, -1, v136
    v_mfma_f32_16x16x32_bf16 v[124:127], v[72:75], a[212:215], v[124:127]
    s_cbranch_vccnz L_qkv_slow2
L_qkv_back2:
    ds_write_b128 v17, v[128:131] offset:0
    v_mfma_f32_16x16x32_bf16 v[96:99], v[76:79], a[216:219], v[96:99]
    ds_write_b128 v17, v[132:135] offset:2048
    ds_read_b64_tr_b16 v[60:61], v10 offset:16384
    v_mfma_f32_16x16x32_bf16 v[100:103], v[76:79], a[220:223], v[100:103]
    ds_read_b64_tr_b16 v[62:63], v10 offset:16896
    ds_read_b64_tr_b16 v[64:65], v11 offset:16384
    v_mfma_f32_16x16x32_bf16 v[44:47], v[76:79], v[32:35], v[44:47]
    buffer_load_dwordx4 v5, s[16:19], s32 offen offset:3072 lds
    ds_read_b64_tr_b16 v[66:67], v11 offset:16896
    v_mfma_f32_16x16x32_bf16 v[104:107], v[80:83], a[216:219], v[104:107]
    s_add_u32 m0, s33, 147456
    s_add_u32 s32, s30, 1835008
    s_waitcnt lgkmcnt(4)
    s_barrier
    ds_read_b128 a[152:155], v18 offset:4096
    v_mfma_f32_16x16x32_bf16 v[108:111], v[80:83], a[220:223], v[108:111]
    ds_read_b128 a[176:179], v19 offset:4096
    ds_read_b128 a[156:159], v18 offset:5120
    ds_read_b64_tr_b16 v[56:57], v10 offset:28672
    ds_read_b64_tr_b16 v[58:59], v10 offset:29184
    v_mfma_f32_16x16x32_bf16 v[112:115], v[84:87], a[216:219], v[112:115]
    ds_read_b128 a[180:183], v19 offset:5120
    ds_read_b128 a[136:139], v18 offset:0
    v_mfma_f32_16x16x32_bf16 v[116:119], v[84:87], a[220:223], v[116:119]
    s_waitcnt lgkmcnt(2)
    ds_read_b128 a[160:163], v19 offset:0
    ds_read_b128 a[140:143], v18 offset:1024
    v_mfma_f32_16x16x32_bf16 v[44:47], v[56:59], v[32:35], v[44:47]
    ds_read_b128 a[164:167], v19 offset:1024
    ds_read_b128 a[144:147], v18 offset:2048
    v_mfma_f32_16x16x32_bf16 v[120:123], v[88:91], a[216:219], v[120:123]
    ds_read_b128 a[168:171], v19 offset:2048
    ds_read_b128 a[148:151], v18 offset:3072
    v_mfma_f32_16x16x32_bf16 v[124:127], v[88:91], a[220:223], v[124:127]
    ds_read_b128 a[172:175], v19 offset:3072
    ds_read_b128 a[184:187], v21
    v_mfma_f32_16x16x32_bf16 v[96:99], v[60:63], a[224:227], v[96:99]
    ds_read_b128 a[188:191], v23
    ds_read_b64_tr_b16 v[68:69], v12 offset:16384
    v_mfma_f32_16x16x32_bf16 v[100:103], v[60:63], a[228:231], v[100:103]
    ds_read_b64_tr_b16 v[70:71], v12 offset:16896
    ds_read_b64_tr_b16 v[72:73], v13 offset:16384
    v_mfma_f32_16x16x32_bf16 v[104:107], v[64:67], a[224:227], v[104:107]
    s_mov_b32 exec_lo, 0x10001
    s_mov_b32 exec_hi, 0x10001
    ds_write_b128 v22, v[44:47] offset:512
    s_mov_b64 exec, -1
    v_mfma_f32_16x16x32_bf16 v[108:111], v[64:67], a[228:231], v[108:111]
    s_waitcnt lgkmcnt(2)
    ds_read_b64_tr_b16 v[74:75], v13 offset:16896
    ds_read_b64_tr_b16 v[76:77], v10 offset:20480
    v_mfma_f32_16x16x32_bf16 v[112:115], v[68:71], a[224:227], v[112:115]
    ds_read_b64_tr_b16 v[78:79], v10 offset:20992
    ds_read_b64_tr_b16 v[80:81], v11 offset:20480
    v_mfma_f32_16x16x32_bf16 v[116:119], v[68:71], a[228:231], v[116:119]
    s_waitcnt lgkmcnt(3)
    ds_read_b64_tr_b16 v[82:83], v11 offset:20992
    ds_read_b64_tr_b16 v[84:85], v12 offset:20480
    v_mfma_f32_16x16x32_bf16 v[120:123], v[72:75], a[224:227], v[120:123]
    ds_read_b64_tr_b16 v[86:87], v12 offset:20992
    ds_read_b64_tr_b16 v[88:89], v13 offset:20480
    v_mfma_f32_16x16x32_bf16 v[124:127], v[72:75], a[228:231], v[124:127]
    s_waitcnt lgkmcnt(5)
    ds_read_b64_tr_b16 v[90:91], v13 offset:20992
    v_mfma_f32_16x16x32_bf16 v[96:99], v[76:79], a[232:235], v[96:99]
    s_barrier
    ds_read_b64_tr_b16 v[60:61], v10 offset:24576
    ds_read_b64_tr_b16 v[62:63], v10 offset:25088
    v_xor_b32 v8, 0, v22
    v_mfma_f32_16x16x32_bf16 v[100:103], v[76:79], a[236:239], v[100:103]
    s_waitcnt lgkmcnt(6)
    ds_read_b128 v[192:195], v8 offset:512
    v_xor_b32 v9, 64, v22
    v_mfma_f32_16x16x32_bf16 v[104:107], v[80:83], a[232:235], v[104:107]
    ds_read_b128 v[196:199], v9 offset:512
    ds_read_b64_tr_b16 v[64:65], v11 offset:24576
    v_xor_b32 v8, 128, v22
    v_mfma_f32_16x16x32_bf16 v[108:111], v[80:83], a[236:239], v[108:111]
    s_waitcnt lgkmcnt(7)
    ds_read_b128 v[200:203], v8 offset:512
    ds_read_b64_tr_b16 v[66:67], v11 offset:25088
    v_xor_b32 v9, 192, v22
    v_mfma_f32_16x16x32_bf16 v[112:115], v[84:87], a[232:235], v[112:115]
    ds_read_b128 v[204:207], v9 offset:512
    s_waitcnt lgkmcnt(0)
    s_barrier
    v_mfma_f32_16x16x32_bf16 v[116:119], v[84:87], a[236:239], v[116:119]
    buffer_load_dwordx4 v2, s[16:19], s32 offen offset:0 lds
    ds_read_b64_tr_b16 v[68:69], v12 offset:24576
    v_mfma_f32_16x16x32_bf16 v[120:123], v[88:91], a[232:235], v[120:123]
    ds_read_b64_tr_b16 v[70:71], v12 offset:25088
    ds_read_b64_tr_b16 v[72:73], v13 offset:24576
    v_mfma_f32_16x16x32_bf16 v[124:127], v[88:91], a[236:239], v[124:127]
    ds_read_b64_tr_b16 v[74:75], v13 offset:25088
    v_mfma_f32_16x16x32_bf16 v[96:99], v[60:63], a[240:243], v[96:99]
    ds_read_b64_tr_b16 v[76:77], v10 offset:28672
    ds_read_b64_tr_b16 v[78:79], v10 offset:29184
    v_mfma_f32_16x16x32_bf16 v[100:103], v[60:63], a[244:247], v[100:103]
    ds_read_b64_tr_b16 v[80:81], v11 offset:28672
    v_mfma_f32_16x16x32_bf16 v[104:107], v[64:67], a[240:243], v[104:107]
    ds_read_b64_tr_b16 v[82:83], v11 offset:29184
    v_mfma_f32_16x16x32_bf16 v[108:111], v[64:67], a[244:247], v[108:111]
    s_waitcnt lgkmcnt(6)
    ds_read_b64_tr_b16 v[84:85], v12 offset:28672
    v_mfma_f32_16x16x32_bf16 v[112:115], v[68:71], a[240:243], v[112:115]
    buffer_load_dwordx4 v3, s[16:19], s32 offen offset:1024 lds
    ds_read_b64_tr_b16 v[86:87], v12 offset:29184
    v_mfma_f32_16x16x32_bf16 v[116:119], v[68:71], a[244:247], v[116:119]
    s_waitcnt lgkmcnt(6)
    ds_read_b64_tr_b16 v[88:89], v13 offset:28672
    v_mfma_f32_16x16x32_bf16 v[120:123], v[72:75], a[240:243], v[120:123]
    ds_read_b64_tr_b16 v[90:91], v13 offset:29184
    v_mfma_f32_16x16x32_bf16 v[124:127], v[72:75], a[244:247], v[124:127]
    s_waitcnt lgkmcnt(5)
    v_mfma_f32_16x16x32_bf16 v[96:99], v[76:79], a[248:251], v[96:99]
    v_mfma_f32_16x16x32_bf16 v[100:103], v[76:79], a[252:255], v[100:103]
    s_waitcnt lgkmcnt(3)
    v_mfma_f32_16x16x32_bf16 v[104:107], v[80:83], a[248:251], v[104:107]
    buffer_load_dwordx4 v4, s[16:19], s32 offen offset:2048 lds
    v_mfma_f32_16x16x32_bf16 v[108:111], v[80:83], a[252:255], v[108:111]
    s_waitcnt lgkmcnt(1)
    v_mfma_f32_16x16x32_bf16 v[112:115], v[84:87], a[248:251], v[112:115]
    v_mfma_f32_16x16x32_bf16 v[116:119], v[84:87], a[252:255], v[116:119]
    s_waitcnt lgkmcnt(0)
    v_mfma_f32_16x16x32_bf16 v[120:123], v[88:91], a[248:251], v[120:123]
    v_mfma_f32_16x16x32_bf16 v[124:127], v[88:91], a[252:255], v[124:127]
    s_waitcnt vmcnt(7)
    s_barrier
    v_fma_f32 v96, -v92, v192, v96
    v_fma_f32 v97, -v92, v193, v97
    v_fma_f32 v98, -v92, v194, v98
    v_fma_f32 v99, -v92, v195, v99
    v_cvt_pk_bf16_f32 v160, v96, v97
    v_cvt_pk_bf16_f32 v161, v98, v99
    v_fma_f32 v104, -v92, v196, v104
    v_fma_f32 v105, -v92, v197, v105
    v_fma_f32 v106, -v92, v198, v106
    v_fma_f32 v107, -v92, v199, v107
    v_cvt_pk_bf16_f32 v162, v104, v105
    v_cvt_pk_bf16_f32 v163, v106, v107
    v_fma_f32 v112, -v92, v200, v112
    v_fma_f32 v113, -v92, v201, v113
    v_fma_f32 v114, -v92, v202, v114
    v_fma_f32 v115, -v92, v203, v115
    v_cvt_pk_bf16_f32 v168, v112, v113
    v_cvt_pk_bf16_f32 v169, v114, v115
    v_fma_f32 v120, -v92, v204, v120
    v_fma_f32 v121, -v92, v205, v121
    v_fma_f32 v122, -v92, v206, v122
    v_fma_f32 v123, -v92, v207, v123
    v_cvt_pk_bf16_f32 v170, v120, v121
    v_cvt_pk_bf16_f32 v171, v122, v123
    v_mfma_f32_16x16x32_bf16 v[96:99], v[176:179], v[160:163], 0
    v_fma_f32 v100, -v94, v192, v100
    v_fma_f32 v101, -v94, v193, v101
    v_mfma_f32_16x16x32_bf16 v[104:107], v[180:183], v[160:163], 0
    v_fma_f32 v102, -v94, v194, v102
    v_fma_f32 v103, -v94, v195, v103
    v_mfma_f32_16x16x32_bf16 v[112:115], v[184:187], v[168:171], 0
    v_cvt_pk_bf16_f32 v164, v100, v101
    v_cvt_pk_bf16_f32 v165, v102, v103
    v_mfma_f32_16x16x32_bf16 v[120:123], v[188:191], v[168:171], 0
    v_fma_f32 v108, -v94, v196, v108
    v_fma_f32 v109, -v94, v197, v109
    v_max3_f32 v224, v96, v97, v98
    v_max3_f32 v225, -v96, -v97, -v98
    s_nop 0
    v_max3_f32 v226, v112, v113, v114
    v_max3_f32 v227, -v112, -v113, -v114
    v_max3_f32 v224, v224, v99, v104
    v_max3_f32 v225, v225, -v99, -v104
    v_max3_f32 v226, v226, v115, v120
    v_max3_f32 v227, v227, -v115, -v120
    v_max3_f32 v224, v224, v105, v106
    v_max3_f32 v225, v225, -v105, -v106
    v_max3_f32 v226, v226, v121, v122
    v_max3_f32 v227, v227, -v121, -v122
    v_max_f32 v224, v224, v107
    v_max_f32 v225, v225, -v107
    v_max_f32 v226, v226, v123
    v_max_f32 v227, v227, -v123
    v_permlane32_swap_b32 v224, v225
    v_fma_f32 v110, -v94, v198, v110
    v_permlane32_swap_b32 v226, v227
    v_fma_f32 v111, -v94, v199, v111
    v_max_f32 v224, v224, v225
    v_cvt_pk_bf16_f32 v166, v108, v109
    v_max_f32 v226, v226, v227
    v_cvt_pk_bf16_f32 v167, v110, v111
    s_nop 0
    v_permlane16_swap_b32 v224, v226
    v_fma_f32 v116, -v94, v200, v116
    v_max_f32 v224, v224, v226
    v_fma_f32 v117, -v94, v201, v117
    v_mul_f32 v224, v93, v224
    v_fma_f32 v118, -v94, v202, v118
    v_mov_b32 v226, v224
    v_fma_f32 v119, -v94, v203, v119
    s_nop 0
    v_permlane16_swap_b32 v224, v226
    v_cvt_pk_bf16_f32 v172, v116, v117
    v_mov_b32 v225, v224
    v_cvt_pk_bf16_f32 v173, v118, v119
    v_mov_b32 v227, v226
    v_fma_f32 v124, -v94, v204, v124
    v_permlane32_swap_b32 v224, v225
    v_fma_f32 v125, -v94, v205, v125
    v_permlane32_swap_b32 v226, v227
    v_fma_f32 v126, -v94, v206, v126
    v_fma_f32 v127, -v94, v207, v127
    v_cvt_pk_bf16_f32 v174, v124, v125
    v_cvt_pk_bf16_f32 v175, v126, v127
    v_lshlrev_b32 v15, 2, v29
    v_lshl_add_u32 v42, v26, 9, v15
    v_mfma_f32_16x16x32_bf16 v[100:103], v[176:179], v[164:167], 0
    v_mfma_f32_16x16x32_bf16 v[108:111], v[180:183], v[164:167], 0
    v_mfma_f32_16x16x32_bf16 v[116:119], v[184:187], v[172:175], 0
    v_mfma_f32_16x16x32_bf16 v[124:127], v[188:191], v[172:175], 0
    v_fma_f32 v208, -v96, v93, -v225
    v_fma_f32 v96, v96, v93, -v224
    v_fma_f32 v209, -v97, v93, -v225
    v_fma_f32 v97, v97, v93, -v224
    v_exp_f32 v208, v208
    v_exp_f32 v96, v96
    v_fma_f32 v210, -v98, v93, -v225
    v_fma_f32 v98, v98, v93, -v224
    v_exp_f32 v209, v209
    v_exp_f32 v97, v97
    v_fma_f32 v211, -v99, v93, -v225
    v_fma_f32 v99, v99, v93, -v224
    v_exp_f32 v210, v210
    v_exp_f32 v98, v98
    v_fma_f32 v212, -v104, v93, -v225
    v_fma_f32 v104, v104, v93, -v224
    v_exp_f32 v211, v211
    v_exp_f32 v99, v99
    v_fma_f32 v213, -v105, v93, -v225
    v_fma_f32 v105, v105, v93, -v224
    v_exp_f32 v212, v212
    v_exp_f32 v104, v104
    v_fma_f32 v214, -v106, v93, -v225
    v_fma_f32 v106, v106, v93, -v224
    v_exp_f32 v213, v213
    v_exp_f32 v105, v105
    v_fma_f32 v215, -v107, v93, -v225
    v_fma_f32 v107, v107, v93, -v224
    v_exp_f32 v214, v214
    v_exp_f32 v106, v106
    v_fma_f32 v216, -v112, v93, -v227
    v_fma_f32 v112, v112, v93, -v226
    v_exp_f32 v215, v215
    v_exp_f32 v107, v107
    v_cvt_pk_bf16_f32 v96, v96, v97
    v_cvt_pk_bf16_f32 v97, v98, v99
    v_cvt_pk_bf16_f32 v98, v104, v105
    v_cvt_pk_bf16_f32 v99, v106, v107
    v_cvt_pk_bf16_f32 v104, v208, v209
    v_cvt_pk_bf16_f32 v105, v210, v211
    v_cvt_pk_bf16_f32 v106, v212, v213
    v_cvt_pk_bf16_f32 v107, v214, v215
    v_fma_f32 v217, -v113, v93, -v227
    v_fma_f32 v113, v113, v93, -v226
    v_exp_f32 v216, v216
    v_exp_f32 v112, v112
    v_mfma_f32_16x16x32_bf16 v[128:131], a[152:155], v[96:99], 0
    v_fma_f32 v218, -v114, v93, -v227
    v_fma_f32 v114, v114, v93, -v226
    v_mfma_f32_16x16x32_bf16 v[132:135], a[156:159], v[104:107], 0
    v_exp_f32 v217, v217
    v_exp_f32 v113, v113
    v_mfma_f32_16x16x32_bf16 v[60:63], a[136:139], v[96:99], 0
    v_fma_f32 v219, -v115, v93, -v227
    v_fma_f32 v115, v115, v93, -v226
    v_mfma_f32_16x16x32_bf16 v[64:67], a[144:147], v[96:99], 0
    v_exp_f32 v218, v218
    v_exp_f32 v114, v114
    v_mfma_f32_16x16x32_bf16 v[68:71], a[140:143], v[104:107], 0
    v_fma_f32 v220, -v120, v93, -v227
    v_fma_f32 v120, v120, v93, -v226
    v_mfma_f32_16x16x32_bf16 v[72:75], a[148:151], v[104:107], 0
    v_exp_f32 v219, v219
    v_exp_f32 v115, v115
    v_fma_f32 v221, -v121, v93, -v227
    v_fma_f32 v121, v121, v93, -v226
    v_exp_f32 v220, v220
    v_exp_f32 v120, v120
    v_fma_f32 v222, -v122, v93, -v227
    v_fma_f32 v122, v122, v93, -v226
    v_exp_f32 v221, v221
    v_exp_f32 v121, v121
    v_fma_f32 v223, -v123, v93, -v227
    v_fma_f32 v123, v123, v93, -v226
    v_exp_f32 v222, v222
    v_exp_f32 v122, v122
    v_exp_f32 v223, v223
    v_exp_f32 v123, v123
    v_cvt_pk_bf16_f32 v112, v112, v113
    v_cvt_pk_bf16_f32 v113, v114, v115
    v_cvt_pk_bf16_f32 v114, v120, v121
    v_cvt_pk_bf16_f32 v115, v122, v123
    v_cvt_pk_bf16_f32 v120, v216, v217
    v_cvt_pk_bf16_f32 v121, v218, v219
    v_cvt_pk_bf16_f32 v122, v220, v221
    v_cvt_pk_bf16_f32 v123, v222, v223
    v_rcp_f32 v129, v129
    v_rcp_f32 v133, v133
    v_mfma_f32_16x16x32_bf16 v[136:139], a[176:179], v[112:115], 0
    v_fmaak_f32 v128, v128, v129, 0x358637bd
    v_fmac_f32 v128, v132, v133
    v_mfma_f32_16x16x32_bf16 v[140:143], a[180:183], v[120:123], 0
    v_rcp_f32 v128, v128
    s_nop 0
    v_mul_f32 v129, v129, v128
    v_mfma_f32_16x16x32_bf16 v[76:79], a[160:163], v[112:115], 0
    v_mul_f32 v133, v133, v128
    v_mul_f32 v60, v60, v129
    v_mfma_f32_16x16x32_bf16 v[80:83], a[168:171], v[112:115], 0
    v_mul_f32 v61, v61, v129
    v_mul_f32 v62, v62, v129
    v_mfma_f32_16x16x32_bf16 v[84:87], a[164:167], v[120:123], 0
    v_mul_f32 v63, v63, v129
    v_mul_f32 v64, v64, v129
    v_mfma_f32_16x16x32_bf16 v[88:91], a[172:175], v[120:123], 0
    v_mul_f32 v65, v65, v129
    v_mul_f32 v66, v66, v129
    v_mul_f32 v67, v67, v129
    v_fmac_f32 v60, v68, v133
    v_fmac_f32 v61, v69, v133
    v_fmac_f32 v62, v70, v133
    v_fmac_f32 v63, v71, v133
    v_fmac_f32 v64, v72, v133
    v_fmac_f32 v65, v73, v133
    v_fmac_f32 v66, v74, v133
    v_fmac_f32 v67, v75, v133
    v_cvt_pk_bf16_f32 v60, v60, v61
    v_cvt_pk_bf16_f32 v61, v62, v63
    v_cvt_pk_bf16_f32 v62, v64, v65
    v_cvt_pk_bf16_f32 v63, v66, v67
    buffer_store_dwordx4 v[60:63], v1, s[40:43], s48 offen offset:0 sc1
    v_rcp_f32 v137, v137
    v_rcp_f32 v141, v141
    v_fmaak_f32 v136, v136, v137, 0x358637bd
    v_fmac_f32 v136, v140, v141
    v_rcp_f32 v136, v136
    s_nop 0
    v_mul_f32 v137, v137, v136
    v_mul_f32 v141, v141, v136
    v_mul_f32 v76, v76, v137
    v_mul_f32 v77, v77, v137
    v_mfma_f32_16x16x32_bf16 v[44:47], a[184:187], v[60:63], 0
    v_mul_f32 v78, v78, v137
    v_mul_f32 v79, v79, v137
    v_mul_f32 v80, v80, v137
    v_mul_f32 v81, v81, v137
    v_mul_f32 v82, v82, v137
    v_mul_f32 v83, v83, v137
    v_fmac_f32 v76, v84, v141
    v_fmac_f32 v77, v85, v141
    v_fmac_f32 v78, v86, v141
    v_fmac_f32 v79, v87, v141
    v_fmac_f32 v80, v88, v141
    v_fmac_f32 v81, v89, v141
    v_fmac_f32 v82, v90, v141
    v_fmac_f32 v83, v91, v141
    v_cvt_pk_bf16_f32 v76, v76, v77
    v_cvt_pk_bf16_f32 v77, v78, v79
    v_cvt_pk_bf16_f32 v78, v80, v81
    v_cvt_pk_bf16_f32 v79, v82, v83
    buffer_store_dwordx4 v[76:79], v1, s[40:43], s49 offen offset:0 sc1
    v_max3_f32 v248, v100, v101, v102
    v_max3_f32 v249, -v100, -v101, -v102
    v_mfma_f32_16x16x32_bf16 v[44:47], a[188:191], v[76:79], v[44:47]
    v_max3_f32 v250, v116, v117, v118
    v_max3_f32 v251, -v116, -v117, -v118
    v_max3_f32 v248, v248, v103, v108
    v_max3_f32 v249, v249, -v103, -v108
    v_max3_f32 v250, v250, v119, v124
    v_max3_f32 v251, v251, -v119, -v124
    v_max3_f32 v248, v248, v109, v110
    v_max3_f32 v249, v249, -v109, -v110
    s_mov_b64 exec, 0xffff
    buffer_store_dword v44, v15, s[36:39], s25 offen offset:0 sc1
    s_mov_b64 exec, -1
    v_max3_f32 v250, v250, v125, v126
    v_max3_f32 v251, v251, -v125, -v126
    v_max_f32 v248, v248, v111
    v_max_f32 v249, v249, -v111
    v_max_f32 v250, v250, v127
    v_max_f32 v251, v251, -v127
    v_permlane32_swap_b32 v248, v249
    v_mfma_f32_16x16x32_bf16 v[96:99], v[38:41], v[144:147], 0
    v_permlane32_swap_b32 v250, v251
    buffer_load_dwordx4 v5, s[16:19], s32 offen offset:3072 lds
    v_mfma_f32_16x16x32_bf16 v[104:107], v[36:39], v[144:147], 0
    s_load_dwordx4 s[4:7], s[0:1], 40
    s_load_dwordx2 s[20:21], s[0:1], 80
    s_load_dwordx4 s[60:63], s[0:1], 56
    v_bfe_u32 v24, v0, 2, 3
    v_lshrrev_b32 v10, 5, v0
    v_lshlrev_b32 v10, 10, v10
    v_lshl_add_u32 v10, v24, 7, v10
    v_lshl_add_u32 v10, v31, 3, v10
    v_lshrrev_b32 v24, 1, v24
    v_lshl_add_u32 v10, v24, 5, v10
    s_lshl_b32 s50, s65, 15
    s_add_u32 s51, s50, 32768
    v_add_u32 v10, s51, v10
    s_add_u32 s50, s50, s24
    v_add_u32 v17, s50, v1
    v_xor_b32 v18, 65536, v17
    s_mov_b32 s24, 0
    s_lshl_b32 s50, s28, 12
    s_add_u32 s50, s50, 81920
    v_add_u32 v19, s50, v1
    v_xor_b32 v20, 4096, v19
    v_xor_b32 v11, 32, v10
    v_xor_b32 v12, 64, v10
    v_xor_b32 v13, 96, v10
    s_and_b32 s74, s2, 7
    s_lshr_b32 s75, s2, 3
    s_lshr_b32 s26, s74, 2
    s_and_b32 s27, s74, 3
    s_lshr_b32 s76, s75, 3
    s_and_b32 s77, s75, 7
    s_mul_i32 s26, s26, 4
    s_add_u32 s26, s26, s76
    s_mul_i32 s27, s27, 8
    s_add_u32 s27, s27, s77
    v_bfe_u32 v6, v0, 2, 2
    s_and_b32 s33, s27, 1
    v_add_u32 v7, s33, v26
    v_lshrrev_b32 v8, 2, v7
    v_and_b32 v7, 3, v7
    v_lshlrev_b32 v8, 1, v8
    v_xor_b32 v8, v8, v31
    s_lshr_b32 s22, s27, 2
    s_and_b32 s30, s27, 3
    s_mul_i32 s30, s30, 224
    s_and_b32 s30, s30, 0xffffffc0
    s_add_u32 s23, s22, 3
    s_and_b32 s23, s23, 7
    s_lshl_b32 s23, s23, 7
    s_add_u32 s30, s30, s23
    v_lshl_add_u32 v7, v7, 6, s30
    v_subrev_u32 v2, 896, v7
    v_min_u32 v7, v7, v2
    v_mul_u32_u24 v2, 7168, v6
    v_add_u32 v2, v7, v2
    v_lshl_add_u32 v2, v8, 4, v2
    s_mul_i32 s30, s22, 896
    s_mul_i32 s31, s28, 57344
    s_add_u32 s30, s30, s31
    v_add_u32 v2, s30, v2
    v_xor_b32 v3, 32, v2
    v_add_u32 v3, 26624, v3
    s_lshl_b32 s29, s26, 2
    s_add_u32 s29, s29, s28
    s_lshl_b32 s31, s29, 17
    s_lshl_b32 s32, s28, 12
    s_mov_b32 s30, 0
    s_waitcnt lgkmcnt(0)
    s_mov_b32 s12, s4
    s_and_b32 s13, s5, 0xffff
    s_mov_b32 s14, 7340032
    s_mov_b32 s15, 0x00020000
    s_sub_u32 s16, s6, 1024
    s_subb_u32 s17, s7, 0
    s_and_b32 s17, s17, 0xffff
    s_mov_b32 s18, 7341056
    s_mov_b32 s19, 0x00020000
    s_add_u32 s8, s20, 0x800000
    s_addc_u32 s9, s21, 0
    s_and_b32 s9, s9, 0xffff
    s_mov_b32 s10, 4194304
    s_mov_b32 s11, 0x00020000
    v_lshlrev_b32 v4, 11, v26
    v_lshl_add_u32 v4, v6, 6, v4
    v_lshl_add_u32 v4, v31, 3, v4
    v_and_b32 v7, 1, v26
    v_lshl_add_u32 v4, v7, 5, v4
    v_xor_b32 v5, 32, v4
    s_add_u32 s44, s20, 0x1a00000
    s_addc_u32 s45, s21, 0
    s_and_b32 s45, s45, 0xffff
    s_mov_b32 s46, 31457280
    s_mov_b32 s47, 0x00020000
    v_add_u32 v6, 65536, v4
    v_add_u32 v7, 65536, v5
    v_add_u32 v8, 131072, v4
    v_add_u32 v9, 131072, v5
    s_add_u32 m0, s32, 0
    v_max_f32 v248, v248, v249
    v_mfma_f32_16x16x32_bf16 v[112:115], v[38:41], v[148:151], 0
    ds_read_b64_tr_b16 a[0:1], v10 offset:0
    ds_read_b64_tr_b16 a[2:3], v10 offset:2048
    ds_read_b64_tr_b16 a[4:5], v11 offset:0
    ds_read_b64_tr_b16 a[6:7], v11 offset:2048
    ds_read_b64_tr_b16 a[8:9], v12 offset:0
    ds_read_b64_tr_b16 a[10:11], v12 offset:2048
    s_mov_b32 s30, 0
    ds_read_b64_tr_b16 a[12:13], v13 offset:0
    ds_read_b64_tr_b16 a[14:15], v13 offset:2048
    ds_read_b64_tr_b16 a[16:17], v10 offset:4096
    ds_read_b64_tr_b16 a[18:19], v10 offset:6144
    ds_read_b64_tr_b16 a[20:21], v11 offset:4096
    v_max_f32 v250, v250, v251
    ds_read_b64_tr_b16 a[22:23], v11 offset:6144
    buffer_load_dwordx4 v2, s[12:15], s30 offen offset:0 lds
    ds_read_b64_tr_b16 a[24:25], v12 offset:4096
    ds_read_b64_tr_b16 a[26:27], v12 offset:6144
    ds_read_b64_tr_b16 a[28:29], v13 offset:4096
    ds_read_b64_tr_b16 a[30:31], v13 offset:6144
    ds_read_b64_tr_b16 a[32:33], v10 offset:8192
    ds_read_b64_tr_b16 a[34:35], v10 offset:10240
    buffer_load_dwordx4 v2, s[16:19], s30 offen offset:1024 lds
    ds_read_b64_tr_b16 a[36:37], v11 offset:8192
    ds_read_b64_tr_b16 a[38:39], v11 offset:10240
    ds_read_b64_tr_b16 a[40:41], v12 offset:8192
    ds_read_b64_tr_b16 a[42:43], v12 offset:10240
    ds_read_b64_tr_b16 a[44:45], v13 offset:8192
    ds_read_b64_tr_b16 a[46:47], v13 offset:10240
    buffer_load_dwordx4 v3, s[12:15], s30 offen offset:2048 lds
    ds_read_b64_tr_b16 a[48:49], v10 offset:12288
    ds_read_b64_tr_b16 a[50:51], v10 offset:14336
    v_mfma_f32_16x16x32_bf16 v[120:123], v[36:39], v[148:151], 0
    ds_read_b64_tr_b16 a[52:53], v11 offset:12288
    ds_read_b64_tr_b16 a[54:55], v11 offset:14336
    ds_read_b64_tr_b16 a[56:57], v12 offset:12288
    ds_read_b64_tr_b16 a[58:59], v12 offset:14336
    buffer_load_dwordx4 v3, s[16:19], s30 offen offset:3072 lds
    ds_read_b64_tr_b16 a[60:61], v13 offset:12288
    ds_read_b64_tr_b16 a[62:63], v13 offset:14336
    ds_read_b64_tr_b16 a[64:65], v10 offset:16384
    ds_read_b64_tr_b16 a[66:67], v10 offset:18432
    ds_read_b64_tr_b16 a[68:69], v11 offset:16384
    ds_read_b64_tr_b16 a[70:71], v11 offset:18432
    s_add_u32 m0, s32, 16384
    ds_read_b64_tr_b16 a[72:73], v12 offset:16384
    ds_read_b64_tr_b16 a[74:75], v12 offset:18432
    ds_read_b64_tr_b16 a[76:77], v13 offset:16384
    ds_read_b64_tr_b16 a[78:79], v13 offset:18432
    ds_read_b64_tr_b16 a[80:81], v10 offset:20480
    ds_read_b64_tr_b16 a[82:83], v10 offset:22528
    s_mov_b32 s30, 229376
    ds_read_b64_tr_b16 a[84:85], v11 offset:20480
    ds_read_b64_tr_b16 a[86:87], v11 offset:22528
    ds_read_b64_tr_b16 a[88:89], v12 offset:20480
    ds_read_b64_tr_b16 a[90:91], v12 offset:22528
    ds_read_b64_tr_b16 a[92:93], v13 offset:20480
    ds_read_b64_tr_b16 a[94:95], v13 offset:22528
    buffer_load_dwordx4 v2, s[12:15], s30 offen offset:0 lds
    ds_read_b64_tr_b16 a[96:97], v10 offset:24576
    ds_read_b64_tr_b16 a[98:99], v10 offset:26624
    ds_read_b64_tr_b16 a[100:101], v11 offset:24576
    ds_read_b64_tr_b16 a[102:103], v11 offset:26624
    ds_read_b64_tr_b16 a[104:105], v12 offset:24576
    ds_read_b64_tr_b16 a[106:107], v12 offset:26624
    v_permlane16_swap_b32 v248, v250
    buffer_load_dwordx4 v2, s[16:19], s30 offen offset:1024 lds
    ds_read_b64_tr_b16 a[108:109], v13 offset:24576
    ds_read_b64_tr_b16 a[110:111], v13 offset:26624
    ds_read_b64_tr_b16 a[112:113], v10 offset:28672
    ds_read_b64_tr_b16 a[114:115], v10 offset:30720
    ds_read_b64_tr_b16 a[116:117], v11 offset:28672
    ds_read_b64_tr_b16 a[118:119], v11 offset:30720
    buffer_load_dwordx4 v3, s[12:15], s30 offen offset:2048 lds
    ds_read_b64_tr_b16 a[120:121], v12 offset:28672
    ds_read_b64_tr_b16 a[122:123], v12 offset:30720
    ds_read_b64_tr_b16 a[124:125], v13 offset:28672
    ds_read_b64_tr_b16 a[126:127], v13 offset:30720
    buffer_load_dwordx4 v3, s[16:19], s30 offen offset:3072 lds
    v_add_u32 v10, 65536, v10
    v_add_u32 v11, 65536, v11
    v_add_u32 v12, 65536, v12
    v_add_u32 v13, 65536, v13
    v_max_f32 v248, v248, v250
    v_mov_b32 v14, 1
    s_waitcnt vmcnt(9) lgkmcnt(0)
    s_barrier
    s_cmp_eq_u32 s28, 0
    s_cbranch_scc0 L_qkv_f1
    s_mov_b64 exec, 1
    buffer_store_dword v14, off, s[36:39], s56 sc1
    s_mov_b64 exec, -1
L_qkv_f1:
    s_add_u32 m0, s32, 32768
    s_mov_b32 s30, 458752
    v_mul_f32 v248, v95, v248
    v_mov_b32 v250, v248
    s_nop 1
    v_permlane16_swap_b32 v248, v250
    s_nop 0
    v_mov_b32 v249, v248
    v_mov_b32 v251, v250
    s_nop 0
    v_permlane32_swap_b32 v248, v249
    v_permlane32_swap_b32 v250, v251
    v_fma_f32 v232, -v100, v95, -v249
    v_fma_f32 v100, v100, v95, -v248
    buffer_load_dwordx4 v2, s[12:15], s30 offen offset:0 lds
    v_fma_f32 v233, -v101, v95, -v249
    v_fma_f32 v101, v101, v95, -v248
    v_exp_f32 v232, v232
    v_exp_f32 v100, v100
    v_fma_f32 v234, -v102, v95, -v249
    v_fma_f32 v102, v102, v95, -v248
    v_exp_f32 v233, v233
    v_exp_f32 v101, v101
    v_fma_f32 v235, -v103, v95, -v249
    v_fma_f32 v103, v103, v95, -v248
    v_exp_f32 v234, v234
    v_exp_f32 v102, v102
    v_fma_f32 v236, -v108, v95, -v249
    v_fma_f32 v108, v108, v95, -v248
    buffer_load_dwordx4 v2, s[16:19], s30 offen offset:1024 lds
    v_exp_f32 v235, v235
    v_exp_f32 v103, v103
    v_fma_f32 v237, -v109, v95, -v249
    v_fma_f32 v109, v109, v95, -v248
    v_exp_f32 v236, v236
    v_exp_f32 v108, v108
    v_fma_f32 v238, -v110, v95, -v249
    v_fma_f32 v110, v110, v95, -v248
    v_exp_f32 v237, v237
    v_exp_f32 v109, v109
    v_fma_f32 v239, -v111, v95, -v249
    v_fma_f32 v111, v111, v95, -v248
    v_exp_f32 v238, v238
    buffer_load_dwordx4 v3, s[12:15], s30 offen offset:2048 lds
    v_exp_f32 v110, v110
    v_fma_f32 v240, -v116, v95, -v251
    v_fma_f32 v116, v116, v95, -v250
    v_exp_f32 v239, v239
    v_exp_f32 v111, v111
    v_cvt_pk_bf16_f32 v100, v100, v101
    v_cvt_pk_bf16_f32 v101, v102, v103
    v_cvt_pk_bf16_f32 v102, v108, v109
    v_cvt_pk_bf16_f32 v103, v110, v111
    v_cvt_pk_bf16_f32 v108, v232, v233
    v_cvt_pk_bf16_f32 v109, v234, v235
    v_cvt_pk_bf16_f32 v110, v236, v237
    v_cvt_pk_bf16_f32 v111, v238, v239
    v_fma_f32 v241, -v117, v95, -v251
    v_fma_f32 v117, v117, v95, -v250
    v_exp_f32 v240, v240
    buffer_load_dwordx4 v3, s[16:19], s30 offen offset:3072 lds
    v_exp_f32 v116, v116
    v_mfma_f32_16x16x32_bf16 v[128:131], a[152:155], v[100:103], 0
    v_fma_f32 v242, -v118, v95, -v251
    v_fma_f32 v118, v118, v95, -v250
    v_mfma_f32_16x16x32_bf16 v[132:135], a[156:159], v[108:111], 0
    v_exp_f32 v241, v241
    v_exp_f32 v117, v117
    s_add_u32 m0, s32, 49152
    s_mov_b32 s30, 688128
    buffer_load_dwordx4 v2, s[12:15], s30 offen offset:0 lds
    v_mfma_f32_16x16x32_bf16 v[208:211], a[136:139], v[100:103], 0
    v_fma_f32 v243, -v119, v95, -v251
    v_fma_f32 v119, v119, v95, -v250
    v_mfma_f32_16x16x32_bf16 v[212:215], a[144:147], v[100:103], 0
    v_exp_f32 v242, v242
    v_exp_f32 v118, v118
    buffer_load_dwordx4 v2, s[16:19], s30 offen offset:1024 lds
    v_mfma_f32_16x16x32_bf16 v[216:219], a[140:143], v[108:111], 0
    v_fma_f32 v244, -v124, v95, -v251
    v_fma_f32 v124, v124, v95, -v250
    v_mfma_f32_16x16x32_bf16 v[220:223], a[148:151], v[108:111], 0
    v_exp_f32 v243, v243
    v_exp_f32 v119, v119
    v_fma_f32 v245, -v125, v95, -v251
    v_fma_f32 v125, v125, v95, -v250
    v_exp_f32 v244, v244
    v_exp_f32 v124, v124
    v_fma_f32 v246, -v126, v95, -v251
    v_fma_f32 v126, v126, v95, -v250
    v_exp_f32 v245, v245
    v_exp_f32 v125, v125
    v_fma_f32 v247, -v127, v95, -v251
    v_fma_f32 v127, v127, v95, -v250
    v_exp_f32 v246, v246
    v_exp_f32 v126, v126
    buffer_load_dwordx4 v3, s[12:15], s30 offen offset:2048 lds
    v_exp_f32 v247, v247
    v_exp_f32 v127, v127
    v_cvt_pk_bf16_f32 v116, v116, v117
    v_cvt_pk_bf16_f32 v117, v118, v119
    v_cvt_pk_bf16_f32 v118, v124, v125
    v_cvt_pk_bf16_f32 v119, v126, v127
    v_cvt_pk_bf16_f32 v124, v240, v241
    v_cvt_pk_bf16_f32 v125, v242, v243
    v_cvt_pk_bf16_f32 v126, v244, v245
    v_cvt_pk_bf16_f32 v127, v246, v247
    v_rcp_f32 v129, v129
    v_rcp_f32 v133, v133
    v_mfma_f32_16x16x32_bf16 v[136:139], a[176:179], v[116:119], 0
    buffer_load_dwordx4 v3, s[16:19], s30 offen offset:3072 lds
    v_fmaak_f32 v128, v128, v129, 0x358637bd
    v_fmac_f32 v128, v132, v133
    v_mfma_f32_16x16x32_bf16 v[140:143], a[180:183], v[124:127], 0
    v_rcp_f32 v128, v128
    s_nop 0
    v_mul_f32 v129, v129, v128
    v_mfma_f32_16x16x32_bf16 v[224:227], a[160:163], v[116:119], 0
    v_mul_f32 v133, v133, v128
    v_mul_f32 v208, v208, v129
    s_add_u32 m0, s32, 65536
    s_mov_b32 s30, 917504
    buffer_load_dwordx4 v2, s[12:15], s30 offen offset:0 lds
    v_mfma_f32_16x16x32_bf16 v[228:231], a[168:171], v[116:119], 0
    v_mul_f32 v209, v209, v129
    v_mul_f32 v210, v210, v129
    v_mfma_f32_16x16x32_bf16 v[232:235], a[164:167], v[124:127], 0
    v_mul_f32 v211, v211, v129
    v_mul_f32 v212, v212, v129
    buffer_load_dwordx4 v2, s[16:19], s30 offen offset:1024 lds
    v_mfma_f32_16x16x32_bf16 v[236:239], a[172:175], v[124:127], 0
    v_mul_f32 v213, v213, v129
    v_mul_f32 v214, v214, v129
    v_mul_f32 v215, v215, v129
    v_fmac_f32 v208, v216, v133
    v_fmac_f32 v209, v217, v133
    v_fmac_f32 v210, v218, v133
    v_fmac_f32 v211, v219, v133
    v_fmac_f32 v212, v220, v133
    v_fmac_f32 v213, v221, v133
    v_fmac_f32 v214, v222, v133
    v_fmac_f32 v215, v223, v133
    v_cvt_pk_bf16_f32 v208, v208, v209
    v_cvt_pk_bf16_f32 v209, v210, v211
    v_cvt_pk_bf16_f32 v210, v212, v213
    v_cvt_pk_bf16_f32 v211, v214, v215
    buffer_load_dwordx4 v3, s[12:15], s30 offen offset:2048 lds
    buffer_store_dwordx4 v[208:211], v1, s[40:43], s48 offen offset:1024 sc1
    v_rcp_f32 v137, v137
    v_rcp_f32 v141, v141
    v_fmaak_f32 v136, v136, v137, 0x358637bd
    v_fmac_f32 v136, v140, v141
    v_rcp_f32 v136, v136
    s_nop 0
    v_mul_f32 v137, v137, v136
    v_mul_f32 v141, v141, v136
    v_mul_f32 v224, v224, v137
    v_mul_f32 v225, v225, v137
    v_mfma_f32_16x16x32_bf16 v[48:51], a[184:187], v[208:211], 0
    buffer_load_dwordx4 v3, s[16:19], s30 offen offset:3072 lds
    v_mul_f32 v226, v226, v137
    v_mul_f32 v227, v227, v137
    v_mul_f32 v228, v228, v137
    v_mul_f32 v229, v229, v137
    v_mul_f32 v230, v230, v137
    v_mul_f32 v231, v231, v137
    v_fmac_f32 v224, v232, v141
    v_fmac_f32 v225, v233, v141
    v_fmac_f32 v226, v234, v141
    v_fmac_f32 v227, v235, v141
    v_fmac_f32 v228, v236, v141
    v_fmac_f32 v229, v237, v141
    v_fmac_f32 v230, v238, v141
    v_fmac_f32 v231, v239, v141
    v_cvt_pk_bf16_f32 v224, v224, v225
    v_cvt_pk_bf16_f32 v225, v226, v227
    v_cvt_pk_bf16_f32 v226, v228, v229
    v_cvt_pk_bf16_f32 v227, v230, v231
    buffer_store_dwordx4 v[224:227], v1, s[40:43], s49 offen offset:1024 sc1
    v_mfma_f32_16x16x32_bf16 v[100:103], v[38:41], v[152:155], 0
    v_mfma_f32_16x16x32_bf16 v[108:111], v[36:39], v[152:155], 0
    v_mfma_f32_16x16x32_bf16 v[48:51], a[188:191], v[224:227], v[48:51]
    v_mfma_f32_16x16x32_bf16 v[116:119], v[38:41], v[156:159], 0
    v_mfma_f32_16x16x32_bf16 v[124:127], v[36:39], v[156:159], 0
    s_mov_b64 exec, 0xffff
    s_nop 4
    buffer_store_dword v48, v15, s[36:39], s25 offen offset:64 sc1
    s_mov_b64 exec, -1
    s_cmp_eq_u32 s28, 1
    s_cbranch_scc0 L_qkv_p1
    buffer_load_dword v16, v28, s[36:39], s57 offen sc1
L_qkv_p1:
    s_cmp_eq_u32 s28, 1
    s_cbranch_scc0 L_qkv_back1w
    s_waitcnt vmcnt(0)
    v_cmp_gt_i32 vcc, 1, v16
    s_nop 1
    s_cbranch_vccnz L_qkv_slow1w
L_qkv_back1w:
    s_waitcnt vmcnt(0)
    s_barrier
    v_mov_b32 v14, 2
    s_cmp_eq_u32 s28, 0
    s_cbranch_scc0 L_qkv_f2
    s_mov_b64 exec, 1
    buffer_store_dword v14, off, s[36:39], s56 sc1
    s_mov_b64 exec, -1
L_qkv_f2:
    buffer_load_dwordx4 a[128:131], v17, s[40:43], s24 offen offset:0 sc1
    buffer_load_dwordx4 a[132:135], v18, s[40:43], s24 offen offset:0 sc1
    buffer_load_dwordx4 a[136:139], v17, s[40:43], s24 offen offset:2048 sc1
    buffer_load_dwordx4 a[140:143], v18, s[40:43], s24 offen offset:2048 sc1
    s_mov_b32 s24, 4096
    buffer_load_dwordx4 a[144:147], v17, s[40:43], s24 offen offset:0 sc1
    buffer_load_dwordx4 a[148:151], v18, s[40:43], s24 offen offset:0 sc1
    buffer_load_dwordx4 a[152:155], v17, s[40:43], s24 offen offset:2048 sc1
    buffer_load_dwordx4 a[156:159], v18, s[40:43], s24 offen offset:2048 sc1
    s_mov_b32 s24, 8192
    buffer_load_dwordx4 a[160:163], v17, s[40:43], s24 offen offset:0 sc1
    buffer_load_dwordx4 a[164:167], v18, s[40:43], s24 offen offset:0 sc1
    buffer_load_dwordx4 a[168:171], v17, s[40:43], s24 offen offset:2048 sc1
    buffer_load_dwordx4 a[172:175], v18, s[40:43], s24 offen offset:2048 sc1
    s_mov_b32 s24, 12288
    buffer_load_dwordx4 a[176:179], v17, s[40:43], s24 offen offset:0 sc1
    buffer_load_dwordx4 a[180:183], v18, s[40:43], s24 offen offset:0 sc1
    buffer_load_dwordx4 a[184:187], v17, s[40:43], s24 offen offset:2048 sc1
    buffer_load_dwordx4 a[188:191], v18, s[40:43], s24 offen offset:2048 sc1
    s_mov_b32 s24, 16384
    s_waitcnt vmcnt(15)
    v_mfma_f32_16x16x32_bf16 v[96:99], a[0:3], a[128:131], v[96:99]
    s_waitcnt vmcnt(14)
    buffer_load_dword v52, v42, s[36:39], s35 offen offset:0 sc1
    s_add_u32 m0, s32, 81920
    v_mfma_f32_16x16x32_bf16 v[160:163], a[0:3], a[132:135], 0
    buffer_load_dword v53, v42, s[36:39], s35 offen offset:128 sc1
    s_mov_b32 s30, 1146880
    v_mfma_f32_16x16x32_bf16 v[104:107], a[4:7], a[128:131], v[104:107]
    buffer_load_dword v54, v42, s[36:39], s35 offen offset:256 sc1
    v_mfma_f32_16x16x32_bf16 v[164:167], a[4:7], a[132:135], 0
    buffer_load_dword v55, v42, s[36:39], s35 offen offset:384 sc1
    v_mfma_f32_16x16x32_bf16 v[112:115], a[8:11], a[128:131], v[112:115]
    v_mfma_f32_16x16x32_bf16 v[168:171], a[8:11], a[132:135], 0
    v_mfma_f32_16x16x32_bf16 v[120:123], a[12:15], a[128:131], v[120:123]
    buffer_load_dwordx4 a[192:195], v17, s[40:43], s24 offen offset:0 sc1
    v_mfma_f32_16x16x32_bf16 v[172:175], a[12:15], a[132:135], 0
    s_waitcnt vmcnt(18)
    v_mfma_f32_16x16x32_bf16 v[96:99], a[16:19], a[136:139], v[96:99]
    s_waitcnt vmcnt(17)
    v_mfma_f32_16x16x32_bf16 v[160:163], a[16:19], a[140:143], v[160:163]
    buffer_load_dwordx4 a[196:199], v18, s[40:43], s24 offen offset:0 sc1
    v_mfma_f32_16x16x32_bf16 v[104:107], a[20:23], a[136:139], v[104:107]
    v_mfma_f32_16x16x32_bf16 v[164:167], a[20:23], a[140:143], v[164:167]
    v_mfma_f32_16x16x32_bf16 v[112:115], a[24:27], a[136:139], v[112:115]
    buffer_load_dwordx4 a[200:203], v17, s[40:43], s24 offen offset:2048 sc1
    v_mfma_f32_16x16x32_bf16 v[168:171], a[24:27], a[140:143], v[168:171]
    v_mfma_f32_16x16x32_bf16 v[120:123], a[28:31], a[136:139], v[120:123]
    v_mfma_f32_16x16x32_bf16 v[172:175], a[28:31], a[140:143], v[172:175]
    s_waitcnt vmcnt(18)
    v_mfma_f32_16x16x32_bf16 v[96:99], a[32:35], a[144:147], v[96:99]
    s_waitcnt vmcnt(17)
    v_mfma_f32_16x16x32_bf16 v[160:163], a[32:35], a[148:151], v[160:163]
    buffer_load_dwordx4 a[204:207], v18, s[40:43], s24 offen offset:2048 sc1
    s_mov_b32 s24, 20480
    v_mfma_f32_16x16x32_bf16 v[104:107], a[36:39], a[144:147], v[104:107]
    v_mfma_f32_16x16x32_bf16 v[164:167], a[36:39], a[148:151], v[164:167]
    v_mfma_f32_16x16x32_bf16 v[112:115], a[40:43], a[144:147], v[112:115]
    buffer_load_dwordx4 a[208:211], v17, s[40:43], s24 offen offset:0 sc1
    v_mfma_f32_16x16x32_bf16 v[168:171], a[40:43], a[148:151], v[168:171]
    v_mfma_f32_16x16x32_bf16 v[120:123], a[44:47], a[144:147], v[120:123]
    v_mfma_f32_16x16x32_bf16 v[172:175], a[44:47], a[148:151], v[172:175]
    s_waitcnt vmcnt(18)
    v_mfma_f32_16x16x32_bf16 v[96:99], a[48:51], a[152:155], v[96:99]
    s_waitcnt vmcnt(17)
    v_mfma_f32_16x16x32_bf16 v[160:163], a[48:51], a[156:159], v[160:163]
    buffer_load_dwordx4 a[212:215], v18, s[40:43], s24 offen offset:0 sc1
    v_mfma_f32_16x16x32_bf16 v[104:107], a[52:55], a[152:155], v[104:107]
    v_mfma_f32_16x16x32_bf16 v[164:167], a[52:55], a[156:159], v[164:167]
    v_mfma_f32_16x16x32_bf16 v[112:115], a[56:59], a[152:155], v[112:115]
    buffer_load_dwordx4 a[216:219], v17, s[40:43], s24 offen offset:2048 sc1
    v_mfma_f32_16x16x32_bf16 v[168:171], a[56:59], a[156:159], v[168:171]
    v_mfma_f32_16x16x32_bf16 v[120:123], a[60:63], a[152:155], v[120:123]
    v_mfma_f32_16x16x32_bf16 v[172:175], a[60:63], a[156:159], v[172:175]
    s_waitcnt vmcnt(18)
    v_mfma_f32_16x16x32_bf16 v[96:99], a[64:67], a[160:163], v[96:99]
    s_waitcnt vmcnt(17)
    v_mfma_f32_16x16x32_bf16 v[160:163], a[64:67], a[164:167], v[160:163]
    buffer_load_dwordx4 a[220:223], v18, s[40:43], s24 offen offset:2048 sc1
    s_mov_b32 s24, 24576
    v_mfma_f32_16x16x32_bf16 v[104:107], a[68:71], a[160:163], v[104:107]
    v_mfma_f32_16x16x32_bf16 v[164:167], a[68:71], a[164:167], v[164:167]
    v_mfma_f32_16x16x32_bf16 v[112:115], a[72:75], a[160:163], v[112:115]
    buffer_load_dwordx4 a[224:227], v17, s[40:43], s24 offen offset:0 sc1
    v_mfma_f32_16x16x32_bf16 v[168:171], a[72:75], a[164:167], v[168:171]
    v_mfma_f32_16x16x32_bf16 v[120:123], a[76:79], a[160:163], v[120:123]
    v_mfma_f32_16x16x32_bf16 v[172:175], a[76:79], a[164:167], v[172:175]
    s_waitcnt vmcnt(18)
    v_mfma_f32_16x16x32_bf16 v[96:99], a[80:83], a[168:171], v[96:99]
    s_waitcnt vmcnt(17)
    v_mfma_f32_16x16x32_bf16 v[160:163], a[80:83], a[172:175], v[160:163]
    buffer_load_dwordx4 a[228:231], v18, s[40:43], s24 offen offset:0 sc1
    v_mfma_f32_16x16x32_bf16 v[104:107], a[84:87], a[168:171], v[104:107]
    v_mfma_f32_16x16x32_bf16 v[164:167], a[84:87], a[172:175], v[164:167]
    v_mfma_f32_16x16x32_bf16 v[112:115], a[88:91], a[168:171], v[112:115]
    buffer_load_dwordx4 a[232:235], v17, s[40:43], s24 offen offset:2048 sc1
    v_mfma_f32_16x16x32_bf16 v[168:171], a[88:91], a[172:175], v[168:171]
    v_mfma_f32_16x16x32_bf16 v[120:123], a[92:95], a[168:171], v[120:123]
    v_mfma_f32_16x16x32_bf16 v[172:175], a[92:95], a[172:175], v[172:175]
    s_waitcnt vmcnt(18)
    v_mfma_f32_16x16x32_bf16 v[96:99], a[96:99], a[176:179], v[96:99]
    s_waitcnt vmcnt(17)
    v_mfma_f32_16x16x32_bf16 v[160:163], a[96:99], a[180:183], v[160:163]
    buffer_load_dwordx4 a[236:239], v18, s[40:43], s24 offen offset:2048 sc1
    s_mov_b32 s24, 28672
    v_mfma_f32_16x16x32_bf16 v[104:107], a[100:103], a[176:179], v[104:107]
    ds_read_b64_tr_b16 v[60:61], v10 offset:0
    v_mfma_f32_16x16x32_bf16 v[164:167], a[100:103], a[180:183], v[164:167]
    ds_read_b64_tr_b16 v[62:63], v10 offset:2048
    v_mfma_f32_16x16x32_bf16 v[112:115], a[104:107], a[176:179], v[112:115]
    buffer_load_dwordx4 a[240:243], v17, s[40:43], s24 offen offset:0 sc1
    v_mfma_f32_16x16x32_bf16 v[168:171], a[104:107], a[180:183], v[168:171]
    ds_read_b64_tr_b16 v[64:65], v11 offset:0
    v_mfma_f32_16x16x32_bf16 v[120:123], a[108:111], a[176:179], v[120:123]
    ds_read_b64_tr_b16 v[66:67], v11 offset:2048
    v_mfma_f32_16x16x32_bf16 v[172:175], a[108:111], a[180:183], v[172:175]
    s_waitcnt vmcnt(18)
    ds_read_b64_tr_b16 v[68:69], v12 offset:0
    v_mfma_f32_16x16x32_bf16 v[96:99], a[112:115], a[184:187], v[96:99]
    s_waitcnt vmcnt(17)
    ds_read_b64_tr_b16 v[70:71], v12 offset:2048
    v_mfma_f32_16x16x32_bf16 v[160:163], a[112:115], a[188:191], v[160:163]
    buffer_load_dwordx4 a[244:247], v18, s[40:43], s24 offen offset:0 sc1
    v_mfma_f32_16x16x32_bf16 v[104:107], a[116:119], a[184:187], v[104:107]
    ds_read_b64_tr_b16 v[72:73], v13 offset:0
    v_mfma_f32_16x16x32_bf16 v[164:167], a[116:119], a[188:191], v[164:167]
    ds_read_b64_tr_b16 v[74:75], v13 offset:2048
    v_mfma_f32_16x16x32_bf16 v[112:115], a[120:123], a[184:187], v[112:115]
    buffer_load_dwordx4 a[248:251], v17, s[40:43], s24 offen offset:2048 sc1
    s_cmp_eq_u32 s28, 1
    s_cbranch_scc0 L_qkv_p2
    buffer_load_dword v16, v28, s[36:39], s57 offen sc1
L_qkv_p2:
    v_mfma_f32_16x16x32_bf16 v[168:171], a[120:123], a[188:191], v[168:171]
    ds_read_b64_tr_b16 v[76:77], v10 offset:4096
    v_mfma_f32_16x16x32_bf16 v[120:123], a[124:127], a[184:187], v[120:123]
    buffer_load_dwordx4 a[252:255], v18, s[40:43], s24 offen offset:2048 sc1
    s_mov_b32 s24, 0
    v_mfma_f32_16x16x32_bf16 v[172:175], a[124:127], a[188:191], v[172:175]
    s_waitcnt vmcnt(15) lgkmcnt(3)
    ds_read_b64_tr_b16 v[78:79], v10 offset:6144
    v_mfma_f32_16x16x32_bf16 v[96:99], v[60:63], a[192:195], v[96:99]
    s_waitcnt vmcnt(14)
    ds_read_b64_tr_b16 v[80:81], v11 offset:4096
    v_mfma_f32_16x16x32_bf16 v[160:163], v[60:63], a[196:199], v[160:163]
    ds_read_b64_tr_b16 v[82:83], v11 offset:6144
    v_mfma_f32_16x16x32_bf16 v[104:107], v[64:67], a[192:195], v[104:107]
    v_add_f32 v52, v52, v53
    v_mfma_f32_16x16x32_bf16 v[164:167], v[64:67], a[196:199], v[164:167]
    ds_read_b64_tr_b16 v[84:85], v12 offset:4096
    v_mfma_f32_16x16x32_bf16 v[112:115], v[68:71], a[192:195], v[112:115]
    ds_read_b64_tr_b16 v[86:87], v12 offset:6144
    v_add_f32 v54, v54, v55
    v_mfma_f32_16x16x32_bf16 v[168:171], v[68:71], a[196:199], v[168:171]
    s_waitcnt lgkmcnt(4)
    ds_read_b64_tr_b16 v[88:89], v13 offset:4096
    v_mfma_f32_16x16x32_bf16 v[120:123], v[72:75], a[192:195], v[120:123]
    ds_read_b64_tr_b16 v[90:91], v13 offset:6144
    v_add_f32 v52, v52, v54
    v_mfma_f32_16x16x32_bf16 v[172:175], v[72:75], a[196:199], v[172:175]
    s_waitcnt vmcnt(13)
    ds_read_b64_tr_b16 v[60:61], v10 offset:8192
    v_mov_b32 v53, v52
    v_mfma_f32_16x16x32_bf16 v[96:99], v[76:79], a[200:203], v[96:99]
    s_waitcnt vmcnt(12)
    ds_read_b64_tr_b16 v[62:63], v10 offset:10240
    v_mfma_f32_16x16x32_bf16 v[160:163], v[76:79], a[204:207], v[160:163]
    s_waitcnt lgkmcnt(5)
    ds_read_b64_tr_b16 v[64:65], v11 offset:8192
    v_mfma_f32_16x16x32_bf16 v[104:107], v[80:83], a[200:203], v[104:107]
    ds_read_b64_tr_b16 v[66:67], v11 offset:10240
    v_mfma_f32_16x16x32_bf16 v[164:167], v[80:83], a[204:207], v[164:167]
    s_waitcnt lgkmcnt(5)
    ds_read_b64_tr_b16 v[68:69], v12 offset:8192
    v_permlane16_swap_b32 v52, v53
    v_mfma_f32_16x16x32_bf16 v[112:115], v[84:87], a[200:203], v[112:115]
    ds_read_b64_tr_b16 v[70:71], v12 offset:10240
    v_add_f32 v52, v52, v53
    v_mfma_f32_16x16x32_bf16 v[168:171], v[84:87], a[204:207], v[168:171]
    s_waitcnt lgkmcnt(5)
    ds_read_b64_tr_b16 v[72:73], v13 offset:8192
    v_mfma_f32_16x16x32_bf16 v[120:123], v[88:91], a[200:203], v[120:123]
    ds_read_b64_tr_b16 v[74:75], v13 offset:10240
    v_mov_b32 v53, v52
    v_mfma_f32_16x16x32_bf16 v[172:175], v[88:91], a[204:207], v[172:175]
    s_waitcnt vmcnt(11) lgkmcnt(5)
    ds_read_b64_tr_b16 v[76:77], v10 offset:12288
    v_mfma_f32_16x16x32_bf16 v[96:99], v[60:63], a[208:211], v[96:99]
    s_waitcnt vmcnt(10)
    ds_read_b64_tr_b16 v[78:79], v10 offset:14336
    v_mfma_f32_16x16x32_bf16 v[160:163], v[60:63], a[212:215], v[160:163]
    s_waitcnt lgkmcnt(5)
    ds_read_b64_tr_b16 v[80:81], v11 offset:12288
    v_permlane32_swap_b32 v52, v53
    v_mfma_f32_16x16x32_bf16 v[104:107], v[64:67], a[208:211], v[104:107]
    ds_read_b64_tr_b16 v[82:83], v11 offset:14336
    v_add_f32 v52, v52, v53
    v_mfma_f32_16x16x32_bf16 v[164:167], v[64:67], a[212:215], v[164:167]
    s_waitcnt lgkmcnt(5)
    ds_read_b64_tr_b16 v[84:85], v12 offset:12288
    v_mfma_f32_16x16x32_bf16 v[112:115], v[68:71], a[208:211], v[112:115]
    ds_read_b64_tr_b16 v[86:87], v12 offset:14336
    v_add_f32 v44, v52, v92
    v_mfma_f32_16x16x32_bf16 v[168:171], v[68:71], a[212:215], v[168:171]
    s_waitcnt lgkmcnt(5)
    ds_read_b64_tr_b16 v[88:89], v13 offset:12288
    v_mfma_f32_16x16x32_bf16 v[120:123], v[72:75], a[208:211], v[120:123]
    ds_read_b64_tr_b16 v[90:91], v13 offset:14336
    v_mfma_f32_16x16x32_bf16 v[172:175], v[72:75], a[212:215], v[172:175]
    s_waitcnt vmcnt(9) lgkmcnt(5)
    ds_read_b64_tr_b16 v[60:61], v10 offset:16384
    v_mfma_f32_16x16x32_bf16 v[96:99], v[76:79], a[216:219], v[96:99]
    s_waitcnt vmcnt(8)
    ds_read_b64_tr_b16 v[62:63], v10 offset:18432
    v_mfma_f32_16x16x32_bf16 v[160:163], v[76:79], a[220:223], v[160:163]
    s_waitcnt lgkmcnt(5)
    ds_read_b64_tr_b16 v[64:65], v11 offset:16384
    v_mfma_f32_16x16x32_bf16 v[104:107], v[80:83], a[216:219], v[104:107]
    ds_read_b64_tr_b16 v[66:67], v11 offset:18432
    v_mfma_f32_16x16x32_bf16 v[164:167], v[80:83], a[220:223], v[164:167]
    s_waitcnt lgkmcnt(5)
    ds_read_b64_tr_b16 v[68:69], v12 offset:16384
    v_mfma_f32_16x16x32_bf16 v[112:115], v[84:87], a[216:219], v[112:115]
    ds_read_b64_tr_b16 v[70:71], v12 offset:18432
    v_sub_f32 v96, v96, v44
    v_mfma_f32_16x16x32_bf16 v[168:171], v[84:87], a[220:223], v[168:171]
    s_waitcnt lgkmcnt(5)
    s_cmp_eq_u32 s28, 1
    s_cbranch_scc0 L_qkv_back2w
    s_waitcnt vmcnt(1)
    v_cmp_gt_i32 vcc, 2, v16
    s_nop 1
    s_cbranch_vccnz L_qkv_slow2w
L_qkv_back2w:
    s_barrier
    v_and_b32 v28, 19, v0
    v_mul_u32_u24 v28, 640, v28
    v_mfma_f32_16x16x32_bf16 v[120:123], v[88:91], a[216:219], v[120:123]
    buffer_load_dwordx4 a[128:131], v17, s[40:43], s24 offen offset:1024 sc1
    s_mul_i32 s57, s26, 20480
    v_sub_f32 v104, v104, v44
    v_mfma_f32_16x16x32_bf16 v[172:175], v[88:91], a[220:223], v[172:175]
    s_waitcnt vmcnt(8) lgkmcnt(3)
    s_add_u32 s57, s57, 8912896
    ds_read_b64_tr_b16 v[72:73], v13 offset:16384
    v_mfma_f32_16x16x32_bf16 v[96:99], v[60:63], a[224:227], v[96:99]
    s_waitcnt vmcnt(7)
    ds_read_b64_tr_b16 v[74:75], v13 offset:18432
    ds_read_b64_tr_b16 v[76:77], v10 offset:20480
    v_sub_f32 v112, v112, v44
    v_mfma_f32_16x16x32_bf16 v[160:163], v[60:63], a[228:231], v[160:163]
    s_waitcnt lgkmcnt(4)
    ds_read_b64_tr_b16 v[78:79], v10 offset:22528
    v_mfma_f32_16x16x32_bf16 v[104:107], v[64:67], a[224:227], v[104:107]
    buffer_load_dwordx4 a[132:135], v18, s[40:43], s24 offen offset:1024 sc1
    ds_read_b64_tr_b16 v[80:81], v11 offset:20480
    v_sub_f32 v120, v120, v44
    v_mfma_f32_16x16x32_bf16 v[164:167], v[64:67], a[228:231], v[164:167]
    s_waitcnt lgkmcnt(5)
    ds_read_b64_tr_b16 v[82:83], v11 offset:22528
    v_mfma_f32_16x16x32_bf16 v[112:115], v[68:71], a[224:227], v[112:115]
    ds_read_b64_tr_b16 v[84:85], v12 offset:20480
    ds_read_b64_tr_b16 v[86:87], v12 offset:22528
    v_sub_f32 v97, v97, v44
    v_mfma_f32_16x16x32_bf16 v[168:171], v[68:71], a[228:231], v[168:171]
    s_waitcnt lgkmcnt(6)
    ds_read_b64_tr_b16 v[88:89], v13 offset:20480
    v_mfma_f32_16x16x32_bf16 v[120:123], v[72:75], a[224:227], v[120:123]
    buffer_load_dwordx4 a[136:139], v17, s[40:43], s24 offen offset:3072 sc1
    ds_read_b64_tr_b16 v[90:91], v13 offset:22528
    v_sub_f32 v105, v105, v44
    v_mfma_f32_16x16x32_bf16 v[172:175], v[72:75], a[228:231], v[172:175]
    s_waitcnt vmcnt(8) lgkmcnt(6)
    ds_read_b64_tr_b16 v[60:61], v10 offset:24576
    v_mfma_f32_16x16x32_bf16 v[96:99], v[76:79], a[232:235], v[96:99]
    s_waitcnt vmcnt(7)
    ds_read_b64_tr_b16 v[62:63], v10 offset:26624
    v_sub_f32 v113, v113, v44
    v_mfma_f32_16x16x32_bf16 v[160:163], v[76:79], a[236:239], v[160:163]
    s_waitcnt lgkmcnt(6)
    ds_read_b64_tr_b16 v[64:65], v11 offset:24576
    v_mfma_f32_16x16x32_bf16 v[104:107], v[80:83], a[232:235], v[104:107]
    buffer_load_dwordx4 a[140:143], v18, s[40:43], s24 offen offset:3072 sc1
    s_mov_b32 s24, 4096
    v_sub_f32 v121, v121, v44
    v_mfma_f32_16x16x32_bf16 v[164:167], v[80:83], a[236:239], v[164:167]
    s_waitcnt lgkmcnt(4)
    ds_read_b64_tr_b16 v[66:67], v11 offset:26624
    v_mfma_f32_16x16x32_bf16 v[112:115], v[84:87], a[232:235], v[112:115]
    ds_read_b64_tr_b16 v[68:69], v12 offset:24576
    ds_read_b64_tr_b16 v[70:71], v12 offset:26624
    v_sub_f32 v98, v98, v44
    v_mfma_f32_16x16x32_bf16 v[168:171], v[84:87], a[236:239], v[168:171]
    s_waitcnt lgkmcnt(5)
    ds_read_b64_tr_b16 v[72:73], v13 offset:24576
    v_mfma_f32_16x16x32_bf16 v[120:123], v[88:91], a[232:235], v[120:123]
    buffer_load_dwordx4 a[144:147], v17, s[40:43], s24 offen offset:1024 sc1
    ds_read_b64_tr_b16 v[74:75], v13 offset:26624
    v_sub_f32 v106, v106, v44
    v_mfma_f32_16x16x32_bf16 v[172:175], v[88:91], a[236:239], v[172:175]
    s_waitcnt vmcnt(8) lgkmcnt(5)
    ds_read_b64_tr_b16 v[76:77], v10 offset:28672
    v_mfma_f32_16x16x32_bf16 v[96:99], v[60:63], a[240:243], v[96:99]
    s_waitcnt vmcnt(7)
    ds_read_b64_tr_b16 v[78:79], v10 offset:30720
    v_sub_f32 v114, v114, v44
    v_mfma_f32_16x16x32_bf16 v[160:163], v[60:63], a[244:247], v[160:163]
    s_waitcnt lgkmcnt(6)
    ds_read_b64_tr_b16 v[80:81], v11 offset:28672
    v_mfma_f32_16x16x32_bf16 v[104:107], v[64:67], a[240:243], v[104:107]
    buffer_load_dwordx4 a[148:151], v18, s[40:43], s24 offen offset:1024 sc1
    ds_read_b64_tr_b16 v[82:83], v11 offset:30720
    v_sub_f32 v122, v122, v44
    v_mfma_f32_16x16x32_bf16 v[164:167], v[64:67], a[244:247], v[164:167]
    s_waitcnt lgkmcnt(5)
    ds_read_b64_tr_b16 v[84:85], v12 offset:28672
    v_mfma_f32_16x16x32_bf16 v[112:115], v[68:71], a[240:243], v[112:115]
    ds_read_b64_tr_b16 v[86:87], v12 offset:30720
    v_sub_f32 v99, v99, v44
    v_mfma_f32_16x16x32_bf16 v[168:171], v[68:71], a[244:247], v[168:171]
    s_waitcnt lgkmcnt(5)
    ds_read_b64_tr_b16 v[88:89], v13 offset:28672
    v_mfma_f32_16x16x32_bf16 v[120:123], v[72:75], a[240:243], v[120:123]
    buffer_load_dwordx4 a[152:155], v17, s[40:43], s24 offen offset:3072 sc1
    ds_read_b64_tr_b16 v[90:91], v13 offset:30720
    v_sub_f32 v107, v107, v44
    v_mfma_f32_16x16x32_bf16 v[172:175], v[72:75], a[244:247], v[172:175]
    s_waitcnt vmcnt(8) lgkmcnt(5)
    v_mfma_f32_16x16x32_bf16 v[96:99], v[76:79], a[248:251], v[96:99]
    s_waitcnt vmcnt(7)
    v_sub_f32 v115, v115, v44
    v_mfma_f32_16x16x32_bf16 v[160:163], v[76:79], a[252:255], v[160:163]
    s_waitcnt lgkmcnt(3)
    v_mfma_f32_16x16x32_bf16 v[104:107], v[80:83], a[248:251], v[104:107]
    buffer_load_dwordx4 a[156:159], v18, s[40:43], s24 offen offset:3072 sc1
    s_mov_b32 s24, 8192
    v_sub_f32 v123, v123, v44
    v_mfma_f32_16x16x32_bf16 v[164:167], v[80:83], a[252:255], v[164:167]
    s_waitcnt lgkmcnt(1)
    v_mfma_f32_16x16x32_bf16 v[112:115], v[84:87], a[248:251], v[112:115]
    v_mfma_f32_16x16x32_bf16 v[168:171], v[84:87], a[252:255], v[168:171]
    s_waitcnt lgkmcnt(0)
    ds_write_b128 v20, v[160:163] offset:0
    v_mfma_f32_16x16x32_bf16 v[120:123], v[88:91], a[248:251], v[120:123]
    buffer_load_dwordx4 a[160:163], v17, s[40:43], s24 offen offset:1024 sc1
    v_mfma_f32_16x16x32_bf16 v[172:175], v[88:91], a[252:255], v[172:175]
    s_waitcnt vmcnt(8)
    ds_write_b128 v20, v[164:167] offset:1024
    v_mfma_f32_16x16x32_bf16 v[100:103], a[0:3], a[128:131], v[100:103]
    s_waitcnt vmcnt(7)
    v_mfma_f32_16x16x32_bf16 v[212:215], a[0:3], a[132:135], 0
    buffer_load_dwordx4 a[164:167], v18, s[40:43], s24 offen offset:1024 sc1
    ds_write_b128 v20, v[168:171] offset:2048
    v_mfma_f32_16x16x32_bf16 v[108:111], a[4:7], a[128:131], v[108:111]
    v_mfma_f32_16x16x32_bf16 v[220:223], a[4:7], a[132:135], 0
    ds_write_b128 v20, v[172:175] offset:3072
    v_mfma_f32_16x16x32_bf16 v[116:119], a[8:11], a[128:131], v[116:119]
    buffer_load_dwordx4 a[168:171], v17, s[40:43], s24 offen offset:3072 sc1
    v_mfma_f32_16x16x32_bf16 v[228:231], a[8:11], a[132:135], 0
    v_mfma_f32_16x16x32_bf16 v[124:127], a[12:15], a[128:131], v[124:127]
    v_mfma_f32_16x16x32_bf16 v[236:239], a[12:15], a[132:135], 0
    s_waitcnt vmcnt(8)
    s_waitcnt lgkmcnt(0)
    s_barrier
    ds_read_b128 v[160:163], v19 offset:0
    ds_read_b128 v[164:167], v19 offset:1024
    v_mfma_f32_16x16x32_bf16 v[100:103], a[16:19], a[136:139], v[100:103]
    s_waitcnt vmcnt(7)
    ds_read_b128 v[168:171], v19 offset:2048
    ds_read_b128 v[172:175], v19 offset:3072
    v_mfma_f32_16x16x32_bf16 v[212:215], a[16:19], a[140:143], v[212:215]
    buffer_load_dwordx4 a[172:175], v18, s[40:43], s24 offen offset:3072 sc1
    s_mov_b32 s24, 12288
    v_mfma_f32_16x16x32_bf16 v[108:111], a[20:23], a[136:139], v[108:111]
    v_mfma_f32_16x16x32_bf16 v[220:223], a[20:23], a[140:143], v[220:223]
    v_mfma_f32_16x16x32_bf16 v[116:119], a[24:27], a[136:139], v[116:119]
    buffer_load_dwordx4 a[176:179], v17, s[40:43], s24 offen offset:1024 sc1
    v_mfma_f32_16x16x32_bf16 v[228:231], a[24:27], a[140:143], v[228:231]
    v_mfma_f32_16x16x32_bf16 v[124:127], a[28:31], a[136:139], v[124:127]
    v_mfma_f32_16x16x32_bf16 v[236:239], a[28:31], a[140:143], v[236:239]
    s_waitcnt vmcnt(8)
    s_waitcnt lgkmcnt(0)
    v_add_f32 v96, v96, v160
    v_add_f32 v97, v97, v161
    v_add_f32 v98, v98, v162
    v_add_f32 v99, v99, v163
    v_cvt_pk_bf16_f32 v128, v96, v97
    v_mfma_f32_16x16x32_bf16 v[100:103], a[32:35], a[144:147], v[100:103]
    s_waitcnt vmcnt(7)
    v_cvt_pk_bf16_f32 v129, v98, v99
    v_add_f32 v104, v104, v164
    v_add_f32 v105, v105, v165
    v_add_f32 v106, v106, v166
    v_add_f32 v107, v107, v167
    v_cvt_pk_bf16_f32 v130, v104, v105
    v_mfma_f32_16x16x32_bf16 v[212:215], a[32:35], a[148:151], v[212:215]
    buffer_load_dwordx4 a[180:183], v18, s[40:43], s24 offen offset:1024 sc1
    v_cvt_pk_bf16_f32 v131, v106, v107
    v_mfma_f32_16x16x32_bf16 v[108:111], a[36:39], a[144:147], v[108:111]
    buffer_store_dwordx4 v[128:131], v1, s[40:43], s58 offen offset:0 sc1
    v_add_f32 v112, v112, v168
    v_add_f32 v113, v113, v169
    v_add_f32 v114, v114, v170
    v_add_f32 v115, v115, v171
    v_mfma_f32_16x16x32_bf16 v[220:223], a[36:39], a[148:151], v[220:223]
    v_cvt_pk_bf16_f32 v132, v112, v113
    v_cvt_pk_bf16_f32 v133, v114, v115
    v_add_f32 v120, v120, v172
    v_add_f32 v121, v121, v173
    v_add_f32 v122, v122, v174
    v_add_f32 v123, v123, v175
    v_mfma_f32_16x16x32_bf16 v[116:119], a[40:43], a[144:147], v[116:119]
    buffer_load_dwordx4 a[184:187], v17, s[40:43], s24 offen offset:3072 sc1
    v_cvt_pk_bf16_f32 v134, v120, v121
    v_cvt_pk_bf16_f32 v135, v122, v123
    v_mfma_f32_16x16x32_bf16 v[228:231], a[40:43], a[148:151], v[228:231]
    buffer_store_dwordx4 v[132:135], v1, s[40:43], s59 offen offset:0 sc1
    v_mfma_f32_16x16x32_bf16 v[124:127], a[44:47], a[144:147], v[124:127]
    v_mfma_f32_16x16x32_bf16 v[236:239], a[44:47], a[148:151], v[236:239]
    s_waitcnt vmcnt(10)
    v_mfma_f32_16x16x32_bf16 v[100:103], a[48:51], a[152:155], v[100:103]
    s_waitcnt vmcnt(9)
    v_mfma_f32_16x16x32_bf16 v[212:215], a[48:51], a[156:159], v[212:215]
    buffer_load_dwordx4 a[188:191], v18, s[40:43], s24 offen offset:3072 sc1
    s_mov_b32 s24, 16384
    v_mfma_f32_16x16x32_bf16 v[108:111], a[52:55], a[152:155], v[108:111]
    buffer_load_dword v56, v42, s[36:39], s35 offen offset:64 sc1
    v_mfma_f32_16x16x32_bf16 v[220:223], a[52:55], a[156:159], v[220:223]
    buffer_load_dword v57, v42, s[36:39], s35 offen offset:192 sc1
    v_mfma_f32_16x16x32_bf16 v[116:119], a[56:59], a[152:155], v[116:119]
    buffer_load_dword v58, v42, s[36:39], s35 offen offset:320 sc1
    v_mfma_f32_16x16x32_bf16 v[228:231], a[56:59], a[156:159], v[228:231]
    buffer_load_dword v59, v42, s[36:39], s35 offen offset:448 sc1
    v_mfma_f32_16x16x32_bf16 v[124:127], a[60:63], a[152:155], v[124:127]
    v_mfma_f32_16x16x32_bf16 v[236:239], a[60:63], a[156:159], v[236:239]
    s_waitcnt vmcnt(13)
    v_mfma_f32_16x16x32_bf16 v[100:103], a[64:67], a[160:163], v[100:103]
    s_waitcnt vmcnt(12)
    v_mfma_f32_16x16x32_bf16 v[212:215], a[64:67], a[164:167], v[212:215]
    buffer_load_dwordx4 a[192:195], v17, s[40:43], s24 offen offset:1024 sc1
    v_mfma_f32_16x16x32_bf16 v[108:111], a[68:71], a[160:163], v[108:111]
    v_mul_f32 v22, v96, v96
    v_mfma_f32_16x16x32_bf16 v[220:223], a[68:71], a[164:167], v[220:223]
    v_mul_f32 v24, v97, v97
    v_mfma_f32_16x16x32_bf16 v[116:119], a[72:75], a[160:163], v[116:119]
    buffer_load_dwordx4 a[196:199], v18, s[40:43], s24 offen offset:1024 sc1
    v_mfma_f32_16x16x32_bf16 v[228:231], a[72:75], a[164:167], v[228:231]
    v_fmac_f32 v22, v98, v98
    v_mfma_f32_16x16x32_bf16 v[124:127], a[76:79], a[160:163], v[124:127]
    v_mfma_f32_16x16x32_bf16 v[236:239], a[76:79], a[164:167], v[236:239]
    s_waitcnt vmcnt(13)
    v_fmac_f32 v24, v99, v99
    v_mfma_f32_16x16x32_bf16 v[100:103], a[80:83], a[168:171], v[100:103]
    s_waitcnt vmcnt(12)
    v_mfma_f32_16x16x32_bf16 v[212:215], a[80:83], a[172:175], v[212:215]
    buffer_load_dwordx4 a[200:203], v17, s[40:43], s24 offen offset:3072 sc1
    v_mfma_f32_16x16x32_bf16 v[108:111], a[84:87], a[168:171], v[108:111]
    v_fmac_f32 v22, v104, v104
    v_mfma_f32_16x16x32_bf16 v[220:223], a[84:87], a[172:175], v[220:223]
    v_mfma_f32_16x16x32_bf16 v[116:119], a[88:91], a[168:171], v[116:119]
    buffer_load_dwordx4 a[204:207], v18, s[40:43], s24 offen offset:3072 sc1
    s_mov_b32 s24, 20480
    v_mfma_f32_16x16x32_bf16 v[228:231], a[88:91], a[172:175], v[228:231]
    v_fmac_f32 v24, v105, v105
    v_mfma_f32_16x16x32_bf16 v[124:127], a[92:95], a[168:171], v[124:127]
    v_fmac_f32 v22, v106, v106
    v_mfma_f32_16x16x32_bf16 v[236:239], a[92:95], a[172:175], v[236:239]
    s_waitcnt vmcnt(13)
    v_mfma_f32_16x16x32_bf16 v[100:103], a[96:99], a[176:179], v[100:103]
    s_waitcnt vmcnt(12)
    v_mfma_f32_16x16x32_bf16 v[212:215], a[96:99], a[180:183], v[212:215]
    buffer_load_dwordx4 a[208:211], v17, s[40:43], s24 offen offset:1024 sc1
    v_mfma_f32_16x16x32_bf16 v[108:111], a[100:103], a[176:179], v[108:111]
    ds_read_b64_tr_b16 v[60:61], v10 offset:0
    v_fmac_f32 v24, v107, v107
    v_mfma_f32_16x16x32_bf16 v[220:223], a[100:103], a[180:183], v[220:223]
    ds_read_b64_tr_b16 v[62:63], v10 offset:2048
    v_fmac_f32 v22, v112, v112
    v_mfma_f32_16x16x32_bf16 v[116:119], a[104:107], a[176:179], v[116:119]
    buffer_load_dwordx4 a[212:215], v18, s[40:43], s24 offen offset:1024 sc1
    v_mfma_f32_16x16x32_bf16 v[228:231], a[104:107], a[180:183], v[228:231]
    ds_read_b64_tr_b16 v[64:65], v11 offset:0
    v_fmac_f32 v24, v113, v113
    v_mfma_f32_16x16x32_bf16 v[124:127], a[108:111], a[176:179], v[124:127]
    ds_read_b64_tr_b16 v[66:67], v11 offset:2048
    v_mfma_f32_16x16x32_bf16 v[236:239], a[108:111], a[180:183], v[236:239]
    s_waitcnt vmcnt(12)
    ds_read_b64_tr_b16 v[68:69], v12 offset:0
    v_mfma_f32_16x16x32_bf16 v[100:103], a[112:115], a[184:187], v[100:103]
    s_waitcnt vmcnt(10)
    ds_read_b64_tr_b16 v[70:71], v12 offset:2048
    v_fmac_f32 v22, v114, v114
    v_mfma_f32_16x16x32_bf16 v[212:215], a[112:115], a[188:191], v[212:215]
    buffer_load_dwordx4 a[216:219], v17, s[40:43], s24 offen offset:3072 sc1
    v_mfma_f32_16x16x32_bf16 v[108:111], a[116:119], a[184:187], v[108:111]
    ds_read_b64_tr_b16 v[72:73], v13 offset:0
    v_fmac_f32 v24, v115, v115
    v_mfma_f32_16x16x32_bf16 v[220:223], a[116:119], a[188:191], v[220:223]
    ds_read_b64_tr_b16 v[74:75], v13 offset:2048
    v_mfma_f32_16x16x32_bf16 v[116:119], a[120:123], a[184:187], v[116:119]
    buffer_load_dwordx4 a[220:223], v18, s[40:43], s24 offen offset:3072 sc1
    s_mov_b32 s24, 24576
    v_mfma_f32_16x16x32_bf16 v[228:231], a[120:123], a[188:191], v[228:231]
    ds_read_b64_tr_b16 v[76:77], v10 offset:4096
    v_fmac_f32 v22, v120, v120
    v_mfma_f32_16x16x32_bf16 v[124:127], a[124:127], a[184:187], v[124:127]
    ds_read_b64_tr_b16 v[78:79], v10 offset:6144
    v_mfma_f32_16x16x32_bf16 v[236:239], a[124:127], a[188:191], v[236:239]
    s_waitcnt vmcnt(7) lgkmcnt(4)
    ds_read_b64_tr_b16 v[80:81], v11 offset:4096
    v_fmac_f32 v24, v121, v121
    v_mfma_f32_16x16x32_bf16 v[100:103], v[60:63], a[192:195], v[100:103]
    s_waitcnt vmcnt(6)
    ds_read_b64_tr_b16 v[82:83], v11 offset:6144
    v_mfma_f32_16x16x32_bf16 v[212:215], v[60:63], a[196:199], v[212:215]
    buffer_load_dwordx4 a[224:227], v17, s[40:43], s24 offen offset:1024 sc1
    v_mfma_f32_16x16x32_bf16 v[108:111], v[64:67], a[192:195], v[108:111]
    v_add_f32 v56, v56, v57
    v_fmac_f32 v22, v122, v122
    v_mfma_f32_16x16x32_bf16 v[220:223], v[64:67], a[196:199], v[220:223]
    ds_read_b64_tr_b16 v[84:85], v12 offset:4096
    v_fmac_f32 v24, v123, v123
    v_mfma_f32_16x16x32_bf16 v[116:119], v[68:71], a[192:195], v[116:119]
    buffer_load_dwordx4 a[228:231], v18, s[40:43], s24 offen offset:1024 sc1
    ds_read_b64_tr_b16 v[86:87], v12 offset:6144
    v_mfma_f32_16x16x32_bf16 v[228:231], v[68:71], a[196:199], v[228:231]
    s_waitcnt lgkmcnt(3)
    ds_read_b64_tr_b16 v[88:89], v13 offset:4096
    v_add_f32 v58, v58, v59
    v_mfma_f32_16x16x32_bf16 v[124:127], v[72:75], a[192:195], v[124:127]
    ds_read_b64_tr_b16 v[90:91], v13 offset:6144
    v_mov_b32 v14, 3
    s_waitcnt lgkmcnt(4)
    s_barrier
    s_cmp_eq_u32 s28, 0
    s_cbranch_scc0 L_qkv_f3
    s_mov_b64 exec, 1
    buffer_store_dword v14, off, s[36:39], s56 sc1
    s_mov_b64 exec, -1
L_qkv_f3:
    v_mfma_f32_16x16x32_bf16 v[236:239], v[72:75], a[196:199], v[236:239]
    s_waitcnt vmcnt(7)
    ds_read_b64_tr_b16 v[60:61], v10 offset:8192
    v_add_f32 v22, v22, v24
    v_mfma_f32_16x16x32_bf16 v[100:103], v[76:79], a[200:203], v[100:103]
    s_waitcnt vmcnt(6)
    ds_read_b64_tr_b16 v[62:63], v10 offset:10240
    v_add_f32 v56, v56, v58
    v_mfma_f32_16x16x32_bf16 v[212:215], v[76:79], a[204:207], v[212:215]
    buffer_load_dwordx4 a[232:235], v17, s[40:43], s24 offen offset:3072 sc1
    v_mov_b32 v57, v56
    v_mfma_f32_16x16x32_bf16 v[108:111], v[80:83], a[200:203], v[108:111]
    ds_read_b64_tr_b16 v[64:65], v11 offset:8192
    ds_read_b64_tr_b16 v[66:67], v11 offset:10240
    v_lshlrev_b32 v15, 3, v29
    v_mfma_f32_16x16x32_bf16 v[220:223], v[80:83], a[204:207], v[220:223]
    s_waitcnt lgkmcnt(5)
    s_add_u32 s25, s25, 131072
    s_lshl_b32 s34, s29, 12
    v_permlane16_swap_b32 v56, v57
    v_mfma_f32_16x16x32_bf16 v[116:119], v[84:87], a[200:203], v[116:119]
    buffer_load_dwordx4 a[236:239], v18, s[40:43], s24 offen offset:3072 sc1
    s_mov_b32 s24, 28672
    v_mfma_f32_16x16x32_bf16 v[228:231], v[84:87], a[204:207], v[228:231]
    s_waitcnt lgkmcnt(3)
    s_add_u32 s34, s34, 8650752
    ds_read_b64_tr_b16 v[68:69], v12 offset:8192
    v_mfma_f32_16x16x32_bf16 v[124:127], v[88:91], a[200:203], v[124:127]
    ds_read_b64_tr_b16 v[70:71], v12 offset:10240
    ds_read_b64_tr_b16 v[72:73], v13 offset:8192
    v_add_f32 v56, v56, v57
    v_mfma_f32_16x16x32_bf16 v[236:239], v[88:91], a[204:207], v[236:239]
    s_waitcnt vmcnt(7) lgkmcnt(5)
    ds_read_b64_tr_b16 v[74:75], v13 offset:10240
    v_mov_b32 v57, v56
    v_mfma_f32_16x16x32_bf16 v[100:103], v[60:63], a[208:211], v[100:103]
    s_waitcnt vmcnt(6)
    ds_read_b64_tr_b16 v[76:77], v10 offset:12288
    ds_read_b64_tr_b16 v[78:79], v10 offset:14336
    v_mfma_f32_16x16x32_bf16 v[212:215], v[60:63], a[212:215], v[212:215]
    s_waitcnt lgkmcnt(6)
    ds_read_b64_tr_b16 v[80:81], v11 offset:12288
    v_permlane32_swap_b32 v56, v57
    v_mfma_f32_16x16x32_bf16 v[108:111], v[64:67], a[208:211], v[108:111]
    buffer_load_dwordx4 a[240:243], v17, s[40:43], s24 offen offset:1024 sc1
    ds_read_b64_tr_b16 v[82:83], v11 offset:14336
    v_mfma_f32_16x16x32_bf16 v[220:223], v[64:67], a[212:215], v[220:223]
    s_waitcnt lgkmcnt(6)
    ds_read_b64_tr_b16 v[84:85], v12 offset:12288
    v_add_f32 v56, v56, v57
    v_mfma_f32_16x16x32_bf16 v[116:119], v[68:71], a[208:211], v[116:119]
    ds_read_b64_tr_b16 v[86:87], v12 offset:14336
    v_add_f32 v48, v56, v94
    v_mfma_f32_16x16x32_bf16 v[228:231], v[68:71], a[212:215], v[228:231]
    s_waitcnt lgkmcnt(6)
    ds_read_b64_tr_b16 v[88:89], v13 offset:12288
    v_mfma_f32_16x16x32_bf16 v[124:127], v[72:75], a[208:211], v[124:127]
    buffer_load_dwordx4 a[244:247], v18, s[40:43], s24 offen offset:1024 sc1
    ds_read_b64_tr_b16 v[90:91], v13 offset:14336
    v_mfma_f32_16x16x32_bf16 v[236:239], v[72:75], a[212:215], v[236:239]
    s_waitcnt vmcnt(7) lgkmcnt(5)
    ds_read_b64_tr_b16 v[60:61], v10 offset:16384
    v_mfma_f32_16x16x32_bf16 v[100:103], v[76:79], a[216:219], v[100:103]
    s_waitcnt vmcnt(6)
    ds_read_b64_tr_b16 v[62:63], v10 offset:18432
    v_mfma_f32_16x16x32_bf16 v[212:215], v[76:79], a[220:223], v[212:215]
    s_waitcnt lgkmcnt(5)
    ds_read_b64_tr_b16 v[64:65], v11 offset:16384
    v_mfma_f32_16x16x32_bf16 v[108:111], v[80:83], a[216:219], v[108:111]
    buffer_load_dwordx4 a[248:251], v17, s[40:43], s24 offen offset:3072 sc1
    ds_read_b64_tr_b16 v[66:67], v11 offset:18432
    v_mfma_f32_16x16x32_bf16 v[220:223], v[80:83], a[220:223], v[220:223]
    s_waitcnt lgkmcnt(5)
    ds_read_b64_tr_b16 v[68:69], v12 offset:16384
    v_mfma_f32_16x16x32_bf16 v[116:119], v[84:87], a[216:219], v[116:119]
    ds_read_b64_tr_b16 v[70:71], v12 offset:18432
    v_sub_f32 v100, v100, v48
    v_mfma_f32_16x16x32_bf16 v[228:231], v[84:87], a[220:223], v[228:231]
    s_waitcnt lgkmcnt(5)
    ds_read_b64_tr_b16 a[0:1], v4 offset:0
    v_mfma_f32_16x16x32_bf16 v[124:127], v[88:91], a[216:219], v[124:127]
    buffer_load_dwordx4 a[252:255], v18, s[40:43], s24 offen offset:3072 sc1
    s_mov_b32 s24, 0
    s_cmp_eq_u32 s52, 0
    s_cbranch_scc0 L_qkv_nohm
    buffer_store_dword v44, v43, s[36:39], s53 offen offset:0 sc1
    buffer_store_dword v48, v43, s[36:39], s53 offen offset:64 sc1
L_qkv_nohm:
    v_sub_f32 v108, v108, v48
    v_mfma_f32_16x16x32_bf16 v[236:239], v[88:91], a[220:223], v[236:239]
    s_waitcnt vmcnt(7) lgkmcnt(4)
    buffer_load_dwordx4 v2, s[12:15], s30 offen offset:0 lds
    v_mfma_f32_16x16x32_bf16 v[100:103], v[60:63], a[224:227], v[100:103]
    s_waitcnt vmcnt(7)
    ds_read_b64_tr_b16 a[2:3], v4 offset:8192
    ds_read_b64_tr_b16 a[4:5], v4 offset:1024
    v_sub_f32 v116, v116, v48
    v_mfma_f32_16x16x32_bf16 v[212:215], v[60:63], a[228:231], v[212:215]
    s_waitcnt lgkmcnt(4)
    s_barrier
    ds_read_b64_tr_b16 a[6:7], v4 offset:9216
    v_mfma_f32_16x16x32_bf16 v[108:111], v[64:67], a[224:227], v[108:111]
    buffer_load_dwordx4 v2, s[16:19], s30 offen offset:1024 lds
    ds_read_b64_tr_b16 v[72:73], v13 offset:16384
    ds_read_b64_tr_b16 v[74:75], v13 offset:18432
    v_sub_f32 v124, v124, v48
    v_mfma_f32_16x16x32_bf16 v[220:223], v[64:67], a[228:231], v[220:223]
    s_waitcnt lgkmcnt(5)
    ds_read_b64_tr_b16 v[76:77], v10 offset:20480
    ds_read_b64_tr_b16 v[78:79], v10 offset:22528
    v_mfma_f32_16x16x32_bf16 v[116:119], v[68:71], a[224:227], v[116:119]
    buffer_load_dwordx4 v3, s[12:15], s30 offen offset:2048 lds
    s_cmp_eq_u32 s28, 1
    s_cbranch_scc0 L_qkv_p3
    buffer_load_dword v16, v28, s[36:39], s57 offen sc1
L_qkv_p3:
    v_sub_f32 v101, v101, v48
    v_mfma_f32_16x16x32_bf16 v[228:231], v[68:71], a[228:231], v[228:231]
    s_waitcnt lgkmcnt(2)
    ds_read_b64_tr_b16 a[8:9], v5 offset:0
    ds_read_b64_tr_b16 a[10:11], v5 offset:8192
    v_mfma_f32_16x16x32_bf16 v[124:127], v[72:75], a[224:227], v[124:127]
    buffer_load_dwordx4 v3, s[16:19], s30 offen offset:3072 lds
    s_add_u32 m0, s32, 98304
    s_mov_b32 s30, 1376256
    ds_read_b64_tr_b16 v[80:81], v11 offset:20480
    ds_read_b64_tr_b16 v[82:83], v11 offset:22528
    v_sub_f32 v109, v109, v48
    v_mfma_f32_16x16x32_bf16 v[236:239], v[72:75], a[228:231], v[236:239]
    s_waitcnt vmcnt(9) lgkmcnt(4)
    ds_read_b64_tr_b16 a[12:13], v5 offset:1024
    ds_read_b64_tr_b16 a[14:15], v5 offset:9216
    v_mfma_f32_16x16x32_bf16 v[100:103], v[76:79], a[232:235], v[100:103]
    s_waitcnt vmcnt(8)
    buffer_load_dwordx4 v2, s[12:15], s30 offen offset:0 lds
    ds_read_b64_tr_b16 v[84:85], v12 offset:20480
    ds_read_b64_tr_b16 v[86:87], v12 offset:22528
    v_sub_f32 v117, v117, v48
    v_mfma_f32_16x16x32_bf16 v[212:215], v[76:79], a[236:239], v[212:215]
    s_waitcnt lgkmcnt(4)
    ds_read_b64_tr_b16 a[16:17], v4 offset:256
    ds_read_b64_tr_b16 a[18:19], v4 offset:8448
    v_mfma_f32_16x16x32_bf16 v[108:111], v[80:83], a[232:235], v[108:111]
    buffer_load_dwordx4 v2, s[16:19], s30 offen offset:1024 lds
    ds_read_b64_tr_b16 a[20:21], v4 offset:1280
    ds_read_b64_tr_b16 v[88:89], v13 offset:20480
    ds_read_b64_tr_b16 v[90:91], v13 offset:22528
    v_sub_f32 v125, v125, v48
    v_mfma_f32_16x16x32_bf16 v[220:223], v[80:83], a[236:239], v[220:223]
    s_waitcnt lgkmcnt(5)
    ds_read_b64_tr_b16 a[22:23], v4 offset:9472
    ds_read_b64_tr_b16 v[60:61], v10 offset:24576
    v_mfma_f32_16x16x32_bf16 v[116:119], v[84:87], a[232:235], v[116:119]
    buffer_load_dwordx4 v3, s[12:15], s30 offen offset:2048 lds
    ds_read_b64_tr_b16 v[62:63], v10 offset:26624
    v_sub_f32 v102, v102, v48
    v_mfma_f32_16x16x32_bf16 v[228:231], v[84:87], a[236:239], v[228:231]
    s_waitcnt lgkmcnt(3)
    ds_read_b64_tr_b16 a[24:25], v5 offset:256
    ds_read_b64_tr_b16 a[26:27], v5 offset:8448
    v_mfma_f32_16x16x32_bf16 v[124:127], v[88:91], a[232:235], v[124:127]
    ds_read_b64_tr_b16 a[28:29], v5 offset:1280
    ds_read_b64_tr_b16 a[30:31], v5 offset:9472
    ds_read_b64_tr_b16 v[64:65], v11 offset:24576
    ds_read_b64_tr_b16 v[66:67], v11 offset:26624
    v_sub_f32 v110, v110, v48
    v_mfma_f32_16x16x32_bf16 v[236:239], v[88:91], a[236:239], v[236:239]
    s_waitcnt vmcnt(10) lgkmcnt(6)
    buffer_load_dwordx4 v3, s[16:19], s30 offen offset:3072 lds
    s_add_u32 m0, s32, 114688
    v_mfma_f32_16x16x32_bf16 v[100:103], v[60:63], a[240:243], v[100:103]
    s_waitcnt vmcnt(10)
    s_mov_b32 s30, 1605632
    ds_read_b64_tr_b16 v[68:69], v12 offset:24576
    ds_read_b64_tr_b16 v[70:71], v12 offset:26624
    v_sub_f32 v118, v118, v48
    v_mfma_f32_16x16x32_bf16 v[212:215], v[60:63], a[244:247], v[212:215]
    s_waitcnt lgkmcnt(2)
    ds_read_b64_tr_b16 a[32:33], v4 offset:512
    ds_read_b64_tr_b16 a[34:35], v4 offset:8704
    v_mfma_f32_16x16x32_bf16 v[108:111], v[64:67], a[240:243], v[108:111]
    ds_read_b64_tr_b16 a[36:37], v4 offset:1536
    ds_read_b64_tr_b16 a[38:39], v4 offset:9728
    ds_read_b64_tr_b16 v[72:73], v13 offset:24576
    ds_read_b64_tr_b16 v[74:75], v13 offset:26624
    v_sub_f32 v126, v126, v48
    v_mfma_f32_16x16x32_bf16 v[220:223], v[64:67], a[244:247], v[220:223]
    s_waitcnt lgkmcnt(6)
    ds_read_b64_tr_b16 v[76:77], v10 offset:28672
    ds_read_b64_tr_b16 v[78:79], v10 offset:30720
    v_mfma_f32_16x16x32_bf16 v[116:119], v[68:71], a[240:243], v[116:119]
    ds_read_b64_tr_b16 a[40:41], v5 offset:512
    ds_read_b64_tr_b16 a[42:43], v5 offset:8704
    v_sub_f32 v103, v103, v48
    v_mfma_f32_16x16x32_bf16 v[228:231], v[68:71], a[244:247], v[228:231]
    s_waitcnt lgkmcnt(4)
    ds_read_b64_tr_b16 a[44:45], v5 offset:1536
    ds_read_b64_tr_b16 a[46:47], v5 offset:9728
    v_mfma_f32_16x16x32_bf16 v[124:127], v[72:75], a[240:243], v[124:127]
    ds_read_b64_tr_b16 v[80:81], v11 offset:28672
    ds_read_b64_tr_b16 v[82:83], v11 offset:30720
    v_sub_f32 v111, v111, v48
    v_mfma_f32_16x16x32_bf16 v[236:239], v[72:75], a[244:247], v[236:239]
    s_waitcnt vmcnt(9) lgkmcnt(6)
    ds_read_b64_tr_b16 v[84:85], v12 offset:28672
    ds_read_b64_tr_b16 v[86:87], v12 offset:30720
    v_mfma_f32_16x16x32_bf16 v[100:103], v[76:79], a[248:251], v[100:103]
    s_waitcnt vmcnt(8)
    ds_read_b64_tr_b16 a[48:49], v4 offset:768
    ds_read_b64_tr_b16 a[50:51], v4 offset:8960
    v_sub_f32 v119, v119, v48
    v_mfma_f32_16x16x32_bf16 v[212:215], v[76:79], a[252:255], v[212:215]
    s_waitcnt lgkmcnt(4)
    s_cmp_eq_u32 s28, 1
    s_cbranch_scc0 L_qkv_back3w
    s_waitcnt vmcnt(5)
    v_cmp_gt_i32 vcc, 3, v16
    s_nop 1
    s_cbranch_vccnz L_qkv_slow3w
L_qkv_back3w:
    s_barrier
    v_and_b32 v28, 31, v0
    v_mul_u32_u24 v28, 640, v28
    v_mfma_f32_16x16x32_bf16 v[108:111], v[80:83], a[248:251], v[108:111]
    buffer_load_dwordx4 a[56:59], v1, s[8:11], s31 offen offset:0 sc1
    ds_read_b64_tr_b16 a[52:53], v4 offset:1792
    ds_read_b64_tr_b16 v[88:89], v13 offset:28672
    ds_read_b64_tr_b16 v[90:91], v13 offset:30720
    v_sub_f32 v127, v127, v48
    v_mfma_f32_16x16x32_bf16 v[220:223], v[80:83], a[252:255], v[220:223]
    s_waitcnt lgkmcnt(5)
    ds_read_b64_tr_b16 a[54:55], v4 offset:9984
    v_mfma_f32_16x16x32_bf16 v[116:119], v[84:87], a[248:251], v[116:119]
    buffer_load_dwordx4 a[64:67], v1, s[8:11], s31 offen offset:2048 sc1
    s_add_u32 s31, s31, 4096
    v_mfma_f32_16x16x32_bf16 v[228:231], v[84:87], a[252:255], v[228:231]
    s_waitcnt lgkmcnt(1)
    ds_write_b128 v20, v[212:215] offset:49152
    v_mfma_f32_16x16x32_bf16 v[124:127], v[88:91], a[248:251], v[124:127]
    v_mfma_f32_16x16x32_bf16 v[236:239], v[88:91], a[252:255], v[236:239]
    buffer_load_dwordx4 a[72:75], v1, s[8:11], s31 offen offset:0 sc1
    ds_write_b128 v20, v[220:223] offset:50176
    buffer_load_dwordx4 a[80:83], v1, s[8:11], s31 offen offset:2048 sc1
    s_waitcnt vmcnt(3)
    v_mfma_f32_16x16x32_bf16 v[32:35], a[0:3], a[56:59], 0
    s_waitcnt vmcnt(2)
    s_add_u32 s31, s31, 4096
    buffer_load_dwordx4 a[88:91], v1, s[8:11], s31 offen offset:0 sc1
    v_mfma_f32_16x16x32_bf16 v[40:43], a[0:3], a[64:67], 0
    buffer_load_dwordx4 a[96:99], v1, s[8:11], s31 offen offset:2048 sc1
    ds_write_b128 v20, v[228:231] offset:51200
    v_mfma_f32_16x16x32_bf16 v[48:51], a[4:7], a[56:59], 0
    s_add_u32 s31, s31, 4096
    ds_read_b64_tr_b16 a[0:1], v4 offset:16384
    v_mfma_f32_16x16x32_bf16 v[56:59], a[4:7], a[64:67], 0
    ds_write_b128 v20, v[236:239] offset:52224
    v_mfma_f32_16x16x32_bf16 v[64:67], a[8:11], a[56:59], 0
    buffer_load_dwordx4 a[104:107], v1, s[8:11], s31 offen offset:0 sc1
    v_mfma_f32_16x16x32_bf16 v[72:75], a[8:11], a[64:67], 0
    s_waitcnt lgkmcnt(3)
    s_barrier
    ds_read_b64_tr_b16 a[2:3], v4 offset:24576
    v_mfma_f32_16x16x32_bf16 v[80:83], a[12:15], a[56:59], 0
    ds_read_b64_tr_b16 a[4:5], v4 offset:17408
    v_mfma_f32_16x16x32_bf16 v[88:91], a[12:15], a[64:67], 0
    buffer_load_dwordx4 a[112:115], v1, s[8:11], s31 offen offset:2048 sc1
    s_add_u32 s31, s31, 4096
    s_waitcnt lgkmcnt(2)
    s_barrier
    ds_read_b128 v[212:215], v19 offset:49152
    v_mfma_f32_16x16x32_bf16 v[96:99], a[16:19], a[56:59], 0
    ds_read_b128 v[220:223], v19 offset:50176
    ds_read_b128 v[228:231], v19 offset:51200
    ds_read_b128 v[236:239], v19 offset:52224
    v_mfma_f32_16x16x32_bf16 v[104:107], a[16:19], a[64:67], 0
    buffer_load_dwordx4 a[120:123], v1, s[8:11], s31 offen offset:0 sc1
    v_mfma_f32_16x16x32_bf16 v[112:115], a[20:23], a[56:59], 0
    s_lshl_b32 s0, s2, 2
    s_add_u32 s0, s0, s28
    s_mul_i32 s0, s0, 7168
    ds_read_b64_tr_b16 a[6:7], v4 offset:25600
    v_mfma_f32_16x16x32_bf16 v[120:123], a[20:23], a[64:67], 0
    s_add_u32 s0, s0, s60
    s_addc_u32 s1, s61, 0
    s_lshl_b32 s89, s2, 2
    ds_read_b64_tr_b16 a[8:9], v5 offset:16384
    v_mfma_f32_16x16x32_bf16 v[128:131], a[24:27], a[56:59], 0
    buffer_load_dwordx4 a[128:131], v1, s[8:11], s31 offen offset:2048 sc1
    s_add_u32 s31, s31, 4096
    v_mfma_f32_16x16x32_bf16 v[136:139], a[24:27], a[64:67], 0
    s_add_u32 s89, s89, s28
    s_mul_i32 s89, s89, 2560
    s_add_u32 s89, s89, 4718592
    ds_read_b64_tr_b16 a[10:11], v5 offset:24576
    v_mfma_f32_16x16x32_bf16 v[144:147], a[28:31], a[56:59], 0
    ds_read_b64_tr_b16 a[12:13], v5 offset:17408
    ds_read_b64_tr_b16 a[14:15], v5 offset:25600
    v_mfma_f32_16x16x32_bf16 v[152:155], a[28:31], a[64:67], 0
    buffer_load_dwordx4 a[136:139], v1, s[8:11], s31 offen offset:0 sc1
    s_waitcnt lgkmcnt(5)
    v_add_f32 v100, v100, v212
    v_add_f32 v101, v101, v213
    v_add_f32 v102, v102, v214
    v_mfma_f32_16x16x32_bf16 v[160:163], a[32:35], a[56:59], 0
    ds_read_b64_tr_b16 a[16:17], v4 offset:16640
    ds_read_b64_tr_b16 a[18:19], v4 offset:24832
    v_add_f32 v103, v103, v215
    v_cvt_pk_bf16_f32 v244, v100, v101
    v_cvt_pk_bf16_f32 v245, v102, v103
    v_mfma_f32_16x16x32_bf16 v[168:171], a[32:35], a[64:67], 0
    buffer_load_dwordx4 a[144:147], v1, s[8:11], s31 offen offset:2048 sc1
    s_add_u32 s31, s31, 4096
    v_add_f32 v108, v108, v220
    v_add_f32 v109, v109, v221
    v_add_f32 v110, v110, v222
    v_mfma_f32_16x16x32_bf16 v[176:179], a[36:39], a[56:59], 0
    ds_read_b64_tr_b16 a[20:21], v4 offset:17664
    ds_read_b64_tr_b16 a[22:23], v4 offset:25856
    v_add_f32 v111, v111, v223
    v_cvt_pk_bf16_f32 v246, v108, v109
    v_cvt_pk_bf16_f32 v247, v110, v111
    v_mfma_f32_16x16x32_bf16 v[184:187], a[36:39], a[64:67], 0
    buffer_load_dwordx4 v2, s[12:15], s30 offen offset:0 lds
    buffer_store_dwordx4 v[244:247], v1, s[40:43], s58 offen offset:1024 sc1
    v_mfma_f32_16x16x32_bf16 v[192:195], a[40:43], a[56:59], 0
    v_add_f32 v116, v116, v228
    v_add_f32 v117, v117, v229
    v_add_f32 v118, v118, v230
    v_add_f32 v119, v119, v231
    v_cvt_pk_bf16_f32 v252, v116, v117
    v_cvt_pk_bf16_f32 v253, v118, v119
    v_mfma_f32_16x16x32_bf16 v[200:203], a[40:43], a[64:67], 0
    buffer_load_dwordx4 v2, s[16:19], s30 offen offset:1024 lds
    v_add_f32 v124, v124, v236
    v_add_f32 v125, v125, v237
    v_add_f32 v126, v126, v238
    v_add_f32 v127, v127, v239
    v_mfma_f32_16x16x32_bf16 v[208:211], a[44:47], a[56:59], 0
    ds_read_b64_tr_b16 a[24:25], v5 offset:16640
    ds_read_b64_tr_b16 a[26:27], v5 offset:24832
    v_cvt_pk_bf16_f32 v254, v124, v125
    v_cvt_pk_bf16_f32 v255, v126, v127
    v_mfma_f32_16x16x32_bf16 v[216:219], a[44:47], a[64:67], 0
    buffer_load_dwordx4 v3, s[12:15], s30 offen offset:2048 lds
    buffer_store_dwordx4 v[252:255], v1, s[40:43], s59 offen offset:1024 sc1
    v_mul_f32 v23, v100, v100
    v_mfma_f32_16x16x32_bf16 v[224:227], a[48:51], a[56:59], 0
    ds_read_b64_tr_b16 a[28:29], v5 offset:17664
    ds_read_b64_tr_b16 a[30:31], v5 offset:25856
    v_mul_f32 v25, v101, v101
    v_fmac_f32 v23, v102, v102
    v_fmac_f32 v25, v103, v103
    v_mfma_f32_16x16x32_bf16 v[232:235], a[48:51], a[64:67], 0
    buffer_load_dwordx4 v3, s[16:19], s30 offen offset:3072 lds
    s_add_u32 m0, s32, 131072
    s_mov_b32 s30, 1835008
    v_fmac_f32 v23, v108, v108
    v_fmac_f32 v25, v109, v109
    v_mfma_f32_16x16x32_bf16 v[240:243], a[52:55], a[56:59], 0
    ds_read_b64_tr_b16 a[32:33], v4 offset:16896
    ds_read_b64_tr_b16 a[34:35], v4 offset:25088
    v_fmac_f32 v23, v110, v110
    v_fmac_f32 v25, v111, v111
    v_fmac_f32 v23, v116, v116
    v_mfma_f32_16x16x32_bf16 v[248:251], a[52:55], a[64:67], 0
    s_waitcnt vmcnt(14)
    buffer_load_dwordx4 a[152:155], v1, s[8:11], s31 offen offset:0 sc1
    v_fmac_f32 v25, v117, v117
    v_fmac_f32 v23, v118, v118
    v_fmac_f32 v25, v119, v119
    v_mfma_f32_16x16x32_bf16 v[32:35], a[0:3], a[72:75], v[32:35]
    ds_read_b64_tr_b16 a[36:37], v4 offset:17920
    ds_read_b64_tr_b16 a[38:39], v4 offset:26112
    v_fmac_f32 v23, v124, v124
    v_fmac_f32 v25, v125, v125
    v_fmac_f32 v23, v126, v126
    v_mfma_f32_16x16x32_bf16 v[40:43], a[0:3], a[80:83], v[40:43]
    s_waitcnt lgkmcnt(6)
    buffer_load_dwordx4 a[160:163], v1, s[8:11], s31 offen offset:2048 sc1
    s_add_u32 s31, s31, 4294942720
    v_fmac_f32 v25, v127, v127
    v_add_f32 v23, v23, v25
    v_mfma_f32_16x16x32_bf16 v[48:51], a[4:7], a[72:75], v[48:51]
    ds_read_b64_tr_b16 a[40:41], v5 offset:16896
    ds_read_b64_tr_b16 a[42:43], v5 offset:25088
    v_mov_b32 v24, v22
    v_mov_b32 v25, v23
    v_mfma_f32_16x16x32_bf16 v[56:59], a[4:7], a[80:83], v[56:59]
    s_waitcnt lgkmcnt(6)
    s_barrier
    buffer_load_dwordx4 v2, s[12:15], s30 offen offset:0 lds
    v_permlane16_swap_b32 v22, v24
    v_mfma_f32_16x16x32_bf16 v[64:67], a[8:11], a[72:75], v[64:67]
    ds_read_b64_tr_b16 a[44:45], v5 offset:17920
    ds_read_b64_tr_b16 a[46:47], v5 offset:26112
    v_permlane16_swap_b32 v23, v25
    v_add_f32 v22, v22, v24
    v_mfma_f32_16x16x32_bf16 v[72:75], a[8:11], a[80:83], v[72:75]
    buffer_load_dwordx4 v2, s[16:19], s30 offen offset:1024 lds
    ds_read_b64_tr_b16 a[48:49], v4 offset:17152
    v_add_f32 v23, v23, v25
    v_mov_b32 v24, v22
    v_mov_b32 v25, v23
    v_mfma_f32_16x16x32_bf16 v[80:83], a[12:15], a[72:75], v[80:83]
    ds_read_b64_tr_b16 a[50:51], v4 offset:25344
    ds_read_b64_tr_b16 a[52:53], v4 offset:18176
    v_permlane32_swap_b32 v22, v24
    v_mfma_f32_16x16x32_bf16 v[88:91], a[12:15], a[80:83], v[88:91]
    buffer_load_dwordx4 v3, s[12:15], s30 offen offset:2048 lds
    ds_read_b64_tr_b16 a[54:55], v4 offset:26368
    v_permlane32_swap_b32 v23, v25
    v_add_f32 v22, v22, v24
    v_mfma_f32_16x16x32_bf16 v[96:99], a[16:19], a[72:75], v[96:99]
    ds_read_b64_tr_b16 a[0:1], v4 offset:32768
    ds_read_b64_tr_b16 a[2:3], v4 offset:40960
    v_add_f32 v23, v23, v25
    v_mfma_f32_16x16x32_bf16 v[104:107], a[16:19], a[80:83], v[104:107]
    buffer_load_dwordx4 v3, s[16:19], s30 offen offset:3072 lds
    buffer_store_dwordx2 v[22:23], v15, s[36:39], s25 offen sc1
    v_lshl_add_u32 v15, v26, 9, v15
    v_mfma_f32_16x16x32_bf16 v[112:115], a[20:23], a[72:75], v[112:115]
    s_add_u32 m0, s32, 147456
    s_mov_b32 s30, 2064384
    ds_read_b64_tr_b16 a[4:5], v4 offset:33792
    v_mfma_f32_16x16x32_bf16 v[120:123], a[20:23], a[80:83], v[120:123]
    buffer_load_dwordx4 v2, s[12:15], s30 offen offset:0 lds
    ds_read_b64_tr_b16 a[6:7], v4 offset:41984
    v_mfma_f32_16x16x32_bf16 v[128:131], a[24:27], a[72:75], v[128:131]
    s_buffer_load_dwordx2 s[100:101], s[12:15], s89 offset:60
    ds_read_b64_tr_b16 a[8:9], v5 offset:32768
    ds_read_b64_tr_b16 a[10:11], v5 offset:40960
    v_mfma_f32_16x16x32_bf16 v[136:139], a[24:27], a[80:83], v[136:139]
    ds_read_b64_tr_b16 a[12:13], v5 offset:33792
    v_mfma_f32_16x16x32_bf16 v[144:147], a[28:31], a[72:75], v[144:147]
    buffer_load_dwordx4 v2, s[16:19], s30 offen offset:1024 lds
    ds_read_b64_tr_b16 a[14:15], v5 offset:41984
    v_mfma_f32_16x16x32_bf16 v[152:155], a[28:31], a[80:83], v[152:155]
    s_waitcnt lgkmcnt(15)
    ds_read_b64_tr_b16 a[16:17], v4 offset:33024
    v_mfma_f32_16x16x32_bf16 v[160:163], a[32:35], a[72:75], v[160:163]
    ds_read_b64_tr_b16 a[18:19], v4 offset:41216
    v_mfma_f32_16x16x32_bf16 v[168:171], a[32:35], a[80:83], v[168:171]
    buffer_load_dwordx4 v3, s[12:15], s30 offen offset:2048 lds
    ds_read_b64_tr_b16 a[20:21], v4 offset:34048
    v_mfma_f32_16x16x32_bf16 v[176:179], a[36:39], a[72:75], v[176:179]
    ds_read_b64_tr_b16 a[22:23], v4 offset:42240
    v_mfma_f32_16x16x32_bf16 v[184:187], a[36:39], a[80:83], v[184:187]
    s_waitcnt lgkmcnt(15)
    ds_read_b64_tr_b16 a[24:25], v5 offset:33024
    v_mfma_f32_16x16x32_bf16 v[192:195], a[40:43], a[72:75], v[192:195]
    buffer_load_dwordx4 v3, s[16:19], s30 offen offset:3072 lds
    ds_read_b64_tr_b16 a[26:27], v5 offset:41216
    v_mfma_f32_16x16x32_bf16 v[200:203], a[40:43], a[80:83], v[200:203]
    s_add_u32 m0, s32, 0
    s_mov_b32 s30, 2293760
    ds_read_b64_tr_b16 a[28:29], v5 offset:34048
    v_mfma_f32_16x16x32_bf16 v[208:211], a[44:47], a[72:75], v[208:211]
    ds_read_b64_tr_b16 a[30:31], v5 offset:42240
    v_mfma_f32_16x16x32_bf16 v[216:219], a[44:47], a[80:83], v[216:219]
    s_waitcnt lgkmcnt(15)
    ds_read_b64_tr_b16 a[32:33], v4 offset:33280
    v_mfma_f32_16x16x32_bf16 v[224:227], a[48:51], a[72:75], v[224:227]
    ds_read_b64_tr_b16 a[34:35], v4 offset:41472
    v_mfma_f32_16x16x32_bf16 v[232:235], a[48:51], a[80:83], v[232:235]
    ds_read_b64_tr_b16 a[36:37], v4 offset:34304
    v_mfma_f32_16x16x32_bf16 v[240:243], a[52:55], a[72:75], v[240:243]
    ds_read_b64_tr_b16 a[38:39], v4 offset:42496
    v_mfma_f32_16x16x32_bf16 v[248:251], a[52:55], a[80:83], v[248:251]
    s_waitcnt vmcnt(23) lgkmcnt(15)
    ds_read_b64_tr_b16 a[40:41], v5 offset:33280
    v_mfma_f32_16x16x32_bf16 v[32:35], a[0:3], a[88:91], v[32:35]
    ds_read_b64_tr_b16 a[42:43], v5 offset:41472
    v_mfma_f32_16x16x32_bf16 v[40:43], a[0:3], a[96:99], v[40:43]
    s_buffer_load_dwordx2 s[100:101], s[16:19], s89 offset:1084
    ds_read_b64_tr_b16 a[44:45], v5 offset:34304
    v_mfma_f32_16x16x32_bf16 v[48:51], a[4:7], a[88:91], v[48:51]
    ds_read_b64_tr_b16 a[46:47], v5 offset:42496
    v_mfma_f32_16x16x32_bf16 v[56:59], a[4:7], a[96:99], v[56:59]
    s_waitcnt lgkmcnt(15)
    ds_read_b64_tr_b16 a[48:49], v4 offset:33536
    v_mfma_f32_16x16x32_bf16 v[64:67], a[8:11], a[88:91], v[64:67]
    ds_read_b64_tr_b16 a[50:51], v4 offset:41728
    v_mfma_f32_16x16x32_bf16 v[72:75], a[8:11], a[96:99], v[72:75]
    ds_read_b64_tr_b16 a[52:53], v4 offset:34560
    v_mfma_f32_16x16x32_bf16 v[80:83], a[12:15], a[88:91], v[80:83]
    ds_read_b64_tr_b16 a[54:55], v4 offset:42752
    v_mfma_f32_16x16x32_bf16 v[88:91], a[12:15], a[96:99], v[88:91]
    s_waitcnt lgkmcnt(15)
    ds_read_b64_tr_b16 a[0:1], v4 offset:49152
    v_mfma_f32_16x16x32_bf16 v[96:99], a[16:19], a[88:91], v[96:99]
    ds_read_b64_tr_b16 a[2:3], v4 offset:57344
    v_mfma_f32_16x16x32_bf16 v[104:107], a[16:19], a[96:99], v[104:107]
    ds_read_b64_tr_b16 a[4:5], v4 offset:50176
    v_mfma_f32_16x16x32_bf16 v[112:115], a[20:23], a[88:91], v[112:115]
    ds_read_b64_tr_b16 a[6:7], v4 offset:58368
    v_mfma_f32_16x16x32_bf16 v[120:123], a[20:23], a[96:99], v[120:123]
    s_waitcnt lgkmcnt(15)
    ds_read_b64_tr_b16 a[8:9], v5 offset:49152
    v_mfma_f32_16x16x32_bf16 v[128:131], a[24:27], a[88:91], v[128:131]
    ds_read_b64_tr_b16 a[10:11], v5 offset:57344
    v_mfma_f32_16x16x32_bf16 v[136:139], a[24:27], a[96:99], v[136:139]
    ds_read_b64_tr_b16 a[12:13], v5 offset:50176
    v_mfma_f32_16x16x32_bf16 v[144:147], a[28:31], a[88:91], v[144:147]
    ds_read_b64_tr_b16 a[14:15], v5 offset:58368
    v_mfma_f32_16x16x32_bf16 v[152:155], a[28:31], a[96:99], v[152:155]
    s_waitcnt lgkmcnt(15)
    ds_read_b64_tr_b16 a[16:17], v4 offset:49408
    v_mfma_f32_16x16x32_bf16 v[160:163], a[32:35], a[88:91], v[160:163]
    ds_read_b64_tr_b16 a[18:19], v4 offset:57600
    v_mfma_f32_16x16x32_bf16 v[168:171], a[32:35], a[96:99], v[168:171]
    ds_read_b64_tr_b16 a[20:21], v4 offset:50432
    v_mfma_f32_16x16x32_bf16 v[176:179], a[36:39], a[88:91], v[176:179]
    s_buffer_load_dwordx2 s[100:101], s[12:15], s89 offset:188
    ds_read_b64_tr_b16 a[22:23], v4 offset:58624
    v_mfma_f32_16x16x32_bf16 v[184:187], a[36:39], a[96:99], v[184:187]
    s_waitcnt lgkmcnt(15)
    ds_read_b64_tr_b16 a[24:25], v5 offset:49408
    v_mfma_f32_16x16x32_bf16 v[192:195], a[40:43], a[88:91], v[192:195]
    ds_read_b64_tr_b16 a[26:27], v5 offset:57600
    v_mfma_f32_16x16x32_bf16 v[200:203], a[40:43], a[96:99], v[200:203]
    ds_read_b64_tr_b16 a[28:29], v5 offset:50432
    v_mfma_f32_16x16x32_bf16 v[208:211], a[44:47], a[88:91], v[208:211]
    ds_read_b64_tr_b16 a[30:31], v5 offset:58624
    v_mfma_f32_16x16x32_bf16 v[216:219], a[44:47], a[96:99], v[216:219]
    s_waitcnt lgkmcnt(15)
    ds_read_b64_tr_b16 a[32:33], v4 offset:49664
    v_mfma_f32_16x16x32_bf16 v[224:227], a[48:51], a[88:91], v[224:227]
    ds_read_b64_tr_b16 a[34:35], v4 offset:57856
    v_mov_b32 v14, 4
    s_waitcnt vmcnt(4)
    s_barrier
    s_cmp_eq_u32 s28, 0
    s_cbranch_scc0 L_qkv_f4
    s_mov_b64 exec, 1
    buffer_store_dword v14, off, s[36:39], s56 sc1
    s_mov_b64 exec, -1
L_qkv_f4:
    v_mfma_f32_16x16x32_bf16 v[232:235], a[48:51], a[96:99], v[232:235]
    ds_read_b64_tr_b16 a[36:37], v4 offset:50688
    v_mfma_f32_16x16x32_bf16 v[240:243], a[52:55], a[88:91], v[240:243]
    ds_read_b64_tr_b16 a[38:39], v4 offset:58880
    v_mfma_f32_16x16x32_bf16 v[248:251], a[52:55], a[96:99], v[248:251]
    s_waitcnt lgkmcnt(15)
    ds_read_b64_tr_b16 a[40:41], v5 offset:49664
    v_mfma_f32_16x16x32_bf16 v[32:35], a[0:3], a[104:107], v[32:35]
    ds_read_b64_tr_b16 a[42:43], v5 offset:57856
    v_mfma_f32_16x16x32_bf16 v[40:43], a[0:3], a[112:115], v[40:43]
    ds_read_b64_tr_b16 a[44:45], v5 offset:50688
    v_mfma_f32_16x16x32_bf16 v[48:51], a[4:7], a[104:107], v[48:51]
    ds_read_b64_tr_b16 a[46:47], v5 offset:58880
    v_mfma_f32_16x16x32_bf16 v[56:59], a[4:7], a[112:115], v[56:59]
    s_waitcnt lgkmcnt(15)
    s_barrier
    ds_read_b64_tr_b16 a[48:49], v4 offset:49920
    v_mfma_f32_16x16x32_bf16 v[64:67], a[8:11], a[104:107], v[64:67]
    ds_read_b64_tr_b16 a[50:51], v4 offset:58112
    v_mfma_f32_16x16x32_bf16 v[72:75], a[8:11], a[112:115], v[72:75]
    ds_read_b64_tr_b16 a[52:53], v4 offset:50944
    v_mfma_f32_16x16x32_bf16 v[80:83], a[12:15], a[104:107], v[80:83]
    ds_read_b64_tr_b16 a[54:55], v4 offset:59136
    v_mfma_f32_16x16x32_bf16 v[88:91], a[12:15], a[112:115], v[88:91]
    s_waitcnt lgkmcnt(15)
    s_buffer_load_dwordx2 s[100:101], s[16:19], s89 offset:1212
    ds_read_b64_tr_b16 a[0:1], v6 offset:0
    v_mfma_f32_16x16x32_bf16 v[96:99], a[16:19], a[104:107], v[96:99]
    ds_read_b64_tr_b16 a[2:3], v6 offset:8192
    v_mfma_f32_16x16x32_bf16 v[104:107], a[16:19], a[112:115], v[104:107]
    ds_read_b64_tr_b16 a[4:5], v6 offset:1024
    v_mfma_f32_16x16x32_bf16 v[112:115], a[20:23], a[104:107], v[112:115]
    ds_read_b64_tr_b16 a[6:7], v6 offset:9216
    v_mfma_f32_16x16x32_bf16 v[120:123], a[20:23], a[112:115], v[120:123]
    s_waitcnt lgkmcnt(15)
    ds_read_b64_tr_b16 a[8:9], v7 offset:0
    v_mfma_f32_16x16x32_bf16 v[128:131], a[24:27], a[104:107], v[128:131]
    ds_read_b64_tr_b16 a[10:11], v7 offset:8192
    v_mfma_f32_16x16x32_bf16 v[136:139], a[24:27], a[112:115], v[136:139]
    ds_read_b64_tr_b16 a[12:13], v7 offset:1024
    v_mfma_f32_16x16x32_bf16 v[144:147], a[28:31], a[104:107], v[144:147]
    ds_read_b64_tr_b16 a[14:15], v7 offset:9216
    v_mfma_f32_16x16x32_bf16 v[152:155], a[28:31], a[112:115], v[152:155]
    s_waitcnt lgkmcnt(15)
    ds_read_b64_tr_b16 a[16:17], v6 offset:256
    v_mfma_f32_16x16x32_bf16 v[160:163], a[32:35], a[104:107], v[160:163]
    ds_read_b64_tr_b16 a[18:19], v6 offset:8448
    v_mfma_f32_16x16x32_bf16 v[168:171], a[32:35], a[112:115], v[168:171]
    ds_read_b64_tr_b16 a[20:21], v6 offset:1280
    v_mfma_f32_16x16x32_bf16 v[176:179], a[36:39], a[104:107], v[176:179]
    ds_read_b64_tr_b16 a[22:23], v6 offset:9472
    v_mfma_f32_16x16x32_bf16 v[184:187], a[36:39], a[112:115], v[184:187]
    s_waitcnt lgkmcnt(15)
    ds_read_b64_tr_b16 a[24:25], v7 offset:256
    v_mfma_f32_16x16x32_bf16 v[192:195], a[40:43], a[104:107], v[192:195]
    ds_read_b64_tr_b16 a[26:27], v7 offset:8448
    v_mfma_f32_16x16x32_bf16 v[200:203], a[40:43], a[112:115], v[200:203]
    ds_read_b64_tr_b16 a[28:29], v7 offset:1280
    v_mfma_f32_16x16x32_bf16 v[208:211], a[44:47], a[104:107], v[208:211]
    ds_read_b64_tr_b16 a[30:31], v7 offset:9472
    v_mfma_f32_16x16x32_bf16 v[216:219], a[44:47], a[112:115], v[216:219]
    s_waitcnt lgkmcnt(15)
    ds_read_b64_tr_b16 a[32:33], v6 offset:512
    v_mfma_f32_16x16x32_bf16 v[224:227], a[48:51], a[104:107], v[224:227]
    s_buffer_load_dwordx2 s[100:101], s[12:15], s89 offset:316
    ds_read_b64_tr_b16 a[34:35], v6 offset:8704
    v_mfma_f32_16x16x32_bf16 v[232:235], a[48:51], a[112:115], v[232:235]
    ds_read_b64_tr_b16 a[36:37], v6 offset:1536
    v_mfma_f32_16x16x32_bf16 v[240:243], a[52:55], a[104:107], v[240:243]
    ds_read_b64_tr_b16 a[38:39], v6 offset:9728
    v_mfma_f32_16x16x32_bf16 v[248:251], a[52:55], a[112:115], v[248:251]
    s_waitcnt lgkmcnt(15)
    ds_read_b64_tr_b16 a[40:41], v7 offset:512
    v_mfma_f32_16x16x32_bf16 v[32:35], a[0:3], a[120:123], v[32:35]
    ds_read_b64_tr_b16 a[42:43], v7 offset:8704
    v_mfma_f32_16x16x32_bf16 v[40:43], a[0:3], a[128:131], v[40:43]
    ds_read_b64_tr_b16 a[44:45], v7 offset:1536
    v_mfma_f32_16x16x32_bf16 v[48:51], a[4:7], a[120:123], v[48:51]
    ds_read_b64_tr_b16 a[46:47], v7 offset:9728
    v_mfma_f32_16x16x32_bf16 v[56:59], a[4:7], a[128:131], v[56:59]
    s_waitcnt lgkmcnt(15)
    ds_read_b64_tr_b16 a[48:49], v6 offset:768
    v_mfma_f32_16x16x32_bf16 v[64:67], a[8:11], a[120:123], v[64:67]
    ds_read_b64_tr_b16 a[50:51], v6 offset:8960
    v_mfma_f32_16x16x32_bf16 v[72:75], a[8:11], a[128:131], v[72:75]
    ds_read_b64_tr_b16 a[52:53], v6 offset:1792
    v_mfma_f32_16x16x32_bf16 v[80:83], a[12:15], a[120:123], v[80:83]
    s_cmp_eq_u32 s28, 1
    s_cbranch_scc0 L_qkv_p4
    buffer_load_dword v16, v28, s[36:39], s57 offen sc1
L_qkv_p4:
    v_mfma_f32_16x16x32_bf16 v[88:91], a[12:15], a[128:131], v[88:91]
    s_waitcnt lgkmcnt(15)
    ds_read_b64_tr_b16 a[54:55], v6 offset:9984
    ds_read_b64_tr_b16 a[0:1], v6 offset:16384
    v_mfma_f32_16x16x32_bf16 v[96:99], a[16:19], a[120:123], v[96:99]
    ds_read_b64_tr_b16 a[2:3], v6 offset:24576
    v_mfma_f32_16x16x32_bf16 v[104:107], a[16:19], a[128:131], v[104:107]
    ds_read_b64_tr_b16 a[4:5], v6 offset:17408
    v_mfma_f32_16x16x32_bf16 v[112:115], a[20:23], a[120:123], v[112:115]
    ds_read_b64_tr_b16 a[6:7], v6 offset:25600
    v_mfma_f32_16x16x32_bf16 v[120:123], a[20:23], a[128:131], v[120:123]
    s_waitcnt lgkmcnt(15)
    ds_read_b64_tr_b16 a[8:9], v7 offset:16384
    v_mfma_f32_16x16x32_bf16 v[128:131], a[24:27], a[120:123], v[128:131]
    ds_read_b64_tr_b16 a[10:11], v7 offset:24576
    v_mfma_f32_16x16x32_bf16 v[136:139], a[24:27], a[128:131], v[136:139]
    s_buffer_load_dwordx2 s[100:101], s[16:19], s89 offset:1340
    ds_read_b64_tr_b16 a[12:13], v7 offset:17408
    v_mfma_f32_16x16x32_bf16 v[144:147], a[28:31], a[120:123], v[144:147]
    ds_read_b64_tr_b16 a[14:15], v7 offset:25600
    v_mfma_f32_16x16x32_bf16 v[152:155], a[28:31], a[128:131], v[152:155]
    s_waitcnt lgkmcnt(15)
    ds_read_b64_tr_b16 a[16:17], v6 offset:16640
    v_mfma_f32_16x16x32_bf16 v[160:163], a[32:35], a[120:123], v[160:163]
    ds_read_b64_tr_b16 a[18:19], v6 offset:24832
    v_mfma_f32_16x16x32_bf16 v[168:171], a[32:35], a[128:131], v[168:171]
    ds_read_b64_tr_b16 a[20:21], v6 offset:17664
    v_mfma_f32_16x16x32_bf16 v[176:179], a[36:39], a[120:123], v[176:179]
    ds_read_b64_tr_b16 a[22:23], v6 offset:25856
    v_mfma_f32_16x16x32_bf16 v[184:187], a[36:39], a[128:131], v[184:187]
    s_waitcnt lgkmcnt(15)
    ds_read_b64_tr_b16 a[24:25], v7 offset:16640
    v_mfma_f32_16x16x32_bf16 v[192:195], a[40:43], a[120:123], v[192:195]
    ds_read_b64_tr_b16 a[26:27], v7 offset:24832
    v_mfma_f32_16x16x32_bf16 v[200:203], a[40:43], a[128:131], v[200:203]
    ds_read_b64_tr_b16 a[28:29], v7 offset:17664
    v_mfma_f32_16x16x32_bf16 v[208:211], a[44:47], a[120:123], v[208:211]
    ds_read_b64_tr_b16 a[30:31], v7 offset:25856
    v_mfma_f32_16x16x32_bf16 v[216:219], a[44:47], a[128:131], v[216:219]
    s_waitcnt lgkmcnt(15)
    ds_read_b64_tr_b16 a[32:33], v6 offset:16896
    v_mfma_f32_16x16x32_bf16 v[224:227], a[48:51], a[120:123], v[224:227]
    ds_read_b64_tr_b16 a[34:35], v6 offset:25088
    v_mfma_f32_16x16x32_bf16 v[232:235], a[48:51], a[128:131], v[232:235]
    ds_read_b64_tr_b16 a[36:37], v6 offset:17920
    v_mfma_f32_16x16x32_bf16 v[240:243], a[52:55], a[120:123], v[240:243]
    ds_read_b64_tr_b16 a[38:39], v6 offset:26112
    v_mfma_f32_16x16x32_bf16 v[248:251], a[52:55], a[128:131], v[248:251]
    s_waitcnt lgkmcnt(15)
    ds_read_b64_tr_b16 a[40:41], v7 offset:16896
    v_mfma_f32_16x16x32_bf16 v[32:35], a[0:3], a[136:139], v[32:35]
    ds_read_b64_tr_b16 a[42:43], v7 offset:25088
    v_mfma_f32_16x16x32_bf16 v[40:43], a[0:3], a[144:147], v[40:43]
    ds_read_b64_tr_b16 a[44:45], v7 offset:17920
    v_mfma_f32_16x16x32_bf16 v[48:51], a[4:7], a[136:139], v[48:51]
    s_buffer_load_dwordx2 s[100:101], s[12:15], s89 offset:444
    ds_read_b64_tr_b16 a[46:47], v7 offset:26112
    v_mfma_f32_16x16x32_bf16 v[56:59], a[4:7], a[144:147], v[56:59]
    s_waitcnt lgkmcnt(15)
    s_barrier
    ds_read_b64_tr_b16 a[48:49], v6 offset:17152
    v_mfma_f32_16x16x32_bf16 v[64:67], a[8:11], a[136:139], v[64:67]
    ds_read_b64_tr_b16 a[50:51], v6 offset:25344
    v_mfma_f32_16x16x32_bf16 v[72:75], a[8:11], a[144:147], v[72:75]
    ds_read_b64_tr_b16 a[52:53], v6 offset:18176
    v_mfma_f32_16x16x32_bf16 v[80:83], a[12:15], a[136:139], v[80:83]
    ds_read_b64_tr_b16 a[54:55], v6 offset:26368
    v_mfma_f32_16x16x32_bf16 v[88:91], a[12:15], a[144:147], v[88:91]
    s_waitcnt lgkmcnt(15)
    ds_read_b64_tr_b16 a[0:1], v6 offset:32768
    v_mfma_f32_16x16x32_bf16 v[96:99], a[16:19], a[136:139], v[96:99]
    ds_read_b64_tr_b16 a[2:3], v6 offset:40960
    v_mfma_f32_16x16x32_bf16 v[104:107], a[16:19], a[144:147], v[104:107]
    ds_read_b64_tr_b16 a[4:5], v6 offset:33792
    v_mfma_f32_16x16x32_bf16 v[112:115], a[20:23], a[136:139], v[112:115]
    ds_read_b64_tr_b16 a[6:7], v6 offset:41984
    v_mfma_f32_16x16x32_bf16 v[120:123], a[20:23], a[144:147], v[120:123]
    s_waitcnt lgkmcnt(15)
    ds_read_b64_tr_b16 a[8:9], v7 offset:32768
    v_mfma_f32_16x16x32_bf16 v[128:131], a[24:27], a[136:139], v[128:131]
    ds_read_b64_tr_b16 a[10:11], v7 offset:40960
    v_mfma_f32_16x16x32_bf16 v[136:139], a[24:27], a[144:147], v[136:139]
    s_cmp_eq_u32 s28, 1
    s_cbranch_scc0 L_qkv_back4w
    s_waitcnt vmcnt(0)
    v_cmp_gt_i32 vcc, 4, v16
    s_nop 1
    s_cbranch_vccnz L_qkv_slow4w
L_qkv_back4w:
    s_barrier
    v_mfma_f32_16x16x32_bf16 v[144:147], a[28:31], a[136:139], v[144:147]
    buffer_load_dwordx4 a[60:63], v1, s[8:11], s31 offen offset:1024 sc1
    ds_read_b64_tr_b16 a[12:13], v7 offset:33792
    v_mfma_f32_16x16x32_bf16 v[152:155], a[28:31], a[144:147], v[152:155]
    s_waitcnt lgkmcnt(15)
    buffer_load_dwordx4 a[68:71], v1, s[8:11], s31 offen offset:3072 sc1
    s_add_u32 s31, s31, 4096
    v_mfma_f32_16x16x32_bf16 v[160:163], a[32:35], a[136:139], v[160:163]
    buffer_load_dwordx4 a[76:79], v1, s[8:11], s31 offen offset:1024 sc1
    ds_read_b64_tr_b16 a[14:15], v7 offset:41984
    v_mfma_f32_16x16x32_bf16 v[168:171], a[32:35], a[144:147], v[168:171]
    buffer_load_dwordx4 a[84:87], v1, s[8:11], s31 offen offset:3072 sc1
    s_add_u32 s31, s31, 4096
    v_mfma_f32_16x16x32_bf16 v[176:179], a[36:39], a[136:139], v[176:179]
    ds_read_b64_tr_b16 a[16:17], v6 offset:33024
    ds_read_b64_tr_b16 a[18:19], v6 offset:41216
    v_mfma_f32_16x16x32_bf16 v[184:187], a[36:39], a[144:147], v[184:187]
    s_waitcnt lgkmcnt(15)
    s_buffer_load_dwordx2 s[100:101], s[16:19], s89 offset:1468
    ds_read_b64_tr_b16 a[20:21], v6 offset:34048
    v_mfma_f32_16x16x32_bf16 v[192:195], a[40:43], a[136:139], v[192:195]
    ds_read_b64_tr_b16 a[22:23], v6 offset:42240
    ds_read_b64_tr_b16 a[24:25], v7 offset:33024
    v_mfma_f32_16x16x32_bf16 v[200:203], a[40:43], a[144:147], v[200:203]
    s_waitcnt lgkmcnt(15)
    ds_read_b64_tr_b16 a[26:27], v7 offset:41216
    ds_read_b64_tr_b16 a[28:29], v7 offset:34048
    v_mfma_f32_16x16x32_bf16 v[208:211], a[44:47], a[136:139], v[208:211]
    buffer_load_dwordx4 a[92:95], v1, s[8:11], s31 offen offset:1024 sc1
    ds_read_b64_tr_b16 a[30:31], v7 offset:42240
    v_mfma_f32_16x16x32_bf16 v[216:219], a[44:47], a[144:147], v[216:219]
    ds_read_b64_tr_b16 a[32:33], v6 offset:33280
    v_mfma_f32_16x16x32_bf16 v[224:227], a[48:51], a[136:139], v[224:227]
    ds_read_b64_tr_b16 a[34:35], v6 offset:41472
    v_mfma_f32_16x16x32_bf16 v[232:235], a[48:51], a[144:147], v[232:235]
    s_waitcnt lgkmcnt(15)
    ds_read_b64_tr_b16 a[36:37], v6 offset:34304
    v_mfma_f32_16x16x32_bf16 v[240:243], a[52:55], a[136:139], v[240:243]
    ds_read_b64_tr_b16 a[38:39], v6 offset:42496
    v_mfma_f32_16x16x32_bf16 v[248:251], a[52:55], a[144:147], v[248:251]
    ds_read_b64_tr_b16 a[40:41], v7 offset:33280
    v_mfma_f32_16x16x32_bf16 v[32:35], a[0:3], a[152:155], v[32:35]
    buffer_load_dwordx4 a[100:103], v1, s[8:11], s31 offen offset:3072 sc1
    s_add_u32 s31, s31, 4096
    v_mfma_f32_16x16x32_bf16 v[40:43], a[0:3], a[160:163], v[40:43]
    s_waitcnt lgkmcnt(15)
    ds_read_b64_tr_b16 a[42:43], v7 offset:41472
    ds_read_b64_tr_b16 a[44:45], v7 offset:34304
    v_mfma_f32_16x16x32_bf16 v[48:51], a[4:7], a[152:155], v[48:51]
    ds_read_b64_tr_b16 a[46:47], v7 offset:42496
    v_mfma_f32_16x16x32_bf16 v[56:59], a[4:7], a[160:163], v[56:59]
    ds_read_b64_tr_b16 a[48:49], v6 offset:33536
    v_mfma_f32_16x16x32_bf16 v[64:67], a[8:11], a[152:155], v[64:67]
    ds_read_b64_tr_b16 a[50:51], v6 offset:41728
    v_mfma_f32_16x16x32_bf16 v[72:75], a[8:11], a[160:163], v[72:75]
    s_waitcnt lgkmcnt(15)
    ds_read_b64_tr_b16 a[52:53], v6 offset:34560
    v_mfma_f32_16x16x32_bf16 v[80:83], a[12:15], a[152:155], v[80:83]
    buffer_load_dwordx4 a[108:111], v1, s[8:11], s31 offen offset:1024 sc1
    ds_read_b64_tr_b16 a[54:55], v6 offset:42752
    v_mfma_f32_16x16x32_bf16 v[88:91], a[12:15], a[160:163], v[88:91]
    ds_read_b64_tr_b16 a[0:1], v4 offset:0
    v_mfma_f32_16x16x32_bf16 v[96:99], a[16:19], a[152:155], v[96:99]
    s_buffer_load_dwordx2 s[100:101], s[12:15], s89 offset:572
    ds_read_b64_tr_b16 a[2:3], v4 offset:8192
    v_mfma_f32_16x16x32_bf16 v[104:107], a[16:19], a[160:163], v[104:107]
    s_waitcnt lgkmcnt(15)
    ds_read_b64_tr_b16 a[4:5], v4 offset:1024
    v_mfma_f32_16x16x32_bf16 v[112:115], a[20:23], a[152:155], v[112:115]
    ds_read_b64_tr_b16 a[6:7], v4 offset:9216
    v_mfma_f32_16x16x32_bf16 v[120:123], a[20:23], a[160:163], v[120:123]
    ds_read_b64_tr_b16 a[8:9], v5 offset:0
    v_mfma_f32_16x16x32_bf16 v[128:131], a[24:27], a[152:155], v[128:131]
    buffer_load_dwordx4 a[116:119], v1, s[8:11], s31 offen offset:3072 sc1
    s_add_u32 s31, s31, 4096
    v_mfma_f32_16x16x32_bf16 v[136:139], a[24:27], a[160:163], v[136:139]
    s_waitcnt lgkmcnt(15)
    ds_read_b64_tr_b16 a[10:11], v5 offset:8192
    ds_read_b64_tr_b16 a[12:13], v5 offset:1024
    v_mfma_f32_16x16x32_bf16 v[144:147], a[28:31], a[152:155], v[144:147]
    ds_read_b64_tr_b16 a[14:15], v5 offset:9216
    v_mfma_f32_16x16x32_bf16 v[152:155], a[28:31], a[160:163], v[152:155]
    ds_read_b64_tr_b16 a[16:17], v4 offset:256
    v_mfma_f32_16x16x32_bf16 v[160:163], a[32:35], a[152:155], v[160:163]
    ds_read_b64_tr_b16 a[18:19], v4 offset:8448
    v_mfma_f32_16x16x32_bf16 v[168:171], a[32:35], a[160:163], v[168:171]
    s_waitcnt lgkmcnt(15)
    ds_read_b64_tr_b16 a[20:21], v4 offset:1280
    v_mfma_f32_16x16x32_bf16 v[176:179], a[36:39], a[152:155], v[176:179]
    buffer_load_dwordx4 a[124:127], v1, s[8:11], s31 offen offset:1024 sc1
    ds_read_b64_tr_b16 a[22:23], v4 offset:9472
    v_mfma_f32_16x16x32_bf16 v[184:187], a[36:39], a[160:163], v[184:187]
    ds_read_b64_tr_b16 a[24:25], v5 offset:256
    v_mfma_f32_16x16x32_bf16 v[192:195], a[40:43], a[152:155], v[192:195]
    ds_read_b64_tr_b16 a[26:27], v5 offset:8448
    v_mfma_f32_16x16x32_bf16 v[200:203], a[40:43], a[160:163], v[200:203]
    s_waitcnt lgkmcnt(15)
    ds_read_b64_tr_b16 a[28:29], v5 offset:1280
    v_mfma_f32_16x16x32_bf16 v[208:211], a[44:47], a[152:155], v[208:211]
    ds_read_b64_tr_b16 a[30:31], v5 offset:9472
    v_mfma_f32_16x16x32_bf16 v[216:219], a[44:47], a[160:163], v[216:219]
    ds_read_b64_tr_b16 a[32:33], v4 offset:512
    v_mfma_f32_16x16x32_bf16 v[224:227], a[48:51], a[152:155], v[224:227]
    buffer_load_dwordx4 a[132:135], v1, s[8:11], s31 offen offset:3072 sc1
    s_add_u32 s31, s31, 4096
    v_mfma_f32_16x16x32_bf16 v[232:235], a[48:51], a[160:163], v[232:235]
    s_waitcnt lgkmcnt(15)
    s_buffer_load_dwordx2 s[100:101], s[16:19], s89 offset:1596
    ds_read_b64_tr_b16 a[34:35], v4 offset:8704
    v_mfma_f32_16x16x32_bf16 v[240:243], a[52:55], a[152:155], v[240:243]
    ds_read_b64_tr_b16 a[36:37], v4 offset:1536
    ds_read_b64_tr_b16 a[38:39], v4 offset:9728
    v_mfma_f32_16x16x32_bf16 v[248:251], a[52:55], a[160:163], v[248:251]
    s_waitcnt vmcnt(9)
    ds_read_b64_tr_b16 a[40:41], v5 offset:512
    v_mfma_f32_16x16x32_bf16 v[36:39], a[0:3], a[60:63], 0
    s_waitcnt vmcnt(8)
    ds_read_b64_tr_b16 a[42:43], v5 offset:8704
    v_mfma_f32_16x16x32_bf16 v[44:47], a[0:3], a[68:71], 0
    s_waitcnt lgkmcnt(15)
    ds_read_b64_tr_b16 a[44:45], v5 offset:1536
    v_mfma_f32_16x16x32_bf16 v[52:55], a[4:7], a[60:63], 0
    buffer_load_dwordx4 a[140:143], v1, s[8:11], s31 offen offset:1024 sc1
    ds_read_b64_tr_b16 a[46:47], v5 offset:9728
    v_mfma_f32_16x16x32_bf16 v[60:63], a[4:7], a[68:71], 0
    ds_read_b64_tr_b16 a[48:49], v4 offset:768
    v_mfma_f32_16x16x32_bf16 v[68:71], a[8:11], a[60:63], 0
    ds_read_b64_tr_b16 a[50:51], v4 offset:8960
    v_mfma_f32_16x16x32_bf16 v[76:79], a[8:11], a[68:71], 0
    s_waitcnt lgkmcnt(15)
    ds_read_b64_tr_b16 a[52:53], v4 offset:1792
    v_mfma_f32_16x16x32_bf16 v[84:87], a[12:15], a[60:63], 0
    ds_read_b64_tr_b16 a[54:55], v4 offset:9984
    v_mfma_f32_16x16x32_bf16 v[92:95], a[12:15], a[68:71], 0
    ds_read_b64_tr_b16 a[0:1], v4 offset:16384
    v_mfma_f32_16x16x32_bf16 v[100:103], a[16:19], a[60:63], 0
    buffer_load_dwordx4 a[148:151], v1, s[8:11], s31 offen offset:3072 sc1
    s_add_u32 s31, s31, 4096
    v_mfma_f32_16x16x32_bf16 v[108:111], a[16:19], a[68:71], 0
    s_waitcnt lgkmcnt(15)
    ds_read_b64_tr_b16 a[2:3], v4 offset:24576
    ds_read_b64_tr_b16 a[4:5], v4 offset:17408
    v_mfma_f32_16x16x32_bf16 v[116:119], a[20:23], a[60:63], 0
    ds_read_b64_tr_b16 a[6:7], v4 offset:25600
    v_mfma_f32_16x16x32_bf16 v[124:127], a[20:23], a[68:71], 0
    ds_read_b64_tr_b16 a[8:9], v5 offset:16384
    v_mfma_f32_16x16x32_bf16 v[132:135], a[24:27], a[60:63], 0
    ds_read_b64_tr_b16 a[10:11], v5 offset:24576
    v_mfma_f32_16x16x32_bf16 v[140:143], a[24:27], a[68:71], 0
    s_waitcnt lgkmcnt(15)
    ds_read_b64_tr_b16 a[12:13], v5 offset:17408
    v_mfma_f32_16x16x32_bf16 v[148:151], a[28:31], a[60:63], 0
    buffer_load_dwordx4 a[156:159], v1, s[8:11], s31 offen offset:1024 sc1
    ds_read_b64_tr_b16 a[14:15], v5 offset:25600
    v_mfma_f32_16x16x32_bf16 v[156:159], a[28:31], a[68:71], 0
    s_buffer_load_dwordx2 s[100:101], s[12:15], s89 offset:700
    ds_read_b64_tr_b16 a[16:17], v4 offset:16640
    v_mfma_f32_16x16x32_bf16 v[164:167], a[32:35], a[60:63], 0
    ds_read_b64_tr_b16 a[18:19], v4 offset:24832
    v_mfma_f32_16x16x32_bf16 v[172:175], a[32:35], a[68:71], 0
    s_waitcnt lgkmcnt(15)
    ds_read_b64_tr_b16 a[20:21], v4 offset:17664
    v_mfma_f32_16x16x32_bf16 v[180:183], a[36:39], a[60:63], 0
    ds_read_b64_tr_b16 a[22:23], v4 offset:25856
    v_mfma_f32_16x16x32_bf16 v[188:191], a[36:39], a[68:71], 0
    ds_read_b64_tr_b16 a[24:25], v5 offset:16640
    v_mfma_f32_16x16x32_bf16 v[196:199], a[40:43], a[60:63], 0
    buffer_load_dwordx4 a[164:167], v1, s[8:11], s31 offen offset:3072 sc1
    s_add_u32 s31, s31, 4096
    v_mfma_f32_16x16x32_bf16 v[204:207], a[40:43], a[68:71], 0
    s_waitcnt lgkmcnt(15)
    buffer_load_dwordx2 v[16:17], v15, s[44:47], s34 offen offset:0 sc1
    v_mfma_f32_16x16x32_bf16 v[212:215], a[44:47], a[60:63], 0
    buffer_load_dwordx2 v[18:19], v15, s[44:47], s34 offen offset:128 sc1
    ds_read_b64_tr_b16 a[26:27], v5 offset:24832
    v_mfma_f32_16x16x32_bf16 v[220:223], a[44:47], a[68:71], 0
    buffer_load_dwordx2 v[20:21], v15, s[44:47], s34 offen offset:256 sc1
    ds_read_b64_tr_b16 a[28:29], v5 offset:17664
    v_mfma_f32_16x16x32_bf16 v[228:231], a[48:51], a[60:63], 0
    buffer_load_dwordx2 v[22:23], v15, s[44:47], s34 offen offset:384 sc1
    ds_read_b64_tr_b16 a[30:31], v5 offset:25856
    v_mfma_f32_16x16x32_bf16 v[236:239], a[48:51], a[68:71], 0
    s_waitcnt lgkmcnt(15)
    ds_read_b64_tr_b16 a[32:33], v4 offset:16896
    ds_read_b64_tr_b16 a[34:35], v4 offset:25088
    v_mfma_f32_16x16x32_bf16 v[244:247], a[52:55], a[60:63], 0
    buffer_load_dwordx2 v[24:25], v15, s[44:47], s34 offen offset:2048 sc1
    ds_read_b64_tr_b16 a[36:37], v4 offset:17920
    v_mfma_f32_16x16x32_bf16 v[252:255], a[52:55], a[68:71], 0
    s_waitcnt vmcnt(15) lgkmcnt(15)
    ds_read_b64_tr_b16 a[38:39], v4 offset:26112
    ds_read_b64_tr_b16 a[40:41], v5 offset:16896
    v_mfma_f32_16x16x32_bf16 v[36:39], a[0:3], a[76:79], v[36:39]
    ds_read_b64_tr_b16 a[42:43], v5 offset:25088
    v_mfma_f32_16x16x32_bf16 v[44:47], a[0:3], a[84:87], v[44:47]
    buffer_load_dwordx2 v[26:27], v15, s[44:47], s34 offen offset:2176 sc1
    ds_read_b64_tr_b16 a[44:45], v5 offset:17920
    v_mfma_f32_16x16x32_bf16 v[52:55], a[4:7], a[76:79], v[52:55]
    ds_read_b64_tr_b16 a[46:47], v5 offset:26112
    v_mfma_f32_16x16x32_bf16 v[60:63], a[4:7], a[84:87], v[60:63]
    s_waitcnt lgkmcnt(15)
    s_buffer_load_dwordx2 s[100:101], s[16:19], s89 offset:1724
    ds_read_b64_tr_b16 a[48:49], v4 offset:17152
    v_mfma_f32_16x16x32_bf16 v[68:71], a[8:11], a[76:79], v[68:71]
    ds_read_b64_tr_b16 a[50:51], v4 offset:25344
    v_mfma_f32_16x16x32_bf16 v[76:79], a[8:11], a[84:87], v[76:79]
    ds_read_b64_tr_b16 a[52:53], v4 offset:18176
    v_mfma_f32_16x16x32_bf16 v[84:87], a[12:15], a[76:79], v[84:87]
    buffer_load_dwordx2 v[28:29], v15, s[44:47], s34 offen offset:2304 sc1
    ds_read_b64_tr_b16 a[54:55], v4 offset:26368
    v_mfma_f32_16x16x32_bf16 v[92:95], a[12:15], a[84:87], v[92:95]
    s_waitcnt lgkmcnt(15)
    ds_read_b64_tr_b16 a[0:1], v4 offset:32768
    v_mfma_f32_16x16x32_bf16 v[100:103], a[16:19], a[76:79], v[100:103]
    ds_read_b64_tr_b16 a[2:3], v4 offset:40960
    v_mfma_f32_16x16x32_bf16 v[108:111], a[16:19], a[84:87], v[108:111]
    ds_read_b64_tr_b16 a[4:5], v4 offset:33792
    v_mfma_f32_16x16x32_bf16 v[116:119], a[20:23], a[76:79], v[116:119]
    ds_read_b64_tr_b16 a[6:7], v4 offset:41984
    v_mfma_f32_16x16x32_bf16 v[124:127], a[20:23], a[84:87], v[124:127]
    s_waitcnt lgkmcnt(15)
    ds_read_b64_tr_b16 a[8:9], v5 offset:32768
    v_mfma_f32_16x16x32_bf16 v[132:135], a[24:27], a[76:79], v[132:135]
    buffer_load_dwordx4 a[168:171], v1, s[8:11], s31 offen offset:0 sc1
    ds_read_b64_tr_b16 a[10:11], v5 offset:40960
    v_mfma_f32_16x16x32_bf16 v[140:143], a[24:27], a[84:87], v[140:143]
    buffer_load_dwordx2 v[30:31], v15, s[44:47], s34 offen offset:2432 sc1
    ds_read_b64_tr_b16 a[12:13], v5 offset:33792
    v_mfma_f32_16x16x32_bf16 v[148:151], a[28:31], a[76:79], v[148:151]
    ds_read_b64_tr_b16 a[14:15], v5 offset:41984
    v_mfma_f32_16x16x32_bf16 v[156:159], a[28:31], a[84:87], v[156:159]
    s_waitcnt lgkmcnt(15)
    ds_read_b64_tr_b16 a[16:17], v4 offset:33024
    v_mfma_f32_16x16x32_bf16 v[164:167], a[32:35], a[76:79], v[164:167]
    ds_read_b64_tr_b16 a[18:19], v4 offset:41216
    v_mfma_f32_16x16x32_bf16 v[172:175], a[32:35], a[84:87], v[172:175]
    ds_read_b64_tr_b16 a[20:21], v4 offset:34048
    v_mfma_f32_16x16x32_bf16 v[180:183], a[36:39], a[76:79], v[180:183]
    ds_read_b64_tr_b16 a[22:23], v4 offset:42240
    v_mfma_f32_16x16x32_bf16 v[188:191], a[36:39], a[84:87], v[188:191]
    s_waitcnt lgkmcnt(15)
    ds_read_b64_tr_b16 a[24:25], v5 offset:33024
    v_mfma_f32_16x16x32_bf16 v[196:199], a[40:43], a[76:79], v[196:199]
    buffer_load_dwordx4 a[172:175], v1, s[8:11], s31 offen offset:1024 sc1
    ds_read_b64_tr_b16 a[26:27], v5 offset:41216
    v_mfma_f32_16x16x32_bf16 v[204:207], a[40:43], a[84:87], v[204:207]
    s_add_u32 s36, s20, 0xc00000
    s_addc_u32 s37, s21, 0
    s_and_b32 s37, s37, 0xffff
    s_mov_b32 s38, 14680064
    s_mov_b32 s39, 0x00020000
    v_mfma_f32_16x16x32_bf16 v[212:215], a[44:47], a[76:79], v[212:215]
    s_buffer_load_dwordx2 s[100:101], s[12:15], s89 offset:828
    ds_read_b64_tr_b16 a[28:29], v5 offset:34048
    ds_read_b64_tr_b16 a[30:31], v5 offset:42240
    v_mfma_f32_16x16x32_bf16 v[220:223], a[44:47], a[84:87], v[220:223]
    s_waitcnt lgkmcnt(15)
    ds_read_b64_tr_b16 a[32:33], v4 offset:33280
    v_mfma_f32_16x16x32_bf16 v[228:231], a[48:51], a[76:79], v[228:231]
    ds_read_b64_tr_b16 a[34:35], v4 offset:41472
    v_mfma_f32_16x16x32_bf16 v[236:239], a[48:51], a[84:87], v[236:239]
    buffer_load_dwordx4 a[176:179], v1, s[8:11], s31 offen offset:2048 sc1
    ds_read_b64_tr_b16 a[36:37], v4 offset:34304
    v_mfma_f32_16x16x32_bf16 v[244:247], a[52:55], a[76:79], v[244:247]
    s_mov_b32 s40, s60
    s_and_b32 s41, s61, 0xffff
    ds_read_b64_tr_b16 a[38:39], v4 offset:42496
    v_mfma_f32_16x16x32_bf16 v[252:255], a[52:55], a[84:87], v[252:255]
    s_waitcnt vmcnt(19) lgkmcnt(15)
    s_mov_b32 s42, 7340032
    ds_read_b64_tr_b16 a[40:41], v5 offset:33280
    v_mfma_f32_16x16x32_bf16 v[36:39], a[0:3], a[92:95], v[36:39]
    s_mov_b32 s43, 0x00020000
    ds_read_b64_tr_b16 a[42:43], v5 offset:41472
    v_mfma_f32_16x16x32_bf16 v[44:47], a[0:3], a[100:103], v[44:47]
    s_mov_b32 s48, s62
    ds_read_b64_tr_b16 a[44:45], v5 offset:34304
    v_mfma_f32_16x16x32_bf16 v[52:55], a[4:7], a[92:95], v[52:55]
    s_and_b32 s49, s63, 0xffff
    ds_read_b64_tr_b16 a[46:47], v5 offset:42496
    v_mfma_f32_16x16x32_bf16 v[60:63], a[4:7], a[100:103], v[60:63]
    s_waitcnt lgkmcnt(15)
    s_mov_b32 s50, 4194304
    ds_read_b64_tr_b16 a[48:49], v4 offset:33536
    v_mfma_f32_16x16x32_bf16 v[68:71], a[8:11], a[92:95], v[68:71]
    buffer_load_dwordx4 a[180:183], v1, s[8:11], s31 offen offset:3072 sc1
    s_add_u32 s31, s31, 4096
    v_mfma_f32_16x16x32_bf16 v[76:79], a[8:11], a[100:103], v[76:79]
    s_mov_b32 s51, 0x00020000
    s_lshr_b32 s60, s27, 3
    ds_read_b64_tr_b16 a[50:51], v4 offset:41728
    v_mfma_f32_16x16x32_bf16 v[84:87], a[12:15], a[92:95], v[84:87]
    s_and_b32 s24, s27, 7
    ds_read_b64_tr_b16 a[52:53], v4 offset:34560
    ds_read_b64_tr_b16 a[54:55], v4 offset:42752
    v_mfma_f32_16x16x32_bf16 v[92:95], a[12:15], a[100:103], v[92:95]
    s_waitcnt lgkmcnt(15)
    ds_read_b64_tr_b16 a[0:1], v4 offset:49152
    v_mfma_f32_16x16x32_bf16 v[100:103], a[16:19], a[92:95], v[100:103]
    s_mul_i32 s34, s29, 458752
    ds_read_b64_tr_b16 a[2:3], v4 offset:57344
    v_mfma_f32_16x16x32_bf16 v[108:111], a[16:19], a[100:103], v[108:111]
    buffer_load_dwordx4 a[192:195], v1, s[8:11], s31 offen offset:0 sc1
    ds_read_b64_tr_b16 a[4:5], v4 offset:50176
    v_mfma_f32_16x16x32_bf16 v[116:119], a[20:23], a[92:95], v[116:119]
    s_mul_i32 s62, s60, 114688
    s_buffer_load_dwordx2 s[100:101], s[16:19], s89 offset:1852
    s_add_u32 s52, s34, s62
    ds_read_b64_tr_b16 a[6:7], v4 offset:58368
    v_mfma_f32_16x16x32_bf16 v[124:127], a[20:23], a[100:103], v[124:127]
    s_waitcnt lgkmcnt(15)
    s_lshr_b32 s62, s27, 1
    ds_read_b64_tr_b16 a[8:9], v5 offset:49152
    v_mfma_f32_16x16x32_bf16 v[132:135], a[24:27], a[92:95], v[132:135]
    s_mul_i32 s62, s62, 28672
    ds_read_b64_tr_b16 a[10:11], v5 offset:57344
    v_mfma_f32_16x16x32_bf16 v[140:143], a[24:27], a[100:103], v[140:143]
    s_add_u32 s34, s34, s62
    ds_read_b64_tr_b16 a[12:13], v5 offset:50176
    v_mfma_f32_16x16x32_bf16 v[148:151], a[28:31], a[92:95], v[148:151]
    buffer_load_dwordx4 a[196:199], v1, s[8:11], s31 offen offset:1024 sc1
    ds_read_b64_tr_b16 a[14:15], v5 offset:58368
    v_mfma_f32_16x16x32_bf16 v[156:159], a[28:31], a[100:103], v[156:159]
    s_waitcnt lgkmcnt(15)
    s_lshl_b32 s59, s33, 10
    s_add_u32 s53, s34, s59
    ds_read_b64_tr_b16 a[16:17], v4 offset:49408
    v_mfma_f32_16x16x32_bf16 v[164:167], a[32:35], a[92:95], v[164:167]
    s_add_u32 s53, s53, 12288
    ds_read_b64_tr_b16 a[18:19], v4 offset:57600
    v_mfma_f32_16x16x32_bf16 v[172:175], a[32:35], a[100:103], v[172:175]
    s_lshl_b32 s59, s33, 14
    ds_read_b64_tr_b16 a[20:21], v4 offset:50432
    v_mfma_f32_16x16x32_bf16 v[180:183], a[36:39], a[92:95], v[180:183]
    s_add_u32 s34, s34, s59
    ds_read_b64_tr_b16 a[22:23], v4 offset:58624
    v_mfma_f32_16x16x32_bf16 v[188:191], a[36:39], a[100:103], v[188:191]
    s_waitcnt lgkmcnt(15)
    s_lshr_b32 s23, s60, 1
    ds_read_b64_tr_b16 a[24:25], v5 offset:49408
    v_mfma_f32_16x16x32_bf16 v[196:199], a[40:43], a[92:95], v[196:199]
    buffer_load_dwordx4 a[200:203], v1, s[8:11], s31 offen offset:2048 sc1
    ds_read_b64_tr_b16 a[26:27], v5 offset:57600
    v_mfma_f32_16x16x32_bf16 v[204:207], a[40:43], a[100:103], v[204:207]
    s_lshl_b32 s23, s23, 7
    s_lshr_b32 s25, s24, 2
    ds_read_b64_tr_b16 a[28:29], v5 offset:50432
    v_mfma_f32_16x16x32_bf16 v[212:215], a[44:47], a[92:95], v[212:215]
    s_mul_i32 s62, s25, 57344
    ds_read_b64_tr_b16 a[30:31], v5 offset:58624
    v_mfma_f32_16x16x32_bf16 v[220:223], a[44:47], a[100:103], v[220:223]
    s_waitcnt lgkmcnt(15)
    ds_read_b64_tr_b16 a[32:33], v4 offset:49664
    v_mfma_f32_16x16x32_bf16 v[228:231], a[48:51], a[92:95], v[228:231]
    s_xor_b32 s65, s62, 57344
    ds_read_b64_tr_b16 a[34:35], v4 offset:57856
    v_mfma_f32_16x16x32_bf16 v[236:239], a[48:51], a[100:103], v[236:239]
    s_add_u32 s65, s65, s52
    ds_read_b64_tr_b16 a[36:37], v4 offset:50688
    v_mfma_f32_16x16x32_bf16 v[244:247], a[52:55], a[92:95], v[244:247]
    buffer_load_dwordx4 a[204:207], v1, s[8:11], s31 offen offset:3072 sc1
    s_add_u32 s31, s31, 4096
    v_mfma_f32_16x16x32_bf16 v[252:255], a[52:55], a[100:103], v[252:255]
    s_waitcnt vmcnt(22) lgkmcnt(15)
    s_add_u32 s52, s52, s62
    s_buffer_load_dwordx2 s[100:101], s[12:15], s89 offset:956
    ds_read_b64_tr_b16 a[38:39], v4 offset:58880
    v_mfma_f32_16x16x32_bf16 v[36:39], a[0:3], a[108:111], v[36:39]
    s_and_b32 s59, s24, 3
    s_cmp_le_u32 s59, 0
    s_cselect_b32 s77, 4, 0
    ds_read_b64_tr_b16 a[40:41], v5 offset:49664
    v_mfma_f32_16x16x32_bf16 v[44:47], a[0:3], a[116:119], v[44:47]
    ds_read_b64_tr_b16 a[42:43], v5 offset:57856
    ds_read_b64_tr_b16 a[44:45], v5 offset:50688
    v_mfma_f32_16x16x32_bf16 v[52:55], a[4:7], a[108:111], v[52:55]
    s_lshl_b32 s74, s77, 12
    ds_read_b64_tr_b16 a[46:47], v5 offset:58880
    v_mfma_f32_16x16x32_bf16 v[60:63], a[4:7], a[116:119], v[60:63]
    s_waitcnt lgkmcnt(15)
    s_add_u32 s74, s74, s52
    ds_read_b64_tr_b16 a[48:49], v4 offset:49920
    v_mfma_f32_16x16x32_bf16 v[68:71], a[8:11], a[108:111], v[68:71]
    buffer_load_dwordx4 a[208:211], v1, s[8:11], s31 offen offset:0 sc1
    ds_read_b64_tr_b16 a[50:51], v4 offset:58112
    v_mfma_f32_16x16x32_bf16 v[76:79], a[8:11], a[116:119], v[76:79]
    s_lshl_b32 s77, s77, 16
    s_cmp_le_u32 s59, 1
    s_cselect_b32 s78, 7, 4
    ds_read_b64_tr_b16 a[52:53], v4 offset:50944
    v_mfma_f32_16x16x32_bf16 v[84:87], a[12:15], a[108:111], v[84:87]
    ds_read_b64_tr_b16 a[54:55], v4 offset:59136
    v_mfma_f32_16x16x32_bf16 v[92:95], a[12:15], a[116:119], v[92:95]
    s_waitcnt lgkmcnt(15)
    s_lshl_b32 s75, s78, 12
    ds_read_b64_tr_b16 a[0:1], v6 offset:0
    v_mfma_f32_16x16x32_bf16 v[100:103], a[16:19], a[108:111], v[100:103]
    s_add_u32 s75, s75, s52
    ds_read_b64_tr_b16 a[2:3], v6 offset:8192
    v_mfma_f32_16x16x32_bf16 v[108:111], a[16:19], a[116:119], v[108:111]
    buffer_load_dwordx4 a[212:215], v1, s[8:11], s31 offen offset:1024 sc1
    ds_read_b64_tr_b16 a[4:5], v6 offset:1024
    v_mfma_f32_16x16x32_bf16 v[116:119], a[20:23], a[108:111], v[116:119]
    s_lshl_b32 s78, s78, 16
    s_cmp_le_u32 s59, 2
    s_cselect_b32 s79, 11, 7
    ds_read_b64_tr_b16 a[6:7], v6 offset:9216
    v_mfma_f32_16x16x32_bf16 v[124:127], a[20:23], a[116:119], v[124:127]
    s_waitcnt lgkmcnt(15)
    ds_read_b64_tr_b16 a[8:9], v7 offset:0
    v_mfma_f32_16x16x32_bf16 v[132:135], a[24:27], a[108:111], v[132:135]
    ds_read_b64_tr_b16 a[10:11], v7 offset:8192
    v_mfma_f32_16x16x32_bf16 v[140:143], a[24:27], a[116:119], v[140:143]
    s_lshl_b32 s76, s79, 12
    ds_read_b64_tr_b16 a[12:13], v7 offset:1024
    v_mfma_f32_16x16x32_bf16 v[148:151], a[28:31], a[108:111], v[148:151]
    buffer_load_dwordx4 a[216:219], v1, s[8:11], s31 offen offset:2048 sc1
    ds_read_b64_tr_b16 a[14:15], v7 offset:9216
    v_mfma_f32_16x16x32_bf16 v[156:159], a[28:31], a[116:119], v[156:159]
    s_waitcnt lgkmcnt(15)
    s_add_u32 s76, s76, s52
    s_lshl_b32 s79, s79, 16
    ds_read_b64_tr_b16 a[16:17], v6 offset:256
    v_mfma_f32_16x16x32_bf16 v[164:167], a[32:35], a[108:111], v[164:167]
    s_buffer_load_dwordx2 s[100:101], s[16:19], s89 offset:1980
    s_lshl_b32 s62, s59, 2
    ds_read_b64_tr_b16 a[18:19], v6 offset:8448
    v_mfma_f32_16x16x32_bf16 v[172:175], a[32:35], a[116:119], v[172:175]
    s_lshr_b32 s59, s59, 1
    ds_read_b64_tr_b16 a[20:21], v6 offset:1280
    v_mfma_f32_16x16x32_bf16 v[180:183], a[36:39], a[108:111], v[180:183]
    s_sub_u32 s62, s62, s59
    ds_read_b64_tr_b16 a[22:23], v6 offset:9472
    v_mfma_f32_16x16x32_bf16 v[188:191], a[36:39], a[116:119], v[188:191]
    s_waitcnt lgkmcnt(15)
    s_lshl_b32 s33, s62, 16
    ds_read_b64_tr_b16 a[24:25], v7 offset:256
    v_mfma_f32_16x16x32_bf16 v[196:199], a[40:43], a[108:111], v[196:199]
    buffer_load_dwordx4 a[220:223], v1, s[8:11], s31 offen offset:3072 sc1
    s_add_u32 s31, s31, 4096
    v_mfma_f32_16x16x32_bf16 v[204:207], a[40:43], a[116:119], v[204:207]
    s_lshl_b32 s62, s60, 1
    s_xor_b32 s59, s25, 0
    ds_read_b64_tr_b16 a[26:27], v7 offset:8448
    v_mfma_f32_16x16x32_bf16 v[212:215], a[44:47], a[108:111], v[212:215]
    s_add_u32 s62, s62, s59
    ds_read_b64_tr_b16 a[28:29], v7 offset:1280
    ds_read_b64_tr_b16 a[30:31], v7 offset:9472
    v_mfma_f32_16x16x32_bf16 v[220:223], a[44:47], a[116:119], v[220:223]
    s_waitcnt lgkmcnt(15)
    s_add_u32 s62, s62, 3
    ds_read_b64_tr_b16 a[32:33], v6 offset:512
    v_mfma_f32_16x16x32_bf16 v[228:231], a[48:51], a[108:111], v[228:231]
    s_and_b32 s62, s62, 7
    ds_read_b64_tr_b16 a[34:35], v6 offset:8704
    v_mfma_f32_16x16x32_bf16 v[236:239], a[48:51], a[116:119], v[236:239]
    buffer_load_dwordx4 a[224:227], v1, s[8:11], s31 offen offset:0 sc1
    ds_read_b64_tr_b16 a[36:37], v6 offset:1536
    v_mfma_f32_16x16x32_bf16 v[244:247], a[52:55], a[108:111], v[244:247]
    s_lshl_b32 s62, s62, 17
    ds_read_b64_tr_b16 a[38:39], v6 offset:9728
    v_mfma_f32_16x16x32_bf16 v[252:255], a[52:55], a[116:119], v[252:255]
    s_waitcnt vmcnt(25) lgkmcnt(15)
    s_add_u32 s4, s62, s23
    ds_read_b64_tr_b16 a[40:41], v7 offset:512
    v_mfma_f32_16x16x32_bf16 v[36:39], a[0:3], a[124:127], v[36:39]
    s_xor_b32 s5, s4, 128
    ds_read_b64_tr_b16 a[42:43], v7 offset:8704
    v_mfma_f32_16x16x32_bf16 v[44:47], a[0:3], a[132:135], v[44:47]
    s_lshl_b32 s62, s60, 1
    ds_read_b64_tr_b16 a[44:45], v7 offset:1536
    v_mfma_f32_16x16x32_bf16 v[52:55], a[4:7], a[124:127], v[52:55]
    s_xor_b32 s59, s25, 1
    ds_read_b64_tr_b16 a[46:47], v7 offset:9728
    v_mfma_f32_16x16x32_bf16 v[60:63], a[4:7], a[132:135], v[60:63]
    s_waitcnt lgkmcnt(15)
    s_add_u32 s62, s62, s59
    ds_read_b64_tr_b16 a[48:49], v6 offset:768
    v_mfma_f32_16x16x32_bf16 v[68:71], a[8:11], a[124:127], v[68:71]
    buffer_load_dwordx4 a[228:231], v1, s[8:11], s31 offen offset:1024 sc1
    ds_read_b64_tr_b16 a[50:51], v6 offset:8960
    v_mfma_f32_16x16x32_bf16 v[76:79], a[8:11], a[132:135], v[76:79]
    s_add_u32 s62, s62, 3
    s_buffer_load_dwordx2 s[100:101], s[12:15], s89 offset:1084
    s_and_b32 s62, s62, 7
    ds_read_b64_tr_b16 a[52:53], v6 offset:1792
    v_mfma_f32_16x16x32_bf16 v[84:87], a[12:15], a[124:127], v[84:87]
    s_lshl_b32 s62, s62, 17
    ds_read_b64_tr_b16 a[54:55], v6 offset:9984
    v_mfma_f32_16x16x32_bf16 v[92:95], a[12:15], a[132:135], v[92:95]
    s_waitcnt lgkmcnt(15)
    s_add_u32 s6, s62, s23
    ds_read_b64_tr_b16 a[0:1], v6 offset:16384
    v_mfma_f32_16x16x32_bf16 v[100:103], a[16:19], a[124:127], v[100:103]
    s_xor_b32 s7, s6, 128
    ds_read_b64_tr_b16 a[2:3], v6 offset:24576
    v_mfma_f32_16x16x32_bf16 v[108:111], a[16:19], a[132:135], v[108:111]
    buffer_load_dwordx4 a[232:235], v1, s[8:11], s31 offen offset:2048 sc1
    ds_read_b64_tr_b16 a[4:5], v6 offset:17408
    v_mfma_f32_16x16x32_bf16 v[116:119], a[20:23], a[124:127], v[116:119]
    s_lshl_b32 s54, s28, 10
    s_lshl_b32 s56, s29, 5
    ds_read_b64_tr_b16 a[6:7], v6 offset:25600
    v_mfma_f32_16x16x32_bf16 v[124:127], a[20:23], a[132:135], v[124:127]
    s_waitcnt lgkmcnt(15)
    s_add_u32 s56, s56, s27
    ds_read_b64_tr_b16 a[8:9], v7 offset:16384
    v_mfma_f32_16x16x32_bf16 v[132:135], a[24:27], a[124:127], v[132:135]
    s_lshl_b32 s61, s56, 14
    ds_read_b64_tr_b16 a[10:11], v7 offset:24576
    v_mfma_f32_16x16x32_bf16 v[140:143], a[24:27], a[132:135], v[140:143]
    s_lshl_b32 s56, s56, 7
    ds_read_b64_tr_b16 a[12:13], v7 offset:17408
    v_mfma_f32_16x16x32_bf16 v[148:151], a[28:31], a[124:127], v[148:151]
    ds_read_b64_tr_b16 a[14:15], v7 offset:25600
    v_mfma_f32_16x16x32_bf16 v[156:159], a[28:31], a[132:135], v[156:159]
    s_waitcnt lgkmcnt(15)
    s_add_u32 s56, s56, 8781824
    ds_read_b64_tr_b16 a[16:17], v6 offset:16640
    v_mfma_f32_16x16x32_bf16 v[164:167], a[32:35], a[124:127], v[164:167]
    buffer_load_dwordx4 a[236:239], v1, s[8:11], s31 offen offset:3072 sc1
    s_add_u32 s31, s31, 4096
    v_mfma_f32_16x16x32_bf16 v[172:175], a[32:35], a[132:135], v[172:175]
    s_andn2_b32 s57, s56, 1023
    s_andn2_b32 s58, s56, 3072
    ds_read_b64_tr_b16 a[18:19], v6 offset:24832
    v_mfma_f32_16x16x32_bf16 v[180:183], a[36:39], a[124:127], v[180:183]
    ds_read_b64_tr_b16 a[20:21], v6 offset:17664
    ds_read_b64_tr_b16 a[22:23], v6 offset:25856
    v_mfma_f32_16x16x32_bf16 v[188:191], a[36:39], a[132:135], v[188:191]
    s_waitcnt lgkmcnt(15)
    ds_read_b64_tr_b16 a[24:25], v7 offset:16640
    v_lshrrev_b32 v10, 3, v0
    v_mfma_f32_16x16x32_bf16 v[196:199], a[40:43], a[124:127], v[196:199]
    ds_read_b64_tr_b16 a[26:27], v7 offset:24832
    v_lshrrev_b32 v11, 4, v0
    v_mfma_f32_16x16x32_bf16 v[204:207], a[40:43], a[132:135], v[204:207]
    buffer_load_dwordx4 a[240:243], v1, s[8:11], s31 offen offset:0 sc1
    ds_read_b64_tr_b16 a[28:29], v7 offset:17664
    v_mfma_f32_16x16x32_bf16 v[212:215], a[44:47], a[124:127], v[212:215]
    s_buffer_load_dwordx2 s[100:101], s[16:19], s89 offset:2108
    ds_read_b64_tr_b16 a[30:31], v7 offset:25856
    v_lshlrev_b32 v11, 1, v11
    v_mfma_f32_16x16x32_bf16 v[220:223], a[44:47], a[132:135], v[220:223]
    s_waitcnt lgkmcnt(15)
    ds_read_b64_tr_b16 a[32:33], v6 offset:16896
    v_mfma_f32_16x16x32_bf16 v[228:231], a[48:51], a[124:127], v[228:231]
    ds_read_b64_tr_b16 a[34:35], v6 offset:25088
    v_and_b32 v12, 7, v0
    v_mfma_f32_16x16x32_bf16 v[236:239], a[48:51], a[132:135], v[236:239]
    ds_read_b64_tr_b16 a[36:37], v6 offset:17920
    v_mfma_f32_16x16x32_bf16 v[244:247], a[52:55], a[124:127], v[244:247]
    ds_read_b64_tr_b16 a[38:39], v6 offset:26112
    v_xor_b32 v11, v11, v12
    v_mfma_f32_16x16x32_bf16 v[252:255], a[52:55], a[132:135], v[252:255]
    s_waitcnt vmcnt(27) lgkmcnt(15)
    ds_read_b64_tr_b16 a[40:41], v7 offset:16896
    v_mfma_f32_16x16x32_bf16 v[36:39], a[0:3], a[140:143], v[36:39]
    buffer_load_dwordx4 a[244:247], v1, s[8:11], s31 offen offset:1024 sc1
    ds_read_b64_tr_b16 a[42:43], v7 offset:25088
    v_mfma_f32_16x16x32_bf16 v[44:47], a[0:3], a[148:151], v[44:47]
    ds_read_b64_tr_b16 a[44:45], v7 offset:17920
    v_lshlrev_b32 v10, 11, v10
    v_mfma_f32_16x16x32_bf16 v[52:55], a[4:7], a[140:143], v[52:55]
    ds_read_b64_tr_b16 a[46:47], v7 offset:26112
    v_mfma_f32_16x16x32_bf16 v[60:63], a[4:7], a[148:151], v[60:63]
    s_waitcnt lgkmcnt(15)
    ds_read_b64_tr_b16 a[48:49], v6 offset:17152
    v_lshl_add_u32 v10, v11, 4, v10
    v_mfma_f32_16x16x32_bf16 v[68:71], a[8:11], a[140:143], v[68:71]
    ds_read_b64_tr_b16 a[50:51], v6 offset:25344
    v_mfma_f32_16x16x32_bf16 v[76:79], a[8:11], a[148:151], v[76:79]
    s_mul_i32 s62, s60, 112
    ds_read_b64_tr_b16 a[52:53], v6 offset:18176
    v_mfma_f32_16x16x32_bf16 v[84:87], a[12:15], a[140:143], v[84:87]
    buffer_load_dwordx4 a[248:251], v1, s[8:11], s31 offen offset:2048 sc1
    ds_read_b64_tr_b16 a[54:55], v6 offset:26368
    v_mfma_f32_16x16x32_bf16 v[92:95], a[12:15], a[148:151], v[92:95]
    s_waitcnt lgkmcnt(15)
    s_add_u32 s62, s62, s28
    s_lshl_b32 s62, s62, 14
    ds_read_b64_tr_b16 a[0:1], v6 offset:32768
    v_mfma_f32_16x16x32_bf16 v[100:103], a[16:19], a[140:143], v[100:103]
    s_lshl_b32 s59, s24, 8
    ds_read_b64_tr_b16 a[2:3], v6 offset:40960
    v_mfma_f32_16x16x32_bf16 v[108:111], a[16:19], a[148:151], v[108:111]
    s_add_u32 s62, s62, s59
    ds_read_b64_tr_b16 a[4:5], v6 offset:33792
    v_mfma_f32_16x16x32_bf16 v[116:119], a[20:23], a[140:143], v[116:119]
    s_buffer_load_dwordx2 s[100:101], s[12:15], s89 offset:1212
    ds_read_b64_tr_b16 a[6:7], v6 offset:41984
    v_add_u32 v10, s62, v10
    v_mfma_f32_16x16x32_bf16 v[124:127], a[20:23], a[148:151], v[124:127]
    s_waitcnt lgkmcnt(15)
    ds_read_b64_tr_b16 a[8:9], v7 offset:32768
    v_mfma_f32_16x16x32_bf16 v[132:135], a[24:27], a[140:143], v[132:135]
    buffer_load_dwordx4 a[252:255], v1, s[8:11], s31 offen offset:3072 sc1
    s_add_u32 s31, s31, 4096
    v_mfma_f32_16x16x32_bf16 v[140:143], a[24:27], a[148:151], v[140:143]
    s_mul_i32 s62, s25, 917504
    s_xor_b32 s59, s62, 917504
    ds_read_b64_tr_b16 a[10:11], v7 offset:40960
    v_mfma_f32_16x16x32_bf16 v[148:151], a[28:31], a[140:143], v[148:151]
    ds_read_b64_tr_b16 a[12:13], v7 offset:33792
    ds_read_b64_tr_b16 a[14:15], v7 offset:41984
    v_mfma_f32_16x16x32_bf16 v[156:159], a[28:31], a[148:151], v[156:159]
    s_waitcnt lgkmcnt(15)
    ds_read_b64_tr_b16 a[16:17], v6 offset:33024
    v_add_u32 v11, s59, v10
    v_mfma_f32_16x16x32_bf16 v[164:167], a[32:35], a[140:143], v[164:167]
    ds_read_b64_tr_b16 a[18:19], v6 offset:41216
    v_add_u32 v10, s62, v10
    v_mfma_f32_16x16x32_bf16 v[172:175], a[32:35], a[148:151], v[172:175]
    buffer_load_dwordx4 a[56:59], v1, s[8:11], s31 offen offset:0 sc1
    ds_read_b64_tr_b16 a[20:21], v6 offset:34048
    v_mfma_f32_16x16x32_bf16 v[180:183], a[36:39], a[140:143], v[180:183]
    ds_read_b64_tr_b16 a[22:23], v6 offset:42240
    v_mfma_f32_16x16x32_bf16 v[188:191], a[36:39], a[148:151], v[188:191]
    s_waitcnt lgkmcnt(15)
    ds_read_b64_tr_b16 a[24:25], v7 offset:33024
    v_lshlrev_b32 v12, 7, v12
    v_mfma_f32_16x16x32_bf16 v[196:199], a[40:43], a[140:143], v[196:199]
    ds_read_b64_tr_b16 a[26:27], v7 offset:41216
    v_mfma_f32_16x16x32_bf16 v[204:207], a[40:43], a[148:151], v[204:207]
    ds_read_b64_tr_b16 a[28:29], v7 offset:34048
    v_min_u32 v14, 17, v0
    v_mfma_f32_16x16x32_bf16 v[212:215], a[44:47], a[140:143], v[212:215]
    ds_read_b64_tr_b16 a[30:31], v7 offset:42240
    v_mfma_f32_16x16x32_bf16 v[220:223], a[44:47], a[148:151], v[220:223]
    s_waitcnt lgkmcnt(15)
    ds_read_b64_tr_b16 a[32:33], v6 offset:33280
    v_lshlrev_b32 v14, 7, v14
    v_mfma_f32_16x16x32_bf16 v[228:231], a[48:51], a[140:143], v[228:231]
    buffer_load_dwordx4 a[60:63], v1, s[8:11], s31 offen offset:1024 sc1
    ds_read_b64_tr_b16 a[34:35], v6 offset:41472
    v_mfma_f32_16x16x32_bf16 v[236:239], a[48:51], a[148:151], v[236:239]
    s_lshl_b32 s63, s2, 2
    ds_read_b64_tr_b16 a[36:37], v6 offset:34304
    v_mfma_f32_16x16x32_bf16 v[244:247], a[52:55], a[140:143], v[244:247]
    s_add_u32 s63, s63, s28
    ds_read_b64_tr_b16 a[38:39], v6 offset:42496
    v_mfma_f32_16x16x32_bf16 v[252:255], a[52:55], a[148:151], v[252:255]
    s_waitcnt vmcnt(30) lgkmcnt(15)
    s_mul_i32 s63, s63, 7168
    s_buffer_load_dwordx2 s[100:101], s[16:19], s89 offset:2236
    ds_read_b64_tr_b16 a[40:41], v7 offset:33280
    v_mfma_f32_16x16x32_bf16 v[36:39], a[0:3], a[156:159], v[36:39]
    s_add_u32 s64, s61, 14680064
    ds_read_b64_tr_b16 a[42:43], v7 offset:41472
    v_mfma_f32_16x16x32_bf16 v[44:47], a[0:3], a[164:167], v[44:47]
    buffer_load_dwordx4 a[64:67], v1, s[8:11], s31 offen offset:2048 sc1
    ds_read_b64_tr_b16 a[44:45], v7 offset:34304
    v_mfma_f32_16x16x32_bf16 v[52:55], a[4:7], a[156:159], v[52:55]
    ds_read_b64_tr_b16 a[46:47], v7 offset:42496
    v_and_b32 v15, 31, v0
    v_mfma_f32_16x16x32_bf16 v[60:63], a[4:7], a[164:167], v[60:63]
    s_waitcnt lgkmcnt(15)
    ds_read_b64_tr_b16 a[48:49], v6 offset:33536
    v_lshlrev_b32 v15, 2, v15
    v_mfma_f32_16x16x32_bf16 v[68:71], a[8:11], a[156:159], v[68:71]
    ds_read_b64_tr_b16 a[50:51], v6 offset:41728
    v_mfma_f32_16x16x32_bf16 v[76:79], a[8:11], a[164:167], v[76:79]
    ds_read_b64_tr_b16 a[52:53], v6 offset:34560
    v_mfma_f32_16x16x32_bf16 v[84:87], a[12:15], a[156:159], v[84:87]
    ds_read_b64_tr_b16 a[54:55], v6 offset:42752
    v_mfma_f32_16x16x32_bf16 v[92:95], a[12:15], a[164:167], v[92:95]
    s_waitcnt lgkmcnt(15)
    ds_read_b64_tr_b16 a[0:1], v6 offset:49152
    v_mfma_f32_16x16x32_bf16 v[100:103], a[16:19], a[156:159], v[100:103]
    buffer_load_dwordx4 a[68:71], v1, s[8:11], s31 offen offset:3072 sc1
    s_add_u32 s31, s31, 4096
    v_mfma_f32_16x16x32_bf16 v[108:111], a[16:19], a[164:167], v[108:111]
    ds_read_b64_tr_b16 a[2:3], v6 offset:57344
    ds_read_b64_tr_b16 a[4:5], v6 offset:50176
    v_mfma_f32_16x16x32_bf16 v[116:119], a[20:23], a[156:159], v[116:119]
    ds_read_b64_tr_b16 a[6:7], v6 offset:58368
    v_mfma_f32_16x16x32_bf16 v[124:127], a[20:23], a[164:167], v[124:127]
    s_waitcnt lgkmcnt(15)
    ds_read_b64_tr_b16 a[8:9], v7 offset:49152
    v_mfma_f32_16x16x32_bf16 v[132:135], a[24:27], a[156:159], v[132:135]
    ds_read_b64_tr_b16 a[10:11], v7 offset:57344
    v_mfma_f32_16x16x32_bf16 v[140:143], a[24:27], a[164:167], v[140:143]
    buffer_load_dwordx4 a[72:75], v1, s[8:11], s31 offen offset:0 sc1
    ds_read_b64_tr_b16 a[12:13], v7 offset:50176
    v_mfma_f32_16x16x32_bf16 v[148:151], a[28:31], a[156:159], v[148:151]
    ds_read_b64_tr_b16 a[14:15], v7 offset:58368
    v_mfma_f32_16x16x32_bf16 v[156:159], a[28:31], a[164:167], v[156:159]
    s_waitcnt lgkmcnt(15)
    ds_read_b64_tr_b16 a[16:17], v6 offset:49408
    v_mfma_f32_16x16x32_bf16 v[164:167], a[32:35], a[156:159], v[164:167]
    s_waitcnt vmcnt(24)
    v_add_f32 v16, v16, v18
    s_buffer_load_dwordx2 s[100:101], s[12:15], s89 offset:1340
    v_mfma_f32_16x16x32_bf16 v[172:175], a[32:35], a[164:167], v[172:175]
    ds_read_b64_tr_b16 a[18:19], v6 offset:57600
    ds_read_b64_tr_b16 a[20:21], v6 offset:50432
    v_mfma_f32_16x16x32_bf16 v[180:183], a[36:39], a[156:159], v[180:183]
    buffer_load_dwordx4 a[76:79], v1, s[8:11], s31 offen offset:1024 sc1
    ds_read_b64_tr_b16 a[22:23], v6 offset:58624
    v_mfma_f32_16x16x32_bf16 v[188:191], a[36:39], a[164:167], v[188:191]
    s_waitcnt lgkmcnt(15)
    ds_read_b64_tr_b16 a[24:25], v7 offset:49408
    v_add_f32 v17, v17, v19
    v_mfma_f32_16x16x32_bf16 v[196:199], a[40:43], a[156:159], v[196:199]
    ds_read_b64_tr_b16 a[26:27], v7 offset:57600
    v_add_f32 v24, v24, v26
    v_mfma_f32_16x16x32_bf16 v[204:207], a[40:43], a[164:167], v[204:207]
    ds_read_b64_tr_b16 a[28:29], v7 offset:50432
    v_add_f32 v25, v25, v27
    v_mfma_f32_16x16x32_bf16 v[212:215], a[44:47], a[156:159], v[212:215]
    ds_read_b64_tr_b16 a[30:31], v7 offset:58624
    v_add_f32 v20, v20, v22
    v_mfma_f32_16x16x32_bf16 v[220:223], a[44:47], a[164:167], v[220:223]
    s_waitcnt lgkmcnt(15)
    ds_read_b64_tr_b16 a[32:33], v6 offset:49664
    v_add_f32 v21, v21, v23
    v_mfma_f32_16x16x32_bf16 v[228:231], a[48:51], a[156:159], v[228:231]
    buffer_load_dwordx4 a[80:83], v1, s[8:11], s31 offen offset:2048 sc1
    ds_read_b64_tr_b16 a[34:35], v6 offset:57856
    v_mfma_f32_16x16x32_bf16 v[236:239], a[48:51], a[164:167], v[236:239]
    ds_read_b64_tr_b16 a[36:37], v6 offset:50688
    v_add_f32 v28, v28, v30
    v_mfma_f32_16x16x32_bf16 v[244:247], a[52:55], a[156:159], v[244:247]
    ds_read_b64_tr_b16 a[38:39], v6 offset:58880
    v_add_f32 v29, v29, v31
    v_mfma_f32_16x16x32_bf16 v[252:255], a[52:55], a[164:167], v[252:255]
    s_waitcnt vmcnt(23) lgkmcnt(15)
    ds_read_b64_tr_b16 a[40:41], v7 offset:49664
    v_add_f32 v16, v16, v20
    v_mfma_f32_16x16x32_bf16 v[32:35], a[0:3], a[168:171], v[32:35]
    ds_read_b64_tr_b16 a[42:43], v7 offset:57856
    v_add_f32 v17, v17, v21
    v_mfma_f32_16x16x32_bf16 v[36:39], a[0:3], a[172:175], v[36:39]
    ds_read_b64_tr_b16 a[44:45], v7 offset:50688
    v_add_f32 v24, v24, v28
    v_mfma_f32_16x16x32_bf16 v[40:43], a[0:3], a[176:179], v[40:43]
    buffer_load_dwordx4 a[84:87], v1, s[8:11], s31 offen offset:3072 sc1
    s_add_u32 s31, s31, 4096
    v_add_f32 v25, v25, v29
    v_mfma_f32_16x16x32_bf16 v[44:47], a[0:3], a[180:183], v[44:47]
    ds_read_b64_tr_b16 a[46:47], v7 offset:58880
    ds_read_b64_tr_b16 a[48:49], v6 offset:49920
    v_mfma_f32_16x16x32_bf16 v[48:51], a[4:7], a[168:171], v[48:51]
    ds_read_b64_tr_b16 a[50:51], v6 offset:58112
    v_mov_b32 v18, v16
    v_mfma_f32_16x16x32_bf16 v[52:55], a[4:7], a[172:175], v[52:55]
    s_buffer_load_dwordx2 s[100:101], s[16:19], s89 offset:2364
    ds_read_b64_tr_b16 a[52:53], v6 offset:50944
    v_mov_b32 v19, v17
    v_mfma_f32_16x16x32_bf16 v[56:59], a[4:7], a[176:179], v[56:59]
    ds_read_b64_tr_b16 a[54:55], v6 offset:59136
    v_mov_b32 v26, v24
    v_mfma_f32_16x16x32_bf16 v[60:63], a[4:7], a[180:183], v[60:63]
    s_waitcnt lgkmcnt(15)
    ds_read_b64_tr_b16 a[0:1], v8 offset:0
    v_mov_b32 v27, v25
    v_mfma_f32_16x16x32_bf16 v[64:67], a[8:11], a[168:171], v[64:67]
    buffer_load_dwordx4 a[88:91], v1, s[8:11], s31 offen offset:0 sc1
    v_permlane32_swap_b32 v16, v18
    v_mfma_f32_16x16x32_bf16 v[68:71], a[8:11], a[172:175], v[68:71]
    ds_read_b64_tr_b16 a[2:3], v8 offset:8192
    v_mfma_f32_16x16x32_bf16 v[72:75], a[8:11], a[176:179], v[72:75]
    ds_read_b64_tr_b16 a[4:5], v8 offset:1024
    v_permlane32_swap_b32 v17, v19
    v_mfma_f32_16x16x32_bf16 v[76:79], a[8:11], a[180:183], v[76:79]
    ds_read_b64_tr_b16 a[6:7], v8 offset:9216
    v_mfma_f32_16x16x32_bf16 v[80:83], a[12:15], a[168:171], v[80:83]
    ds_read_b64_tr_b16 a[8:9], v9 offset:0
    v_mfma_f32_16x16x32_bf16 v[84:87], a[12:15], a[172:175], v[84:87]
    buffer_load_dwordx4 a[92:95], v1, s[8:11], s31 offen offset:1024 sc1
    v_permlane32_swap_b32 v24, v26
    v_mfma_f32_16x16x32_bf16 v[88:91], a[12:15], a[176:179], v[88:91]
    ds_read_b64_tr_b16 a[10:11], v9 offset:8192
    v_mfma_f32_16x16x32_bf16 v[92:95], a[12:15], a[180:183], v[92:95]
    ds_read_b64_tr_b16 a[12:13], v9 offset:1024
    v_permlane32_swap_b32 v25, v27
    v_mfma_f32_16x16x32_bf16 v[96:99], a[16:19], a[168:171], v[96:99]
    ds_read_b64_tr_b16 a[14:15], v9 offset:9216
    v_add_f32 v16, v16, v18
    v_mfma_f32_16x16x32_bf16 v[100:103], a[16:19], a[172:175], v[100:103]
    v_add_f32 v17, v17, v19
    v_add_f32 v24, v24, v26
    v_mfma_f32_16x16x32_bf16 v[104:107], a[16:19], a[176:179], v[104:107]
    buffer_load_dwordx4 a[96:99], v1, s[8:11], s31 offen offset:2048 sc1
    v_mfma_f32_16x16x32_bf16 v[108:111], a[16:19], a[180:183], v[108:111]
    ds_read_b64_tr_b16 a[16:17], v8 offset:256
    v_add_f32 v25, v25, v27
    v_mfma_f32_16x16x32_bf16 v[112:115], a[20:23], a[168:171], v[112:115]
    ds_read_b64_tr_b16 a[18:19], v8 offset:8448
    v_mov_b32 v18, v16
    v_mfma_f32_16x16x32_bf16 v[116:119], a[20:23], a[172:175], v[116:119]
    v_mov_b32 v19, v17
    v_mfma_f32_16x16x32_bf16 v[120:123], a[20:23], a[176:179], v[120:123]
    s_buffer_load_dwordx2 s[100:101], s[12:15], s89 offset:1468
    v_mov_b32 v26, v24
    v_mfma_f32_16x16x32_bf16 v[124:127], a[20:23], a[180:183], v[124:127]
    s_waitcnt lgkmcnt(15)
    ds_read_b64_tr_b16 a[20:21], v8 offset:1280
    v_mov_b32 v27, v25
    v_mfma_f32_16x16x32_bf16 v[128:131], a[24:27], a[168:171], v[128:131]
    buffer_load_dwordx4 a[100:103], v1, s[8:11], s31 offen offset:3072 sc1
    s_add_u32 s31, s31, 4096
    v_mfma_f32_16x16x32_bf16 v[132:135], a[24:27], a[172:175], v[132:135]
    ds_read_b64_tr_b16 a[22:23], v8 offset:9472
    v_mfma_f32_16x16x32_bf16 v[136:139], a[24:27], a[176:179], v[136:139]
    v_permlane16_swap_b32 v16, v18
    v_mfma_f32_16x16x32_bf16 v[140:143], a[24:27], a[180:183], v[140:143]
    ds_read_b64_tr_b16 a[24:25], v9 offset:256
    v_mfma_f32_16x16x32_bf16 v[144:147], a[28:31], a[168:171], v[144:147]
    ds_read_b64_tr_b16 a[26:27], v9 offset:8448
    v_permlane16_swap_b32 v17, v19
    v_mfma_f32_16x16x32_bf16 v[148:151], a[28:31], a[172:175], v[148:151]
    buffer_load_dwordx4 a[104:107], v1, s[8:11], s31 offen offset:0 sc1
    v_mfma_f32_16x16x32_bf16 v[152:155], a[28:31], a[176:179], v[152:155]
    v_permlane16_swap_b32 v24, v26
    v_mfma_f32_16x16x32_bf16 v[156:159], a[28:31], a[180:183], v[156:159]
    s_barrier
    ds_read_b64_tr_b16 a[28:29], v9 offset:1280
    v_mfma_f32_16x16x32_bf16 v[160:163], a[32:35], a[168:171], v[160:163]
    ds_read_b64_tr_b16 a[30:31], v9 offset:9472
    v_mfma_f32_16x16x32_bf16 v[164:167], a[32:35], a[172:175], v[164:167]
    v_permlane16_swap_b32 v25, v27
    v_mfma_f32_16x16x32_bf16 v[168:171], a[32:35], a[176:179], v[168:171]
    v_add_f32 v16, v16, v18
    v_add_f32 v17, v17, v19
    v_mfma_f32_16x16x32_bf16 v[172:175], a[32:35], a[180:183], v[172:175]
    buffer_load_dwordx4 v2, s[12:15], s30 offen offset:0 lds
    v_mfma_f32_16x16x32_bf16 v[176:179], a[36:39], a[168:171], v[176:179]
    ds_read_b64_tr_b16 a[32:33], v8 offset:512
    v_add_f32 v24, v24, v26
    v_mfma_f32_16x16x32_bf16 v[180:183], a[36:39], a[172:175], v[180:183]
    ds_read_b64_tr_b16 a[34:35], v8 offset:8704
    v_add_f32 v25, v25, v27
    v_mfma_f32_16x16x32_bf16 v[184:187], a[36:39], a[176:179], v[184:187]
    s_mov_b32 s62, 0x3a800000
    v_mov_b32 v29, 0x3727c5ac
    v_mfma_f32_16x16x32_bf16 v[188:191], a[36:39], a[180:183], v[188:191]
    s_buffer_load_dwordx2 s[100:101], s[16:19], s89 offset:2492
    ds_read_b64_tr_b16 a[36:37], v8 offset:1536
    v_fma_f32 v16, v16, s62, v29
    v_mfma_f32_16x16x32_bf16 v[192:195], a[40:43], a[168:171], v[192:195]
    ds_read_b64_tr_b16 a[38:39], v8 offset:9728
    v_mfma_f32_16x16x32_bf16 v[196:199], a[40:43], a[172:175], v[196:199]
    buffer_load_dwordx4 v2, s[16:19], s30 offen offset:1024 lds
    v_mfma_f32_16x16x32_bf16 v[200:203], a[40:43], a[176:179], v[200:203]
    v_fma_f32 v18, v17, s62, v29
    v_fma_f32 v19, v24, s62, v29
    v_mfma_f32_16x16x32_bf16 v[204:207], a[40:43], a[180:183], v[204:207]
    s_waitcnt lgkmcnt(15)
    ds_read_b64_tr_b16 a[40:41], v9 offset:512
    v_fma_f32 v20, v25, s62, v29
    v_mfma_f32_16x16x32_bf16 v[208:211], a[44:47], a[168:171], v[208:211]
    ds_read_b64_tr_b16 a[42:43], v9 offset:8704
    v_mfma_f32_16x16x32_bf16 v[212:215], a[44:47], a[172:175], v[212:215]
    v_rsq_f32 v17, v16
    v_mfma_f32_16x16x32_bf16 v[216:219], a[44:47], a[176:179], v[216:219]
    v_rsq_f32 v21, v18
    v_mfma_f32_16x16x32_bf16 v[220:223], a[44:47], a[180:183], v[220:223]
    buffer_load_dwordx4 v3, s[12:15], s30 offen offset:2048 lds
    v_mfma_f32_16x16x32_bf16 v[224:227], a[48:51], a[168:171], v[224:227]
    ds_read_b64_tr_b16 a[44:45], v9 offset:1536
    v_mfma_f32_16x16x32_bf16 v[228:231], a[48:51], a[172:175], v[228:231]
    ds_read_b64_tr_b16 a[46:47], v9 offset:9728
    v_mfma_f32_16x16x32_bf16 v[232:235], a[48:51], a[176:179], v[232:235]
    v_rsq_f32 v22, v19
    v_mfma_f32_16x16x32_bf16 v[236:239], a[48:51], a[180:183], v[236:239]
    ds_read_b64_tr_b16 a[48:49], v8 offset:768
    v_mfma_f32_16x16x32_bf16 v[240:243], a[52:55], a[168:171], v[240:243]
    ds_read_b64_tr_b16 a[50:51], v8 offset:8960
    v_mfma_f32_16x16x32_bf16 v[244:247], a[52:55], a[172:175], v[244:247]
    buffer_load_dwordx4 v3, s[16:19], s30 offen offset:3072 lds
    v_rsq_f32 v23, v20
    v_mfma_f32_16x16x32_bf16 v[248:251], a[52:55], a[176:179], v[248:251]
    s_add_u32 m0, s32, 16384
    s_mov_b32 s30, 2523136
    v_mul_f32 v17, 0xbfb8aa3b, v17
    v_mfma_f32_16x16x32_bf16 v[252:255], a[52:55], a[180:183], v[252:255]
    s_waitcnt vmcnt(29)
    ds_read_b64_tr_b16 a[52:53], v8 offset:1792
    v_mul_f32 v21, 0xbfb8aa3b, v21
    v_mfma_f32_16x16x32_bf16 v[32:35], a[0:3], a[192:195], v[32:35]
    s_buffer_load_dwordx2 s[100:101], s[12:15], s89 offset:1596
    ds_read_b64_tr_b16 a[54:55], v8 offset:9984
    v_mul_f32 v22, 0xbfb8aa3b, v22
    v_mfma_f32_16x16x32_bf16 v[36:39], a[0:3], a[196:199], v[36:39]
    v_mul_f32 v23, 0xbfb8aa3b, v23
    v_mfma_f32_16x16x32_bf16 v[40:43], a[0:3], a[200:203], v[40:43]
    buffer_load_dwordx4 v2, s[12:15], s30 offen offset:0 lds
    v_mfma_f32_16x16x32_bf16 v[44:47], a[0:3], a[204:207], v[44:47]
    ds_read_b64_tr_b16 a[0:1], v8 offset:16384
    v_mfma_f32_16x16x32_bf16 v[48:51], a[4:7], a[192:195], v[48:51]
    ds_read_b64_tr_b16 a[2:3], v8 offset:24576
    v_mfma_f32_16x16x32_bf16 v[52:55], a[4:7], a[196:199], v[52:55]
    v_mfma_f32_16x16x32_bf16 v[56:59], a[4:7], a[200:203], v[56:59]
    v_mfma_f32_16x16x32_bf16 v[60:63], a[4:7], a[204:207], v[60:63]
    s_waitcnt lgkmcnt(15)
    ds_read_b64_tr_b16 a[4:5], v8 offset:17408
    v_mfma_f32_16x16x32_bf16 v[64:67], a[8:11], a[192:195], v[64:67]
    buffer_load_dwordx4 v2, s[16:19], s30 offen offset:1024 lds
    v_mfma_f32_16x16x32_bf16 v[68:71], a[8:11], a[196:199], v[68:71]
    ds_read_b64_tr_b16 a[6:7], v8 offset:25600
    v_mfma_f32_16x16x32_bf16 v[72:75], a[8:11], a[200:203], v[72:75]
    v_mfma_f32_16x16x32_bf16 v[76:79], a[8:11], a[204:207], v[76:79]
    ds_read_b64_tr_b16 a[8:9], v9 offset:16384
    v_mfma_f32_16x16x32_bf16 v[80:83], a[12:15], a[192:195], v[80:83]
    ds_read_b64_tr_b16 a[10:11], v9 offset:24576
    v_mfma_f32_16x16x32_bf16 v[84:87], a[12:15], a[196:199], v[84:87]
    v_mfma_f32_16x16x32_bf16 v[88:91], a[12:15], a[200:203], v[88:91]
    buffer_load_dwordx4 v3, s[12:15], s30 offen offset:2048 lds
    v_mfma_f32_16x16x32_bf16 v[92:95], a[12:15], a[204:207], v[92:95]
    ds_read_b64_tr_b16 a[12:13], v9 offset:17408
    v_mfma_f32_16x16x32_bf16 v[96:99], a[16:19], a[192:195], v[96:99]
    ds_read_b64_tr_b16 a[14:15], v9 offset:25600
    v_mfma_f32_16x16x32_bf16 v[100:103], a[16:19], a[196:199], v[100:103]
    s_buffer_load_dwordx2 s[100:101], s[16:19], s89 offset:2620
    v_mfma_f32_16x16x32_bf16 v[104:107], a[16:19], a[200:203], v[104:107]
    buffer_load_dwordx4 v3, s[16:19], s30 offen offset:3072 lds
    v_mfma_f32_16x16x32_bf16 v[108:111], a[16:19], a[204:207], v[108:111]
    s_add_u32 m0, s32, 32768
    s_mov_b32 s30, 2752512
    ds_read_b64_tr_b16 a[16:17], v8 offset:16640
    v_mfma_f32_16x16x32_bf16 v[112:115], a[20:23], a[192:195], v[112:115]
    ds_read_b64_tr_b16 a[18:19], v8 offset:24832
    v_mfma_f32_16x16x32_bf16 v[116:119], a[20:23], a[196:199], v[116:119]
    v_mfma_f32_16x16x32_bf16 v[120:123], a[20:23], a[200:203], v[120:123]
    v_mfma_f32_16x16x32_bf16 v[124:127], a[20:23], a[204:207], v[124:127]
    ds_read_b64_tr_b16 a[20:21], v8 offset:17664
    v_mfma_f32_16x16x32_bf16 v[128:131], a[24:27], a[192:195], v[128:131]
    buffer_load_dwordx4 v2, s[12:15], s30 offen offset:0 lds
    v_mfma_f32_16x16x32_bf16 v[132:135], a[24:27], a[196:199], v[132:135]
    ds_read_b64_tr_b16 a[22:23], v8 offset:25856
    v_mfma_f32_16x16x32_bf16 v[136:139], a[24:27], a[200:203], v[136:139]
    v_mfma_f32_16x16x32_bf16 v[140:143], a[24:27], a[204:207], v[140:143]
    s_waitcnt lgkmcnt(15)
    ds_read_b64_tr_b16 a[24:25], v9 offset:16640
    v_mfma_f32_16x16x32_bf16 v[144:147], a[28:31], a[192:195], v[144:147]
    ds_read_b64_tr_b16 a[26:27], v9 offset:24832
    v_mfma_f32_16x16x32_bf16 v[148:151], a[28:31], a[196:199], v[148:151]
    v_mfma_f32_16x16x32_bf16 v[152:155], a[28:31], a[200:203], v[152:155]
    buffer_load_dwordx4 v2, s[16:19], s30 offen offset:1024 lds
    v_mfma_f32_16x16x32_bf16 v[156:159], a[28:31], a[204:207], v[156:159]
    ds_read_b64_tr_b16 a[28:29], v9 offset:17664
    v_mfma_f32_16x16x32_bf16 v[160:163], a[32:35], a[192:195], v[160:163]
    ds_read_b64_tr_b16 a[30:31], v9 offset:25856
    v_mfma_f32_16x16x32_bf16 v[164:167], a[32:35], a[196:199], v[164:167]
    v_mfma_f32_16x16x32_bf16 v[168:171], a[32:35], a[200:203], v[168:171]
    s_buffer_load_dwordx2 s[100:101], s[12:15], s89 offset:1724
    v_mfma_f32_16x16x32_bf16 v[172:175], a[32:35], a[204:207], v[172:175]
    ds_read_b64_tr_b16 a[32:33], v8 offset:16896
    v_mfma_f32_16x16x32_bf16 v[176:179], a[36:39], a[192:195], v[176:179]
    buffer_load_dwordx4 v3, s[12:15], s30 offen offset:2048 lds
    v_mfma_f32_16x16x32_bf16 v[180:183], a[36:39], a[196:199], v[180:183]
    ds_read_b64_tr_b16 a[34:35], v8 offset:25088
    v_mfma_f32_16x16x32_bf16 v[184:187], a[36:39], a[200:203], v[184:187]
    v_mfma_f32_16x16x32_bf16 v[188:191], a[36:39], a[204:207], v[188:191]
    ds_read_b64_tr_b16 a[36:37], v8 offset:17920
    v_mfma_f32_16x16x32_bf16 v[192:195], a[40:43], a[192:195], v[192:195]
    ds_read_b64_tr_b16 a[38:39], v8 offset:26112
    v_mfma_f32_16x16x32_bf16 v[196:199], a[40:43], a[196:199], v[196:199]
    v_mfma_f32_16x16x32_bf16 v[200:203], a[40:43], a[200:203], v[200:203]
    buffer_load_dwordx4 v3, s[16:19], s30 offen offset:3072 lds
    v_mfma_f32_16x16x32_bf16 v[204:207], a[40:43], a[204:207], v[204:207]
    s_add_u32 m0, s32, 49152
    s_mov_b32 s30, 2981888
    ds_read_b64_tr_b16 a[40:41], v9 offset:16896
    v_mfma_f32_16x16x32_bf16 v[208:211], a[44:47], a[192:195], v[208:211]
    ds_read_b64_tr_b16 a[42:43], v9 offset:25088
    v_mfma_f32_16x16x32_bf16 v[212:215], a[44:47], a[196:199], v[212:215]
    v_mfma_f32_16x16x32_bf16 v[216:219], a[44:47], a[200:203], v[216:219]
    v_mfma_f32_16x16x32_bf16 v[220:223], a[44:47], a[204:207], v[220:223]
    s_waitcnt lgkmcnt(15)
    ds_read_b64_tr_b16 a[44:45], v9 offset:17920
    v_mfma_f32_16x16x32_bf16 v[224:227], a[48:51], a[192:195], v[224:227]
    buffer_load_dwordx4 v2, s[12:15], s30 offen offset:0 lds
    v_mfma_f32_16x16x32_bf16 v[228:231], a[48:51], a[196:199], v[228:231]
    ds_read_b64_tr_b16 a[46:47], v9 offset:26112
    v_mfma_f32_16x16x32_bf16 v[232:235], a[48:51], a[200:203], v[232:235]
    v_mfma_f32_16x16x32_bf16 v[236:239], a[48:51], a[204:207], v[236:239]
    s_buffer_load_dwordx2 s[100:101], s[16:19], s89 offset:2748
    ds_read_b64_tr_b16 a[48:49], v8 offset:17152
    v_mfma_f32_16x16x32_bf16 v[240:243], a[52:55], a[192:195], v[240:243]
    ds_read_b64_tr_b16 a[50:51], v8 offset:25344
    v_mfma_f32_16x16x32_bf16 v[244:247], a[52:55], a[196:199], v[244:247]
    v_mfma_f32_16x16x32_bf16 v[248:251], a[52:55], a[200:203], v[248:251]
    buffer_load_dwordx4 v2, s[16:19], s30 offen offset:1024 lds
    v_mfma_f32_16x16x32_bf16 v[252:255], a[52:55], a[204:207], v[252:255]
    s_waitcnt vmcnt(35)
    ds_read_b64_tr_b16 a[52:53], v8 offset:18176
    v_mfma_f32_16x16x32_bf16 v[32:35], a[0:3], a[208:211], v[32:35]
    ds_read_b64_tr_b16 a[54:55], v8 offset:26368
    v_mfma_f32_16x16x32_bf16 v[36:39], a[0:3], a[212:215], v[36:39]
    v_mfma_f32_16x16x32_bf16 v[40:43], a[0:3], a[216:219], v[40:43]
    v_mfma_f32_16x16x32_bf16 v[44:47], a[0:3], a[220:223], v[44:47]
    v_mfma_f32_16x16x32_bf16 v[48:51], a[4:7], a[208:211], v[48:51]
    buffer_load_dwordx4 v3, s[12:15], s30 offen offset:2048 lds
    v_mfma_f32_16x16x32_bf16 v[52:55], a[4:7], a[212:215], v[52:55]
    v_mfma_f32_16x16x32_bf16 v[56:59], a[4:7], a[216:219], v[56:59]
    v_mfma_f32_16x16x32_bf16 v[60:63], a[4:7], a[220:223], v[60:63]
    v_mfma_f32_16x16x32_bf16 v[64:67], a[8:11], a[208:211], v[64:67]
    v_mfma_f32_16x16x32_bf16 v[68:71], a[8:11], a[212:215], v[68:71]
    v_mfma_f32_16x16x32_bf16 v[72:75], a[8:11], a[216:219], v[72:75]
    buffer_load_dwordx4 v3, s[16:19], s30 offen offset:3072 lds
    v_mfma_f32_16x16x32_bf16 v[76:79], a[8:11], a[220:223], v[76:79]
    s_waitcnt lgkmcnt(15)
    s_add_u32 m0, s32, 65536
    s_mov_b32 s30, 3211264
    v_mfma_f32_16x16x32_bf16 v[80:83], a[12:15], a[208:211], v[80:83]
    s_buffer_load_dwordx2 s[100:101], s[12:15], s89 offset:1852
    v_mfma_f32_16x16x32_bf16 v[84:87], a[12:15], a[212:215], v[84:87]
    v_mfma_f32_16x16x32_bf16 v[88:91], a[12:15], a[216:219], v[88:91]
    v_mfma_f32_16x16x32_bf16 v[92:95], a[12:15], a[220:223], v[92:95]
    v_mfma_f32_16x16x32_bf16 v[96:99], a[16:19], a[208:211], v[96:99]
    buffer_load_dwordx4 v2, s[12:15], s30 offen offset:0 lds
    v_mfma_f32_16x16x32_bf16 v[100:103], a[16:19], a[212:215], v[100:103]
    v_mfma_f32_16x16x32_bf16 v[104:107], a[16:19], a[216:219], v[104:107]
    v_mfma_f32_16x16x32_bf16 v[108:111], a[16:19], a[220:223], v[108:111]
    v_mfma_f32_16x16x32_bf16 v[112:115], a[20:23], a[208:211], v[112:115]
    v_mfma_f32_16x16x32_bf16 v[116:119], a[20:23], a[212:215], v[116:119]
    v_mfma_f32_16x16x32_bf16 v[120:123], a[20:23], a[216:219], v[120:123]
    buffer_load_dwordx4 v2, s[16:19], s30 offen offset:1024 lds
    v_mfma_f32_16x16x32_bf16 v[124:127], a[20:23], a[220:223], v[124:127]
    s_waitcnt lgkmcnt(14)
    v_mfma_f32_16x16x32_bf16 v[128:131], a[24:27], a[208:211], v[128:131]
    v_mfma_f32_16x16x32_bf16 v[132:135], a[24:27], a[212:215], v[132:135]
    v_mfma_f32_16x16x32_bf16 v[136:139], a[24:27], a[216:219], v[136:139]
    v_mfma_f32_16x16x32_bf16 v[140:143], a[24:27], a[220:223], v[140:143]
    s_waitcnt lgkmcnt(12)
    v_mfma_f32_16x16x32_bf16 v[144:147], a[28:31], a[208:211], v[144:147]
    buffer_load_dwordx4 v3, s[12:15], s30 offen offset:2048 lds
    v_mfma_f32_16x16x32_bf16 v[148:151], a[28:31], a[212:215], v[148:151]
    s_buffer_load_dwordx2 s[100:101], s[16:19], s89 offset:2876
    v_mfma_f32_16x16x32_bf16 v[152:155], a[28:31], a[216:219], v[152:155]
    v_mfma_f32_16x16x32_bf16 v[156:159], a[28:31], a[220:223], v[156:159]
    s_waitcnt vmcnt(11) lgkmcnt(10)
    s_barrier
    ds_read_b64_tr_b16 a[0:1], v4 offset:0
    v_mfma_f32_16x16x32_bf16 v[160:163], a[32:35], a[208:211], v[160:163]
    ds_read_b64_tr_b16 a[2:3], v4 offset:8192
    ds_read_b64_tr_b16 a[4:5], v4 offset:1024
    v_mfma_f32_16x16x32_bf16 v[164:167], a[32:35], a[212:215], v[164:167]
    ds_read_b64_tr_b16 a[6:7], v4 offset:9216
    ds_read_b64_tr_b16 a[8:9], v5 offset:0
    v_mfma_f32_16x16x32_bf16 v[168:171], a[32:35], a[216:219], v[168:171]
    buffer_load_dwordx4 v3, s[16:19], s30 offen offset:3072 lds
    ds_read_b64_tr_b16 a[10:11], v5 offset:8192
    v_mfma_f32_16x16x32_bf16 v[172:175], a[32:35], a[220:223], v[172:175]
    s_waitcnt lgkmcnt(14)
    s_add_u32 m0, s32, 81920
    s_mov_b32 s30, 3440640
    ds_read_b64_tr_b16 a[12:13], v5 offset:1024
    v_mfma_f32_16x16x32_bf16 v[176:179], a[36:39], a[208:211], v[176:179]
    ds_read_b64_tr_b16 a[14:15], v5 offset:9216
    ds_read_b64_tr_b16 a[16:17], v4 offset:256
    v_mfma_f32_16x16x32_bf16 v[180:183], a[36:39], a[212:215], v[180:183]
    ds_read_b64_tr_b16 a[18:19], v4 offset:8448
    ds_read_b64_tr_b16 a[20:21], v4 offset:1280
    v_mfma_f32_16x16x32_bf16 v[184:187], a[36:39], a[216:219], v[184:187]
    ds_read_b64_tr_b16 a[22:23], v4 offset:9472
    ds_read_b64_tr_b16 a[24:25], v5 offset:256
    v_mfma_f32_16x16x32_bf16 v[188:191], a[36:39], a[220:223], v[188:191]
    s_waitcnt lgkmcnt(15)
    ds_read_b64_tr_b16 a[26:27], v5 offset:8448
    ds_read_b64_tr_b16 a[28:29], v5 offset:1280
    v_mfma_f32_16x16x32_bf16 v[192:195], a[40:43], a[208:211], v[192:195]
    buffer_load_dwordx4 v2, s[12:15], s30 offen offset:0 lds
    ds_read_b64_tr_b16 a[30:31], v5 offset:9472
    v_mfma_f32_16x16x32_bf16 v[196:199], a[40:43], a[212:215], v[196:199]
    ds_read_b64_tr_b16 a[32:33], v4 offset:512
    v_mfma_f32_16x16x32_bf16 v[200:203], a[40:43], a[216:219], v[200:203]
    ds_read_b64_tr_b16 a[34:35], v4 offset:8704
    v_mfma_f32_16x16x32_bf16 v[204:207], a[40:43], a[220:223], v[204:207]
    ds_read_b64_tr_b16 a[36:37], v4 offset:1536
    v_mfma_f32_16x16x32_bf16 v[208:211], a[44:47], a[208:211], v[208:211]
    ds_read_b64_tr_b16 a[38:39], v4 offset:9728
    v_mfma_f32_16x16x32_bf16 v[212:215], a[44:47], a[212:215], v[212:215]
    ds_read_b64_tr_b16 a[40:41], v5 offset:512
    v_mfma_f32_16x16x32_bf16 v[216:219], a[44:47], a[216:219], v[216:219]
    buffer_load_dwordx4 v2, s[16:19], s30 offen offset:1024 lds
    v_mfma_f32_16x16x32_bf16 v[220:223], a[44:47], a[220:223], v[220:223]
    s_buffer_load_dwordx2 s[100:101], s[12:15], s89 offset:1980
    ds_read_b64_tr_b16 a[42:43], v5 offset:8704
    v_mfma_f32_16x16x32_bf16 v[224:227], a[48:51], a[208:211], v[224:227]
    ds_read_b64_tr_b16 a[44:45], v5 offset:1536
    v_mfma_f32_16x16x32_bf16 v[228:231], a[48:51], a[212:215], v[228:231]
    ds_read_b64_tr_b16 a[46:47], v5 offset:9728
    v_mfma_f32_16x16x32_bf16 v[232:235], a[48:51], a[216:219], v[232:235]
    v_mfma_f32_16x16x32_bf16 v[236:239], a[48:51], a[220:223], v[236:239]
    s_waitcnt lgkmcnt(15)
    ds_read_b64_tr_b16 a[48:49], v4 offset:768
    v_mfma_f32_16x16x32_bf16 v[240:243], a[52:55], a[208:211], v[240:243]
    buffer_load_dwordx4 v3, s[12:15], s30 offen offset:2048 lds
    v_mfma_f32_16x16x32_bf16 v[244:247], a[52:55], a[212:215], v[244:247]
    ds_read_b64_tr_b16 a[50:51], v4 offset:8960
    v_mfma_f32_16x16x32_bf16 v[248:251], a[52:55], a[216:219], v[248:251]
    v_mfma_f32_16x16x32_bf16 v[252:255], a[52:55], a[220:223], v[252:255]
    ds_read_b64_tr_b16 a[52:53], v4 offset:1792
    v_mfma_f32_16x16x32_bf16 v[32:35], a[0:3], a[224:227], v[32:35]
    ds_read_b64_tr_b16 a[54:55], v4 offset:9984
    v_mfma_f32_16x16x32_bf16 v[36:39], a[0:3], a[228:231], v[36:39]
    v_mfma_f32_16x16x32_bf16 v[40:43], a[0:3], a[232:235], v[40:43]
    buffer_load_dwordx4 v3, s[16:19], s30 offen offset:3072 lds
    v_mfma_f32_16x16x32_bf16 v[44:47], a[0:3], a[236:239], v[44:47]
    s_add_u32 m0, s32, 98304
    s_mov_b32 s30, 3670016
    ds_read_b64_tr_b16 a[0:1], v4 offset:16384
    v_mfma_f32_16x16x32_bf16 v[48:51], a[4:7], a[224:227], v[48:51]
    ds_read_b64_tr_b16 a[2:3], v4 offset:24576
    v_mfma_f32_16x16x32_bf16 v[52:55], a[4:7], a[228:231], v[52:55]
    v_mfma_f32_16x16x32_bf16 v[56:59], a[4:7], a[232:235], v[56:59]
    v_mfma_f32_16x16x32_bf16 v[60:63], a[4:7], a[236:239], v[60:63]
    s_buffer_load_dwordx2 s[100:101], s[16:19], s89 offset:3004
    ds_read_b64_tr_b16 a[4:5], v4 offset:17408
    v_mfma_f32_16x16x32_bf16 v[64:67], a[8:11], a[224:227], v[64:67]
    buffer_load_dwordx4 a[108:111], v1, s[8:11], s31 offen offset:1024 sc1
    v_mfma_f32_16x16x32_bf16 v[68:71], a[8:11], a[228:231], v[68:71]
    ds_read_b64_tr_b16 a[6:7], v4 offset:25600
    v_mfma_f32_16x16x32_bf16 v[72:75], a[8:11], a[232:235], v[72:75]
    v_mfma_f32_16x16x32_bf16 v[76:79], a[8:11], a[236:239], v[76:79]
    ds_read_b64_tr_b16 a[8:9], v5 offset:16384
    v_mfma_f32_16x16x32_bf16 v[80:83], a[12:15], a[224:227], v[80:83]
    ds_read_b64_tr_b16 a[10:11], v5 offset:24576
    v_mfma_f32_16x16x32_bf16 v[84:87], a[12:15], a[228:231], v[84:87]
    v_mfma_f32_16x16x32_bf16 v[88:91], a[12:15], a[232:235], v[88:91]
    buffer_load_dwordx4 a[112:115], v1, s[8:11], s31 offen offset:2048 sc1
    v_mfma_f32_16x16x32_bf16 v[92:95], a[12:15], a[236:239], v[92:95]
    s_waitcnt lgkmcnt(15)
    ds_read_b64_tr_b16 a[12:13], v5 offset:17408
    v_mfma_f32_16x16x32_bf16 v[96:99], a[16:19], a[224:227], v[96:99]
    ds_read_b64_tr_b16 a[14:15], v5 offset:25600
    v_mfma_f32_16x16x32_bf16 v[100:103], a[16:19], a[228:231], v[100:103]
    v_mfma_f32_16x16x32_bf16 v[104:107], a[16:19], a[232:235], v[104:107]
    v_mfma_f32_16x16x32_bf16 v[108:111], a[16:19], a[236:239], v[108:111]
    ds_read_b64_tr_b16 a[16:17], v4 offset:16640
    v_mfma_f32_16x16x32_bf16 v[112:115], a[20:23], a[224:227], v[112:115]
    buffer_load_dwordx4 a[116:119], v1, s[8:11], s31 offen offset:3072 sc1
    s_add_u32 s31, s31, 4096
    v_mfma_f32_16x16x32_bf16 v[116:119], a[20:23], a[228:231], v[116:119]
    ds_read_b64_tr_b16 a[18:19], v4 offset:24832
    v_mfma_f32_16x16x32_bf16 v[120:123], a[20:23], a[232:235], v[120:123]
    v_mfma_f32_16x16x32_bf16 v[124:127], a[20:23], a[236:239], v[124:127]
    ds_read_b64_tr_b16 a[20:21], v4 offset:17664
    v_mfma_f32_16x16x32_bf16 v[128:131], a[24:27], a[224:227], v[128:131]
    s_buffer_load_dwordx2 s[100:101], s[12:15], s89 offset:2108
    ds_read_b64_tr_b16 a[22:23], v4 offset:25856
    v_mfma_f32_16x16x32_bf16 v[132:135], a[24:27], a[228:231], v[132:135]
    v_mfma_f32_16x16x32_bf16 v[136:139], a[24:27], a[232:235], v[136:139]
    buffer_load_dwordx4 v2, s[12:15], s30 offen offset:0 lds
    v_mfma_f32_16x16x32_bf16 v[140:143], a[24:27], a[236:239], v[140:143]
    ds_read_b64_tr_b16 a[24:25], v5 offset:16640
    v_mfma_f32_16x16x32_bf16 v[144:147], a[28:31], a[224:227], v[144:147]
    ds_read_b64_tr_b16 a[26:27], v5 offset:24832
    v_mfma_f32_16x16x32_bf16 v[148:151], a[28:31], a[228:231], v[148:151]
    v_mfma_f32_16x16x32_bf16 v[152:155], a[28:31], a[232:235], v[152:155]
    v_mfma_f32_16x16x32_bf16 v[156:159], a[28:31], a[236:239], v[156:159]
    ds_read_b64_tr_b16 a[28:29], v5 offset:17664
    v_mfma_f32_16x16x32_bf16 v[160:163], a[32:35], a[224:227], v[160:163]
    buffer_load_dwordx4 v2, s[16:19], s30 offen offset:1024 lds
    v_mfma_f32_16x16x32_bf16 v[164:167], a[32:35], a[228:231], v[164:167]
    ds_read_b64_tr_b16 a[30:31], v5 offset:25856
    v_mfma_f32_16x16x32_bf16 v[168:171], a[32:35], a[232:235], v[168:171]
    v_mfma_f32_16x16x32_bf16 v[172:175], a[32:35], a[236:239], v[172:175]
    s_waitcnt lgkmcnt(15)
    ds_read_b64_tr_b16 a[32:33], v4 offset:16896
    v_mfma_f32_16x16x32_bf16 v[176:179], a[36:39], a[224:227], v[176:179]
    ds_read_b64_tr_b16 a[34:35], v4 offset:25088
    v_mfma_f32_16x16x32_bf16 v[180:183], a[36:39], a[228:231], v[180:183]
    v_mfma_f32_16x16x32_bf16 v[184:187], a[36:39], a[232:235], v[184:187]
    buffer_load_dwordx4 v3, s[12:15], s30 offen offset:2048 lds
    v_mfma_f32_16x16x32_bf16 v[188:191], a[36:39], a[236:239], v[188:191]
    ds_read_b64_tr_b16 a[36:37], v4 offset:17920
    v_mfma_f32_16x16x32_bf16 v[192:195], a[40:43], a[224:227], v[192:195]
    ds_read_b64_tr_b16 a[38:39], v4 offset:26112
    v_mfma_f32_16x16x32_bf16 v[196:199], a[40:43], a[228:231], v[196:199]
    s_buffer_load_dwordx2 s[100:101], s[16:19], s89 offset:3132
    v_mfma_f32_16x16x32_bf16 v[200:203], a[40:43], a[232:235], v[200:203]
    v_mfma_f32_16x16x32_bf16 v[204:207], a[40:43], a[236:239], v[204:207]
    ds_read_b64_tr_b16 a[40:41], v5 offset:16896
    v_mfma_f32_16x16x32_bf16 v[208:211], a[44:47], a[224:227], v[208:211]
    buffer_load_dwordx4 v3, s[16:19], s30 offen offset:3072 lds
    v_mfma_f32_16x16x32_bf16 v[212:215], a[44:47], a[228:231], v[212:215]
    s_add_u32 m0, s32, 114688
    s_mov_b32 s30, 3899392
    ds_read_b64_tr_b16 a[42:43], v5 offset:25088
    v_mfma_f32_16x16x32_bf16 v[216:219], a[44:47], a[232:235], v[216:219]
    v_mfma_f32_16x16x32_bf16 v[220:223], a[44:47], a[236:239], v[220:223]
    ds_read_b64_tr_b16 a[44:45], v5 offset:17920
    v_mfma_f32_16x16x32_bf16 v[224:227], a[48:51], a[224:227], v[224:227]
    ds_read_b64_tr_b16 a[46:47], v5 offset:26112
    v_mfma_f32_16x16x32_bf16 v[228:231], a[48:51], a[228:231], v[228:231]
    v_mfma_f32_16x16x32_bf16 v[232:235], a[48:51], a[232:235], v[232:235]
    buffer_load_dwordx4 v2, s[12:15], s30 offen offset:0 lds
    v_mfma_f32_16x16x32_bf16 v[236:239], a[48:51], a[236:239], v[236:239]
    ds_read_b64_tr_b16 a[48:49], v4 offset:17152
    v_mfma_f32_16x16x32_bf16 v[240:243], a[52:55], a[224:227], v[240:243]
    ds_read_b64_tr_b16 a[50:51], v4 offset:25344
    v_mfma_f32_16x16x32_bf16 v[244:247], a[52:55], a[228:231], v[244:247]
    v_mfma_f32_16x16x32_bf16 v[248:251], a[52:55], a[232:235], v[248:251]
    v_mfma_f32_16x16x32_bf16 v[252:255], a[52:55], a[236:239], v[252:255]
    s_waitcnt lgkmcnt(15)
    ds_read_b64_tr_b16 a[52:53], v4 offset:18176
    v_mfma_f32_16x16x32_bf16 v[32:35], a[0:3], a[240:243], v[32:35]
    buffer_load_dwordx4 v2, s[16:19], s30 offen offset:1024 lds
    v_mfma_f32_16x16x32_bf16 v[36:39], a[0:3], a[244:247], v[36:39]
    ds_read_b64_tr_b16 a[54:55], v4 offset:26368
    v_mfma_f32_16x16x32_bf16 v[40:43], a[0:3], a[248:251], v[40:43]
    s_buffer_load_dwordx2 s[100:101], s[12:15], s89 offset:2236
    v_mfma_f32_16x16x32_bf16 v[44:47], a[0:3], a[252:255], v[44:47]
    v_mfma_f32_16x16x32_bf16 v[48:51], a[4:7], a[240:243], v[48:51]
    v_mfma_f32_16x16x32_bf16 v[52:55], a[4:7], a[244:247], v[52:55]
    v_mfma_f32_16x16x32_bf16 v[56:59], a[4:7], a[248:251], v[56:59]
    buffer_load_dwordx4 v3, s[12:15], s30 offen offset:2048 lds
    v_mfma_f32_16x16x32_bf16 v[60:63], a[4:7], a[252:255], v[60:63]
    v_mfma_f32_16x16x32_bf16 v[64:67], a[8:11], a[240:243], v[64:67]
    v_mfma_f32_16x16x32_bf16 v[68:71], a[8:11], a[244:247], v[68:71]
    v_mfma_f32_16x16x32_bf16 v[72:75], a[8:11], a[248:251], v[72:75]
    v_mfma_f32_16x16x32_bf16 v[76:79], a[8:11], a[252:255], v[76:79]
    v_mfma_f32_16x16x32_bf16 v[80:83], a[12:15], a[240:243], v[80:83]
    buffer_load_dwordx4 v3, s[16:19], s30 offen offset:3072 lds
    v_mfma_f32_16x16x32_bf16 v[84:87], a[12:15], a[244:247], v[84:87]
    s_add_u32 m0, s32, 131072
    s_mov_b32 s30, 4128768
    v_mfma_f32_16x16x32_bf16 v[88:91], a[12:15], a[248:251], v[88:91]
    v_mfma_f32_16x16x32_bf16 v[92:95], a[12:15], a[252:255], v[92:95]
    v_mfma_f32_16x16x32_bf16 v[96:99], a[16:19], a[240:243], v[96:99]
    v_mfma_f32_16x16x32_bf16 v[100:103], a[16:19], a[244:247], v[100:103]
    v_mfma_f32_16x16x32_bf16 v[104:107], a[16:19], a[248:251], v[104:107]
    buffer_load_dwordx4 a[120:123], v1, s[8:11], s31 offen offset:0 sc1
    v_mfma_f32_16x16x32_bf16 v[108:111], a[16:19], a[252:255], v[108:111]
    s_waitcnt lgkmcnt(15)
    s_buffer_load_dwordx2 s[100:101], s[16:19], s89 offset:3260
    v_mfma_f32_16x16x32_bf16 v[112:115], a[20:23], a[240:243], v[112:115]
    v_mfma_f32_16x16x32_bf16 v[116:119], a[20:23], a[244:247], v[116:119]
    v_mfma_f32_16x16x32_bf16 v[120:123], a[20:23], a[248:251], v[120:123]
    v_mfma_f32_16x16x32_bf16 v[124:127], a[20:23], a[252:255], v[124:127]
    s_waitcnt lgkmcnt(14)
    v_mfma_f32_16x16x32_bf16 v[128:131], a[24:27], a[240:243], v[128:131]
    buffer_load_dwordx4 a[124:127], v1, s[8:11], s31 offen offset:1024 sc1
    v_mfma_f32_16x16x32_bf16 v[132:135], a[24:27], a[244:247], v[132:135]
    v_mfma_f32_16x16x32_bf16 v[136:139], a[24:27], a[248:251], v[136:139]
    v_mfma_f32_16x16x32_bf16 v[140:143], a[24:27], a[252:255], v[140:143]
    s_waitcnt lgkmcnt(12)
    v_mfma_f32_16x16x32_bf16 v[144:147], a[28:31], a[240:243], v[144:147]
    v_mfma_f32_16x16x32_bf16 v[148:151], a[28:31], a[244:247], v[148:151]
    v_mfma_f32_16x16x32_bf16 v[152:155], a[28:31], a[248:251], v[152:155]
    buffer_load_dwordx4 a[128:131], v1, s[8:11], s31 offen offset:2048 sc1
    v_mfma_f32_16x16x32_bf16 v[156:159], a[28:31], a[252:255], v[156:159]
    s_waitcnt vmcnt(22) lgkmcnt(10)
    s_barrier
    ds_read_b64_tr_b16 a[0:1], v4 offset:32768
    v_mfma_f32_16x16x32_bf16 v[160:163], a[32:35], a[240:243], v[160:163]
    ds_read_b64_tr_b16 a[2:3], v4 offset:40960
    ds_read_b64_tr_b16 a[4:5], v4 offset:33792
    v_mfma_f32_16x16x32_bf16 v[164:167], a[32:35], a[244:247], v[164:167]
    ds_read_b64_tr_b16 a[6:7], v4 offset:41984
    ds_read_b64_tr_b16 a[8:9], v5 offset:32768
    v_mfma_f32_16x16x32_bf16 v[168:171], a[32:35], a[248:251], v[168:171]
    ds_read_b64_tr_b16 a[10:11], v5 offset:40960
    ds_read_b64_tr_b16 a[12:13], v5 offset:33792
    v_mfma_f32_16x16x32_bf16 v[172:175], a[32:35], a[252:255], v[172:175]
    s_waitcnt lgkmcnt(15)
    ds_read_b64_tr_b16 a[14:15], v5 offset:41984
    ds_read_b64_tr_b16 a[16:17], v4 offset:33024
    v_mfma_f32_16x16x32_bf16 v[176:179], a[36:39], a[240:243], v[176:179]
    buffer_load_dwordx4 a[132:135], v1, s[8:11], s31 offen offset:3072 sc1
    s_add_u32 s31, s31, 4096
    v_mfma_f32_16x16x32_bf16 v[180:183], a[36:39], a[244:247], v[180:183]
    s_buffer_load_dwordx2 s[100:101], s[12:15], s89 offset:2364
    ds_read_b64_tr_b16 a[18:19], v4 offset:41216
    ds_read_b64_tr_b16 a[20:21], v4 offset:34048
    v_mfma_f32_16x16x32_bf16 v[184:187], a[36:39], a[248:251], v[184:187]
    ds_read_b64_tr_b16 a[22:23], v4 offset:42240
    ds_read_b64_tr_b16 a[24:25], v5 offset:33024
    v_mfma_f32_16x16x32_bf16 v[188:191], a[36:39], a[252:255], v[188:191]
    s_waitcnt lgkmcnt(15)
    ds_read_b64_tr_b16 a[26:27], v5 offset:41216
    ds_read_b64_tr_b16 a[28:29], v5 offset:34048
    v_mfma_f32_16x16x32_bf16 v[192:195], a[40:43], a[240:243], v[192:195]
    ds_read_b64_tr_b16 a[30:31], v5 offset:42240
    v_mfma_f32_16x16x32_bf16 v[196:199], a[40:43], a[244:247], v[196:199]
    buffer_load_dwordx4 a[136:139], v1, s[8:11], s31 offen offset:0 sc1
    ds_read_b64_tr_b16 a[32:33], v4 offset:33280
    v_mfma_f32_16x16x32_bf16 v[200:203], a[40:43], a[248:251], v[200:203]
    ds_read_b64_tr_b16 a[34:35], v4 offset:41472
    v_mfma_f32_16x16x32_bf16 v[204:207], a[40:43], a[252:255], v[204:207]
    ds_read_b64_tr_b16 a[36:37], v4 offset:34304
    v_mfma_f32_16x16x32_bf16 v[208:211], a[44:47], a[240:243], v[208:211]
    ds_read_b64_tr_b16 a[38:39], v4 offset:42496
    v_mfma_f32_16x16x32_bf16 v[212:215], a[44:47], a[244:247], v[212:215]
    ds_read_b64_tr_b16 a[40:41], v5 offset:33280
    v_mfma_f32_16x16x32_bf16 v[216:219], a[44:47], a[248:251], v[216:219]
    ds_read_b64_tr_b16 a[42:43], v5 offset:41472
    v_mfma_f32_16x16x32_bf16 v[220:223], a[44:47], a[252:255], v[220:223]
    buffer_load_dwordx4 a[140:143], v1, s[8:11], s31 offen offset:1024 sc1
    v_mfma_f32_16x16x32_bf16 v[224:227], a[48:51], a[240:243], v[224:227]
    ds_read_b64_tr_b16 a[44:45], v5 offset:34304
    v_mfma_f32_16x16x32_bf16 v[228:231], a[48:51], a[244:247], v[228:231]
    ds_read_b64_tr_b16 a[46:47], v5 offset:42496
    v_mfma_f32_16x16x32_bf16 v[232:235], a[48:51], a[248:251], v[232:235]
    v_mfma_f32_16x16x32_bf16 v[236:239], a[48:51], a[252:255], v[236:239]
    s_waitcnt lgkmcnt(15)
    ds_read_b64_tr_b16 a[48:49], v4 offset:33536
    v_mfma_f32_16x16x32_bf16 v[240:243], a[52:55], a[240:243], v[240:243]
    ds_read_b64_tr_b16 a[50:51], v4 offset:41728
    v_mfma_f32_16x16x32_bf16 v[244:247], a[52:55], a[244:247], v[244:247]
    buffer_load_dwordx4 a[144:147], v1, s[8:11], s31 offen offset:2048 sc1
    v_mfma_f32_16x16x32_bf16 v[248:251], a[52:55], a[248:251], v[248:251]
    s_buffer_load_dwordx2 s[100:101], s[16:19], s89 offset:3388
    v_mfma_f32_16x16x32_bf16 v[252:255], a[52:55], a[252:255], v[252:255]
    ds_read_b64_tr_b16 a[52:53], v4 offset:34560
    v_mfma_f32_16x16x32_bf16 v[32:35], a[0:3], a[56:59], v[32:35]
    ds_read_b64_tr_b16 a[54:55], v4 offset:42752
    v_mfma_f32_16x16x32_bf16 v[36:39], a[0:3], a[60:63], v[36:39]
    v_mfma_f32_16x16x32_bf16 v[40:43], a[0:3], a[64:67], v[40:43]
    v_mfma_f32_16x16x32_bf16 v[44:47], a[0:3], a[68:71], v[44:47]
    buffer_load_dwordx4 a[148:151], v1, s[8:11], s31 offen offset:3072 sc1
    s_add_u32 s31, s31, 4096
    v_mfma_f32_16x16x32_bf16 v[48:51], a[4:7], a[56:59], v[48:51]
    ds_read_b64_tr_b16 a[0:1], v4 offset:49152
    v_mfma_f32_16x16x32_bf16 v[52:55], a[4:7], a[60:63], v[52:55]
    ds_read_b64_tr_b16 a[2:3], v4 offset:57344
    v_mfma_f32_16x16x32_bf16 v[56:59], a[4:7], a[64:67], v[56:59]
    v_mfma_f32_16x16x32_bf16 v[60:63], a[4:7], a[68:71], v[60:63]
    ds_read_b64_tr_b16 a[4:5], v4 offset:50176
    v_mfma_f32_16x16x32_bf16 v[64:67], a[8:11], a[56:59], v[64:67]
    ds_read_b64_tr_b16 a[6:7], v4 offset:58368
    v_mfma_f32_16x16x32_bf16 v[68:71], a[8:11], a[60:63], v[68:71]
    buffer_load_dwordx4 v2, s[12:15], s30 offen offset:0 lds
    v_mfma_f32_16x16x32_bf16 v[72:75], a[8:11], a[64:67], v[72:75]
    v_mfma_f32_16x16x32_bf16 v[76:79], a[8:11], a[68:71], v[76:79]
    ds_read_b64_tr_b16 a[8:9], v5 offset:49152
    v_mfma_f32_16x16x32_bf16 v[80:83], a[12:15], a[56:59], v[80:83]
    ds_read_b64_tr_b16 a[10:11], v5 offset:57344
    v_mfma_f32_16x16x32_bf16 v[84:87], a[12:15], a[60:63], v[84:87]
    v_mfma_f32_16x16x32_bf16 v[88:91], a[12:15], a[64:67], v[88:91]
    s_buffer_load_dwordx2 s[100:101], s[12:15], s89 offset:2492
    v_mfma_f32_16x16x32_bf16 v[92:95], a[12:15], a[68:71], v[92:95]
    s_waitcnt lgkmcnt(15)
    ds_read_b64_tr_b16 a[12:13], v5 offset:50176
    v_mfma_f32_16x16x32_bf16 v[96:99], a[16:19], a[56:59], v[96:99]
    buffer_load_dwordx4 v2, s[16:19], s30 offen offset:1024 lds
    v_mfma_f32_16x16x32_bf16 v[100:103], a[16:19], a[60:63], v[100:103]
    ds_read_b64_tr_b16 a[14:15], v5 offset:58368
    v_mfma_f32_16x16x32_bf16 v[104:107], a[16:19], a[64:67], v[104:107]
    v_mfma_f32_16x16x32_bf16 v[108:111], a[16:19], a[68:71], v[108:111]
    ds_read_b64_tr_b16 a[16:17], v4 offset:49408
    v_mfma_f32_16x16x32_bf16 v[112:115], a[20:23], a[56:59], v[112:115]
    ds_read_b64_tr_b16 a[18:19], v4 offset:57600
    v_mfma_f32_16x16x32_bf16 v[116:119], a[20:23], a[60:63], v[116:119]
    v_mfma_f32_16x16x32_bf16 v[120:123], a[20:23], a[64:67], v[120:123]
    buffer_load_dwordx4 v3, s[12:15], s30 offen offset:2048 lds
    v_mfma_f32_16x16x32_bf16 v[124:127], a[20:23], a[68:71], v[124:127]
    ds_read_b64_tr_b16 a[20:21], v4 offset:50432
    v_mfma_f32_16x16x32_bf16 v[128:131], a[24:27], a[56:59], v[128:131]
    ds_read_b64_tr_b16 a[22:23], v4 offset:58624
    v_mfma_f32_16x16x32_bf16 v[132:135], a[24:27], a[60:63], v[132:135]
    v_mfma_f32_16x16x32_bf16 v[136:139], a[24:27], a[64:67], v[136:139]
    v_mfma_f32_16x16x32_bf16 v[140:143], a[24:27], a[68:71], v[140:143]
    ds_read_b64_tr_b16 a[24:25], v5 offset:49408
    v_mfma_f32_16x16x32_bf16 v[144:147], a[28:31], a[56:59], v[144:147]
    buffer_load_dwordx4 v3, s[16:19], s30 offen offset:3072 lds
    v_mfma_f32_16x16x32_bf16 v[148:151], a[28:31], a[60:63], v[148:151]
    s_add_u32 m0, s32, 147456
    s_mov_b32 s30, 4358144
    ds_read_b64_tr_b16 a[26:27], v5 offset:57600
    v_mfma_f32_16x16x32_bf16 v[152:155], a[28:31], a[64:67], v[152:155]
    v_mfma_f32_16x16x32_bf16 v[156:159], a[28:31], a[68:71], v[156:159]
    s_buffer_load_dwordx2 s[100:101], s[16:19], s89 offset:3516
    ds_read_b64_tr_b16 a[28:29], v5 offset:50432
    v_mfma_f32_16x16x32_bf16 v[160:163], a[32:35], a[56:59], v[160:163]
    ds_read_b64_tr_b16 a[30:31], v5 offset:58624
    v_mfma_f32_16x16x32_bf16 v[164:167], a[32:35], a[60:63], v[164:167]
    v_mfma_f32_16x16x32_bf16 v[168:171], a[32:35], a[64:67], v[168:171]
    buffer_load_dwordx4 v2, s[12:15], s30 offen offset:0 lds
    v_mfma_f32_16x16x32_bf16 v[172:175], a[32:35], a[68:71], v[172:175]
    s_waitcnt lgkmcnt(15)
    ds_read_b64_tr_b16 a[32:33], v4 offset:49664
    v_mfma_f32_16x16x32_bf16 v[176:179], a[36:39], a[56:59], v[176:179]
    ds_read_b64_tr_b16 a[34:35], v4 offset:57856
    v_mfma_f32_16x16x32_bf16 v[180:183], a[36:39], a[60:63], v[180:183]
    v_mfma_f32_16x16x32_bf16 v[184:187], a[36:39], a[64:67], v[184:187]
    v_mfma_f32_16x16x32_bf16 v[188:191], a[36:39], a[68:71], v[188:191]
    ds_read_b64_tr_b16 a[36:37], v4 offset:50688
    v_mfma_f32_16x16x32_bf16 v[192:195], a[40:43], a[56:59], v[192:195]
    buffer_load_dwordx4 v2, s[16:19], s30 offen offset:1024 lds
    v_mfma_f32_16x16x32_bf16 v[196:199], a[40:43], a[60:63], v[196:199]
    ds_read_b64_tr_b16 a[38:39], v4 offset:58880
    v_mfma_f32_16x16x32_bf16 v[200:203], a[40:43], a[64:67], v[200:203]
    v_mfma_f32_16x16x32_bf16 v[204:207], a[40:43], a[68:71], v[204:207]
    ds_read_b64_tr_b16 a[40:41], v5 offset:49664
    v_mfma_f32_16x16x32_bf16 v[208:211], a[44:47], a[56:59], v[208:211]
    ds_read_b64_tr_b16 a[42:43], v5 offset:57856
    v_mfma_f32_16x16x32_bf16 v[212:215], a[44:47], a[60:63], v[212:215]
    v_mfma_f32_16x16x32_bf16 v[216:219], a[44:47], a[64:67], v[216:219]
    buffer_load_dwordx4 v3, s[12:15], s30 offen offset:2048 lds
    v_mfma_f32_16x16x32_bf16 v[220:223], a[44:47], a[68:71], v[220:223]
    ds_read_b64_tr_b16 a[44:45], v5 offset:50688
    v_mfma_f32_16x16x32_bf16 v[224:227], a[48:51], a[56:59], v[224:227]
    s_load_dwordx2 s[100:101], s[0:1], 7100
    ds_read_b64_tr_b16 a[46:47], v5 offset:58880
    v_mfma_f32_16x16x32_bf16 v[228:231], a[48:51], a[60:63], v[228:231]
    v_mfma_f32_16x16x32_bf16 v[232:235], a[48:51], a[64:67], v[232:235]
    v_mfma_f32_16x16x32_bf16 v[236:239], a[48:51], a[68:71], v[236:239]
    ds_read_b64_tr_b16 a[48:49], v4 offset:49920
    v_mfma_f32_16x16x32_bf16 v[240:243], a[52:55], a[56:59], v[240:243]
    buffer_load_dwordx4 v3, s[16:19], s30 offen offset:3072 lds
    v_mfma_f32_16x16x32_bf16 v[244:247], a[52:55], a[60:63], v[244:247]
    s_add_u32 m0, s32, 0
    s_mov_b32 s30, 4587520
    ds_read_b64_tr_b16 a[50:51], v4 offset:58112
    v_mfma_f32_16x16x32_bf16 v[248:251], a[52:55], a[64:67], v[248:251]
    v_mfma_f32_16x16x32_bf16 v[252:255], a[52:55], a[68:71], v[252:255]
    s_waitcnt lgkmcnt(15)
    ds_read_b64_tr_b16 a[52:53], v4 offset:50944
    v_mfma_f32_16x16x32_bf16 v[32:35], a[0:3], a[72:75], v[32:35]
    ds_read_b64_tr_b16 a[54:55], v4 offset:59136
    v_mfma_f32_16x16x32_bf16 v[36:39], a[0:3], a[76:79], v[36:39]
    v_mfma_f32_16x16x32_bf16 v[40:43], a[0:3], a[80:83], v[40:43]
    buffer_load_dwordx4 a[152:155], v1, s[8:11], s31 offen offset:0 sc1
    v_mfma_f32_16x16x32_bf16 v[44:47], a[0:3], a[84:87], v[44:47]
    v_mfma_f32_16x16x32_bf16 v[48:51], a[4:7], a[72:75], v[48:51]
    v_mfma_f32_16x16x32_bf16 v[52:55], a[4:7], a[76:79], v[52:55]
    v_mfma_f32_16x16x32_bf16 v[56:59], a[4:7], a[80:83], v[56:59]
    v_mfma_f32_16x16x32_bf16 v[60:63], a[4:7], a[84:87], v[60:63]
    v_mfma_f32_16x16x32_bf16 v[64:67], a[8:11], a[72:75], v[64:67]
    buffer_load_dwordx4 a[156:159], v1, s[8:11], s31 offen offset:1024 sc1
    v_mfma_f32_16x16x32_bf16 v[68:71], a[8:11], a[76:79], v[68:71]
    s_load_dwordx2 s[100:101], s[0:1], 6972
    v_mfma_f32_16x16x32_bf16 v[72:75], a[8:11], a[80:83], v[72:75]
    v_mfma_f32_16x16x32_bf16 v[76:79], a[8:11], a[84:87], v[76:79]
    v_mfma_f32_16x16x32_bf16 v[80:83], a[12:15], a[72:75], v[80:83]
    v_mfma_f32_16x16x32_bf16 v[84:87], a[12:15], a[76:79], v[84:87]
    v_mfma_f32_16x16x32_bf16 v[88:91], a[12:15], a[80:83], v[88:91]
    buffer_load_dwordx4 a[160:163], v1, s[8:11], s31 offen offset:2048 sc1
    v_mfma_f32_16x16x32_bf16 v[92:95], a[12:15], a[84:87], v[92:95]
    v_mfma_f32_16x16x32_bf16 v[96:99], a[16:19], a[72:75], v[96:99]
    v_mfma_f32_16x16x32_bf16 v[100:103], a[16:19], a[76:79], v[100:103]
    v_mfma_f32_16x16x32_bf16 v[104:107], a[16:19], a[80:83], v[104:107]
    v_mfma_f32_16x16x32_bf16 v[108:111], a[16:19], a[84:87], v[108:111]
    s_waitcnt lgkmcnt(15)
    v_mfma_f32_16x16x32_bf16 v[112:115], a[20:23], a[72:75], v[112:115]
    buffer_load_dwordx4 a[164:167], v1, s[8:11], s31 offen offset:3072 sc1
    s_add_u32 s31, s31, 4096
    v_mfma_f32_16x16x32_bf16 v[116:119], a[20:23], a[76:79], v[116:119]
    v_mfma_f32_16x16x32_bf16 v[120:123], a[20:23], a[80:83], v[120:123]
    v_mfma_f32_16x16x32_bf16 v[124:127], a[20:23], a[84:87], v[124:127]
    s_waitcnt lgkmcnt(14)
    v_mfma_f32_16x16x32_bf16 v[128:131], a[24:27], a[72:75], v[128:131]
    v_mfma_f32_16x16x32_bf16 v[132:135], a[24:27], a[76:79], v[132:135]
    v_mfma_f32_16x16x32_bf16 v[136:139], a[24:27], a[80:83], v[136:139]
    buffer_load_dwordx4 a[168:171], v1, s[8:11], s31 offen offset:0 sc1
    v_mfma_f32_16x16x32_bf16 v[140:143], a[24:27], a[84:87], v[140:143]
    s_waitcnt lgkmcnt(12)
    s_load_dwordx2 s[100:101], s[0:1], 6844
    v_mfma_f32_16x16x32_bf16 v[144:147], a[28:31], a[72:75], v[144:147]
    v_mfma_f32_16x16x32_bf16 v[148:151], a[28:31], a[76:79], v[148:151]
    v_mfma_f32_16x16x32_bf16 v[152:155], a[28:31], a[80:83], v[152:155]
    v_mfma_f32_16x16x32_bf16 v[156:159], a[28:31], a[84:87], v[156:159]
    s_waitcnt vmcnt(32) lgkmcnt(10)
    s_barrier
    ds_read_b64_tr_b16 a[0:1], v6 offset:0
    v_mfma_f32_16x16x32_bf16 v[160:163], a[32:35], a[72:75], v[160:163]
    buffer_load_dwordx4 a[172:175], v1, s[8:11], s31 offen offset:1024 sc1
    ds_read_b64_tr_b16 a[2:3], v6 offset:8192
    v_mfma_f32_16x16x32_bf16 v[164:167], a[32:35], a[76:79], v[164:167]
    ds_read_b64_tr_b16 a[4:5], v6 offset:1024
    ds_read_b64_tr_b16 a[6:7], v6 offset:9216
    v_mfma_f32_16x16x32_bf16 v[168:171], a[32:35], a[80:83], v[168:171]
    ds_read_b64_tr_b16 a[8:9], v7 offset:0
    ds_read_b64_tr_b16 a[10:11], v7 offset:8192
    v_mfma_f32_16x16x32_bf16 v[172:175], a[32:35], a[84:87], v[172:175]
    s_waitcnt lgkmcnt(14)
    ds_read_b64_tr_b16 a[12:13], v7 offset:1024
    ds_read_b64_tr_b16 a[14:15], v7 offset:9216
    v_mfma_f32_16x16x32_bf16 v[176:179], a[36:39], a[72:75], v[176:179]
    ds_read_b64_tr_b16 a[16:17], v6 offset:256
    ds_read_b64_tr_b16 a[18:19], v6 offset:8448
    v_mfma_f32_16x16x32_bf16 v[180:183], a[36:39], a[76:79], v[180:183]
    buffer_load_dwordx4 a[176:179], v1, s[8:11], s31 offen offset:2048 sc1
    ds_read_b64_tr_b16 a[20:21], v6 offset:1280
    v_mfma_f32_16x16x32_bf16 v[184:187], a[36:39], a[80:83], v[184:187]
    ds_read_b64_tr_b16 a[22:23], v6 offset:9472
    ds_read_b64_tr_b16 a[24:25], v7 offset:256
    v_mfma_f32_16x16x32_bf16 v[188:191], a[36:39], a[84:87], v[188:191]
    s_waitcnt lgkmcnt(15)
    ds_read_b64_tr_b16 a[26:27], v7 offset:8448
    ds_read_b64_tr_b16 a[28:29], v7 offset:1280
    v_mfma_f32_16x16x32_bf16 v[192:195], a[40:43], a[72:75], v[192:195]
    ds_read_b64_tr_b16 a[30:31], v7 offset:9472
    v_mfma_f32_16x16x32_bf16 v[196:199], a[40:43], a[76:79], v[196:199]
    ds_read_b64_tr_b16 a[32:33], v6 offset:512
    v_mfma_f32_16x16x32_bf16 v[200:203], a[40:43], a[80:83], v[200:203]
    buffer_load_dwordx4 a[180:183], v1, s[8:11], s31 offen offset:3072 sc1
    s_add_u32 s31, s31, 4096
    v_mfma_f32_16x16x32_bf16 v[204:207], a[40:43], a[84:87], v[204:207]
    ds_read_b64_tr_b16 a[34:35], v6 offset:8704
    v_mfma_f32_16x16x32_bf16 v[208:211], a[44:47], a[72:75], v[208:211]
    ds_read_b64_tr_b16 a[36:37], v6 offset:1536
    v_mfma_f32_16x16x32_bf16 v[212:215], a[44:47], a[76:79], v[212:215]
    s_load_dwordx2 s[100:101], s[0:1], 6716
    ds_read_b64_tr_b16 a[38:39], v6 offset:9728
    v_mfma_f32_16x16x32_bf16 v[216:219], a[44:47], a[80:83], v[216:219]
    ds_read_b64_tr_b16 a[40:41], v7 offset:512
    v_mfma_f32_16x16x32_bf16 v[220:223], a[44:47], a[84:87], v[220:223]
    ds_read_b64_tr_b16 a[42:43], v7 offset:8704
    v_mfma_f32_16x16x32_bf16 v[224:227], a[48:51], a[72:75], v[224:227]
    buffer_load_dwordx4 v2, s[12:15], s30 offen offset:0 lds
    v_mfma_f32_16x16x32_bf16 v[228:231], a[48:51], a[76:79], v[228:231]
    ds_read_b64_tr_b16 a[44:45], v7 offset:1536
    v_mfma_f32_16x16x32_bf16 v[232:235], a[48:51], a[80:83], v[232:235]
    ds_read_b64_tr_b16 a[46:47], v7 offset:9728
    v_mfma_f32_16x16x32_bf16 v[236:239], a[48:51], a[84:87], v[236:239]
    s_waitcnt lgkmcnt(15)
    ds_read_b64_tr_b16 a[48:49], v6 offset:768
    v_mfma_f32_16x16x32_bf16 v[240:243], a[52:55], a[72:75], v[240:243]
    ds_read_b64_tr_b16 a[50:51], v6 offset:8960
    v_mfma_f32_16x16x32_bf16 v[244:247], a[52:55], a[76:79], v[244:247]
    v_mfma_f32_16x16x32_bf16 v[248:251], a[52:55], a[80:83], v[248:251]
    buffer_load_dwordx4 v2, s[16:19], s30 offen offset:1024 lds
    v_mfma_f32_16x16x32_bf16 v[252:255], a[52:55], a[84:87], v[252:255]
    ds_read_b64_tr_b16 a[52:53], v6 offset:1792
    v_mfma_f32_16x16x32_bf16 v[32:35], a[0:3], a[88:91], v[32:35]
    ds_read_b64_tr_b16 a[54:55], v6 offset:9984
    v_mfma_f32_16x16x32_bf16 v[36:39], a[0:3], a[92:95], v[36:39]
    v_mfma_f32_16x16x32_bf16 v[40:43], a[0:3], a[96:99], v[40:43]
    v_mfma_f32_16x16x32_bf16 v[44:47], a[0:3], a[100:103], v[44:47]
    ds_read_b64_tr_b16 a[0:1], v6 offset:16384
    v_mfma_f32_16x16x32_bf16 v[48:51], a[4:7], a[88:91], v[48:51]
    buffer_load_dwordx4 v3, s[12:15], s30 offen offset:2048 lds
    v_mfma_f32_16x16x32_bf16 v[52:55], a[4:7], a[92:95], v[52:55]
    ds_read_b64_tr_b16 a[2:3], v6 offset:24576
    v_mfma_f32_16x16x32_bf16 v[56:59], a[4:7], a[96:99], v[56:59]
    v_mfma_f32_16x16x32_bf16 v[60:63], a[4:7], a[100:103], v[60:63]
    s_load_dwordx2 s[100:101], s[0:1], 6588
    ds_read_b64_tr_b16 a[4:5], v6 offset:17408
    v_mfma_f32_16x16x32_bf16 v[64:67], a[8:11], a[88:91], v[64:67]
    ds_read_b64_tr_b16 a[6:7], v6 offset:25600
    v_mfma_f32_16x16x32_bf16 v[68:71], a[8:11], a[92:95], v[68:71]
    v_mfma_f32_16x16x32_bf16 v[72:75], a[8:11], a[96:99], v[72:75]
    buffer_load_dwordx4 v3, s[16:19], s30 offen offset:3072 lds
    v_mfma_f32_16x16x32_bf16 v[76:79], a[8:11], a[100:103], v[76:79]
    s_add_u32 m0, s32, 16384
    s_mov_b32 s30, 4816896
    ds_read_b64_tr_b16 a[8:9], v7 offset:16384
    v_mfma_f32_16x16x32_bf16 v[80:83], a[12:15], a[88:91], v[80:83]
    ds_read_b64_tr_b16 a[10:11], v7 offset:24576
    v_mfma_f32_16x16x32_bf16 v[84:87], a[12:15], a[92:95], v[84:87]
    v_mfma_f32_16x16x32_bf16 v[88:91], a[12:15], a[96:99], v[88:91]
    v_mfma_f32_16x16x32_bf16 v[92:95], a[12:15], a[100:103], v[92:95]
    s_waitcnt lgkmcnt(15)
    ds_read_b64_tr_b16 a[12:13], v7 offset:17408
    v_mfma_f32_16x16x32_bf16 v[96:99], a[16:19], a[88:91], v[96:99]
    buffer_load_dwordx4 v2, s[12:15], s30 offen offset:0 lds
    v_mfma_f32_16x16x32_bf16 v[100:103], a[16:19], a[92:95], v[100:103]
    ds_read_b64_tr_b16 a[14:15], v7 offset:25600
    v_mfma_f32_16x16x32_bf16 v[104:107], a[16:19], a[96:99], v[104:107]
    v_mfma_f32_16x16x32_bf16 v[108:111], a[16:19], a[100:103], v[108:111]
    ds_read_b64_tr_b16 a[16:17], v6 offset:16640
    v_mfma_f32_16x16x32_bf16 v[112:115], a[20:23], a[88:91], v[112:115]
    ds_read_b64_tr_b16 a[18:19], v6 offset:24832
    v_mfma_f32_16x16x32_bf16 v[116:119], a[20:23], a[92:95], v[116:119]
    v_mfma_f32_16x16x32_bf16 v[120:123], a[20:23], a[96:99], v[120:123]
    buffer_load_dwordx4 v2, s[16:19], s30 offen offset:1024 lds
    v_mfma_f32_16x16x32_bf16 v[124:127], a[20:23], a[100:103], v[124:127]
    ds_read_b64_tr_b16 a[20:21], v6 offset:17664
    v_mfma_f32_16x16x32_bf16 v[128:131], a[24:27], a[88:91], v[128:131]
    ds_read_b64_tr_b16 a[22:23], v6 offset:25856
    v_mfma_f32_16x16x32_bf16 v[132:135], a[24:27], a[92:95], v[132:135]
    s_load_dwordx2 s[100:101], s[0:1], 6460
    v_mfma_f32_16x16x32_bf16 v[136:139], a[24:27], a[96:99], v[136:139]
    v_mfma_f32_16x16x32_bf16 v[140:143], a[24:27], a[100:103], v[140:143]
    ds_read_b64_tr_b16 a[24:25], v7 offset:16640
    v_mfma_f32_16x16x32_bf16 v[144:147], a[28:31], a[88:91], v[144:147]
    buffer_load_dwordx4 v3, s[12:15], s30 offen offset:2048 lds
    v_mfma_f32_16x16x32_bf16 v[148:151], a[28:31], a[92:95], v[148:151]
    ds_read_b64_tr_b16 a[26:27], v7 offset:24832
    v_mfma_f32_16x16x32_bf16 v[152:155], a[28:31], a[96:99], v[152:155]
    v_mfma_f32_16x16x32_bf16 v[156:159], a[28:31], a[100:103], v[156:159]
    ds_read_b64_tr_b16 a[28:29], v7 offset:17664
    v_mfma_f32_16x16x32_bf16 v[160:163], a[32:35], a[88:91], v[160:163]
    ds_read_b64_tr_b16 a[30:31], v7 offset:25856
    v_mfma_f32_16x16x32_bf16 v[164:167], a[32:35], a[92:95], v[164:167]
    v_mfma_f32_16x16x32_bf16 v[168:171], a[32:35], a[96:99], v[168:171]
    buffer_load_dwordx4 v3, s[16:19], s30 offen offset:3072 lds
    v_mfma_f32_16x16x32_bf16 v[172:175], a[32:35], a[100:103], v[172:175]
    s_waitcnt lgkmcnt(15)
    s_add_u32 m0, s32, 32768
    s_mov_b32 s30, 5046272
    v_mfma_f32_16x16x32_bf16 v[176:179], a[36:39], a[88:91], v[176:179]
    ds_read_b64_tr_b16 a[32:33], v6 offset:16896
    v_mfma_f32_16x16x32_bf16 v[180:183], a[36:39], a[92:95], v[180:183]
    ds_read_b64_tr_b16 a[34:35], v6 offset:25088
    v_mfma_f32_16x16x32_bf16 v[184:187], a[36:39], a[96:99], v[184:187]
    v_mfma_f32_16x16x32_bf16 v[188:191], a[36:39], a[100:103], v[188:191]
    ds_read_b64_tr_b16 a[36:37], v6 offset:17920
    v_mfma_f32_16x16x32_bf16 v[192:195], a[40:43], a[88:91], v[192:195]
    buffer_load_dwordx4 a[192:195], v1, s[8:11], s31 offen offset:0 sc1
    v_mfma_f32_16x16x32_bf16 v[196:199], a[40:43], a[92:95], v[196:199]
    ds_read_b64_tr_b16 a[38:39], v6 offset:26112
    v_mfma_f32_16x16x32_bf16 v[200:203], a[40:43], a[96:99], v[200:203]
    v_mfma_f32_16x16x32_bf16 v[204:207], a[40:43], a[100:103], v[204:207]
    s_load_dwordx2 s[100:101], s[0:1], 6332
    ds_read_b64_tr_b16 a[40:41], v7 offset:16896
    v_mfma_f32_16x16x32_bf16 v[208:211], a[44:47], a[88:91], v[208:211]
    ds_read_b64_tr_b16 a[42:43], v7 offset:25088
    v_mfma_f32_16x16x32_bf16 v[212:215], a[44:47], a[92:95], v[212:215]
    v_mfma_f32_16x16x32_bf16 v[216:219], a[44:47], a[96:99], v[216:219]
    buffer_load_dwordx4 a[196:199], v1, s[8:11], s31 offen offset:1024 sc1
    v_mfma_f32_16x16x32_bf16 v[220:223], a[44:47], a[100:103], v[220:223]
    ds_read_b64_tr_b16 a[44:45], v7 offset:17920
    v_mfma_f32_16x16x32_bf16 v[224:227], a[48:51], a[88:91], v[224:227]
    ds_read_b64_tr_b16 a[46:47], v7 offset:26112
    v_mfma_f32_16x16x32_bf16 v[228:231], a[48:51], a[92:95], v[228:231]
    v_mfma_f32_16x16x32_bf16 v[232:235], a[48:51], a[96:99], v[232:235]
    v_mfma_f32_16x16x32_bf16 v[236:239], a[48:51], a[100:103], v[236:239]
    ds_read_b64_tr_b16 a[48:49], v6 offset:17152
    v_mfma_f32_16x16x32_bf16 v[240:243], a[52:55], a[88:91], v[240:243]
    buffer_load_dwordx4 a[200:203], v1, s[8:11], s31 offen offset:2048 sc1
    v_mfma_f32_16x16x32_bf16 v[244:247], a[52:55], a[92:95], v[244:247]
    ds_read_b64_tr_b16 a[50:51], v6 offset:25344
    v_mfma_f32_16x16x32_bf16 v[248:251], a[52:55], a[96:99], v[248:251]
    v_mfma_f32_16x16x32_bf16 v[252:255], a[52:55], a[100:103], v[252:255]
    s_waitcnt vmcnt(43) lgkmcnt(15)
    ds_read_b64_tr_b16 a[52:53], v6 offset:18176
    v_mfma_f32_16x16x32_bf16 v[32:35], a[0:3], a[104:107], v[32:35]
    ds_read_b64_tr_b16 a[54:55], v6 offset:26368
    v_mfma_f32_16x16x32_bf16 v[36:39], a[0:3], a[108:111], v[36:39]
    v_mfma_f32_16x16x32_bf16 v[40:43], a[0:3], a[112:115], v[40:43]
    buffer_load_dwordx4 a[204:207], v1, s[8:11], s31 offen offset:3072 sc1
    s_add_u32 s31, s31, 4096
    v_mfma_f32_16x16x32_bf16 v[44:47], a[0:3], a[116:119], v[44:47]
    v_mfma_f32_16x16x32_bf16 v[48:51], a[4:7], a[104:107], v[48:51]
    v_mfma_f32_16x16x32_bf16 v[52:55], a[4:7], a[108:111], v[52:55]
    s_load_dwordx2 s[100:101], s[0:1], 6204
    v_mfma_f32_16x16x32_bf16 v[56:59], a[4:7], a[112:115], v[56:59]
    v_mfma_f32_16x16x32_bf16 v[60:63], a[4:7], a[116:119], v[60:63]
    v_mfma_f32_16x16x32_bf16 v[64:67], a[8:11], a[104:107], v[64:67]
    buffer_load_dwordx4 a[208:211], v1, s[8:11], s31 offen offset:0 sc1
    v_mfma_f32_16x16x32_bf16 v[68:71], a[8:11], a[108:111], v[68:71]
    v_mfma_f32_16x16x32_bf16 v[72:75], a[8:11], a[112:115], v[72:75]
    v_mfma_f32_16x16x32_bf16 v[76:79], a[8:11], a[116:119], v[76:79]
    v_mfma_f32_16x16x32_bf16 v[80:83], a[12:15], a[104:107], v[80:83]
    v_mfma_f32_16x16x32_bf16 v[84:87], a[12:15], a[108:111], v[84:87]
    v_mfma_f32_16x16x32_bf16 v[88:91], a[12:15], a[112:115], v[88:91]
    buffer_load_dwordx4 a[212:215], v1, s[8:11], s31 offen offset:1024 sc1
    v_mfma_f32_16x16x32_bf16 v[92:95], a[12:15], a[116:119], v[92:95]
    v_mfma_f32_16x16x32_bf16 v[96:99], a[16:19], a[104:107], v[96:99]
    v_mfma_f32_16x16x32_bf16 v[100:103], a[16:19], a[108:111], v[100:103]
    v_mfma_f32_16x16x32_bf16 v[104:107], a[16:19], a[112:115], v[104:107]
    v_mfma_f32_16x16x32_bf16 v[108:111], a[16:19], a[116:119], v[108:111]
    s_waitcnt lgkmcnt(15)
    v_mfma_f32_16x16x32_bf16 v[112:115], a[20:23], a[104:107], v[112:115]
    buffer_load_dwordx4 a[216:219], v1, s[8:11], s31 offen offset:2048 sc1
    v_mfma_f32_16x16x32_bf16 v[116:119], a[20:23], a[108:111], v[116:119]
    v_mfma_f32_16x16x32_bf16 v[120:123], a[20:23], a[112:115], v[120:123]
    v_mfma_f32_16x16x32_bf16 v[124:127], a[20:23], a[116:119], v[124:127]
    s_waitcnt lgkmcnt(14)
    s_load_dwordx2 s[100:101], s[0:1], 6076
    v_mfma_f32_16x16x32_bf16 v[128:131], a[24:27], a[104:107], v[128:131]
    v_mfma_f32_16x16x32_bf16 v[132:135], a[24:27], a[108:111], v[132:135]
    v_mfma_f32_16x16x32_bf16 v[136:139], a[24:27], a[112:115], v[136:139]
    buffer_load_dwordx4 a[220:223], v1, s[8:11], s31 offen offset:3072 sc1
    s_add_u32 s31, s31, 4096
    v_mfma_f32_16x16x32_bf16 v[140:143], a[24:27], a[116:119], v[140:143]
    s_waitcnt lgkmcnt(12)
    v_mfma_f32_16x16x32_bf16 v[144:147], a[28:31], a[104:107], v[144:147]
    v_mfma_f32_16x16x32_bf16 v[148:151], a[28:31], a[108:111], v[148:151]
    v_mfma_f32_16x16x32_bf16 v[152:155], a[28:31], a[112:115], v[152:155]
    v_mfma_f32_16x16x32_bf16 v[156:159], a[28:31], a[116:119], v[156:159]
    s_waitcnt vmcnt(40) lgkmcnt(10)
    s_barrier
    ds_read_b64_tr_b16 a[0:1], v6 offset:32768
    v_mfma_f32_16x16x32_bf16 v[160:163], a[32:35], a[104:107], v[160:163]
    buffer_load_dwordx4 v2, s[12:15], s30 offen offset:0 lds
    ds_read_b64_tr_b16 a[2:3], v6 offset:40960
    v_mfma_f32_16x16x32_bf16 v[164:167], a[32:35], a[108:111], v[164:167]
    ds_read_b64_tr_b16 a[4:5], v6 offset:33792
    ds_read_b64_tr_b16 a[6:7], v6 offset:41984
    v_mfma_f32_16x16x32_bf16 v[168:171], a[32:35], a[112:115], v[168:171]
    ds_read_b64_tr_b16 a[8:9], v7 offset:32768
    ds_read_b64_tr_b16 a[10:11], v7 offset:40960
    v_mfma_f32_16x16x32_bf16 v[172:175], a[32:35], a[116:119], v[172:175]
    s_waitcnt lgkmcnt(14)
    ds_read_b64_tr_b16 a[12:13], v7 offset:33792
    ds_read_b64_tr_b16 a[14:15], v7 offset:41984
    v_mfma_f32_16x16x32_bf16 v[176:179], a[36:39], a[104:107], v[176:179]
    ds_read_b64_tr_b16 a[16:17], v6 offset:33024
    ds_read_b64_tr_b16 a[18:19], v6 offset:41216
    v_mfma_f32_16x16x32_bf16 v[180:183], a[36:39], a[108:111], v[180:183]
    buffer_load_dwordx4 v2, s[16:19], s30 offen offset:1024 lds
    ds_read_b64_tr_b16 a[20:21], v6 offset:34048
    v_mfma_f32_16x16x32_bf16 v[184:187], a[36:39], a[112:115], v[184:187]
    ds_read_b64_tr_b16 a[22:23], v6 offset:42240
    ds_read_b64_tr_b16 a[24:25], v7 offset:33024
    v_mfma_f32_16x16x32_bf16 v[188:191], a[36:39], a[116:119], v[188:191]
    s_waitcnt lgkmcnt(15)
    ds_read_b64_tr_b16 a[26:27], v7 offset:41216
    ds_read_b64_tr_b16 a[28:29], v7 offset:34048
    v_mfma_f32_16x16x32_bf16 v[192:195], a[40:43], a[104:107], v[192:195]
    ds_read_b64_tr_b16 a[30:31], v7 offset:42240
    v_mfma_f32_16x16x32_bf16 v[196:199], a[40:43], a[108:111], v[196:199]
    s_load_dwordx2 s[100:101], s[0:1], 5948
    ds_read_b64_tr_b16 a[32:33], v6 offset:33280
    v_mfma_f32_16x16x32_bf16 v[200:203], a[40:43], a[112:115], v[200:203]
    buffer_load_dwordx4 v3, s[12:15], s30 offen offset:2048 lds
    ds_read_b64_tr_b16 a[34:35], v6 offset:41472
    v_mfma_f32_16x16x32_bf16 v[204:207], a[40:43], a[116:119], v[204:207]
    ds_read_b64_tr_b16 a[36:37], v6 offset:34304
    v_mfma_f32_16x16x32_bf16 v[208:211], a[44:47], a[104:107], v[208:211]
    ds_read_b64_tr_b16 a[38:39], v6 offset:42496
    v_mfma_f32_16x16x32_bf16 v[212:215], a[44:47], a[108:111], v[212:215]
    ds_read_b64_tr_b16 a[40:41], v7 offset:33280
    v_mfma_f32_16x16x32_bf16 v[216:219], a[44:47], a[112:115], v[216:219]
    ds_read_b64_tr_b16 a[42:43], v7 offset:41472
    v_mfma_f32_16x16x32_bf16 v[220:223], a[44:47], a[116:119], v[220:223]
    ds_read_b64_tr_b16 a[44:45], v7 offset:34304
    v_mfma_f32_16x16x32_bf16 v[224:227], a[48:51], a[104:107], v[224:227]
    buffer_load_dwordx4 v3, s[16:19], s30 offen offset:3072 lds
    v_mfma_f32_16x16x32_bf16 v[228:231], a[48:51], a[108:111], v[228:231]
    s_add_u32 m0, s32, 49152
    s_mov_b32 s30, 5275648
    ds_read_b64_tr_b16 a[46:47], v7 offset:42496
    v_mfma_f32_16x16x32_bf16 v[232:235], a[48:51], a[112:115], v[232:235]
    v_mfma_f32_16x16x32_bf16 v[236:239], a[48:51], a[116:119], v[236:239]
    s_waitcnt lgkmcnt(15)
    ds_read_b64_tr_b16 a[48:49], v6 offset:33536
    v_mfma_f32_16x16x32_bf16 v[240:243], a[52:55], a[104:107], v[240:243]
    ds_read_b64_tr_b16 a[50:51], v6 offset:41728
    v_mfma_f32_16x16x32_bf16 v[244:247], a[52:55], a[108:111], v[244:247]
    v_mfma_f32_16x16x32_bf16 v[248:251], a[52:55], a[112:115], v[248:251]
    buffer_load_dwordx4 v2, s[12:15], s30 offen offset:0 lds
    v_mfma_f32_16x16x32_bf16 v[252:255], a[52:55], a[116:119], v[252:255]
    s_waitcnt vmcnt(41)
    ds_read_b64_tr_b16 a[52:53], v6 offset:34560
    v_mfma_f32_16x16x32_bf16 v[32:35], a[0:3], a[120:123], v[32:35]
    ds_read_b64_tr_b16 a[54:55], v6 offset:42752
    v_mfma_f32_16x16x32_bf16 v[36:39], a[0:3], a[124:127], v[36:39]
    v_mfma_f32_16x16x32_bf16 v[40:43], a[0:3], a[128:131], v[40:43]
    s_load_dwordx2 s[100:101], s[0:1], 5820
    v_mfma_f32_16x16x32_bf16 v[44:47], a[0:3], a[132:135], v[44:47]
    ds_read_b64_tr_b16 a[0:1], v6 offset:49152
    v_mfma_f32_16x16x32_bf16 v[48:51], a[4:7], a[120:123], v[48:51]
    buffer_load_dwordx4 v2, s[16:19], s30 offen offset:1024 lds
    v_mfma_f32_16x16x32_bf16 v[52:55], a[4:7], a[124:127], v[52:55]
    ds_read_b64_tr_b16 a[2:3], v6 offset:57344
    v_mfma_f32_16x16x32_bf16 v[56:59], a[4:7], a[128:131], v[56:59]
    v_mfma_f32_16x16x32_bf16 v[60:63], a[4:7], a[132:135], v[60:63]
    ds_read_b64_tr_b16 a[4:5], v6 offset:50176
    v_mfma_f32_16x16x32_bf16 v[64:67], a[8:11], a[120:123], v[64:67]
    ds_read_b64_tr_b16 a[6:7], v6 offset:58368
    v_mfma_f32_16x16x32_bf16 v[68:71], a[8:11], a[124:127], v[68:71]
    v_mfma_f32_16x16x32_bf16 v[72:75], a[8:11], a[128:131], v[72:75]
    buffer_load_dwordx4 v3, s[12:15], s30 offen offset:2048 lds
    v_mfma_f32_16x16x32_bf16 v[76:79], a[8:11], a[132:135], v[76:79]
    ds_read_b64_tr_b16 a[8:9], v7 offset:49152
    v_mfma_f32_16x16x32_bf16 v[80:83], a[12:15], a[120:123], v[80:83]
    ds_read_b64_tr_b16 a[10:11], v7 offset:57344
    v_mfma_f32_16x16x32_bf16 v[84:87], a[12:15], a[124:127], v[84:87]
    v_mfma_f32_16x16x32_bf16 v[88:91], a[12:15], a[128:131], v[88:91]
    v_mfma_f32_16x16x32_bf16 v[92:95], a[12:15], a[132:135], v[92:95]
    s_waitcnt lgkmcnt(15)
    ds_read_b64_tr_b16 a[12:13], v7 offset:50176
    v_mfma_f32_16x16x32_bf16 v[96:99], a[16:19], a[120:123], v[96:99]
    buffer_load_dwordx4 v3, s[16:19], s30 offen offset:3072 lds
    v_mfma_f32_16x16x32_bf16 v[100:103], a[16:19], a[124:127], v[100:103]
    s_add_u32 m0, s32, 65536
    s_mov_b32 s30, 5505024
    ds_read_b64_tr_b16 a[14:15], v7 offset:58368
    v_mfma_f32_16x16x32_bf16 v[104:107], a[16:19], a[128:131], v[104:107]
    v_mfma_f32_16x16x32_bf16 v[108:111], a[16:19], a[132:135], v[108:111]
    ds_read_b64_tr_b16 a[16:17], v6 offset:49408
    v_mfma_f32_16x16x32_bf16 v[112:115], a[20:23], a[120:123], v[112:115]
    s_load_dwordx2 s[100:101], s[0:1], 5692
    ds_read_b64_tr_b16 a[18:19], v6 offset:57600
    v_mfma_f32_16x16x32_bf16 v[116:119], a[20:23], a[124:127], v[116:119]
    v_mfma_f32_16x16x32_bf16 v[120:123], a[20:23], a[128:131], v[120:123]
    buffer_load_dwordx4 a[224:227], v1, s[8:11], s31 offen offset:0 sc1
    v_mfma_f32_16x16x32_bf16 v[124:127], a[20:23], a[132:135], v[124:127]
    ds_read_b64_tr_b16 a[20:21], v6 offset:50432
    v_mfma_f32_16x16x32_bf16 v[128:131], a[24:27], a[120:123], v[128:131]
    ds_read_b64_tr_b16 a[22:23], v6 offset:58624
    v_mfma_f32_16x16x32_bf16 v[132:135], a[24:27], a[124:127], v[132:135]
    v_mfma_f32_16x16x32_bf16 v[136:139], a[24:27], a[128:131], v[136:139]
    v_mfma_f32_16x16x32_bf16 v[140:143], a[24:27], a[132:135], v[140:143]
    ds_read_b64_tr_b16 a[24:25], v7 offset:49408
    v_mfma_f32_16x16x32_bf16 v[144:147], a[28:31], a[120:123], v[144:147]
    buffer_load_dwordx4 a[228:231], v1, s[8:11], s31 offen offset:1024 sc1
    v_mfma_f32_16x16x32_bf16 v[148:151], a[28:31], a[124:127], v[148:151]
    ds_read_b64_tr_b16 a[26:27], v7 offset:57600
    v_mfma_f32_16x16x32_bf16 v[152:155], a[28:31], a[128:131], v[152:155]
    v_mfma_f32_16x16x32_bf16 v[156:159], a[28:31], a[132:135], v[156:159]
    ds_read_b64_tr_b16 a[28:29], v7 offset:50432
    v_mfma_f32_16x16x32_bf16 v[160:163], a[32:35], a[120:123], v[160:163]
    ds_read_b64_tr_b16 a[30:31], v7 offset:58624
    v_mfma_f32_16x16x32_bf16 v[164:167], a[32:35], a[124:127], v[164:167]
    v_mfma_f32_16x16x32_bf16 v[168:171], a[32:35], a[128:131], v[168:171]
    buffer_load_dwordx4 a[232:235], v1, s[8:11], s31 offen offset:2048 sc1
    v_mfma_f32_16x16x32_bf16 v[172:175], a[32:35], a[132:135], v[172:175]
    s_waitcnt lgkmcnt(15)
    ds_read_b64_tr_b16 a[32:33], v6 offset:49664
    v_mfma_f32_16x16x32_bf16 v[176:179], a[36:39], a[120:123], v[176:179]
    ds_read_b64_tr_b16 a[34:35], v6 offset:57856
    v_mfma_f32_16x16x32_bf16 v[180:183], a[36:39], a[124:127], v[180:183]
    v_mfma_f32_16x16x32_bf16 v[184:187], a[36:39], a[128:131], v[184:187]
    s_load_dwordx2 s[100:101], s[0:1], 5564
    v_mfma_f32_16x16x32_bf16 v[188:191], a[36:39], a[132:135], v[188:191]
    ds_read_b64_tr_b16 a[36:37], v6 offset:50688
    v_mfma_f32_16x16x32_bf16 v[192:195], a[40:43], a[120:123], v[192:195]
    buffer_load_dwordx4 a[236:239], v1, s[8:11], s31 offen offset:3072 sc1
    s_add_u32 s31, s31, 4096
    v_mfma_f32_16x16x32_bf16 v[196:199], a[40:43], a[124:127], v[196:199]
    ds_read_b64_tr_b16 a[38:39], v6 offset:58880
    v_mfma_f32_16x16x32_bf16 v[200:203], a[40:43], a[128:131], v[200:203]
    v_mfma_f32_16x16x32_bf16 v[204:207], a[40:43], a[132:135], v[204:207]
    ds_read_b64_tr_b16 a[40:41], v7 offset:49664
    v_mfma_f32_16x16x32_bf16 v[208:211], a[44:47], a[120:123], v[208:211]
    ds_read_b64_tr_b16 a[42:43], v7 offset:57856
    v_mfma_f32_16x16x32_bf16 v[212:215], a[44:47], a[124:127], v[212:215]
    v_mfma_f32_16x16x32_bf16 v[216:219], a[44:47], a[128:131], v[216:219]
    buffer_load_dwordx4 a[240:243], v1, s[8:11], s31 offen offset:0 sc1
    v_mfma_f32_16x16x32_bf16 v[220:223], a[44:47], a[132:135], v[220:223]
    ds_read_b64_tr_b16 a[44:45], v7 offset:50688
    v_mfma_f32_16x16x32_bf16 v[224:227], a[48:51], a[120:123], v[224:227]
    ds_read_b64_tr_b16 a[46:47], v7 offset:58880
    v_mfma_f32_16x16x32_bf16 v[228:231], a[48:51], a[124:127], v[228:231]
    v_mfma_f32_16x16x32_bf16 v[232:235], a[48:51], a[128:131], v[232:235]
    v_mfma_f32_16x16x32_bf16 v[236:239], a[48:51], a[132:135], v[236:239]
    ds_read_b64_tr_b16 a[48:49], v6 offset:49920
    v_mfma_f32_16x16x32_bf16 v[240:243], a[52:55], a[120:123], v[240:243]
    buffer_load_dwordx4 a[244:247], v1, s[8:11], s31 offen offset:1024 sc1
    v_mfma_f32_16x16x32_bf16 v[244:247], a[52:55], a[124:127], v[244:247]
    ds_read_b64_tr_b16 a[50:51], v6 offset:58112
    v_mfma_f32_16x16x32_bf16 v[248:251], a[52:55], a[128:131], v[248:251]
    v_mfma_f32_16x16x32_bf16 v[252:255], a[52:55], a[132:135], v[252:255]
    s_waitcnt vmcnt(46) lgkmcnt(15)
    ds_read_b64_tr_b16 a[52:53], v6 offset:50944
    v_mfma_f32_16x16x32_bf16 v[32:35], a[0:3], a[136:139], v[32:35]
    s_load_dwordx2 s[100:101], s[0:1], 5436
    ds_read_b64_tr_b16 a[54:55], v6 offset:59136
    v_mfma_f32_16x16x32_bf16 v[36:39], a[0:3], a[140:143], v[36:39]
    v_mfma_f32_16x16x32_bf16 v[40:43], a[0:3], a[144:147], v[40:43]
    buffer_load_dwordx4 a[248:251], v1, s[8:11], s31 offen offset:2048 sc1
    v_mfma_f32_16x16x32_bf16 v[44:47], a[0:3], a[148:151], v[44:47]
    v_mfma_f32_16x16x32_bf16 v[48:51], a[4:7], a[136:139], v[48:51]
    v_mfma_f32_16x16x32_bf16 v[52:55], a[4:7], a[140:143], v[52:55]
    v_mfma_f32_16x16x32_bf16 v[56:59], a[4:7], a[144:147], v[56:59]
    v_mfma_f32_16x16x32_bf16 v[60:63], a[4:7], a[148:151], v[60:63]
    v_mfma_f32_16x16x32_bf16 v[64:67], a[8:11], a[136:139], v[64:67]
    buffer_load_dwordx4 a[252:255], v1, s[8:11], s31 offen offset:3072 sc1
    s_add_u32 s31, s31, 4096
    v_mfma_f32_16x16x32_bf16 v[68:71], a[8:11], a[140:143], v[68:71]
    v_mfma_f32_16x16x32_bf16 v[72:75], a[8:11], a[144:147], v[72:75]
    v_mfma_f32_16x16x32_bf16 v[76:79], a[8:11], a[148:151], v[76:79]
    v_mfma_f32_16x16x32_bf16 v[80:83], a[12:15], a[136:139], v[80:83]
    v_mfma_f32_16x16x32_bf16 v[84:87], a[12:15], a[140:143], v[84:87]
    v_mfma_f32_16x16x32_bf16 v[88:91], a[12:15], a[144:147], v[88:91]
    buffer_load_dwordx4 v2, s[12:15], s30 offen offset:0 lds
    v_mfma_f32_16x16x32_bf16 v[92:95], a[12:15], a[148:151], v[92:95]
    v_mfma_f32_16x16x32_bf16 v[96:99], a[16:19], a[136:139], v[96:99]
    v_mfma_f32_16x16x32_bf16 v[100:103], a[16:19], a[140:143], v[100:103]
    v_mfma_f32_16x16x32_bf16 v[104:107], a[16:19], a[144:147], v[104:107]
    s_load_dwordx2 s[100:101], s[0:1], 5308
    v_mfma_f32_16x16x32_bf16 v[108:111], a[16:19], a[148:151], v[108:111]
    s_waitcnt lgkmcnt(15)
    v_mfma_f32_16x16x32_bf16 v[112:115], a[20:23], a[136:139], v[112:115]
    buffer_load_dwordx4 v2, s[16:19], s30 offen offset:1024 lds
    v_mfma_f32_16x16x32_bf16 v[116:119], a[20:23], a[140:143], v[116:119]
    v_mfma_f32_16x16x32_bf16 v[120:123], a[20:23], a[144:147], v[120:123]
    v_mfma_f32_16x16x32_bf16 v[124:127], a[20:23], a[148:151], v[124:127]
    s_waitcnt lgkmcnt(14)
    v_mfma_f32_16x16x32_bf16 v[128:131], a[24:27], a[136:139], v[128:131]
    v_mfma_f32_16x16x32_bf16 v[132:135], a[24:27], a[140:143], v[132:135]
    v_mfma_f32_16x16x32_bf16 v[136:139], a[24:27], a[144:147], v[136:139]
    buffer_load_dwordx4 v3, s[12:15], s30 offen offset:2048 lds
    v_mfma_f32_16x16x32_bf16 v[140:143], a[24:27], a[148:151], v[140:143]
    s_waitcnt lgkmcnt(12)
    v_mfma_f32_16x16x32_bf16 v[144:147], a[28:31], a[136:139], v[144:147]
    v_mfma_f32_16x16x32_bf16 v[148:151], a[28:31], a[140:143], v[148:151]
    v_mfma_f32_16x16x32_bf16 v[152:155], a[28:31], a[144:147], v[152:155]
    v_mfma_f32_16x16x32_bf16 v[156:159], a[28:31], a[148:151], v[156:159]
    s_waitcnt vmcnt(43) lgkmcnt(10)
    s_barrier
    ds_read_b64_tr_b16 a[0:1], v8 offset:0
    v_mfma_f32_16x16x32_bf16 v[160:163], a[32:35], a[136:139], v[160:163]
    buffer_load_dwordx4 v3, s[16:19], s30 offen offset:3072 lds
    ds_read_b64_tr_b16 a[2:3], v8 offset:8192
    v_mfma_f32_16x16x32_bf16 v[164:167], a[32:35], a[140:143], v[164:167]
    s_add_u32 m0, s32, 81920
    s_mov_b32 s30, 5734400
    ds_read_b64_tr_b16 a[4:5], v8 offset:1024
    v_mfma_f32_16x16x32_bf16 v[168:171], a[32:35], a[144:147], v[168:171]
    ds_read_b64_tr_b16 a[6:7], v8 offset:9216
    ds_read_b64_tr_b16 a[8:9], v9 offset:0
    v_mfma_f32_16x16x32_bf16 v[172:175], a[32:35], a[148:151], v[172:175]
    s_waitcnt lgkmcnt(13)
    ds_read_b64_tr_b16 a[10:11], v9 offset:8192
    ds_read_b64_tr_b16 a[12:13], v9 offset:1024
    v_mfma_f32_16x16x32_bf16 v[176:179], a[36:39], a[136:139], v[176:179]
    s_load_dwordx2 s[100:101], s[0:1], 5180
    ds_read_b64_tr_b16 a[14:15], v9 offset:9216
    ds_read_b64_tr_b16 a[16:17], v8 offset:256
    v_mfma_f32_16x16x32_bf16 v[180:183], a[36:39], a[140:143], v[180:183]
    buffer_load_dwordx4 a[56:59], v1, s[8:11], s31 offen offset:0 sc1
    ds_read_b64_tr_b16 a[18:19], v8 offset:8448
    v_mfma_f32_16x16x32_bf16 v[184:187], a[36:39], a[144:147], v[184:187]
    ds_read_b64_tr_b16 a[20:21], v8 offset:1280
    ds_read_b64_tr_b16 a[22:23], v8 offset:9472
    v_mfma_f32_16x16x32_bf16 v[188:191], a[36:39], a[148:151], v[188:191]
    s_waitcnt lgkmcnt(15)
    ds_read_b64_tr_b16 a[24:25], v9 offset:256
    ds_read_b64_tr_b16 a[26:27], v9 offset:8448
    v_mfma_f32_16x16x32_bf16 v[192:195], a[40:43], a[136:139], v[192:195]
    ds_read_b64_tr_b16 a[28:29], v9 offset:1280
    ds_read_b64_tr_b16 a[30:31], v9 offset:9472
    v_mfma_f32_16x16x32_bf16 v[196:199], a[40:43], a[140:143], v[196:199]
    ds_read_b64_tr_b16 a[32:33], v8 offset:512
    v_mfma_f32_16x16x32_bf16 v[200:203], a[40:43], a[144:147], v[200:203]
    buffer_load_dwordx4 a[60:63], v1, s[8:11], s31 offen offset:1024 sc1
    ds_read_b64_tr_b16 a[34:35], v8 offset:8704
    v_mfma_f32_16x16x32_bf16 v[204:207], a[40:43], a[148:151], v[204:207]
    ds_read_b64_tr_b16 a[36:37], v8 offset:1536
    v_mfma_f32_16x16x32_bf16 v[208:211], a[44:47], a[136:139], v[208:211]
    ds_read_b64_tr_b16 a[38:39], v8 offset:9728
    v_mfma_f32_16x16x32_bf16 v[212:215], a[44:47], a[140:143], v[212:215]
    ds_read_b64_tr_b16 a[40:41], v9 offset:512
    v_mfma_f32_16x16x32_bf16 v[216:219], a[44:47], a[144:147], v[216:219]
    ds_read_b64_tr_b16 a[42:43], v9 offset:8704
    v_mfma_f32_16x16x32_bf16 v[220:223], a[44:47], a[148:151], v[220:223]
    s_waitcnt lgkmcnt(15)
    ds_read_b64_tr_b16 a[44:45], v9 offset:1536
    v_mfma_f32_16x16x32_bf16 v[224:227], a[48:51], a[136:139], v[224:227]
    buffer_load_dwordx4 a[64:67], v1, s[8:11], s31 offen offset:2048 sc1
    v_mfma_f32_16x16x32_bf16 v[228:231], a[48:51], a[140:143], v[228:231]
    s_getpc_b64 s[88:89]
L_up_pc1:
    s_lshr_b32 s3, s2, 3
    s_lshl_b32 s3, s3, 2
    v_mfma_f32_16x16x32_bf16 v[232:235], a[48:51], a[144:147], v[232:235]
    s_add_u32 s3, s3, s28
    s_mul_i32 s3, s3, 384
    ds_read_b64_tr_b16 a[46:47], v9 offset:9728
    v_min_u32 v31, 2, v0
    v_lshlrev_b32 v31, 7, v31
    v_add_u32 v31, s3, v31
    v_min_u32 v31, L_code_end-L_up_pc1-4, v31
    v_mfma_f32_16x16x32_bf16 v[236:239], a[48:51], a[148:151], v[236:239]
    global_load_dword a184, v31, s[88:89]
    v_mfma_f32_16x16x32_bf16 v[240:243], a[52:55], a[136:139], v[240:243]
    ds_read_b64_tr_b16 a[48:49], v8 offset:768
    v_mfma_f32_16x16x32_bf16 v[244:247], a[52:55], a[140:143], v[244:247]
    ds_read_b64_tr_b16 a[50:51], v8 offset:8960
    v_mfma_f32_16x16x32_bf16 v[248:251], a[52:55], a[144:147], v[248:251]
    s_load_dwordx2 s[100:101], s[0:1], 5052
    v_mfma_f32_16x16x32_bf16 v[252:255], a[52:55], a[148:151], v[252:255]
    s_waitcnt vmcnt(44)
    ds_read_b64_tr_b16 a[52:53], v8 offset:1792
    v_mfma_f32_16x16x32_bf16 v[32:35], a[0:3], a[152:155], v[32:35]
    ds_read_b64_tr_b16 a[54:55], v8 offset:9984
    v_mfma_f32_16x16x32_bf16 v[36:39], a[0:3], a[156:159], v[36:39]
    buffer_load_dwordx4 a[68:71], v1, s[8:11], s31 offen offset:3072 sc1
    s_add_u32 s31, s31, 4096
    v_mfma_f32_16x16x32_bf16 v[40:43], a[0:3], a[160:163], v[40:43]
    v_mfma_f32_16x16x32_bf16 v[44:47], a[0:3], a[164:167], v[44:47]
    ds_read_b64_tr_b16 a[0:1], v8 offset:16384
    v_mfma_f32_16x16x32_bf16 v[48:51], a[4:7], a[152:155], v[48:51]
    ds_read_b64_tr_b16 a[2:3], v8 offset:24576
    v_mfma_f32_16x16x32_bf16 v[52:55], a[4:7], a[156:159], v[52:55]
    v_mfma_f32_16x16x32_bf16 v[56:59], a[4:7], a[160:163], v[56:59]
    v_mfma_f32_16x16x32_bf16 v[60:63], a[4:7], a[164:167], v[60:63]
    buffer_load_dwordx4 v2, s[12:15], s30 offen offset:0 lds
    v_mfma_f32_16x16x32_bf16 v[64:67], a[8:11], a[152:155], v[64:67]
    ds_read_b64_tr_b16 a[4:5], v8 offset:17408
    v_mfma_f32_16x16x32_bf16 v[68:71], a[8:11], a[156:159], v[68:71]
    ds_read_b64_tr_b16 a[6:7], v8 offset:25600
    v_mfma_f32_16x16x32_bf16 v[72:75], a[8:11], a[160:163], v[72:75]
    v_mfma_f32_16x16x32_bf16 v[76:79], a[8:11], a[164:167], v[76:79]
    s_waitcnt lgkmcnt(15)
    ds_read_b64_tr_b16 a[8:9], v9 offset:16384
    v_mfma_f32_16x16x32_bf16 v[80:83], a[12:15], a[152:155], v[80:83]
    ds_read_b64_tr_b16 a[10:11], v9 offset:24576
    v_mfma_f32_16x16x32_bf16 v[84:87], a[12:15], a[156:159], v[84:87]
    buffer_load_dwordx4 v2, s[16:19], s30 offen offset:1024 lds
    v_mfma_f32_16x16x32_bf16 v[88:91], a[12:15], a[160:163], v[88:91]
    v_mfma_f32_16x16x32_bf16 v[92:95], a[12:15], a[164:167], v[92:95]
    ds_read_b64_tr_b16 a[12:13], v9 offset:17408
    v_mfma_f32_16x16x32_bf16 v[96:99], a[16:19], a[152:155], v[96:99]
    s_load_dwordx2 s[100:101], s[0:1], 4924
    ds_read_b64_tr_b16 a[14:15], v9 offset:25600
    v_mfma_f32_16x16x32_bf16 v[100:103], a[16:19], a[156:159], v[100:103]
    v_mfma_f32_16x16x32_bf16 v[104:107], a[16:19], a[160:163], v[104:107]
    v_mfma_f32_16x16x32_bf16 v[108:111], a[16:19], a[164:167], v[108:111]
    buffer_load_dwordx4 v3, s[12:15], s30 offen offset:2048 lds
    v_mfma_f32_16x16x32_bf16 v[112:115], a[20:23], a[152:155], v[112:115]
    ds_read_b64_tr_b16 a[16:17], v8 offset:16640
    v_mfma_f32_16x16x32_bf16 v[116:119], a[20:23], a[156:159], v[116:119]
    ds_read_b64_tr_b16 a[18:19], v8 offset:24832
    v_mfma_f32_16x16x32_bf16 v[120:123], a[20:23], a[160:163], v[120:123]
    v_mfma_f32_16x16x32_bf16 v[124:127], a[20:23], a[164:167], v[124:127]
    ds_read_b64_tr_b16 a[20:21], v8 offset:17664
    v_mfma_f32_16x16x32_bf16 v[128:131], a[24:27], a[152:155], v[128:131]
    ds_read_b64_tr_b16 a[22:23], v8 offset:25856
    v_mfma_f32_16x16x32_bf16 v[132:135], a[24:27], a[156:159], v[132:135]
    buffer_load_dwordx4 v3, s[16:19], s30 offen offset:3072 lds
    v_mfma_f32_16x16x32_bf16 v[136:139], a[24:27], a[160:163], v[136:139]
    s_add_u32 m0, s32, 98304
    s_mov_b32 s30, 5963776
    v_mfma_f32_16x16x32_bf16 v[140:143], a[24:27], a[164:167], v[140:143]
    ds_read_b64_tr_b16 a[24:25], v9 offset:16640
    v_mfma_f32_16x16x32_bf16 v[144:147], a[28:31], a[152:155], v[144:147]
    ds_read_b64_tr_b16 a[26:27], v9 offset:24832
    v_mfma_f32_16x16x32_bf16 v[148:151], a[28:31], a[156:159], v[148:151]
    v_mfma_f32_16x16x32_bf16 v[152:155], a[28:31], a[160:163], v[152:155]
    v_mfma_f32_16x16x32_bf16 v[156:159], a[28:31], a[164:167], v[156:159]
    s_waitcnt lgkmcnt(15)
    ds_read_b64_tr_b16 a[28:29], v9 offset:17664
    v_mfma_f32_16x16x32_bf16 v[160:163], a[32:35], a[152:155], v[160:163]
    buffer_load_dwordx4 v2, s[12:15], s30 offen offset:0 lds
    v_mfma_f32_16x16x32_bf16 v[164:167], a[32:35], a[156:159], v[164:167]
    ds_read_b64_tr_b16 a[30:31], v9 offset:25856
    v_mfma_f32_16x16x32_bf16 v[168:171], a[32:35], a[160:163], v[168:171]
    s_load_dwordx2 s[100:101], s[0:1], 4796
    v_mfma_f32_16x16x32_bf16 v[172:175], a[32:35], a[164:167], v[172:175]
    ds_read_b64_tr_b16 a[32:33], v8 offset:16896
    v_mfma_f32_16x16x32_bf16 v[176:179], a[36:39], a[152:155], v[176:179]
    ds_read_b64_tr_b16 a[34:35], v8 offset:25088
    v_mfma_f32_16x16x32_bf16 v[180:183], a[36:39], a[156:159], v[180:183]
    v_mfma_f32_16x16x32_bf16 v[184:187], a[36:39], a[160:163], v[184:187]
    buffer_load_dwordx4 v2, s[16:19], s30 offen offset:1024 lds
    v_mfma_f32_16x16x32_bf16 v[188:191], a[36:39], a[164:167], v[188:191]
    ds_read_b64_tr_b16 a[36:37], v8 offset:17920
    v_mfma_f32_16x16x32_bf16 v[192:195], a[40:43], a[152:155], v[192:195]
    ds_read_b64_tr_b16 a[38:39], v8 offset:26112
    v_mfma_f32_16x16x32_bf16 v[196:199], a[40:43], a[156:159], v[196:199]
    v_mfma_f32_16x16x32_bf16 v[200:203], a[40:43], a[160:163], v[200:203]
    v_mfma_f32_16x16x32_bf16 v[204:207], a[40:43], a[164:167], v[204:207]
    ds_read_b64_tr_b16 a[40:41], v9 offset:16896
    v_mfma_f32_16x16x32_bf16 v[208:211], a[44:47], a[152:155], v[208:211]
    buffer_load_dwordx4 v3, s[12:15], s30 offen offset:2048 lds
    v_mfma_f32_16x16x32_bf16 v[212:215], a[44:47], a[156:159], v[212:215]
    ds_read_b64_tr_b16 a[42:43], v9 offset:25088
    v_mfma_f32_16x16x32_bf16 v[216:219], a[44:47], a[160:163], v[216:219]
    v_mfma_f32_16x16x32_bf16 v[220:223], a[44:47], a[164:167], v[220:223]
    ds_read_b64_tr_b16 a[44:45], v9 offset:17920
    v_mfma_f32_16x16x32_bf16 v[224:227], a[48:51], a[152:155], v[224:227]
    ds_read_b64_tr_b16 a[46:47], v9 offset:26112
    v_mfma_f32_16x16x32_bf16 v[228:231], a[48:51], a[156:159], v[228:231]
    v_mfma_f32_16x16x32_bf16 v[232:235], a[48:51], a[160:163], v[232:235]
    buffer_load_dwordx4 v3, s[16:19], s30 offen offset:3072 lds
    v_mfma_f32_16x16x32_bf16 v[236:239], a[48:51], a[164:167], v[236:239]
    s_waitcnt lgkmcnt(15)
    s_add_u32 m0, s32, 114688
    s_mov_b32 s30, 6193152
    v_mfma_f32_16x16x32_bf16 v[240:243], a[52:55], a[152:155], v[240:243]
    s_load_dwordx2 s[100:101], s[0:1], 4668
    ds_read_b64_tr_b16 a[48:49], v8 offset:17152
    v_mfma_f32_16x16x32_bf16 v[244:247], a[52:55], a[156:159], v[244:247]
    ds_read_b64_tr_b16 a[50:51], v8 offset:25344
    v_mfma_f32_16x16x32_bf16 v[248:251], a[52:55], a[160:163], v[248:251]
    v_mfma_f32_16x16x32_bf16 v[252:255], a[52:55], a[164:167], v[252:255]
    s_waitcnt vmcnt(49)
    ds_read_b64_tr_b16 a[52:53], v8 offset:18176
    v_mfma_f32_16x16x32_bf16 v[32:35], a[0:3], a[168:171], v[32:35]
    buffer_load_dwordx4 a[72:75], v1, s[8:11], s31 offen offset:0 sc1
    v_mfma_f32_16x16x32_bf16 v[36:39], a[0:3], a[172:175], v[36:39]
    ds_read_b64_tr_b16 a[54:55], v8 offset:26368
    v_mfma_f32_16x16x32_bf16 v[40:43], a[0:3], a[176:179], v[40:43]
    v_mfma_f32_16x16x32_bf16 v[44:47], a[0:3], a[180:183], v[44:47]
    v_mfma_f32_16x16x32_bf16 v[48:51], a[4:7], a[168:171], v[48:51]
    v_mfma_f32_16x16x32_bf16 v[52:55], a[4:7], a[172:175], v[52:55]
    v_mfma_f32_16x16x32_bf16 v[56:59], a[4:7], a[176:179], v[56:59]
    buffer_load_dwordx4 a[76:79], v1, s[8:11], s31 offen offset:1024 sc1
    v_mfma_f32_16x16x32_bf16 v[60:63], a[4:7], a[180:183], v[60:63]
    v_mfma_f32_16x16x32_bf16 v[64:67], a[8:11], a[168:171], v[64:67]
    v_mfma_f32_16x16x32_bf16 v[68:71], a[8:11], a[172:175], v[68:71]
    v_mfma_f32_16x16x32_bf16 v[72:75], a[8:11], a[176:179], v[72:75]
    v_mfma_f32_16x16x32_bf16 v[76:79], a[8:11], a[180:183], v[76:79]
    v_mfma_f32_16x16x32_bf16 v[80:83], a[12:15], a[168:171], v[80:83]
    buffer_load_dwordx4 a[80:83], v1, s[8:11], s31 offen offset:2048 sc1
    v_mfma_f32_16x16x32_bf16 v[84:87], a[12:15], a[172:175], v[84:87]
    s_load_dwordx2 s[100:101], s[0:1], 4540
    v_mfma_f32_16x16x32_bf16 v[88:91], a[12:15], a[176:179], v[88:91]
    v_mfma_f32_16x16x32_bf16 v[92:95], a[12:15], a[180:183], v[92:95]
    s_waitcnt lgkmcnt(15)
    v_mfma_f32_16x16x32_bf16 v[96:99], a[16:19], a[168:171], v[96:99]
    v_mfma_f32_16x16x32_bf16 v[100:103], a[16:19], a[172:175], v[100:103]
    v_mfma_f32_16x16x32_bf16 v[104:107], a[16:19], a[176:179], v[104:107]
    buffer_load_dwordx4 a[84:87], v1, s[8:11], s31 offen offset:3072 sc1
    s_add_u32 s31, s31, 4096
    v_mfma_f32_16x16x32_bf16 v[108:111], a[16:19], a[180:183], v[108:111]
    v_mfma_f32_16x16x32_bf16 v[112:115], a[20:23], a[168:171], v[112:115]
    v_mfma_f32_16x16x32_bf16 v[116:119], a[20:23], a[172:175], v[116:119]
    v_mfma_f32_16x16x32_bf16 v[120:123], a[20:23], a[176:179], v[120:123]
    v_mfma_f32_16x16x32_bf16 v[124:127], a[20:23], a[180:183], v[124:127]
    s_waitcnt lgkmcnt(14)
    v_mfma_f32_16x16x32_bf16 v[128:131], a[24:27], a[168:171], v[128:131]
    buffer_load_dwordx4 a[88:91], v1, s[8:11], s31 offen offset:0 sc1
    v_mfma_f32_16x16x32_bf16 v[132:135], a[24:27], a[172:175], v[132:135]
    v_mfma_f32_16x16x32_bf16 v[136:139], a[24:27], a[176:179], v[136:139]
    v_mfma_f32_16x16x32_bf16 v[140:143], a[24:27], a[180:183], v[140:143]
    s_waitcnt lgkmcnt(12)
    v_mfma_f32_16x16x32_bf16 v[144:147], a[28:31], a[168:171], v[144:147]
    v_mfma_f32_16x16x32_bf16 v[148:151], a[28:31], a[172:175], v[148:151]
    v_mfma_f32_16x16x32_bf16 v[152:155], a[28:31], a[176:179], v[152:155]
    buffer_load_dwordx4 a[92:95], v1, s[8:11], s31 offen offset:1024 sc1
    v_mfma_f32_16x16x32_bf16 v[156:159], a[28:31], a[180:183], v[156:159]
    s_waitcnt vmcnt(47) lgkmcnt(10)
    s_barrier
    s_load_dwordx2 s[100:101], s[0:1], 4412
    ds_read_b64_tr_b16 a[0:1], v4 offset:0
    v_mfma_f32_16x16x32_bf16 v[160:163], a[32:35], a[168:171], v[160:163]
    ds_read_b64_tr_b16 a[2:3], v4 offset:8192
    ds_read_b64_tr_b16 a[4:5], v4 offset:1024
    v_mfma_f32_16x16x32_bf16 v[164:167], a[32:35], a[172:175], v[164:167]
    ds_read_b64_tr_b16 a[6:7], v4 offset:9216
    ds_read_b64_tr_b16 a[8:9], v5 offset:0
    v_mfma_f32_16x16x32_bf16 v[168:171], a[32:35], a[176:179], v[168:171]
    ds_read_b64_tr_b16 a[10:11], v5 offset:8192
    ds_read_b64_tr_b16 a[12:13], v5 offset:1024
    v_mfma_f32_16x16x32_bf16 v[172:175], a[32:35], a[180:183], v[172:175]
    s_waitcnt lgkmcnt(15)
    ds_read_b64_tr_b16 a[14:15], v5 offset:9216
    ds_read_b64_tr_b16 a[16:17], v4 offset:256
    v_mfma_f32_16x16x32_bf16 v[176:179], a[36:39], a[168:171], v[176:179]
    buffer_load_dwordx4 v2, s[12:15], s30 offen offset:0 lds
    ds_read_b64_tr_b16 a[18:19], v4 offset:8448
    v_mfma_f32_16x16x32_bf16 v[180:183], a[36:39], a[172:175], v[180:183]
    ds_read_b64_tr_b16 a[20:21], v4 offset:1280
    ds_read_b64_tr_b16 a[22:23], v4 offset:9472
    v_mfma_f32_16x16x32_bf16 v[184:187], a[36:39], a[176:179], v[184:187]
    ds_read_b64_tr_b16 a[24:25], v5 offset:256
    ds_read_b64_tr_b16 a[26:27], v5 offset:8448
    v_mfma_f32_16x16x32_bf16 v[188:191], a[36:39], a[180:183], v[188:191]
    s_waitcnt lgkmcnt(15)
    ds_read_b64_tr_b16 a[28:29], v5 offset:1280
    ds_read_b64_tr_b16 a[30:31], v5 offset:9472
    v_mfma_f32_16x16x32_bf16 v[192:195], a[40:43], a[168:171], v[192:195]
    ds_read_b64_tr_b16 a[32:33], v4 offset:512
    v_mfma_f32_16x16x32_bf16 v[196:199], a[40:43], a[172:175], v[196:199]
    buffer_load_dwordx4 v2, s[16:19], s30 offen offset:1024 lds
    v_mfma_f32_16x16x32_bf16 v[200:203], a[40:43], a[176:179], v[200:203]
    ds_read_b64_tr_b16 a[34:35], v4 offset:8704
    v_mfma_f32_16x16x32_bf16 v[204:207], a[40:43], a[180:183], v[204:207]
    ds_read_b64_tr_b16 a[36:37], v4 offset:1536
    v_mfma_f32_16x16x32_bf16 v[208:211], a[44:47], a[168:171], v[208:211]
    ds_read_b64_tr_b16 a[38:39], v4 offset:9728
    v_mfma_f32_16x16x32_bf16 v[212:215], a[44:47], a[172:175], v[212:215]
    ds_read_b64_tr_b16 a[40:41], v5 offset:512
    v_mfma_f32_16x16x32_bf16 v[216:219], a[44:47], a[176:179], v[216:219]
    ds_read_b64_tr_b16 a[42:43], v5 offset:8704
    v_mfma_f32_16x16x32_bf16 v[220:223], a[44:47], a[180:183], v[220:223]
    buffer_load_dwordx4 v3, s[12:15], s30 offen offset:2048 lds
    v_mfma_f32_16x16x32_bf16 v[224:227], a[48:51], a[168:171], v[224:227]
    ds_read_b64_tr_b16 a[44:45], v5 offset:1536
    v_mfma_f32_16x16x32_bf16 v[228:231], a[48:51], a[172:175], v[228:231]
    s_load_dwordx2 s[100:101], s[0:1], 4284
    ds_read_b64_tr_b16 a[46:47], v5 offset:9728
    v_mfma_f32_16x16x32_bf16 v[232:235], a[48:51], a[176:179], v[232:235]
    v_mfma_f32_16x16x32_bf16 v[236:239], a[48:51], a[180:183], v[236:239]
    s_waitcnt lgkmcnt(15)
    ds_read_b64_tr_b16 a[48:49], v4 offset:768
    v_mfma_f32_16x16x32_bf16 v[240:243], a[52:55], a[168:171], v[240:243]
    ds_read_b64_tr_b16 a[50:51], v4 offset:8960
    v_mfma_f32_16x16x32_bf16 v[244:247], a[52:55], a[172:175], v[244:247]
    buffer_load_dwordx4 v3, s[16:19], s30 offen offset:3072 lds
    v_mfma_f32_16x16x32_bf16 v[248:251], a[52:55], a[176:179], v[248:251]
    s_add_u32 m0, s32, 131072
    s_mov_b32 s30, 6422528
    v_mfma_f32_16x16x32_bf16 v[252:255], a[52:55], a[180:183], v[252:255]
    s_waitcnt vmcnt(47)
    ds_read_b64_tr_b16 a[52:53], v4 offset:1792
    v_mfma_f32_16x16x32_bf16 v[32:35], a[0:3], a[192:195], v[32:35]
    ds_read_b64_tr_b16 a[54:55], v4 offset:9984
    v_mfma_f32_16x16x32_bf16 v[36:39], a[0:3], a[196:199], v[36:39]
    v_mfma_f32_16x16x32_bf16 v[40:43], a[0:3], a[200:203], v[40:43]
    v_mfma_f32_16x16x32_bf16 v[44:47], a[0:3], a[204:207], v[44:47]
    buffer_load_dwordx4 v2, s[12:15], s30 offen offset:0 lds
    v_mfma_f32_16x16x32_bf16 v[48:51], a[4:7], a[192:195], v[48:51]
    ds_read_b64_tr_b16 a[0:1], v4 offset:16384
    v_mfma_f32_16x16x32_bf16 v[52:55], a[4:7], a[196:199], v[52:55]
    ds_read_b64_tr_b16 a[2:3], v4 offset:24576
    v_mfma_f32_16x16x32_bf16 v[56:59], a[4:7], a[200:203], v[56:59]
    v_mfma_f32_16x16x32_bf16 v[60:63], a[4:7], a[204:207], v[60:63]
    ds_read_b64_tr_b16 a[4:5], v4 offset:17408
    v_mfma_f32_16x16x32_bf16 v[64:67], a[8:11], a[192:195], v[64:67]
    ds_read_b64_tr_b16 a[6:7], v4 offset:25600
    v_mfma_f32_16x16x32_bf16 v[68:71], a[8:11], a[196:199], v[68:71]
    buffer_load_dwordx4 v2, s[16:19], s30 offen offset:1024 lds
    v_mfma_f32_16x16x32_bf16 v[72:75], a[8:11], a[200:203], v[72:75]
    v_mfma_f32_16x16x32_bf16 v[76:79], a[8:11], a[204:207], v[76:79]
    s_load_dwordx2 s[100:101], s[0:1], 4156
    ds_read_b64_tr_b16 a[8:9], v5 offset:16384
    v_mfma_f32_16x16x32_bf16 v[80:83], a[12:15], a[192:195], v[80:83]
    ds_read_b64_tr_b16 a[10:11], v5 offset:24576
    v_mfma_f32_16x16x32_bf16 v[84:87], a[12:15], a[196:199], v[84:87]
    v_mfma_f32_16x16x32_bf16 v[88:91], a[12:15], a[200:203], v[88:91]
    v_mfma_f32_16x16x32_bf16 v[92:95], a[12:15], a[204:207], v[92:95]
    s_waitcnt lgkmcnt(15)
    ds_read_b64_tr_b16 a[12:13], v5 offset:17408
    v_mfma_f32_16x16x32_bf16 v[96:99], a[16:19], a[192:195], v[96:99]
    buffer_load_dwordx4 v3, s[12:15], s30 offen offset:2048 lds
    v_mfma_f32_16x16x32_bf16 v[100:103], a[16:19], a[196:199], v[100:103]
    ds_read_b64_tr_b16 a[14:15], v5 offset:25600
    v_mfma_f32_16x16x32_bf16 v[104:107], a[16:19], a[200:203], v[104:107]
    v_mfma_f32_16x16x32_bf16 v[108:111], a[16:19], a[204:207], v[108:111]
    ds_read_b64_tr_b16 a[16:17], v4 offset:16640
    v_mfma_f32_16x16x32_bf16 v[112:115], a[20:23], a[192:195], v[112:115]
    ds_read_b64_tr_b16 a[18:19], v4 offset:24832
    v_mfma_f32_16x16x32_bf16 v[116:119], a[20:23], a[196:199], v[116:119]
    v_mfma_f32_16x16x32_bf16 v[120:123], a[20:23], a[200:203], v[120:123]
    buffer_load_dwordx4 v3, s[16:19], s30 offen offset:3072 lds
    v_mfma_f32_16x16x32_bf16 v[124:127], a[20:23], a[204:207], v[124:127]
    s_add_u32 m0, s32, 147456
    s_mov_b32 s30, 6651904
    ds_read_b64_tr_b16 a[20:21], v4 offset:17664
    v_mfma_f32_16x16x32_bf16 v[128:131], a[24:27], a[192:195], v[128:131]
    ds_read_b64_tr_b16 a[22:23], v4 offset:25856
    v_mfma_f32_16x16x32_bf16 v[132:135], a[24:27], a[196:199], v[132:135]
    v_mfma_f32_16x16x32_bf16 v[136:139], a[24:27], a[200:203], v[136:139]
    v_mfma_f32_16x16x32_bf16 v[140:143], a[24:27], a[204:207], v[140:143]
    ds_read_b64_tr_b16 a[24:25], v5 offset:16640
    v_mfma_f32_16x16x32_bf16 v[144:147], a[28:31], a[192:195], v[144:147]
    buffer_load_dwordx4 a[96:99], v1, s[8:11], s31 offen offset:2048 sc1
    v_mfma_f32_16x16x32_bf16 v[148:151], a[28:31], a[196:199], v[148:151]
    s_load_dwordx2 s[100:101], s[0:1], 4028
    ds_read_b64_tr_b16 a[26:27], v5 offset:24832
    v_mfma_f32_16x16x32_bf16 v[152:155], a[28:31], a[200:203], v[152:155]
    v_mfma_f32_16x16x32_bf16 v[156:159], a[28:31], a[204:207], v[156:159]
    ds_read_b64_tr_b16 a[28:29], v5 offset:17664
    v_mfma_f32_16x16x32_bf16 v[160:163], a[32:35], a[192:195], v[160:163]
    ds_read_b64_tr_b16 a[30:31], v5 offset:25856
    v_mfma_f32_16x16x32_bf16 v[164:167], a[32:35], a[196:199], v[164:167]
    v_mfma_f32_16x16x32_bf16 v[168:171], a[32:35], a[200:203], v[168:171]
    buffer_load_dwordx4 a[100:103], v1, s[8:11], s31 offen offset:3072 sc1
    s_add_u32 s31, s31, 4096
    v_mfma_f32_16x16x32_bf16 v[172:175], a[32:35], a[204:207], v[172:175]
    s_waitcnt lgkmcnt(15)
    ds_read_b64_tr_b16 a[32:33], v4 offset:16896
    v_mfma_f32_16x16x32_bf16 v[176:179], a[36:39], a[192:195], v[176:179]
    ds_read_b64_tr_b16 a[34:35], v4 offset:25088
    v_mfma_f32_16x16x32_bf16 v[180:183], a[36:39], a[196:199], v[180:183]
    v_mfma_f32_16x16x32_bf16 v[184:187], a[36:39], a[200:203], v[184:187]
    v_mfma_f32_16x16x32_bf16 v[188:191], a[36:39], a[204:207], v[188:191]
    ds_read_b64_tr_b16 a[36:37], v4 offset:17920
    v_mfma_f32_16x16x32_bf16 v[192:195], a[40:43], a[192:195], v[192:195]
    buffer_load_dwordx4 a[104:107], v1, s[8:11], s31 offen offset:0 sc1
    v_mfma_f32_16x16x32_bf16 v[196:199], a[40:43], a[196:199], v[196:199]
    ds_read_b64_tr_b16 a[38:39], v4 offset:26112
    v_mfma_f32_16x16x32_bf16 v[200:203], a[40:43], a[200:203], v[200:203]
    v_mfma_f32_16x16x32_bf16 v[204:207], a[40:43], a[204:207], v[204:207]
    ds_read_b64_tr_b16 a[40:41], v5 offset:16896
    v_mfma_f32_16x16x32_bf16 v[208:211], a[44:47], a[192:195], v[208:211]
    ds_read_b64_tr_b16 a[42:43], v5 offset:25088
    v_mfma_f32_16x16x32_bf16 v[212:215], a[44:47], a[196:199], v[212:215]
    v_mfma_f32_16x16x32_bf16 v[216:219], a[44:47], a[200:203], v[216:219]
    buffer_load_dwordx4 a[108:111], v1, s[8:11], s31 offen offset:1024 sc1
    v_mfma_f32_16x16x32_bf16 v[220:223], a[44:47], a[204:207], v[220:223]
    s_load_dwordx2 s[100:101], s[0:1], 3900
    ds_read_b64_tr_b16 a[44:45], v5 offset:17920
    v_mfma_f32_16x16x32_bf16 v[224:227], a[48:51], a[192:195], v[224:227]
    ds_read_b64_tr_b16 a[46:47], v5 offset:26112
    v_mfma_f32_16x16x32_bf16 v[228:231], a[48:51], a[196:199], v[228:231]
    v_mfma_f32_16x16x32_bf16 v[232:235], a[48:51], a[200:203], v[232:235]
    v_mfma_f32_16x16x32_bf16 v[236:239], a[48:51], a[204:207], v[236:239]
    ds_read_b64_tr_b16 a[48:49], v4 offset:17152
    v_mfma_f32_16x16x32_bf16 v[240:243], a[52:55], a[192:195], v[240:243]
    buffer_load_dwordx4 a[112:115], v1, s[8:11], s31 offen offset:2048 sc1
    v_mfma_f32_16x16x32_bf16 v[244:247], a[52:55], a[196:199], v[244:247]
    ds_read_b64_tr_b16 a[50:51], v4 offset:25344
    v_mfma_f32_16x16x32_bf16 v[248:251], a[52:55], a[200:203], v[248:251]
    v_mfma_f32_16x16x32_bf16 v[252:255], a[52:55], a[204:207], v[252:255]
    s_waitcnt vmcnt(52) lgkmcnt(15)
    ds_read_b64_tr_b16 a[52:53], v4 offset:18176
    v_mfma_f32_16x16x32_bf16 v[32:35], a[0:3], a[208:211], v[32:35]
    ds_read_b64_tr_b16 a[54:55], v4 offset:26368
    v_mfma_f32_16x16x32_bf16 v[36:39], a[0:3], a[212:215], v[36:39]
    v_mfma_f32_16x16x32_bf16 v[40:43], a[0:3], a[216:219], v[40:43]
    buffer_load_dwordx4 a[116:119], v1, s[8:11], s31 offen offset:3072 sc1
    s_add_u32 s31, s31, 4096
    v_mfma_f32_16x16x32_bf16 v[44:47], a[0:3], a[220:223], v[44:47]
    v_mfma_f32_16x16x32_bf16 v[48:51], a[4:7], a[208:211], v[48:51]
    v_mfma_f32_16x16x32_bf16 v[52:55], a[4:7], a[212:215], v[52:55]
    v_mfma_f32_16x16x32_bf16 v[56:59], a[4:7], a[216:219], v[56:59]
    v_mfma_f32_16x16x32_bf16 v[60:63], a[4:7], a[220:223], v[60:63]
    v_mfma_f32_16x16x32_bf16 v[64:67], a[8:11], a[208:211], v[64:67]
    buffer_load_dwordx4 a[120:123], v1, s[8:11], s31 offen offset:0 sc1
    v_mfma_f32_16x16x32_bf16 v[68:71], a[8:11], a[212:215], v[68:71]
    s_load_dwordx2 s[100:101], s[0:1], 3772
    v_mfma_f32_16x16x32_bf16 v[72:75], a[8:11], a[216:219], v[72:75]
    v_mfma_f32_16x16x32_bf16 v[76:79], a[8:11], a[220:223], v[76:79]
    v_mfma_f32_16x16x32_bf16 v[80:83], a[12:15], a[208:211], v[80:83]
    v_mfma_f32_16x16x32_bf16 v[84:87], a[12:15], a[212:215], v[84:87]
    v_mfma_f32_16x16x32_bf16 v[88:91], a[12:15], a[216:219], v[88:91]
    buffer_load_dwordx4 a[124:127], v1, s[8:11], s31 offen offset:1024 sc1
    v_mfma_f32_16x16x32_bf16 v[92:95], a[12:15], a[220:223], v[92:95]
    v_mfma_f32_16x16x32_bf16 v[96:99], a[16:19], a[208:211], v[96:99]
    v_mfma_f32_16x16x32_bf16 v[100:103], a[16:19], a[212:215], v[100:103]
    v_mfma_f32_16x16x32_bf16 v[104:107], a[16:19], a[216:219], v[104:107]
    v_mfma_f32_16x16x32_bf16 v[108:111], a[16:19], a[220:223], v[108:111]
    s_waitcnt lgkmcnt(15)
    v_mfma_f32_16x16x32_bf16 v[112:115], a[20:23], a[208:211], v[112:115]
    buffer_load_dwordx4 a[128:131], v1, s[8:11], s31 offen offset:2048 sc1
    v_mfma_f32_16x16x32_bf16 v[116:119], a[20:23], a[212:215], v[116:119]
    v_mfma_f32_16x16x32_bf16 v[120:123], a[20:23], a[216:219], v[120:123]
    v_mfma_f32_16x16x32_bf16 v[124:127], a[20:23], a[220:223], v[124:127]
    s_waitcnt lgkmcnt(14)
    v_mfma_f32_16x16x32_bf16 v[128:131], a[24:27], a[208:211], v[128:131]
    v_mfma_f32_16x16x32_bf16 v[132:135], a[24:27], a[212:215], v[132:135]
    v_mfma_f32_16x16x32_bf16 v[136:139], a[24:27], a[216:219], v[136:139]
    buffer_load_dwordx4 a[132:135], v1, s[8:11], s31 offen offset:3072 sc1
    s_add_u32 s31, s31, 4096
    v_mfma_f32_16x16x32_bf16 v[140:143], a[24:27], a[220:223], v[140:143]
    s_waitcnt lgkmcnt(12)
    s_load_dwordx2 s[100:101], s[0:1], 3644
    v_mfma_f32_16x16x32_bf16 v[144:147], a[28:31], a[208:211], v[144:147]
    v_mfma_f32_16x16x32_bf16 v[148:151], a[28:31], a[212:215], v[148:151]
    v_mfma_f32_16x16x32_bf16 v[152:155], a[28:31], a[216:219], v[152:155]
    v_mfma_f32_16x16x32_bf16 v[156:159], a[28:31], a[220:223], v[156:159]
    s_waitcnt vmcnt(49) lgkmcnt(10)
    s_barrier
    ds_read_b64_tr_b16 a[0:1], v4 offset:32768
    v_mfma_f32_16x16x32_bf16 v[160:163], a[32:35], a[208:211], v[160:163]
    buffer_load_dwordx4 v2, s[12:15], s30 offen offset:0 lds
    ds_read_b64_tr_b16 a[2:3], v4 offset:40960
    v_mfma_f32_16x16x32_bf16 v[164:167], a[32:35], a[212:215], v[164:167]
    ds_read_b64_tr_b16 a[4:5], v4 offset:33792
    ds_read_b64_tr_b16 a[6:7], v4 offset:41984
    v_mfma_f32_16x16x32_bf16 v[168:171], a[32:35], a[216:219], v[168:171]
    ds_read_b64_tr_b16 a[8:9], v5 offset:32768
    ds_read_b64_tr_b16 a[10:11], v5 offset:40960
    v_mfma_f32_16x16x32_bf16 v[172:175], a[32:35], a[220:223], v[172:175]
    s_waitcnt lgkmcnt(14)
    ds_read_b64_tr_b16 a[12:13], v5 offset:33792
    ds_read_b64_tr_b16 a[14:15], v5 offset:41984
    v_mfma_f32_16x16x32_bf16 v[176:179], a[36:39], a[208:211], v[176:179]
    ds_read_b64_tr_b16 a[16:17], v4 offset:33024
    ds_read_b64_tr_b16 a[18:19], v4 offset:41216
    v_mfma_f32_16x16x32_bf16 v[180:183], a[36:39], a[212:215], v[180:183]
    buffer_load_dwordx4 v2, s[16:19], s30 offen offset:1024 lds
    ds_read_b64_tr_b16 a[20:21], v4 offset:34048
    v_mfma_f32_16x16x32_bf16 v[184:187], a[36:39], a[216:219], v[184:187]
    ds_read_b64_tr_b16 a[22:23], v4 offset:42240
    ds_read_b64_tr_b16 a[24:25], v5 offset:33024
    v_mfma_f32_16x16x32_bf16 v[188:191], a[36:39], a[220:223], v[188:191]
    s_waitcnt lgkmcnt(15)
    ds_read_b64_tr_b16 a[26:27], v5 offset:41216
    ds_read_b64_tr_b16 a[28:29], v5 offset:34048
    v_mfma_f32_16x16x32_bf16 v[192:195], a[40:43], a[208:211], v[192:195]
    ds_read_b64_tr_b16 a[30:31], v5 offset:42240
    v_mfma_f32_16x16x32_bf16 v[196:199], a[40:43], a[212:215], v[196:199]
    ds_read_b64_tr_b16 a[32:33], v4 offset:33280
    v_mfma_f32_16x16x32_bf16 v[200:203], a[40:43], a[216:219], v[200:203]
    buffer_load_dwordx4 v3, s[12:15], s30 offen offset:2048 lds
    ds_read_b64_tr_b16 a[34:35], v4 offset:41472
    v_mfma_f32_16x16x32_bf16 v[204:207], a[40:43], a[220:223], v[204:207]
    ds_read_b64_tr_b16 a[36:37], v4 offset:34304
    v_mfma_f32_16x16x32_bf16 v[208:211], a[44:47], a[208:211], v[208:211]
    ds_read_b64_tr_b16 a[38:39], v4 offset:42496
    v_mfma_f32_16x16x32_bf16 v[212:215], a[44:47], a[212:215], v[212:215]
    s_load_dwordx2 s[100:101], s[0:1], 3516
    ds_read_b64_tr_b16 a[40:41], v5 offset:33280
    v_mfma_f32_16x16x32_bf16 v[216:219], a[44:47], a[216:219], v[216:219]
    ds_read_b64_tr_b16 a[42:43], v5 offset:41472
    v_mfma_f32_16x16x32_bf16 v[220:223], a[44:47], a[220:223], v[220:223]
    ds_read_b64_tr_b16 a[44:45], v5 offset:34304
    v_mfma_f32_16x16x32_bf16 v[224:227], a[48:51], a[208:211], v[224:227]
    buffer_load_dwordx4 v3, s[16:19], s30 offen offset:3072 lds
    v_mfma_f32_16x16x32_bf16 v[228:231], a[48:51], a[212:215], v[228:231]
    s_add_u32 m0, s32, 0
    s_mov_b32 s30, 6881280
    ds_read_b64_tr_b16 a[46:47], v5 offset:42496
    v_mfma_f32_16x16x32_bf16 v[232:235], a[48:51], a[216:219], v[232:235]
    v_mfma_f32_16x16x32_bf16 v[236:239], a[48:51], a[220:223], v[236:239]
    s_waitcnt lgkmcnt(15)
    ds_read_b64_tr_b16 a[48:49], v4 offset:33536
    v_mfma_f32_16x16x32_bf16 v[240:243], a[52:55], a[208:211], v[240:243]
    ds_read_b64_tr_b16 a[50:51], v4 offset:41728
    v_mfma_f32_16x16x32_bf16 v[244:247], a[52:55], a[212:215], v[244:247]
    v_mfma_f32_16x16x32_bf16 v[248:251], a[52:55], a[216:219], v[248:251]
    buffer_load_dwordx4 v2, s[12:15], s30 offen offset:0 lds
    v_mfma_f32_16x16x32_bf16 v[252:255], a[52:55], a[220:223], v[252:255]
    s_waitcnt vmcnt(50)
    ds_read_b64_tr_b16 a[52:53], v4 offset:34560
    v_mfma_f32_16x16x32_bf16 v[32:35], a[0:3], a[224:227], v[32:35]
    ds_read_b64_tr_b16 a[54:55], v4 offset:42752
    v_mfma_f32_16x16x32_bf16 v[36:39], a[0:3], a[228:231], v[36:39]
    v_mfma_f32_16x16x32_bf16 v[40:43], a[0:3], a[232:235], v[40:43]
    v_mfma_f32_16x16x32_bf16 v[44:47], a[0:3], a[236:239], v[44:47]
    ds_read_b64_tr_b16 a[0:1], v4 offset:49152
    v_mfma_f32_16x16x32_bf16 v[48:51], a[4:7], a[224:227], v[48:51]
    buffer_load_dwordx4 v2, s[16:19], s30 offen offset:1024 lds
    v_mfma_f32_16x16x32_bf16 v[52:55], a[4:7], a[228:231], v[52:55]
    ds_read_b64_tr_b16 a[2:3], v4 offset:57344
    v_mfma_f32_16x16x32_bf16 v[56:59], a[4:7], a[232:235], v[56:59]
    s_load_dwordx2 s[100:101], s[0:1], 3388
    v_mfma_f32_16x16x32_bf16 v[60:63], a[4:7], a[236:239], v[60:63]
    ds_read_b64_tr_b16 a[4:5], v4 offset:50176
    v_mfma_f32_16x16x32_bf16 v[64:67], a[8:11], a[224:227], v[64:67]
    ds_read_b64_tr_b16 a[6:7], v4 offset:58368
    v_mfma_f32_16x16x32_bf16 v[68:71], a[8:11], a[228:231], v[68:71]
    v_mfma_f32_16x16x32_bf16 v[72:75], a[8:11], a[232:235], v[72:75]
    buffer_load_dwordx4 v3, s[12:15], s30 offen offset:2048 lds
    v_mfma_f32_16x16x32_bf16 v[76:79], a[8:11], a[236:239], v[76:79]
    ds_read_b64_tr_b16 a[8:9], v5 offset:49152
    v_mfma_f32_16x16x32_bf16 v[80:83], a[12:15], a[224:227], v[80:83]
    ds_read_b64_tr_b16 a[10:11], v5 offset:57344
    v_mfma_f32_16x16x32_bf16 v[84:87], a[12:15], a[228:231], v[84:87]
    v_mfma_f32_16x16x32_bf16 v[88:91], a[12:15], a[232:235], v[88:91]
    v_mfma_f32_16x16x32_bf16 v[92:95], a[12:15], a[236:239], v[92:95]
    s_waitcnt lgkmcnt(15)
    ds_read_b64_tr_b16 a[12:13], v5 offset:50176
    v_mfma_f32_16x16x32_bf16 v[96:99], a[16:19], a[224:227], v[96:99]
    buffer_load_dwordx4 v3, s[16:19], s30 offen offset:3072 lds
    v_mfma_f32_16x16x32_bf16 v[100:103], a[16:19], a[228:231], v[100:103]
    s_add_u32 m0, s32, 16384
    s_mov_b32 s30, 7110656
    ds_read_b64_tr_b16 a[14:15], v5 offset:58368
    v_mfma_f32_16x16x32_bf16 v[104:107], a[16:19], a[232:235], v[104:107]
    v_mfma_f32_16x16x32_bf16 v[108:111], a[16:19], a[236:239], v[108:111]
    ds_read_b64_tr_b16 a[16:17], v4 offset:49408
    v_mfma_f32_16x16x32_bf16 v[112:115], a[20:23], a[224:227], v[112:115]
    ds_read_b64_tr_b16 a[18:19], v4 offset:57600
    v_mfma_f32_16x16x32_bf16 v[116:119], a[20:23], a[228:231], v[116:119]
    v_mfma_f32_16x16x32_bf16 v[120:123], a[20:23], a[232:235], v[120:123]
    buffer_load_dwordx4 a[136:139], v1, s[8:11], s31 offen offset:0 sc1
    v_mfma_f32_16x16x32_bf16 v[124:127], a[20:23], a[236:239], v[124:127]
    ds_read_b64_tr_b16 a[20:21], v4 offset:50432
    v_mfma_f32_16x16x32_bf16 v[128:131], a[24:27], a[224:227], v[128:131]
    s_load_dwordx2 s[100:101], s[0:1], 3260
    ds_read_b64_tr_b16 a[22:23], v4 offset:58624
    v_mfma_f32_16x16x32_bf16 v[132:135], a[24:27], a[228:231], v[132:135]
    v_mfma_f32_16x16x32_bf16 v[136:139], a[24:27], a[232:235], v[136:139]
    v_mfma_f32_16x16x32_bf16 v[140:143], a[24:27], a[236:239], v[140:143]
    ds_read_b64_tr_b16 a[24:25], v5 offset:49408
    v_mfma_f32_16x16x32_bf16 v[144:147], a[28:31], a[224:227], v[144:147]
    buffer_load_dwordx4 a[140:143], v1, s[8:11], s31 offen offset:1024 sc1
    v_mfma_f32_16x16x32_bf16 v[148:151], a[28:31], a[228:231], v[148:151]
    ds_read_b64_tr_b16 a[26:27], v5 offset:57600
    v_mfma_f32_16x16x32_bf16 v[152:155], a[28:31], a[232:235], v[152:155]
    v_mfma_f32_16x16x32_bf16 v[156:159], a[28:31], a[236:239], v[156:159]
    ds_read_b64_tr_b16 a[28:29], v5 offset:50432
    v_mfma_f32_16x16x32_bf16 v[160:163], a[32:35], a[224:227], v[160:163]
    ds_read_b64_tr_b16 a[30:31], v5 offset:58624
    v_mfma_f32_16x16x32_bf16 v[164:167], a[32:35], a[228:231], v[164:167]
    v_mfma_f32_16x16x32_bf16 v[168:171], a[32:35], a[232:235], v[168:171]
    buffer_load_dwordx4 a[144:147], v1, s[8:11], s31 offen offset:2048 sc1
    v_mfma_f32_16x16x32_bf16 v[172:175], a[32:35], a[236:239], v[172:175]
    s_waitcnt lgkmcnt(15)
    ds_read_b64_tr_b16 a[32:33], v4 offset:49664
    v_mfma_f32_16x16x32_bf16 v[176:179], a[36:39], a[224:227], v[176:179]
    ds_read_b64_tr_b16 a[34:35], v4 offset:57856
    v_mfma_f32_16x16x32_bf16 v[180:183], a[36:39], a[228:231], v[180:183]
    v_mfma_f32_16x16x32_bf16 v[184:187], a[36:39], a[232:235], v[184:187]
    v_mfma_f32_16x16x32_bf16 v[188:191], a[36:39], a[236:239], v[188:191]
    ds_read_b64_tr_b16 a[36:37], v4 offset:50688
    v_mfma_f32_16x16x32_bf16 v[192:195], a[40:43], a[224:227], v[192:195]
    buffer_load_dwordx4 a[148:151], v1, s[8:11], s31 offen offset:3072 sc1
    s_add_u32 s31, s31, 4096
    v_mfma_f32_16x16x32_bf16 v[196:199], a[40:43], a[228:231], v[196:199]
    ds_read_b64_tr_b16 a[38:39], v4 offset:58880
    v_mfma_f32_16x16x32_bf16 v[200:203], a[40:43], a[232:235], v[200:203]
    s_load_dwordx2 s[100:101], s[0:1], 3132
    v_mfma_f32_16x16x32_bf16 v[204:207], a[40:43], a[236:239], v[204:207]
    ds_read_b64_tr_b16 a[40:41], v5 offset:49664
    v_mfma_f32_16x16x32_bf16 v[208:211], a[44:47], a[224:227], v[208:211]
    ds_read_b64_tr_b16 a[42:43], v5 offset:57856
    v_mfma_f32_16x16x32_bf16 v[212:215], a[44:47], a[228:231], v[212:215]
    v_mfma_f32_16x16x32_bf16 v[216:219], a[44:47], a[232:235], v[216:219]
    buffer_load_dwordx4 a[152:155], v1, s[8:11], s31 offen offset:0 sc1
    v_mfma_f32_16x16x32_bf16 v[220:223], a[44:47], a[236:239], v[220:223]
    ds_read_b64_tr_b16 a[44:45], v5 offset:50688
    v_mfma_f32_16x16x32_bf16 v[224:227], a[48:51], a[224:227], v[224:227]
    ds_read_b64_tr_b16 a[46:47], v5 offset:58880
    v_mfma_f32_16x16x32_bf16 v[228:231], a[48:51], a[228:231], v[228:231]
    v_mfma_f32_16x16x32_bf16 v[232:235], a[48:51], a[232:235], v[232:235]
    v_mfma_f32_16x16x32_bf16 v[236:239], a[48:51], a[236:239], v[236:239]
    ds_read_b64_tr_b16 a[48:49], v4 offset:49920
    v_mfma_f32_16x16x32_bf16 v[240:243], a[52:55], a[224:227], v[240:243]
    buffer_load_dwordx4 a[156:159], v1, s[8:11], s31 offen offset:1024 sc1
    v_mfma_f32_16x16x32_bf16 v[244:247], a[52:55], a[228:231], v[244:247]
    ds_read_b64_tr_b16 a[50:51], v4 offset:58112
    v_mfma_f32_16x16x32_bf16 v[248:251], a[52:55], a[232:235], v[248:251]
    v_mfma_f32_16x16x32_bf16 v[252:255], a[52:55], a[236:239], v[252:255]
    s_waitcnt vmcnt(55) lgkmcnt(15)
    ds_read_b64_tr_b16 a[52:53], v4 offset:50944
    v_mfma_f32_16x16x32_bf16 v[32:35], a[0:3], a[240:243], v[32:35]
    ds_read_b64_tr_b16 a[54:55], v4 offset:59136
    v_mfma_f32_16x16x32_bf16 v[36:39], a[0:3], a[244:247], v[36:39]
    v_mfma_f32_16x16x32_bf16 v[40:43], a[0:3], a[248:251], v[40:43]
    buffer_load_dwordx4 a[160:163], v1, s[8:11], s31 offen offset:2048 sc1
    v_mfma_f32_16x16x32_bf16 v[44:47], a[0:3], a[252:255], v[44:47]
    v_mfma_f32_16x16x32_bf16 v[48:51], a[4:7], a[240:243], v[48:51]
    s_load_dwordx2 s[100:101], s[0:1], 3004
    v_mfma_f32_16x16x32_bf16 v[52:55], a[4:7], a[244:247], v[52:55]
    v_mfma_f32_16x16x32_bf16 v[56:59], a[4:7], a[248:251], v[56:59]
    v_mfma_f32_16x16x32_bf16 v[60:63], a[4:7], a[252:255], v[60:63]
    v_mfma_f32_16x16x32_bf16 v[64:67], a[8:11], a[240:243], v[64:67]
    buffer_load_dwordx4 a[164:167], v1, s[8:11], s31 offen offset:3072 sc1
    s_add_u32 s31, s31, 4096
    v_mfma_f32_16x16x32_bf16 v[68:71], a[8:11], a[244:247], v[68:71]
    v_mfma_f32_16x16x32_bf16 v[72:75], a[8:11], a[248:251], v[72:75]
    v_mfma_f32_16x16x32_bf16 v[76:79], a[8:11], a[252:255], v[76:79]
    v_mfma_f32_16x16x32_bf16 v[80:83], a[12:15], a[240:243], v[80:83]
    v_mfma_f32_16x16x32_bf16 v[84:87], a[12:15], a[244:247], v[84:87]
    v_mfma_f32_16x16x32_bf16 v[88:91], a[12:15], a[248:251], v[88:91]
    buffer_load_dwordx4 a[168:171], v1, s[8:11], s31 offen offset:0 sc1
    v_mfma_f32_16x16x32_bf16 v[92:95], a[12:15], a[252:255], v[92:95]
    v_mfma_f32_16x16x32_bf16 v[96:99], a[16:19], a[240:243], v[96:99]
    v_mfma_f32_16x16x32_bf16 v[100:103], a[16:19], a[244:247], v[100:103]
    v_mfma_f32_16x16x32_bf16 v[104:107], a[16:19], a[248:251], v[104:107]
    v_mfma_f32_16x16x32_bf16 v[108:111], a[16:19], a[252:255], v[108:111]
    s_waitcnt lgkmcnt(15)
    v_mfma_f32_16x16x32_bf16 v[112:115], a[20:23], a[240:243], v[112:115]
    buffer_load_dwordx4 a[172:175], v1, s[8:11], s31 offen offset:1024 sc1
    v_mfma_f32_16x16x32_bf16 v[116:119], a[20:23], a[244:247], v[116:119]
    v_mfma_f32_16x16x32_bf16 v[120:123], a[20:23], a[248:251], v[120:123]
    s_load_dwordx2 s[100:101], s[0:1], 2876
    v_mfma_f32_16x16x32_bf16 v[124:127], a[20:23], a[252:255], v[124:127]
    s_waitcnt lgkmcnt(14)
    v_mfma_f32_16x16x32_bf16 v[128:131], a[24:27], a[240:243], v[128:131]
    v_mfma_f32_16x16x32_bf16 v[132:135], a[24:27], a[244:247], v[132:135]
    v_mfma_f32_16x16x32_bf16 v[136:139], a[24:27], a[248:251], v[136:139]
    buffer_load_dwordx4 a[176:179], v1, s[8:11], s31 offen offset:2048 sc1
    v_mfma_f32_16x16x32_bf16 v[140:143], a[24:27], a[252:255], v[140:143]
    s_waitcnt lgkmcnt(12)
    v_mfma_f32_16x16x32_bf16 v[144:147], a[28:31], a[240:243], v[144:147]
    v_mfma_f32_16x16x32_bf16 v[148:151], a[28:31], a[244:247], v[148:151]
    v_mfma_f32_16x16x32_bf16 v[152:155], a[28:31], a[248:251], v[152:155]
    v_mfma_f32_16x16x32_bf16 v[156:159], a[28:31], a[252:255], v[156:159]
    s_waitcnt vmcnt(56) lgkmcnt(10)
    s_barrier
    ds_read_b64_tr_b16 a[0:1], v6 offset:0
    v_mfma_f32_16x16x32_bf16 v[160:163], a[32:35], a[240:243], v[160:163]
    buffer_load_dwordx4 v2, s[12:15], s30 offen offset:0 lds
    ds_read_b64_tr_b16 a[2:3], v6 offset:8192
    v_mfma_f32_16x16x32_bf16 v[164:167], a[32:35], a[244:247], v[164:167]
    ds_read_b64_tr_b16 a[4:5], v6 offset:1024
    ds_read_b64_tr_b16 a[6:7], v6 offset:9216
    v_mfma_f32_16x16x32_bf16 v[168:171], a[32:35], a[248:251], v[168:171]
    ds_read_b64_tr_b16 a[8:9], v7 offset:0
    ds_read_b64_tr_b16 a[10:11], v7 offset:8192
    v_mfma_f32_16x16x32_bf16 v[172:175], a[32:35], a[252:255], v[172:175]
    s_waitcnt lgkmcnt(14)
    ds_read_b64_tr_b16 a[12:13], v7 offset:1024
    ds_read_b64_tr_b16 a[14:15], v7 offset:9216
    v_mfma_f32_16x16x32_bf16 v[176:179], a[36:39], a[240:243], v[176:179]
    ds_read_b64_tr_b16 a[16:17], v6 offset:256
    ds_read_b64_tr_b16 a[18:19], v6 offset:8448
    v_mfma_f32_16x16x32_bf16 v[180:183], a[36:39], a[244:247], v[180:183]
    buffer_load_dwordx4 v2, s[16:19], s30 offen offset:1024 lds
    ds_read_b64_tr_b16 a[20:21], v6 offset:1280
    v_mfma_f32_16x16x32_bf16 v[184:187], a[36:39], a[248:251], v[184:187]
    ds_read_b64_tr_b16 a[22:23], v6 offset:9472
    ds_read_b64_tr_b16 a[24:25], v7 offset:256
    v_mfma_f32_16x16x32_bf16 v[188:191], a[36:39], a[252:255], v[188:191]
    s_waitcnt lgkmcnt(15)
    ds_read_b64_tr_b16 a[26:27], v7 offset:8448
    ds_read_b64_tr_b16 a[28:29], v7 offset:1280
    v_mfma_f32_16x16x32_bf16 v[192:195], a[40:43], a[240:243], v[192:195]
    s_load_dwordx2 s[100:101], s[0:1], 2748
    ds_read_b64_tr_b16 a[30:31], v7 offset:9472
    v_mfma_f32_16x16x32_bf16 v[196:199], a[40:43], a[244:247], v[196:199]
    ds_read_b64_tr_b16 a[32:33], v6 offset:512
    v_mfma_f32_16x16x32_bf16 v[200:203], a[40:43], a[248:251], v[200:203]
    buffer_load_dwordx4 v3, s[12:15], s30 offen offset:2048 lds
    ds_read_b64_tr_b16 a[34:35], v6 offset:8704
    v_mfma_f32_16x16x32_bf16 v[204:207], a[40:43], a[252:255], v[204:207]
    ds_read_b64_tr_b16 a[36:37], v6 offset:1536
    v_mfma_f32_16x16x32_bf16 v[208:211], a[44:47], a[240:243], v[208:211]
    ds_read_b64_tr_b16 a[38:39], v6 offset:9728
    v_mfma_f32_16x16x32_bf16 v[212:215], a[44:47], a[244:247], v[212:215]
    ds_read_b64_tr_b16 a[40:41], v7 offset:512
    v_mfma_f32_16x16x32_bf16 v[216:219], a[44:47], a[248:251], v[216:219]
    ds_read_b64_tr_b16 a[42:43], v7 offset:8704
    v_mfma_f32_16x16x32_bf16 v[220:223], a[44:47], a[252:255], v[220:223]
    ds_read_b64_tr_b16 a[44:45], v7 offset:1536
    v_mfma_f32_16x16x32_bf16 v[224:227], a[48:51], a[240:243], v[224:227]
    buffer_load_dwordx4 v3, s[16:19], s30 offen offset:3072 lds
    v_mfma_f32_16x16x32_bf16 v[228:231], a[48:51], a[244:247], v[228:231]
    s_add_u32 m0, s54, 32768
    s_add_u32 s55, s4, s33
    s_sub_u32 s30, s55, 917504
    v_mfma_f32_16x16x32_bf16 v[232:235], a[48:51], a[248:251], v[232:235]
    s_min_u32 s55, s55, s30
    ds_read_b64_tr_b16 a[46:47], v7 offset:9728
    v_mfma_f32_16x16x32_bf16 v[236:239], a[48:51], a[252:255], v[236:239]
    s_waitcnt lgkmcnt(15)
    ds_read_b64_tr_b16 a[48:49], v6 offset:768
    v_mfma_f32_16x16x32_bf16 v[240:243], a[52:55], a[240:243], v[240:243]
    ds_read_b64_tr_b16 a[50:51], v6 offset:8960
    v_mfma_f32_16x16x32_bf16 v[244:247], a[52:55], a[244:247], v[244:247]
    v_mfma_f32_16x16x32_bf16 v[248:251], a[52:55], a[248:251], v[248:251]
    buffer_load_dwordx4 a[180:183], v1, s[8:11], s31 offen offset:3072 sc1
    v_mfma_f32_16x16x32_bf16 v[252:255], a[52:55], a[252:255], v[252:255]
    s_waitcnt vmcnt(56)
    s_add_u32 s35, s74, 0
    ds_read_b64_tr_b16 a[52:53], v6 offset:1792
    v_mfma_f32_16x16x32_bf16 v[32:35], a[0:3], a[56:59], v[32:35]
    ds_read_b64_tr_b16 a[54:55], v6 offset:9984
    v_mfma_f32_16x16x32_bf16 v[36:39], a[0:3], a[60:63], v[36:39]
    v_mfma_f32_16x16x32_bf16 v[40:43], a[0:3], a[64:67], v[40:43]
    s_load_dwordx2 s[100:101], s[0:1], 2620
    v_mfma_f32_16x16x32_bf16 v[44:47], a[0:3], a[68:71], v[44:47]
    v_mfma_f32_16x16x32_bf16 v[48:51], a[4:7], a[56:59], v[48:51]
    buffer_load_dwordx4 v10, s[40:43], s55 offen lds
    v_mfma_f32_16x16x32_bf16 v[52:55], a[4:7], a[60:63], v[52:55]
    s_add_u32 m0, s54, 36864
    s_add_u32 s55, s5, s33
    s_sub_u32 s30, s55, 917504
    v_mfma_f32_16x16x32_bf16 v[56:59], a[4:7], a[64:67], v[56:59]
    s_min_u32 s55, s55, s30
    v_mfma_f32_16x16x32_bf16 v[60:63], a[4:7], a[68:71], v[60:63]
    v_mfma_f32_16x16x32_bf16 v[64:67], a[8:11], a[56:59], v[64:67]
    v_mfma_f32_16x16x32_bf16 v[68:71], a[8:11], a[60:63], v[68:71]
    v_mfma_f32_16x16x32_bf16 v[72:75], a[8:11], a[64:67], v[72:75]
    buffer_load_dwordx4 v10, s[40:43], s55 offen lds
    v_mfma_f32_16x16x32_bf16 v[76:79], a[8:11], a[68:71], v[76:79]
    s_add_u32 m0, s54, 40960
    s_add_u32 s55, s4, s33
    s_add_u32 s55, s55, 65536
    v_mfma_f32_16x16x32_bf16 v[80:83], a[12:15], a[56:59], v[80:83]
    s_sub_u32 s30, s55, 917504
    s_min_u32 s55, s55, s30
    v_mfma_f32_16x16x32_bf16 v[84:87], a[12:15], a[60:63], v[84:87]
    v_mfma_f32_16x16x32_bf16 v[88:91], a[12:15], a[64:67], v[88:91]
    v_mfma_f32_16x16x32_bf16 v[92:95], a[12:15], a[68:71], v[92:95]
    s_waitcnt lgkmcnt(15)
    v_mfma_f32_16x16x32_bf16 v[96:99], a[16:19], a[56:59], v[96:99]
    buffer_load_dwordx4 v10, s[40:43], s55 offen lds
    v_mfma_f32_16x16x32_bf16 v[100:103], a[16:19], a[60:63], v[100:103]
    s_add_u32 m0, s54, 45056
    s_add_u32 s55, s5, s33
    s_add_u32 s55, s55, 65536
    v_mfma_f32_16x16x32_bf16 v[104:107], a[16:19], a[64:67], v[104:107]
    s_sub_u32 s30, s55, 917504
    s_min_u32 s55, s55, s30
    v_mfma_f32_16x16x32_bf16 v[108:111], a[16:19], a[68:71], v[108:111]
    v_mfma_f32_16x16x32_bf16 v[112:115], a[20:23], a[56:59], v[112:115]
    s_load_dwordx2 s[100:101], s[0:1], 2492
    v_mfma_f32_16x16x32_bf16 v[116:119], a[20:23], a[60:63], v[116:119]
    v_mfma_f32_16x16x32_bf16 v[120:123], a[20:23], a[64:67], v[120:123]
    buffer_load_dwordx4 v10, s[40:43], s55 offen lds
    v_mfma_f32_16x16x32_bf16 v[124:127], a[20:23], a[68:71], v[124:127]
    s_waitcnt lgkmcnt(14)
    s_add_u32 m0, s54, 49152
    s_add_u32 s55, s4, s33
    v_mfma_f32_16x16x32_bf16 v[128:131], a[24:27], a[56:59], v[128:131]
    s_add_u32 s55, s55, 131072
    s_sub_u32 s30, s55, 917504
    s_min_u32 s55, s55, s30
    v_mfma_f32_16x16x32_bf16 v[132:135], a[24:27], a[60:63], v[132:135]
    v_mfma_f32_16x16x32_bf16 v[136:139], a[24:27], a[64:67], v[136:139]
    v_mov_b32 v24, -1
    v_mov_b32 v25, -1
    v_mfma_f32_16x16x32_bf16 v[140:143], a[24:27], a[68:71], v[140:143]
    s_waitcnt lgkmcnt(12)
    v_mov_b32 v26, -1
    v_mov_b32 v27, -1
    v_mfma_f32_16x16x32_bf16 v[144:147], a[28:31], a[56:59], v[144:147]
    buffer_store_dwordx4 v[24:27], v1, s[44:47], s64 offen offset:0 sc1
    v_mfma_f32_16x16x32_bf16 v[148:151], a[28:31], a[60:63], v[148:151]
    v_mfma_f32_16x16x32_bf16 v[152:155], a[28:31], a[64:67], v[152:155]
    v_mfma_f32_16x16x32_bf16 v[156:159], a[28:31], a[68:71], v[156:159]
    s_waitcnt vmcnt(39) lgkmcnt(10)
    s_barrier
    ds_read_b64_tr_b16 a[0:1], v6 offset:16384
    v_mfma_f32_16x16x32_bf16 v[160:163], a[32:35], a[56:59], v[160:163]
    buffer_store_dwordx4 v[24:27], v1, s[44:47], s64 offen offset:1024 sc1
    ds_read_b64_tr_b16 a[2:3], v6 offset:24576
    v_mfma_f32_16x16x32_bf16 v[164:167], a[32:35], a[60:63], v[164:167]
    ds_read_b64_tr_b16 a[4:5], v6 offset:17408
    ds_read_b64_tr_b16 a[6:7], v6 offset:25600
    v_mfma_f32_16x16x32_bf16 v[168:171], a[32:35], a[64:67], v[168:171]
    ds_read_b64_tr_b16 a[8:9], v6 offset:32768
    ds_read_b64_tr_b16 a[10:11], v6 offset:40960
    v_mfma_f32_16x16x32_bf16 v[172:175], a[32:35], a[68:71], v[172:175]
    s_waitcnt lgkmcnt(14)
    ds_read_b64_tr_b16 a[12:13], v6 offset:33792
    ds_read_b64_tr_b16 a[14:15], v6 offset:41984
    v_mfma_f32_16x16x32_bf16 v[176:179], a[36:39], a[56:59], v[176:179]
    ds_read_b64_tr_b16 a[16:17], v6 offset:49152
    ds_read_b64_tr_b16 a[18:19], v6 offset:57344
    v_mfma_f32_16x16x32_bf16 v[180:183], a[36:39], a[60:63], v[180:183]
    buffer_load_dwordx4 v10, s[40:43], s55 offen lds
    ds_read_b64_tr_b16 a[20:21], v6 offset:50176
    v_mfma_f32_16x16x32_bf16 v[184:187], a[36:39], a[64:67], v[184:187]
    buffer_store_dwordx4 v[24:27], v1, s[44:47], s64 offen offset:2048 sc1
    ds_read_b64_tr_b16 a[22:23], v6 offset:58368
    v_mfma_f32_16x16x32_bf16 v[188:191], a[36:39], a[68:71], v[188:191]
    s_waitcnt lgkmcnt(15)
    s_add_u32 m0, s54, 53248
    s_add_u32 s55, s5, s33
    ds_read_b64_tr_b16 a[24:25], v8 offset:0
    v_mfma_f32_16x16x32_bf16 v[192:195], a[40:43], a[56:59], v[192:195]
    s_add_u32 s55, s55, 131072
    s_sub_u32 s30, s55, 917504
    s_min_u32 s55, s55, s30
    ds_read_b64_tr_b16 a[26:27], v8 offset:8192
    v_mfma_f32_16x16x32_bf16 v[196:199], a[40:43], a[60:63], v[196:199]
    s_load_dwordx2 s[100:101], s[0:1], 2364
    ds_read_b64_tr_b16 a[28:29], v8 offset:1024
    ds_read_b64_tr_b16 a[30:31], v8 offset:9216
    v_mfma_f32_16x16x32_bf16 v[200:203], a[40:43], a[64:67], v[200:203]
    v_mfma_f32_16x16x32_bf16 v[204:207], a[40:43], a[68:71], v[204:207]
    buffer_load_dwordx4 v10, s[40:43], s55 offen lds
    v_mfma_f32_16x16x32_bf16 v[208:211], a[44:47], a[56:59], v[208:211]
    buffer_store_dwordx4 v[24:27], v1, s[44:47], s64 offen offset:3072 sc1
    v_mfma_f32_16x16x32_bf16 v[212:215], a[44:47], a[60:63], v[212:215]
    s_add_u32 m0, s54, 57344
    s_add_u32 s55, s4, s77
    s_sub_u32 s30, s55, 917504
    v_mfma_f32_16x16x32_bf16 v[216:219], a[44:47], a[64:67], v[216:219]
    s_min_u32 s55, s55, s30
    v_mfma_f32_16x16x32_bf16 v[220:223], a[44:47], a[68:71], v[220:223]
    s_waitcnt lgkmcnt(15)
    v_mfma_f32_16x16x32_bf16 v[224:227], a[48:51], a[56:59], v[224:227]
    v_mfma_f32_16x16x32_bf16 v[228:231], a[48:51], a[60:63], v[228:231]
    v_mfma_f32_16x16x32_bf16 v[232:235], a[48:51], a[64:67], v[232:235]
    buffer_load_dwordx4 v10, s[40:43], s55 offen lds
    v_mfma_f32_16x16x32_bf16 v[236:239], a[48:51], a[68:71], v[236:239]
    buffer_load_dword a184, v14, s[40:43], s63 offen
    v_mfma_f32_16x16x32_bf16 v[240:243], a[52:55], a[56:59], v[240:243]
    s_add_u32 m0, s54, 61440
    s_add_u32 s55, s5, s77
    s_sub_u32 s30, s55, 917504
    v_mfma_f32_16x16x32_bf16 v[244:247], a[52:55], a[60:63], v[244:247]
    s_min_u32 s55, s55, s30
    v_mfma_f32_16x16x32_bf16 v[248:251], a[52:55], a[64:67], v[248:251]
    v_mfma_f32_16x16x32_bf16 v[252:255], a[52:55], a[68:71], v[252:255]
    s_waitcnt lgkmcnt(14)
    v_mfma_f32_16x16x32_bf16 v[32:35], a[0:3], a[72:75], v[32:35]
    buffer_load_dwordx4 v10, s[40:43], s55 offen lds
    v_mfma_f32_16x16x32_bf16 v[36:39], a[0:3], a[76:79], v[36:39]
    s_add_u32 m0, s54, 65536
    s_add_u32 s55, s4, s78
    s_sub_u32 s30, s55, 917504
    v_mfma_f32_16x16x32_bf16 v[40:43], a[0:3], a[80:83], v[40:43]
    s_min_u32 s55, s55, s30
    v_mfma_f32_16x16x32_bf16 v[44:47], a[0:3], a[84:87], v[44:47]
    s_waitcnt lgkmcnt(12)
    v_mfma_f32_16x16x32_bf16 v[48:51], a[4:7], a[72:75], v[48:51]
    v_mfma_f32_16x16x32_bf16 v[52:55], a[4:7], a[76:79], v[52:55]
    v_mfma_f32_16x16x32_bf16 v[56:59], a[4:7], a[80:83], v[56:59]
    v_mfma_f32_16x16x32_bf16 v[60:63], a[4:7], a[84:87], v[60:63]
    s_waitcnt vmcnt(14) lgkmcnt(10)
    s_barrier
    ds_read_b64_tr_b16 a[32:33], v8 offset:16384
    v_mfma_f32_16x16x32_bf16 v[32:35], a[8:11], a[88:91], v[32:35]
    buffer_load_dwordx4 v10, s[40:43], s55 offen lds
    ds_read_b64_tr_b16 a[34:35], v8 offset:24576
    v_mfma_f32_16x16x32_bf16 v[36:39], a[8:11], a[92:95], v[36:39]
    s_add_u32 m0, s54, 69632
    s_add_u32 s55, s5, s78
    s_sub_u32 s30, s55, 917504
    ds_read_b64_tr_b16 a[36:37], v8 offset:17408
    v_mfma_f32_16x16x32_bf16 v[40:43], a[8:11], a[96:99], v[40:43]
    s_min_u32 s55, s55, s30
    ds_read_b64_tr_b16 a[38:39], v8 offset:25600
    ds_read_b64_tr_b16 a[40:41], v4 offset:0
    v_mfma_f32_16x16x32_bf16 v[44:47], a[8:11], a[100:103], v[44:47]
    s_waitcnt lgkmcnt(13)
    ds_read_b64_tr_b16 a[42:43], v4 offset:8192
    ds_read_b64_tr_b16 a[44:45], v4 offset:1024
    v_mfma_f32_16x16x32_bf16 v[48:51], a[12:15], a[88:91], v[48:51]
    buffer_load_dwordx4 v10, s[40:43], s55 offen lds
    ds_read_b64_tr_b16 a[46:47], v4 offset:9216
    v_mfma_f32_16x16x32_bf16 v[52:55], a[12:15], a[92:95], v[52:55]
    s_add_u32 m0, s54, 73728
    s_add_u32 s55, s4, s79
    s_sub_u32 s30, s55, 917504
    ds_read_b64_tr_b16 a[48:49], v4 offset:16384
    v_mfma_f32_16x16x32_bf16 v[56:59], a[12:15], a[96:99], v[56:59]
    s_min_u32 s55, s55, s30
    ds_read_b64_tr_b16 a[50:51], v4 offset:24576
    ds_read_b64_tr_b16 a[52:53], v4 offset:17408
    v_mfma_f32_16x16x32_bf16 v[60:63], a[12:15], a[100:103], v[60:63]
    s_waitcnt lgkmcnt(15)
    ds_read_b64_tr_b16 a[54:55], v4 offset:25600
    ds_read_b64_tr_b16 a[0:1], v7 offset:16384
    v_mfma_f32_16x16x32_bf16 v[32:35], a[16:19], a[104:107], v[32:35]
    buffer_load_dwordx4 v10, s[40:43], s55 offen lds
    ds_read_b64_tr_b16 a[2:3], v7 offset:24576
    v_mfma_f32_16x16x32_bf16 v[36:39], a[16:19], a[108:111], v[36:39]
    s_add_u32 m0, s54, 77824
    s_add_u32 s55, s5, s79
    s_sub_u32 s30, s55, 917504
    ds_read_b64_tr_b16 a[4:5], v7 offset:17408
    v_mfma_f32_16x16x32_bf16 v[40:43], a[16:19], a[112:115], v[40:43]
    s_min_u32 s55, s55, s30
    ds_read_b64_tr_b16 a[6:7], v7 offset:25600
    ds_read_b64_tr_b16 a[8:9], v7 offset:32768
    v_mfma_f32_16x16x32_bf16 v[44:47], a[16:19], a[116:119], v[44:47]
    ds_read_b64_tr_b16 a[10:11], v7 offset:40960
    v_mfma_f32_16x16x32_bf16 v[48:51], a[20:23], a[104:107], v[48:51]
    ds_read_b64_tr_b16 a[12:13], v7 offset:33792
    v_mfma_f32_16x16x32_bf16 v[52:55], a[20:23], a[108:111], v[52:55]
    buffer_load_dwordx4 v10, s[40:43], s55 offen lds
    v_mfma_f32_16x16x32_bf16 v[56:59], a[20:23], a[112:115], v[56:59]
    s_add_u32 m0, s54, 81920
    s_add_u32 s55, s6, 0
    s_sub_u32 s30, s55, 917504
    ds_read_b64_tr_b16 a[14:15], v7 offset:41984
    v_mfma_f32_16x16x32_bf16 v[60:63], a[20:23], a[116:119], v[60:63]
    s_waitcnt lgkmcnt(15)
    s_min_u32 s55, s55, s30
    ds_read_b64_tr_b16 a[16:17], v7 offset:49152
    v_mfma_f32_16x16x32_bf16 v[32:35], a[24:27], a[120:123], v[32:35]
    ds_read_b64_tr_b16 a[18:19], v7 offset:57344
    v_mfma_f32_16x16x32_bf16 v[36:39], a[24:27], a[124:127], v[36:39]
    ds_read_b64_tr_b16 a[20:21], v7 offset:50176
    v_mfma_f32_16x16x32_bf16 v[40:43], a[24:27], a[128:131], v[40:43]
    ds_read_b64_tr_b16 a[22:23], v7 offset:58368
    v_mfma_f32_16x16x32_bf16 v[44:47], a[24:27], a[132:135], v[44:47]
    ds_read_b64_tr_b16 a[24:25], v9 offset:0
    v_mfma_f32_16x16x32_bf16 v[48:51], a[28:31], a[120:123], v[48:51]
    ds_read_b64_tr_b16 a[26:27], v9 offset:8192
    v_mfma_f32_16x16x32_bf16 v[52:55], a[28:31], a[124:127], v[52:55]
    v_mfma_f32_16x16x32_bf16 v[56:59], a[28:31], a[128:131], v[56:59]
    v_mfma_f32_16x16x32_bf16 v[60:63], a[28:31], a[132:135], v[60:63]
    ds_read_b64_tr_b16 a[28:29], v9 offset:1024
    v_mfma_f32_16x16x32_bf16 v[32:35], a[32:35], a[136:139], v[32:35]
    ds_read_b64_tr_b16 a[30:31], v9 offset:9216
    v_mfma_f32_16x16x32_bf16 v[36:39], a[32:35], a[140:143], v[36:39]
    v_mfma_f32_16x16x32_bf16 v[40:43], a[32:35], a[144:147], v[40:43]
    v_mfma_f32_16x16x32_bf16 v[44:47], a[32:35], a[148:151], v[44:47]
    ds_read_b64_tr_b16 a[32:33], v9 offset:16384
    v_mfma_f32_16x16x32_bf16 v[48:51], a[36:39], a[136:139], v[48:51]
    ds_read_b64_tr_b16 a[34:35], v9 offset:24576
    v_mfma_f32_16x16x32_bf16 v[52:55], a[36:39], a[140:143], v[52:55]
    v_mfma_f32_16x16x32_bf16 v[56:59], a[36:39], a[144:147], v[56:59]
    v_mfma_f32_16x16x32_bf16 v[60:63], a[36:39], a[148:151], v[60:63]
    s_waitcnt lgkmcnt(15)
    ds_read_b64_tr_b16 a[36:37], v9 offset:17408
    v_mfma_f32_16x16x32_bf16 v[32:35], a[40:43], a[152:155], v[32:35]
    ds_read_b64_tr_b16 a[38:39], v9 offset:25600
    v_mfma_f32_16x16x32_bf16 v[36:39], a[40:43], a[156:159], v[36:39]
    v_mfma_f32_16x16x32_bf16 v[40:43], a[40:43], a[160:163], v[40:43]
    v_mfma_f32_16x16x32_bf16 v[44:47], a[40:43], a[164:167], v[44:47]
    ds_read_b64_tr_b16 a[40:41], v5 offset:0
    v_mfma_f32_16x16x32_bf16 v[48:51], a[44:47], a[152:155], v[48:51]
    ds_read_b64_tr_b16 a[42:43], v5 offset:8192
    v_mfma_f32_16x16x32_bf16 v[52:55], a[44:47], a[156:159], v[52:55]
    v_mfma_f32_16x16x32_bf16 v[56:59], a[44:47], a[160:163], v[56:59]
    v_mfma_f32_16x16x32_bf16 v[60:63], a[44:47], a[164:167], v[60:63]
    s_waitcnt vmcnt(17)
    ds_read_b64_tr_b16 a[44:45], v5 offset:1024
    v_mfma_f32_16x16x32_bf16 v[32:35], a[48:51], a[168:171], v[32:35]
    ds_read_b64_tr_b16 a[46:47], v5 offset:9216
    v_mfma_f32_16x16x32_bf16 v[36:39], a[48:51], a[172:175], v[36:39]
    v_mfma_f32_16x16x32_bf16 v[40:43], a[48:51], a[176:179], v[40:43]
    v_mfma_f32_16x16x32_bf16 v[44:47], a[48:51], a[180:183], v[44:47]
    ds_read_b64_tr_b16 a[48:49], v5 offset:16384
    v_mfma_f32_16x16x32_bf16 v[48:51], a[52:55], a[168:171], v[48:51]
    ds_read_b64_tr_b16 a[50:51], v5 offset:24576
    v_mfma_f32_16x16x32_bf16 v[52:55], a[52:55], a[172:175], v[52:55]
    v_mfma_f32_16x16x32_bf16 v[56:59], a[52:55], a[176:179], v[56:59]
    v_mfma_f32_16x16x32_bf16 v[60:63], a[52:55], a[180:183], v[60:63]
    ds_read_b64_tr_b16 a[52:53], v5 offset:17408
    v_mfma_f32_16x16x32_bf16 v[64:67], a[0:3], a[72:75], v[64:67]
    ds_read_b64_tr_b16 a[54:55], v5 offset:25600
    v_mfma_f32_16x16x32_bf16 v[68:71], a[0:3], a[76:79], v[68:71]
    v_mfma_f32_16x16x32_bf16 v[72:75], a[0:3], a[80:83], v[72:75]
    v_mfma_f32_16x16x32_bf16 v[76:79], a[0:3], a[84:87], v[76:79]
    s_waitcnt lgkmcnt(15)
    ds_read_b64_tr_b16 a[0:1], v6 offset:16640
    v_mul_f32 v24, v32, v17
    v_mfma_f32_16x16x32_bf16 v[80:83], a[4:7], a[72:75], v[80:83]
    ds_read_b64_tr_b16 a[2:3], v6 offset:24832
    v_mul_f32 v25, v33, v17
    v_mfma_f32_16x16x32_bf16 v[84:87], a[4:7], a[76:79], v[84:87]
    v_mul_f32 v26, v34, v17
    v_mul_f32 v27, v35, v17
    v_mfma_f32_16x16x32_bf16 v[88:91], a[4:7], a[80:83], v[88:91]
    v_exp_f32 v24, v24
    v_mfma_f32_16x16x32_bf16 v[92:95], a[4:7], a[84:87], v[92:95]
    ds_read_b64_tr_b16 a[4:5], v6 offset:17664
    v_exp_f32 v25, v25
    v_mfma_f32_16x16x32_bf16 v[64:67], a[8:11], a[88:91], v[64:67]
    ds_read_b64_tr_b16 a[6:7], v6 offset:25856
    v_exp_f32 v26, v26
    v_exp_f32 v27, v27
    v_mfma_f32_16x16x32_bf16 v[68:71], a[8:11], a[92:95], v[68:71]
    v_mul_f32 v32, v32, v48
    v_mul_f32 v33, v33, v49
    v_mfma_f32_16x16x32_bf16 v[72:75], a[8:11], a[96:99], v[72:75]
    v_mul_f32 v34, v34, v50
    v_mul_f32 v35, v35, v51
    v_mfma_f32_16x16x32_bf16 v[76:79], a[8:11], a[100:103], v[76:79]
    ds_read_b64_tr_b16 a[8:9], v6 offset:33024
    v_fma_f32 v24, v24, v16, v16
    v_fma_f32 v25, v25, v16, v16
    v_mfma_f32_16x16x32_bf16 v[80:83], a[12:15], a[88:91], v[80:83]
    ds_read_b64_tr_b16 a[10:11], v6 offset:41216
    v_fma_f32 v26, v26, v16, v16
    v_fma_f32 v27, v27, v16, v16
    v_rcp_f32 v24, v24
    v_mfma_f32_16x16x32_bf16 v[84:87], a[12:15], a[92:95], v[84:87]
    v_rcp_f32 v25, v25
    v_mfma_f32_16x16x32_bf16 v[88:91], a[12:15], a[96:99], v[88:91]
    v_rcp_f32 v26, v26
    v_mfma_f32_16x16x32_bf16 v[92:95], a[12:15], a[100:103], v[92:95]
    ds_read_b64_tr_b16 a[12:13], v6 offset:34048
    v_rcp_f32 v27, v27
    v_mul_f32 v32, v32, v24
    v_mfma_f32_16x16x32_bf16 v[64:67], a[16:19], a[104:107], v[64:67]
    ds_read_b64_tr_b16 a[14:15], v6 offset:42240
    v_mul_f32 v33, v33, v25
    v_mul_f32 v34, v34, v26
    v_mfma_f32_16x16x32_bf16 v[68:71], a[16:19], a[108:111], v[68:71]
    v_mul_f32 v35, v35, v27
    v_cvt_pk_bf16_f32 v48, v32, v33
    v_cvt_pk_bf16_f32 v49, v34, v35
    v_mfma_f32_16x16x32_bf16 v[72:75], a[16:19], a[112:115], v[72:75]
    v_mul_f32 v28, v36, v21
    v_mul_f32 v29, v37, v21
    v_mfma_f32_16x16x32_bf16 v[76:79], a[16:19], a[116:119], v[76:79]
    ds_read_b64_tr_b16 a[16:17], v6 offset:49408
    v_mul_f32 v30, v38, v21
    v_mul_f32 v31, v39, v21
    v_exp_f32 v28, v28
    v_mfma_f32_16x16x32_bf16 v[80:83], a[20:23], a[104:107], v[80:83]
    ds_read_b64_tr_b16 a[18:19], v6 offset:57600
    v_exp_f32 v29, v29
    v_mfma_f32_16x16x32_bf16 v[84:87], a[20:23], a[108:111], v[84:87]
    v_exp_f32 v30, v30
    v_mfma_f32_16x16x32_bf16 v[88:91], a[20:23], a[112:115], v[88:91]
    v_exp_f32 v31, v31
    v_mul_f32 v36, v36, v52
    v_mfma_f32_16x16x32_bf16 v[92:95], a[20:23], a[116:119], v[92:95]
    s_waitcnt lgkmcnt(15)
    ds_read_b64_tr_b16 a[20:21], v6 offset:50432
    v_mul_f32 v37, v37, v53
    v_mul_f32 v38, v38, v54
    v_mfma_f32_16x16x32_bf16 v[64:67], a[24:27], a[120:123], v[64:67]
    ds_read_b64_tr_b16 a[22:23], v6 offset:58624
    v_mul_f32 v39, v39, v55
    v_fma_f32 v28, v28, v18, v18
    v_fma_f32 v29, v29, v18, v18
    v_mfma_f32_16x16x32_bf16 v[68:71], a[24:27], a[124:127], v[68:71]
    v_fma_f32 v30, v30, v18, v18
    v_fma_f32 v31, v31, v18, v18
    v_mfma_f32_16x16x32_bf16 v[72:75], a[24:27], a[128:131], v[72:75]
    v_rcp_f32 v28, v28
    v_rcp_f32 v29, v29
    v_mfma_f32_16x16x32_bf16 v[76:79], a[24:27], a[132:135], v[76:79]
    ds_read_b64_tr_b16 a[24:25], v8 offset:256
    v_rcp_f32 v30, v30
    v_mfma_f32_16x16x32_bf16 v[80:83], a[28:31], a[120:123], v[80:83]
    ds_read_b64_tr_b16 a[26:27], v8 offset:8448
    v_rcp_f32 v31, v31
    v_mfma_f32_16x16x32_bf16 v[84:87], a[28:31], a[124:127], v[84:87]
    v_mul_f32 v36, v36, v28
    v_mul_f32 v37, v37, v29
    v_mul_f32 v38, v38, v30
    v_mfma_f32_16x16x32_bf16 v[88:91], a[28:31], a[128:131], v[88:91]
    v_mul_f32 v39, v39, v31
    v_cvt_pk_bf16_f32 v52, v36, v37
    v_mfma_f32_16x16x32_bf16 v[92:95], a[28:31], a[132:135], v[92:95]
    ds_read_b64_tr_b16 a[28:29], v8 offset:1280
    v_cvt_pk_bf16_f32 v53, v38, v39
    v_mul_f32 v24, v40, v22
    v_mul_f32 v25, v41, v22
    v_mfma_f32_16x16x32_bf16 v[64:67], a[32:35], a[136:139], v[64:67]
    ds_read_b64_tr_b16 a[30:31], v8 offset:9472
    v_mul_f32 v26, v42, v22
    v_mul_f32 v27, v43, v22
    v_mfma_f32_16x16x32_bf16 v[68:71], a[32:35], a[140:143], v[68:71]
    v_exp_f32 v24, v24
    v_exp_f32 v25, v25
    v_mfma_f32_16x16x32_bf16 v[72:75], a[32:35], a[144:147], v[72:75]
    v_exp_f32 v26, v26
    v_mfma_f32_16x16x32_bf16 v[76:79], a[32:35], a[148:151], v[76:79]
    ds_read_b64_tr_b16 a[32:33], v8 offset:16640
    v_exp_f32 v27, v27
    v_mfma_f32_16x16x32_bf16 v[80:83], a[36:39], a[136:139], v[80:83]
    ds_read_b64_tr_b16 a[34:35], v8 offset:24832
    v_mul_f32 v40, v40, v56
    v_mul_f32 v41, v41, v57
    v_mul_f32 v42, v42, v58
    v_mfma_f32_16x16x32_bf16 v[84:87], a[36:39], a[140:143], v[84:87]
    v_mul_f32 v43, v43, v59
    v_fma_f32 v24, v24, v19, v19
    v_mfma_f32_16x16x32_bf16 v[88:91], a[36:39], a[144:147], v[88:91]
    v_fma_f32 v25, v25, v19, v19
    v_fma_f32 v26, v26, v19, v19
    v_fma_f32 v27, v27, v19, v19
    v_mfma_f32_16x16x32_bf16 v[92:95], a[36:39], a[148:151], v[92:95]
    ds_read_b64_tr_b16 a[36:37], v8 offset:17664
    v_rcp_f32 v24, v24
    v_mfma_f32_16x16x32_bf16 v[64:67], a[40:43], a[152:155], v[64:67]
    ds_read_b64_tr_b16 a[38:39], v8 offset:25856
    v_rcp_f32 v25, v25
    v_rcp_f32 v26, v26
    v_mfma_f32_16x16x32_bf16 v[68:71], a[40:43], a[156:159], v[68:71]
    v_rcp_f32 v27, v27
    v_mfma_f32_16x16x32_bf16 v[72:75], a[40:43], a[160:163], v[72:75]
    v_mul_f32 v40, v40, v24
    v_mul_f32 v41, v41, v25
    v_mfma_f32_16x16x32_bf16 v[76:79], a[40:43], a[164:167], v[76:79]
    s_waitcnt lgkmcnt(15)
    ds_read_b64_tr_b16 a[40:41], v4 offset:256
    v_mul_f32 v42, v42, v26
    v_mul_f32 v43, v43, v27
    v_cvt_pk_bf16_f32 v56, v40, v41
    v_mfma_f32_16x16x32_bf16 v[80:83], a[44:47], a[152:155], v[80:83]
    ds_read_b64_tr_b16 a[42:43], v4 offset:8448
    v_cvt_pk_bf16_f32 v57, v42, v43
    v_mul_f32 v28, v44, v23
    v_mfma_f32_16x16x32_bf16 v[84:87], a[44:47], a[156:159], v[84:87]
    v_mul_f32 v29, v45, v23
    v_mul_f32 v30, v46, v23
    v_mul_f32 v31, v47, v23
    v_mfma_f32_16x16x32_bf16 v[88:91], a[44:47], a[160:163], v[88:91]
    v_exp_f32 v28, v28
    v_mfma_f32_16x16x32_bf16 v[92:95], a[44:47], a[164:167], v[92:95]
    ds_read_b64_tr_b16 a[44:45], v4 offset:1280
    v_exp_f32 v29, v29
    v_exp_f32 v30, v30
    v_mfma_f32_16x16x32_bf16 v[64:67], a[48:51], a[168:171], v[64:67]
    ds_read_b64_tr_b16 a[46:47], v4 offset:9472
    v_exp_f32 v31, v31
    v_mfma_f32_16x16x32_bf16 v[68:71], a[48:51], a[172:175], v[68:71]
    v_mul_f32 v44, v44, v60
    v_mul_f32 v45, v45, v61
    v_mfma_f32_16x16x32_bf16 v[72:75], a[48:51], a[176:179], v[72:75]
    v_mul_f32 v46, v46, v62
    v_mul_f32 v47, v47, v63
    v_fma_f32 v28, v28, v20, v20
    v_mfma_f32_16x16x32_bf16 v[76:79], a[48:51], a[180:183], v[76:79]
    ds_read_b64_tr_b16 a[48:49], v4 offset:16640
    v_fma_f32 v29, v29, v20, v20
    v_fma_f32 v30, v30, v20, v20
    v_mfma_f32_16x16x32_bf16 v[80:83], a[52:55], a[168:171], v[80:83]
    ds_read_b64_tr_b16 a[50:51], v4 offset:24832
    v_fma_f32 v31, v31, v20, v20
    v_rcp_f32 v28, v28
    v_mfma_f32_16x16x32_bf16 v[84:87], a[52:55], a[172:175], v[84:87]
    v_rcp_f32 v29, v29
    v_mfma_f32_16x16x32_bf16 v[88:91], a[52:55], a[176:179], v[88:91]
    v_rcp_f32 v30, v30
    v_rcp_f32 v31, v31
    v_mfma_f32_16x16x32_bf16 v[92:95], a[52:55], a[180:183], v[92:95]
    ds_read_b64_tr_b16 a[52:53], v4 offset:17664
    v_mul_f32 v44, v44, v28
    v_mfma_f32_16x16x32_bf16 v[96:99], a[0:3], a[72:75], v[96:99]
    ds_read_b64_tr_b16 a[54:55], v4 offset:25856
    v_mul_f32 v45, v45, v29
    v_mul_f32 v46, v46, v30
    v_mul_f32 v47, v47, v31
    v_mfma_f32_16x16x32_bf16 v[100:103], a[0:3], a[76:79], v[100:103]
    v_cvt_pk_bf16_f32 v60, v44, v45
    v_cvt_pk_bf16_f32 v61, v46, v47
    v_mfma_f32_16x16x32_bf16 v[104:107], a[0:3], a[80:83], v[104:107]
    v_mfma_f32_16x16x32_bf16 v[108:111], a[0:3], a[84:87], v[108:111]
    ds_read_b64_tr_b16 a[0:1], v7 offset:16640
    v_mfma_f32_16x16x32_bf16 v[112:115], a[4:7], a[72:75], v[112:115]
    ds_read_b64_tr_b16 a[2:3], v7 offset:24832
    v_mfma_f32_16x16x32_bf16 v[116:119], a[4:7], a[76:79], v[116:119]
    v_mul_f32 v24, v64, v17
    v_mul_f32 v25, v65, v17
    v_mfma_f32_16x16x32_bf16 v[120:123], a[4:7], a[80:83], v[120:123]
    v_mul_f32 v26, v66, v17
    v_mul_f32 v27, v67, v17
    v_mfma_f32_16x16x32_bf16 v[124:127], a[4:7], a[84:87], v[124:127]
    s_waitcnt lgkmcnt(15)
    ds_read_b64_tr_b16 a[4:5], v7 offset:17664
    v_mfma_f32_16x16x32_bf16 v[96:99], a[8:11], a[88:91], v[96:99]
    ds_read_b64_tr_b16 a[6:7], v7 offset:25856
    v_exp_f32 v24, v24
    v_exp_f32 v25, v25
    v_mfma_f32_16x16x32_bf16 v[100:103], a[8:11], a[92:95], v[100:103]
    v_exp_f32 v26, v26
    v_mfma_f32_16x16x32_bf16 v[104:107], a[8:11], a[96:99], v[104:107]
    v_exp_f32 v27, v27
    v_mul_f32 v64, v64, v80
    v_mfma_f32_16x16x32_bf16 v[108:111], a[8:11], a[100:103], v[108:111]
    ds_read_b64_tr_b16 a[8:9], v7 offset:33024
    v_mul_f32 v65, v65, v81
    v_mul_f32 v66, v66, v82
    v_mul_f32 v67, v67, v83
    v_mfma_f32_16x16x32_bf16 v[112:115], a[12:15], a[88:91], v[112:115]
    ds_read_b64_tr_b16 a[10:11], v7 offset:41216
    v_fma_f32 v24, v24, v16, v16
    v_fma_f32 v25, v25, v16, v16
    v_fma_f32 v26, v26, v16, v16
    v_mfma_f32_16x16x32_bf16 v[116:119], a[12:15], a[92:95], v[116:119]
    v_fma_f32 v27, v27, v16, v16
    v_rcp_f32 v24, v24
    v_mfma_f32_16x16x32_bf16 v[120:123], a[12:15], a[96:99], v[120:123]
    v_rcp_f32 v25, v25
    v_rcp_f32 v26, v26
    v_mfma_f32_16x16x32_bf16 v[124:127], a[12:15], a[100:103], v[124:127]
    ds_read_b64_tr_b16 a[12:13], v7 offset:34048
    v_rcp_f32 v27, v27
    v_mfma_f32_16x16x32_bf16 v[96:99], a[16:19], a[104:107], v[96:99]
    ds_read_b64_tr_b16 a[14:15], v7 offset:42240
    v_mul_f32 v64, v64, v24
    v_mul_f32 v65, v65, v25
    v_mul_f32 v66, v66, v26
    v_mfma_f32_16x16x32_bf16 v[100:103], a[16:19], a[108:111], v[100:103]
    v_mul_f32 v67, v67, v27
    v_cvt_pk_bf16_f32 v50, v64, v65
    v_cvt_pk_bf16_f32 v51, v66, v67
    v_mfma_f32_16x16x32_bf16 v[104:107], a[16:19], a[112:115], v[104:107]
    buffer_store_dwordx4 v[48:51], v1, s[36:39], s34 offen offset:0 sc1
    v_accvgpr_write_b32 a192, v48
    v_mfma_f32_16x16x32_bf16 v[108:111], a[16:19], a[116:119], v[108:111]
    ds_read_b64_tr_b16 a[16:17], v7 offset:49408
    v_accvgpr_write_b32 a193, v49
    v_accvgpr_write_b32 a194, v50
    v_accvgpr_write_b32 a195, v51
    v_mfma_f32_16x16x32_bf16 v[112:115], a[20:23], a[104:107], v[112:115]
    ds_read_b64_tr_b16 a[18:19], v7 offset:57600
    v_mul_f32 v28, v68, v21
    v_mul_f32 v29, v69, v21
    v_mul_f32 v30, v70, v21
    v_mfma_f32_16x16x32_bf16 v[116:119], a[20:23], a[108:111], v[116:119]
    v_mul_f32 v31, v71, v21
    v_exp_f32 v28, v28
    v_mfma_f32_16x16x32_bf16 v[120:123], a[20:23], a[112:115], v[120:123]
    v_exp_f32 v29, v29
    v_exp_f32 v30, v30
    v_mfma_f32_16x16x32_bf16 v[124:127], a[20:23], a[116:119], v[124:127]
    ds_read_b64_tr_b16 a[20:21], v7 offset:50432
    v_exp_f32 v31, v31
    v_mfma_f32_16x16x32_bf16 v[96:99], a[24:27], a[120:123], v[96:99]
    ds_read_b64_tr_b16 a[22:23], v7 offset:58624
    v_mul_f32 v68, v68, v84
    v_mul_f32 v69, v69, v85
    v_mul_f32 v70, v70, v86
    v_mfma_f32_16x16x32_bf16 v[100:103], a[24:27], a[124:127], v[100:103]
    v_mul_f32 v71, v71, v87
    v_fma_f32 v28, v28, v18, v18
    v_fma_f32 v29, v29, v18, v18
    v_mfma_f32_16x16x32_bf16 v[104:107], a[24:27], a[128:131], v[104:107]
    v_fma_f32 v30, v30, v18, v18
    v_fma_f32 v31, v31, v18, v18
    v_rcp_f32 v28, v28
    v_mfma_f32_16x16x32_bf16 v[108:111], a[24:27], a[132:135], v[108:111]
    s_waitcnt lgkmcnt(15)
    ds_read_b64_tr_b16 a[24:25], v9 offset:256
    v_rcp_f32 v29, v29
    v_mfma_f32_16x16x32_bf16 v[112:115], a[28:31], a[120:123], v[112:115]
    ds_read_b64_tr_b16 a[26:27], v9 offset:8448
    v_rcp_f32 v30, v30
    v_rcp_f32 v31, v31
    v_mfma_f32_16x16x32_bf16 v[116:119], a[28:31], a[124:127], v[116:119]
    v_mul_f32 v68, v68, v28
    v_mul_f32 v69, v69, v29
    v_mfma_f32_16x16x32_bf16 v[120:123], a[28:31], a[128:131], v[120:123]
    v_mul_f32 v70, v70, v30
    v_mul_f32 v71, v71, v31
    v_cvt_pk_bf16_f32 v54, v68, v69
    v_mfma_f32_16x16x32_bf16 v[124:127], a[28:31], a[132:135], v[124:127]
    ds_read_b64_tr_b16 a[28:29], v9 offset:1280
    v_cvt_pk_bf16_f32 v55, v70, v71
    v_mfma_f32_16x16x32_bf16 v[96:99], a[32:35], a[136:139], v[96:99]
    buffer_store_dwordx4 v[52:55], v1, s[36:39], s34 offen offset:1024 sc1
    v_accvgpr_write_b32 a196, v52
    v_accvgpr_write_b32 a197, v53
    v_accvgpr_write_b32 a198, v54
    v_mfma_f32_16x16x32_bf16 v[100:103], a[32:35], a[140:143], v[100:103]
    ds_read_b64_tr_b16 a[30:31], v9 offset:9472
    v_accvgpr_write_b32 a199, v55
    v_mul_f32 v24, v72, v22
    v_mul_f32 v25, v73, v22
    v_mfma_f32_16x16x32_bf16 v[104:107], a[32:35], a[144:147], v[104:107]
    v_mul_f32 v26, v74, v22
    v_mul_f32 v27, v75, v22
    v_exp_f32 v24, v24
    v_mfma_f32_16x16x32_bf16 v[108:111], a[32:35], a[148:151], v[108:111]
    ds_read_b64_tr_b16 a[32:33], v9 offset:16640
    v_exp_f32 v25, v25
    v_mfma_f32_16x16x32_bf16 v[112:115], a[36:39], a[136:139], v[112:115]
    ds_read_b64_tr_b16 a[34:35], v9 offset:24832
    v_exp_f32 v26, v26
    v_exp_f32 v27, v27
    v_mfma_f32_16x16x32_bf16 v[116:119], a[36:39], a[140:143], v[116:119]
    v_mul_f32 v72, v72, v88
    v_mul_f32 v73, v73, v89
    v_mfma_f32_16x16x32_bf16 v[120:123], a[36:39], a[144:147], v[120:123]
    v_mul_f32 v74, v74, v90
    v_mul_f32 v75, v75, v91
    v_fma_f32 v24, v24, v19, v19
    v_mfma_f32_16x16x32_bf16 v[124:127], a[36:39], a[148:151], v[124:127]
    ds_read_b64_tr_b16 a[36:37], v9 offset:17664
    v_fma_f32 v25, v25, v19, v19
    v_fma_f32 v26, v26, v19, v19
    v_fma_f32 v27, v27, v19, v19
    v_mfma_f32_16x16x32_bf16 v[96:99], a[40:43], a[152:155], v[96:99]
    ds_read_b64_tr_b16 a[38:39], v9 offset:25856
    v_rcp_f32 v24, v24
    v_rcp_f32 v25, v25
    v_mfma_f32_16x16x32_bf16 v[100:103], a[40:43], a[156:159], v[100:103]
    v_rcp_f32 v26, v26
    v_mfma_f32_16x16x32_bf16 v[104:107], a[40:43], a[160:163], v[104:107]
    v_rcp_f32 v27, v27
    v_mul_f32 v72, v72, v24
    v_mul_f32 v73, v73, v25
    v_mfma_f32_16x16x32_bf16 v[108:111], a[40:43], a[164:167], v[108:111]
    ds_read_b64_tr_b16 a[40:41], v5 offset:256
    v_mul_f32 v74, v74, v26
    v_mul_f32 v75, v75, v27
    v_cvt_pk_bf16_f32 v58, v72, v73
    v_mfma_f32_16x16x32_bf16 v[112:115], a[44:47], a[152:155], v[112:115]
    ds_read_b64_tr_b16 a[42:43], v5 offset:8448
    v_cvt_pk_bf16_f32 v59, v74, v75
    v_mfma_f32_16x16x32_bf16 v[116:119], a[44:47], a[156:159], v[116:119]
    buffer_store_dwordx4 v[56:59], v1, s[36:39], s34 offen offset:2048 sc1
    v_accvgpr_write_b32 a200, v56
    v_accvgpr_write_b32 a201, v57
    v_accvgpr_write_b32 a202, v58
    v_mfma_f32_16x16x32_bf16 v[120:123], a[44:47], a[160:163], v[120:123]
    v_accvgpr_write_b32 a203, v59
    v_mul_f32 v28, v76, v23
    v_mul_f32 v29, v77, v23
    v_mfma_f32_16x16x32_bf16 v[124:127], a[44:47], a[164:167], v[124:127]
    s_waitcnt lgkmcnt(2)
    ds_read_b64_tr_b16 a[44:45], v5 offset:1280
    v_mul_f32 v30, v78, v23
    v_mul_f32 v31, v79, v23
    v_exp_f32 v28, v28
    v_mfma_f32_16x16x32_bf16 v[96:99], a[48:51], a[168:171], v[96:99]
    ds_read_b64_tr_b16 a[46:47], v5 offset:9472
    v_exp_f32 v29, v29
    v_mfma_f32_16x16x32_bf16 v[100:103], a[48:51], a[172:175], v[100:103]
    v_exp_f32 v30, v30
    v_exp_f32 v31, v31
    v_mfma_f32_16x16x32_bf16 v[104:107], a[48:51], a[176:179], v[104:107]
    v_mul_f32 v76, v76, v92
    v_mul_f32 v77, v77, v93
    v_mfma_f32_16x16x32_bf16 v[108:111], a[48:51], a[180:183], v[108:111]
    ds_read_b64_tr_b16 a[48:49], v5 offset:16640
    v_mul_f32 v78, v78, v94
    v_mul_f32 v79, v79, v95
    v_fma_f32 v28, v28, v20, v20
    v_mfma_f32_16x16x32_bf16 v[112:115], a[52:55], a[168:171], v[112:115]
    ds_read_b64_tr_b16 a[50:51], v5 offset:24832
    v_fma_f32 v29, v29, v20, v20
    v_fma_f32 v30, v30, v20, v20
    v_fma_f32 v31, v31, v20, v20
    v_mfma_f32_16x16x32_bf16 v[116:119], a[52:55], a[172:175], v[116:119]
    v_rcp_f32 v28, v28
    v_rcp_f32 v29, v29
    v_mfma_f32_16x16x32_bf16 v[120:123], a[52:55], a[176:179], v[120:123]
    v_rcp_f32 v30, v30
    v_mfma_f32_16x16x32_bf16 v[124:127], a[52:55], a[180:183], v[124:127]
    ds_read_b64_tr_b16 a[52:53], v5 offset:17664
    v_rcp_f32 v31, v31
    v_mul_f32 v76, v76, v28
    v_mfma_f32_16x16x32_bf16 v[128:131], a[0:3], a[72:75], v[128:131]
    ds_read_b64_tr_b16 a[54:55], v5 offset:25856
    v_mul_f32 v77, v77, v29
    v_mul_f32 v78, v78, v30
    v_mul_f32 v79, v79, v31
    v_mfma_f32_16x16x32_bf16 v[132:135], a[0:3], a[76:79], v[132:135]
    v_cvt_pk_bf16_f32 v62, v76, v77
    v_cvt_pk_bf16_f32 v63, v78, v79
    v_mfma_f32_16x16x32_bf16 v[136:139], a[0:3], a[80:83], v[136:139]
    buffer_store_dwordx4 v[60:63], v1, s[36:39], s34 offen offset:3072 sc1
    v_bfe_u32 v65, v0, 2, 3
    v_accvgpr_write_b32 a204, v60
    v_accvgpr_write_b32 a205, v61
    v_mfma_f32_16x16x32_bf16 v[140:143], a[0:3], a[84:87], v[140:143]
    ds_read_b64_tr_b16 a[0:1], v6 offset:16896
    v_accvgpr_write_b32 a206, v62
    v_accvgpr_write_b32 a207, v63
    v_mfma_f32_16x16x32_bf16 v[144:147], a[4:7], a[72:75], v[144:147]
    s_add_u32 s34, s34, 4096
    ds_read_b64_tr_b16 a[2:3], v6 offset:25088
    v_lshrrev_b32 v64, 5, v0
    v_mfma_f32_16x16x32_bf16 v[148:151], a[4:7], a[76:79], v[148:151]
    v_mfma_f32_16x16x32_bf16 v[152:155], a[4:7], a[80:83], v[152:155]
    v_mfma_f32_16x16x32_bf16 v[156:159], a[4:7], a[84:87], v[156:159]
    ds_read_b64_tr_b16 a[4:5], v6 offset:17920
    v_mul_f32 v24, v96, v17
    v_mfma_f32_16x16x32_bf16 v[128:131], a[8:11], a[88:91], v[128:131]
    ds_read_b64_tr_b16 a[6:7], v6 offset:26112
    v_mul_f32 v25, v97, v17
    v_mfma_f32_16x16x32_bf16 v[132:135], a[8:11], a[92:95], v[132:135]
    v_mul_f32 v26, v98, v17
    v_lshlrev_b32 v64, 10, v64
    v_mfma_f32_16x16x32_bf16 v[136:139], a[8:11], a[96:99], v[136:139]
    v_mul_f32 v27, v99, v17
    v_exp_f32 v24, v24
    v_mfma_f32_16x16x32_bf16 v[140:143], a[8:11], a[100:103], v[140:143]
    ds_read_b64_tr_b16 a[8:9], v6 offset:33280
    v_exp_f32 v25, v25
    v_mfma_f32_16x16x32_bf16 v[144:147], a[12:15], a[88:91], v[144:147]
    ds_read_b64_tr_b16 a[10:11], v6 offset:41472
    v_exp_f32 v26, v26
    v_exp_f32 v27, v27
    v_mfma_f32_16x16x32_bf16 v[148:151], a[12:15], a[92:95], v[148:151]
    v_mul_f32 v96, v96, v112
    v_lshl_add_u32 v64, v65, 7, v64
    v_mfma_f32_16x16x32_bf16 v[152:155], a[12:15], a[96:99], v[152:155]
    v_mul_f32 v97, v97, v113
    v_mul_f32 v98, v98, v114
    v_mul_f32 v99, v99, v115
    v_mfma_f32_16x16x32_bf16 v[156:159], a[12:15], a[100:103], v[156:159]
    ds_read_b64_tr_b16 a[12:13], v6 offset:34304
    v_fma_f32 v24, v24, v16, v16
    v_fma_f32 v25, v25, v16, v16
    v_mfma_f32_16x16x32_bf16 v[128:131], a[16:19], a[104:107], v[128:131]
    ds_read_b64_tr_b16 a[14:15], v6 offset:42496
    v_fma_f32 v26, v26, v16, v16
    v_fma_f32 v27, v27, v16, v16
    v_rcp_f32 v24, v24
    v_mfma_f32_16x16x32_bf16 v[132:135], a[16:19], a[108:111], v[132:135]
    v_rcp_f32 v25, v25
    v_mfma_f32_16x16x32_bf16 v[136:139], a[16:19], a[112:115], v[136:139]
    v_rcp_f32 v26, v26
    v_mfma_f32_16x16x32_bf16 v[140:143], a[16:19], a[116:119], v[140:143]
    ds_read_b64_tr_b16 a[16:17], v6 offset:49664
    v_and_b32 v66, 3, v0
    v_rcp_f32 v27, v27
    v_mul_f32 v96, v96, v24
    v_mfma_f32_16x16x32_bf16 v[144:147], a[20:23], a[104:107], v[144:147]
    ds_read_b64_tr_b16 a[18:19], v6 offset:57856
    v_mul_f32 v97, v97, v25
    v_mul_f32 v98, v98, v26
    v_mfma_f32_16x16x32_bf16 v[148:151], a[20:23], a[108:111], v[148:151]
    v_mul_f32 v99, v99, v27
    v_cvt_pk_bf16_f32 v112, v96, v97
    v_cvt_pk_bf16_f32 v113, v98, v99
    v_mfma_f32_16x16x32_bf16 v[152:155], a[20:23], a[112:115], v[152:155]
    v_mul_f32 v28, v100, v21
    v_mul_f32 v29, v101, v21
    v_mfma_f32_16x16x32_bf16 v[156:159], a[20:23], a[116:119], v[156:159]
    ds_read_b64_tr_b16 a[20:21], v6 offset:50688
    v_lshl_add_u32 v64, v66, 3, v64
    v_mul_f32 v30, v102, v21
    v_mul_f32 v31, v103, v21
    v_exp_f32 v28, v28
    v_mfma_f32_16x16x32_bf16 v[128:131], a[24:27], a[120:123], v[128:131]
    ds_read_b64_tr_b16 a[22:23], v6 offset:58880
    v_exp_f32 v29, v29
    v_mfma_f32_16x16x32_bf16 v[132:135], a[24:27], a[124:127], v[132:135]
    v_exp_f32 v30, v30
    v_mfma_f32_16x16x32_bf16 v[136:139], a[24:27], a[128:131], v[136:139]
    v_exp_f32 v31, v31
    v_mul_f32 v100, v100, v116
    v_mfma_f32_16x16x32_bf16 v[140:143], a[24:27], a[132:135], v[140:143]
    ds_read_b64_tr_b16 a[24:25], v8 offset:512
    v_lshrrev_b32 v65, 1, v65
    v_mul_f32 v101, v101, v117
    v_mul_f32 v102, v102, v118
    v_mfma_f32_16x16x32_bf16 v[144:147], a[28:31], a[120:123], v[144:147]
    ds_read_b64_tr_b16 a[26:27], v8 offset:8704
    v_mul_f32 v103, v103, v119
    v_fma_f32 v28, v28, v18, v18
    v_fma_f32 v29, v29, v18, v18
    v_mfma_f32_16x16x32_bf16 v[148:151], a[28:31], a[124:127], v[148:151]
    v_fma_f32 v30, v30, v18, v18
    v_fma_f32 v31, v31, v18, v18
    v_mfma_f32_16x16x32_bf16 v[152:155], a[28:31], a[128:131], v[152:155]
    v_rcp_f32 v28, v28
    v_rcp_f32 v29, v29
    v_mfma_f32_16x16x32_bf16 v[156:159], a[28:31], a[132:135], v[156:159]
    ds_read_b64_tr_b16 a[28:29], v8 offset:1536
    v_rcp_f32 v30, v30
    v_mfma_f32_16x16x32_bf16 v[128:131], a[32:35], a[136:139], v[128:131]
    ds_read_b64_tr_b16 a[30:31], v8 offset:9728
    v_lshl_add_u32 v64, v65, 5, v64
    v_rcp_f32 v31, v31
    v_mfma_f32_16x16x32_bf16 v[132:135], a[32:35], a[140:143], v[132:135]
    v_mul_f32 v100, v100, v28
    v_mul_f32 v101, v101, v29
    v_mul_f32 v102, v102, v30
    v_mfma_f32_16x16x32_bf16 v[136:139], a[32:35], a[144:147], v[136:139]
    s_and_b32 s62, s60, 1
    v_mul_f32 v103, v103, v31
    v_cvt_pk_bf16_f32 v116, v100, v101
    v_mfma_f32_16x16x32_bf16 v[140:143], a[32:35], a[148:151], v[140:143]
    ds_read_b64_tr_b16 a[32:33], v8 offset:16896
    v_cvt_pk_bf16_f32 v117, v102, v103
    v_mul_f32 v24, v104, v22
    v_mul_f32 v25, v105, v22
    v_mfma_f32_16x16x32_bf16 v[144:147], a[36:39], a[136:139], v[144:147]
    s_lshl_b32 s62, s62, 6
    ds_read_b64_tr_b16 a[34:35], v8 offset:25088
    v_mul_f32 v26, v106, v22
    v_mul_f32 v27, v107, v22
    v_mfma_f32_16x16x32_bf16 v[148:151], a[36:39], a[140:143], v[148:151]
    v_exp_f32 v24, v24
    v_exp_f32 v25, v25
    v_mfma_f32_16x16x32_bf16 v[152:155], a[36:39], a[144:147], v[152:155]
    v_exp_f32 v26, v26
    v_mfma_f32_16x16x32_bf16 v[156:159], a[36:39], a[148:151], v[156:159]
    s_waitcnt lgkmcnt(2)
    ds_read_b64_tr_b16 a[36:37], v8 offset:17920
    v_exp_f32 v27, v27
    v_mfma_f32_16x16x32_bf16 v[128:131], a[40:43], a[152:155], v[128:131]
    ds_read_b64_tr_b16 a[38:39], v8 offset:26112
    v_xor_b32 v64, s62, v64
    v_mul_f32 v104, v104, v120
    v_mul_f32 v105, v105, v121
    v_mul_f32 v106, v106, v122
    v_mfma_f32_16x16x32_bf16 v[132:135], a[40:43], a[156:159], v[132:135]
    v_mul_f32 v107, v107, v123
    v_fma_f32 v24, v24, v19, v19
    v_mfma_f32_16x16x32_bf16 v[136:139], a[40:43], a[160:163], v[136:139]
    v_fma_f32 v25, v25, v19, v19
    v_fma_f32 v26, v26, v19, v19
    v_fma_f32 v27, v27, v19, v19
    v_mfma_f32_16x16x32_bf16 v[140:143], a[40:43], a[164:167], v[140:143]
    ds_read_b64_tr_b16 a[40:41], v4 offset:512
    v_rcp_f32 v24, v24
    v_mfma_f32_16x16x32_bf16 v[144:147], a[44:47], a[152:155], v[144:147]
    ds_read_b64_tr_b16 a[42:43], v4 offset:8704
    v_rcp_f32 v25, v25
    v_rcp_f32 v26, v26
    v_mfma_f32_16x16x32_bf16 v[148:151], a[44:47], a[156:159], v[148:151]
    v_xor_b32 v65, 32, v64
    v_rcp_f32 v27, v27
    v_mfma_f32_16x16x32_bf16 v[152:155], a[44:47], a[160:163], v[152:155]
    v_mul_f32 v104, v104, v24
    v_mul_f32 v105, v105, v25
    v_mfma_f32_16x16x32_bf16 v[156:159], a[44:47], a[164:167], v[156:159]
    ds_read_b64_tr_b16 a[44:45], v4 offset:1536
    v_mul_f32 v106, v106, v26
    v_mul_f32 v107, v107, v27
    v_cvt_pk_bf16_f32 v120, v104, v105
    v_mfma_f32_16x16x32_bf16 v[128:131], a[48:51], a[168:171], v[128:131]
    ds_read_b64_tr_b16 a[46:47], v4 offset:9728
    v_cvt_pk_bf16_f32 v121, v106, v107
    v_mul_f32 v28, v108, v23
    v_mfma_f32_16x16x32_bf16 v[132:135], a[48:51], a[172:175], v[132:135]
    v_xor_b32 v66, 64, v64
    v_mul_f32 v29, v109, v23
    v_mul_f32 v30, v110, v23
    v_mul_f32 v31, v111, v23
    v_mfma_f32_16x16x32_bf16 v[136:139], a[48:51], a[176:179], v[136:139]
    v_exp_f32 v28, v28
    v_mfma_f32_16x16x32_bf16 v[140:143], a[48:51], a[180:183], v[140:143]
    ds_read_b64_tr_b16 a[48:49], v4 offset:16896
    v_exp_f32 v29, v29
    v_exp_f32 v30, v30
    v_mfma_f32_16x16x32_bf16 v[144:147], a[52:55], a[168:171], v[144:147]
    ds_read_b64_tr_b16 a[50:51], v4 offset:25088
    v_exp_f32 v31, v31
    v_mfma_f32_16x16x32_bf16 v[148:151], a[52:55], a[172:175], v[148:151]
    v_xor_b32 v67, 96, v64
    v_mul_f32 v108, v108, v124
    v_mul_f32 v109, v109, v125
    v_mfma_f32_16x16x32_bf16 v[152:155], a[52:55], a[176:179], v[152:155]
    v_mul_f32 v110, v110, v126
    v_mul_f32 v111, v111, v127
    v_fma_f32 v28, v28, v20, v20
    v_mfma_f32_16x16x32_bf16 v[156:159], a[52:55], a[180:183], v[156:159]
    ds_read_b64_tr_b16 a[52:53], v4 offset:17920
    v_fma_f32 v29, v29, v20, v20
    v_fma_f32 v30, v30, v20, v20
    v_mfma_f32_16x16x32_bf16 v[160:163], a[0:3], a[72:75], v[160:163]
    ds_read_b64_tr_b16 a[54:55], v4 offset:26112
    v_fma_f32 v31, v31, v20, v20
    v_rcp_f32 v28, v28
    v_mfma_f32_16x16x32_bf16 v[164:167], a[0:3], a[76:79], v[164:167]
    v_rcp_f32 v29, v29
    v_mfma_f32_16x16x32_bf16 v[168:171], a[0:3], a[80:83], v[168:171]
    v_rcp_f32 v30, v30
    v_rcp_f32 v31, v31
    v_mfma_f32_16x16x32_bf16 v[172:175], a[0:3], a[84:87], v[172:175]
    ds_read_b64_tr_b16 a[0:1], v7 offset:16896
    v_mul_f32 v108, v108, v28
    v_mfma_f32_16x16x32_bf16 v[176:179], a[4:7], a[72:75], v[176:179]
    ds_read_b64_tr_b16 a[2:3], v7 offset:25088
    v_mul_f32 v109, v109, v29
    v_mul_f32 v110, v110, v30
    v_mul_f32 v111, v111, v31
    v_mfma_f32_16x16x32_bf16 v[180:183], a[4:7], a[76:79], v[180:183]
    v_cvt_pk_bf16_f32 v124, v108, v109
    v_cvt_pk_bf16_f32 v125, v110, v111
    v_mfma_f32_16x16x32_bf16 v[184:187], a[4:7], a[80:83], v[184:187]
    v_mfma_f32_16x16x32_bf16 v[188:191], a[4:7], a[84:87], v[188:191]
    ds_read_b64_tr_b16 a[4:5], v7 offset:17920
    v_mfma_f32_16x16x32_bf16 v[160:163], a[8:11], a[88:91], v[160:163]
    ds_read_b64_tr_b16 a[6:7], v7 offset:26112
    v_mfma_f32_16x16x32_bf16 v[164:167], a[8:11], a[92:95], v[164:167]
    v_mul_f32 v24, v128, v17
    v_mul_f32 v25, v129, v17
    v_mfma_f32_16x16x32_bf16 v[168:171], a[8:11], a[96:99], v[168:171]
    v_mul_f32 v26, v130, v17
    v_mul_f32 v27, v131, v17
    v_mfma_f32_16x16x32_bf16 v[172:175], a[8:11], a[100:103], v[172:175]
    ds_read_b64_tr_b16 a[8:9], v7 offset:33280
    v_mfma_f32_16x16x32_bf16 v[176:179], a[12:15], a[88:91], v[176:179]
    ds_read_b64_tr_b16 a[10:11], v7 offset:41472
    v_exp_f32 v24, v24
    v_exp_f32 v25, v25
    v_mfma_f32_16x16x32_bf16 v[180:183], a[12:15], a[92:95], v[180:183]
    v_exp_f32 v26, v26
    v_mfma_f32_16x16x32_bf16 v[184:187], a[12:15], a[96:99], v[184:187]
    v_exp_f32 v27, v27
    v_mul_f32 v128, v128, v144
    v_mfma_f32_16x16x32_bf16 v[188:191], a[12:15], a[100:103], v[188:191]
    ds_read_b64_tr_b16 a[12:13], v7 offset:34304
    v_mul_f32 v129, v129, v145
    v_mul_f32 v130, v130, v146
    v_mul_f32 v131, v131, v147
    v_mfma_f32_16x16x32_bf16 v[160:163], a[16:19], a[104:107], v[160:163]
    ds_read_b64_tr_b16 a[14:15], v7 offset:42496
    v_fma_f32 v24, v24, v16, v16
    v_fma_f32 v25, v25, v16, v16
    v_fma_f32 v26, v26, v16, v16
    v_mfma_f32_16x16x32_bf16 v[164:167], a[16:19], a[108:111], v[164:167]
    v_mov_b32 v14, 1
    v_fma_f32 v27, v27, v16, v16
    v_rcp_f32 v24, v24
    v_mfma_f32_16x16x32_bf16 v[168:171], a[16:19], a[112:115], v[168:171]
    s_waitcnt vmcnt(0)
    buffer_store_dword v14, v15, s[44:47], s56 offen sc1
    v_rcp_f32 v25, v25
    v_rcp_f32 v26, v26
    v_mfma_f32_16x16x32_bf16 v[172:175], a[16:19], a[116:119], v[172:175]
    ds_read_b64_tr_b16 a[16:17], v7 offset:49664
    v_rcp_f32 v27, v27
    v_mfma_f32_16x16x32_bf16 v[176:179], a[20:23], a[104:107], v[176:179]
    ds_read_b64_tr_b16 a[18:19], v7 offset:57856
    v_mul_f32 v128, v128, v24
    v_mul_f32 v129, v129, v25
    v_mul_f32 v130, v130, v26
    v_mfma_f32_16x16x32_bf16 v[180:183], a[20:23], a[108:111], v[180:183]
    v_mul_f32 v131, v131, v27
    v_cvt_pk_bf16_f32 v114, v128, v129
    v_cvt_pk_bf16_f32 v115, v130, v131
    v_mfma_f32_16x16x32_bf16 v[184:187], a[20:23], a[112:115], v[184:187]
    buffer_store_dwordx4 v[112:115], v1, s[36:39], s34 offen offset:0 sc1
    v_accvgpr_write_b32 a208, v112
    v_mfma_f32_16x16x32_bf16 v[188:191], a[20:23], a[116:119], v[188:191]
    ds_read_b64_tr_b16 a[20:21], v7 offset:50688
    v_accvgpr_write_b32 a209, v113
    v_accvgpr_write_b32 a210, v114
    v_accvgpr_write_b32 a211, v115
    v_mfma_f32_16x16x32_bf16 v[160:163], a[24:27], a[120:123], v[160:163]
    ds_read_b64_tr_b16 a[22:23], v7 offset:58880
    v_mul_f32 v28, v132, v21
    v_mul_f32 v29, v133, v21
    v_mul_f32 v30, v134, v21
    v_mfma_f32_16x16x32_bf16 v[164:167], a[24:27], a[124:127], v[164:167]
    v_mul_f32 v31, v135, v21
    v_exp_f32 v28, v28
    v_mfma_f32_16x16x32_bf16 v[168:171], a[24:27], a[128:131], v[168:171]
    v_exp_f32 v29, v29
    v_exp_f32 v30, v30
    v_mfma_f32_16x16x32_bf16 v[172:175], a[24:27], a[132:135], v[172:175]
    ds_read_b64_tr_b16 a[24:25], v9 offset:512
    v_exp_f32 v31, v31
    v_mfma_f32_16x16x32_bf16 v[176:179], a[28:31], a[120:123], v[176:179]
    ds_read_b64_tr_b16 a[26:27], v9 offset:8704
    v_mul_f32 v132, v132, v148
    v_mul_f32 v133, v133, v149
    v_mul_f32 v134, v134, v150
    v_mfma_f32_16x16x32_bf16 v[180:183], a[28:31], a[124:127], v[180:183]
    v_mul_f32 v135, v135, v151
    v_fma_f32 v28, v28, v18, v18
    v_fma_f32 v29, v29, v18, v18
    v_mfma_f32_16x16x32_bf16 v[184:187], a[28:31], a[128:131], v[184:187]
    v_fma_f32 v30, v30, v18, v18
    v_fma_f32 v31, v31, v18, v18
    v_rcp_f32 v28, v28
    v_mfma_f32_16x16x32_bf16 v[188:191], a[28:31], a[132:135], v[188:191]
    s_waitcnt lgkmcnt(2)
    ds_read_b64_tr_b16 a[28:29], v9 offset:1536
    v_rcp_f32 v29, v29
    v_mfma_f32_16x16x32_bf16 v[160:163], a[32:35], a[136:139], v[160:163]
    ds_read_b64_tr_b16 a[30:31], v9 offset:9728
    v_rcp_f32 v30, v30
    v_rcp_f32 v31, v31
    v_mfma_f32_16x16x32_bf16 v[164:167], a[32:35], a[140:143], v[164:167]
    v_mul_f32 v132, v132, v28
    v_mul_f32 v133, v133, v29
    v_mfma_f32_16x16x32_bf16 v[168:171], a[32:35], a[144:147], v[168:171]
    v_mul_f32 v134, v134, v30
    v_mul_f32 v135, v135, v31
    v_cvt_pk_bf16_f32 v118, v132, v133
    v_mfma_f32_16x16x32_bf16 v[172:175], a[32:35], a[148:151], v[172:175]
    ds_read_b64_tr_b16 a[32:33], v9 offset:16896
    v_cvt_pk_bf16_f32 v119, v134, v135
    v_mfma_f32_16x16x32_bf16 v[176:179], a[36:39], a[136:139], v[176:179]
    buffer_store_dwordx4 v[116:119], v1, s[36:39], s34 offen offset:1024 sc1
    v_accvgpr_write_b32 a212, v116
    v_accvgpr_write_b32 a213, v117
    v_accvgpr_write_b32 a214, v118
    v_mfma_f32_16x16x32_bf16 v[180:183], a[36:39], a[140:143], v[180:183]
    ds_read_b64_tr_b16 a[34:35], v9 offset:25088
    v_accvgpr_write_b32 a215, v119
    v_mul_f32 v24, v136, v22
    v_mul_f32 v25, v137, v22
    v_mfma_f32_16x16x32_bf16 v[184:187], a[36:39], a[144:147], v[184:187]
    v_mul_f32 v26, v138, v22
    v_mul_f32 v27, v139, v22
    v_exp_f32 v24, v24
    v_mfma_f32_16x16x32_bf16 v[188:191], a[36:39], a[148:151], v[188:191]
    ds_read_b64_tr_b16 a[36:37], v9 offset:17920
    v_exp_f32 v25, v25
    v_mfma_f32_16x16x32_bf16 v[160:163], a[40:43], a[152:155], v[160:163]
    ds_read_b64_tr_b16 a[38:39], v9 offset:26112
    v_exp_f32 v26, v26
    v_exp_f32 v27, v27
    v_mfma_f32_16x16x32_bf16 v[164:167], a[40:43], a[156:159], v[164:167]
    v_mul_f32 v136, v136, v152
    v_mul_f32 v137, v137, v153
    v_mfma_f32_16x16x32_bf16 v[168:171], a[40:43], a[160:163], v[168:171]
    v_mul_f32 v138, v138, v154
    v_mul_f32 v139, v139, v155
    v_fma_f32 v24, v24, v19, v19
    v_mfma_f32_16x16x32_bf16 v[172:175], a[40:43], a[164:167], v[172:175]
    ds_read_b64_tr_b16 a[40:41], v5 offset:512
    v_fma_f32 v25, v25, v19, v19
    v_fma_f32 v26, v26, v19, v19
    v_fma_f32 v27, v27, v19, v19
    v_mfma_f32_16x16x32_bf16 v[176:179], a[44:47], a[152:155], v[176:179]
    ds_read_b64_tr_b16 a[42:43], v5 offset:8704
    v_rcp_f32 v24, v24
    v_rcp_f32 v25, v25
    v_mfma_f32_16x16x32_bf16 v[180:183], a[44:47], a[156:159], v[180:183]
    v_rcp_f32 v26, v26
    v_mfma_f32_16x16x32_bf16 v[184:187], a[44:47], a[160:163], v[184:187]
    v_rcp_f32 v27, v27
    v_mul_f32 v136, v136, v24
    v_mul_f32 v137, v137, v25
    v_mfma_f32_16x16x32_bf16 v[188:191], a[44:47], a[164:167], v[188:191]
    ds_read_b64_tr_b16 a[44:45], v5 offset:1536
    v_mul_f32 v138, v138, v26
    v_mul_f32 v139, v139, v27
    v_cvt_pk_bf16_f32 v122, v136, v137
    v_mfma_f32_16x16x32_bf16 v[160:163], a[48:51], a[168:171], v[160:163]
    ds_read_b64_tr_b16 a[46:47], v5 offset:9728
    v_cvt_pk_bf16_f32 v123, v138, v139
    v_mfma_f32_16x16x32_bf16 v[164:167], a[48:51], a[172:175], v[164:167]
    buffer_store_dwordx4 v[120:123], v1, s[36:39], s34 offen offset:2048 sc1
    v_accvgpr_write_b32 a216, v120
    v_accvgpr_write_b32 a217, v121
    v_accvgpr_write_b32 a218, v122
    v_mfma_f32_16x16x32_bf16 v[168:171], a[48:51], a[176:179], v[168:171]
    v_accvgpr_write_b32 a219, v123
    v_mul_f32 v28, v140, v23
    v_mul_f32 v29, v141, v23
    v_mfma_f32_16x16x32_bf16 v[172:175], a[48:51], a[180:183], v[172:175]
    ds_read_b64_tr_b16 a[48:49], v5 offset:16896
    v_mul_f32 v30, v142, v23
    v_mul_f32 v31, v143, v23
    v_exp_f32 v28, v28
    v_mfma_f32_16x16x32_bf16 v[176:179], a[52:55], a[168:171], v[176:179]
    ds_read_b64_tr_b16 a[50:51], v5 offset:25088
    v_exp_f32 v29, v29
    v_mfma_f32_16x16x32_bf16 v[180:183], a[52:55], a[172:175], v[180:183]
    v_exp_f32 v30, v30
    v_exp_f32 v31, v31
    v_mfma_f32_16x16x32_bf16 v[184:187], a[52:55], a[176:179], v[184:187]
    v_mul_f32 v140, v140, v156
    v_mul_f32 v141, v141, v157
    v_mfma_f32_16x16x32_bf16 v[188:191], a[52:55], a[180:183], v[188:191]
    ds_read_b64_tr_b16 a[52:53], v5 offset:17920
    v_mul_f32 v142, v142, v158
    v_mul_f32 v143, v143, v159
    v_fma_f32 v28, v28, v20, v20
    v_mfma_f32_16x16x32_bf16 v[192:195], a[0:3], a[72:75], v[192:195]
    ds_read_b64_tr_b16 a[54:55], v5 offset:26112
    v_fma_f32 v29, v29, v20, v20
    v_fma_f32 v30, v30, v20, v20
    v_fma_f32 v31, v31, v20, v20
    v_mfma_f32_16x16x32_bf16 v[196:199], a[0:3], a[76:79], v[196:199]
    v_rcp_f32 v28, v28
    v_rcp_f32 v29, v29
    v_mfma_f32_16x16x32_bf16 v[200:203], a[0:3], a[80:83], v[200:203]
    v_rcp_f32 v30, v30
    v_mfma_f32_16x16x32_bf16 v[204:207], a[0:3], a[84:87], v[204:207]
    ds_read_b64_tr_b16 a[0:1], v6 offset:17152
    v_rcp_f32 v31, v31
    v_mul_f32 v140, v140, v28
    v_mfma_f32_16x16x32_bf16 v[208:211], a[4:7], a[72:75], v[208:211]
    ds_read_b64_tr_b16 a[2:3], v6 offset:25344
    v_mul_f32 v141, v141, v29
    v_mul_f32 v142, v142, v30
    v_mul_f32 v143, v143, v31
    v_mfma_f32_16x16x32_bf16 v[212:215], a[4:7], a[76:79], v[212:215]
    v_cvt_pk_bf16_f32 v126, v140, v141
    v_cvt_pk_bf16_f32 v127, v142, v143
    v_mfma_f32_16x16x32_bf16 v[216:219], a[4:7], a[80:83], v[216:219]
    buffer_store_dwordx4 v[124:127], v1, s[36:39], s34 offen offset:3072 sc1
    v_accvgpr_write_b32 a220, v124
    v_accvgpr_write_b32 a221, v125
    v_mfma_f32_16x16x32_bf16 v[220:223], a[4:7], a[84:87], v[220:223]
    ds_read_b64_tr_b16 a[4:5], v6 offset:18176
    v_accvgpr_write_b32 a222, v126
    v_accvgpr_write_b32 a223, v127
    v_mfma_f32_16x16x32_bf16 v[192:195], a[8:11], a[88:91], v[192:195]
    s_add_u32 s34, s34, 4096
    ds_read_b64_tr_b16 a[6:7], v6 offset:26368
    v_mfma_f32_16x16x32_bf16 v[196:199], a[8:11], a[92:95], v[196:199]
    v_mfma_f32_16x16x32_bf16 v[200:203], a[8:11], a[96:99], v[200:203]
    v_mfma_f32_16x16x32_bf16 v[204:207], a[8:11], a[100:103], v[204:207]
    ds_read_b64_tr_b16 a[8:9], v6 offset:33536
    v_mul_f32 v24, v160, v17
    v_mfma_f32_16x16x32_bf16 v[208:211], a[12:15], a[88:91], v[208:211]
    ds_read_b64_tr_b16 a[10:11], v6 offset:41728
    v_mul_f32 v25, v161, v17
    v_mfma_f32_16x16x32_bf16 v[212:215], a[12:15], a[92:95], v[212:215]
    v_mul_f32 v26, v162, v17
    v_mul_f32 v27, v163, v17
    v_mfma_f32_16x16x32_bf16 v[216:219], a[12:15], a[96:99], v[216:219]
    v_exp_f32 v24, v24
    v_mfma_f32_16x16x32_bf16 v[220:223], a[12:15], a[100:103], v[220:223]
    ds_read_b64_tr_b16 a[12:13], v6 offset:34560
    v_exp_f32 v25, v25
    v_mfma_f32_16x16x32_bf16 v[192:195], a[16:19], a[104:107], v[192:195]
    ds_read_b64_tr_b16 a[14:15], v6 offset:42752
    v_exp_f32 v26, v26
    v_exp_f32 v27, v27
    v_mfma_f32_16x16x32_bf16 v[196:199], a[16:19], a[108:111], v[196:199]
    v_mul_f32 v160, v160, v176
    v_mul_f32 v161, v161, v177
    v_mfma_f32_16x16x32_bf16 v[200:203], a[16:19], a[112:115], v[200:203]
    v_mul_f32 v162, v162, v178
    v_mul_f32 v163, v163, v179
    v_mfma_f32_16x16x32_bf16 v[204:207], a[16:19], a[116:119], v[204:207]
    ds_read_b64_tr_b16 a[16:17], v6 offset:49920
    v_fma_f32 v24, v24, v16, v16
    v_fma_f32 v25, v25, v16, v16
    v_mfma_f32_16x16x32_bf16 v[208:211], a[20:23], a[104:107], v[208:211]
    ds_read_b64_tr_b16 a[18:19], v6 offset:58112
    v_fma_f32 v26, v26, v16, v16
    v_fma_f32 v27, v27, v16, v16
    v_rcp_f32 v24, v24
    v_mfma_f32_16x16x32_bf16 v[212:215], a[20:23], a[108:111], v[212:215]
    v_rcp_f32 v25, v25
    v_mfma_f32_16x16x32_bf16 v[216:219], a[20:23], a[112:115], v[216:219]
    buffer_load_dword v13, v12, s[44:47], s57 offen sc1
    v_rcp_f32 v26, v26
    v_mfma_f32_16x16x32_bf16 v[220:223], a[20:23], a[116:119], v[220:223]
    s_waitcnt lgkmcnt(2)
    ds_read_b64_tr_b16 a[20:21], v6 offset:50944
    v_rcp_f32 v27, v27
    v_mul_f32 v160, v160, v24
    v_mfma_f32_16x16x32_bf16 v[192:195], a[24:27], a[120:123], v[192:195]
    ds_read_b64_tr_b16 a[22:23], v6 offset:59136
    v_mul_f32 v161, v161, v25
    v_mul_f32 v162, v162, v26
    v_mfma_f32_16x16x32_bf16 v[196:199], a[24:27], a[124:127], v[196:199]
    v_mul_f32 v163, v163, v27
    v_cvt_pk_bf16_f32 v176, v160, v161
    v_cvt_pk_bf16_f32 v177, v162, v163
    v_mfma_f32_16x16x32_bf16 v[200:203], a[24:27], a[128:131], v[200:203]
    v_mul_f32 v28, v164, v21
    v_mul_f32 v29, v165, v21
    v_mfma_f32_16x16x32_bf16 v[204:207], a[24:27], a[132:135], v[204:207]
    ds_read_b64_tr_b16 a[24:25], v8 offset:768
    v_mul_f32 v30, v166, v21
    v_mul_f32 v31, v167, v21
    v_exp_f32 v28, v28
    v_mfma_f32_16x16x32_bf16 v[208:211], a[28:31], a[120:123], v[208:211]
    ds_read_b64_tr_b16 a[26:27], v8 offset:8960
    v_exp_f32 v29, v29
    v_mfma_f32_16x16x32_bf16 v[212:215], a[28:31], a[124:127], v[212:215]
    v_exp_f32 v30, v30
    v_mfma_f32_16x16x32_bf16 v[216:219], a[28:31], a[128:131], v[216:219]
    v_exp_f32 v31, v31
    v_mul_f32 v164, v164, v180
    v_mfma_f32_16x16x32_bf16 v[220:223], a[28:31], a[132:135], v[220:223]
    ds_read_b64_tr_b16 a[28:29], v8 offset:1792
    v_mul_f32 v165, v165, v181
    v_mul_f32 v166, v166, v182
    v_mfma_f32_16x16x32_bf16 v[192:195], a[32:35], a[136:139], v[192:195]
    ds_read_b64_tr_b16 a[30:31], v8 offset:9984
    v_mul_f32 v167, v167, v183
    v_fma_f32 v28, v28, v18, v18
    v_fma_f32 v29, v29, v18, v18
    v_mfma_f32_16x16x32_bf16 v[196:199], a[32:35], a[140:143], v[196:199]
    v_fma_f32 v30, v30, v18, v18
    v_fma_f32 v31, v31, v18, v18
    v_mfma_f32_16x16x32_bf16 v[200:203], a[32:35], a[144:147], v[200:203]
    v_rcp_f32 v28, v28
    v_rcp_f32 v29, v29
    v_mfma_f32_16x16x32_bf16 v[204:207], a[32:35], a[148:151], v[204:207]
    ds_read_b64_tr_b16 a[32:33], v8 offset:17152
    v_rcp_f32 v30, v30
    v_mfma_f32_16x16x32_bf16 v[208:211], a[36:39], a[136:139], v[208:211]
    ds_read_b64_tr_b16 a[34:35], v8 offset:25344
    v_rcp_f32 v31, v31
    v_mfma_f32_16x16x32_bf16 v[212:215], a[36:39], a[140:143], v[212:215]
    v_mul_f32 v164, v164, v28
    v_mul_f32 v165, v165, v29
    v_mul_f32 v166, v166, v30
    v_mfma_f32_16x16x32_bf16 v[216:219], a[36:39], a[144:147], v[216:219]
    v_mul_f32 v167, v167, v31
    v_cvt_pk_bf16_f32 v180, v164, v165
    v_mfma_f32_16x16x32_bf16 v[220:223], a[36:39], a[148:151], v[220:223]
    ds_read_b64_tr_b16 a[36:37], v8 offset:18176
    v_cvt_pk_bf16_f32 v181, v166, v167
    v_mul_f32 v24, v168, v22
    v_mul_f32 v25, v169, v22
    v_mfma_f32_16x16x32_bf16 v[192:195], a[40:43], a[152:155], v[192:195]
    ds_read_b64_tr_b16 a[38:39], v8 offset:26368
    v_mul_f32 v26, v170, v22
    v_mul_f32 v27, v171, v22
    v_mfma_f32_16x16x32_bf16 v[196:199], a[40:43], a[156:159], v[196:199]
    v_exp_f32 v24, v24
    v_exp_f32 v25, v25
    v_mfma_f32_16x16x32_bf16 v[200:203], a[40:43], a[160:163], v[200:203]
    v_exp_f32 v26, v26
    v_mfma_f32_16x16x32_bf16 v[204:207], a[40:43], a[164:167], v[204:207]
    ds_read_b64_tr_b16 a[40:41], v4 offset:768
    v_exp_f32 v27, v27
    v_mfma_f32_16x16x32_bf16 v[208:211], a[44:47], a[152:155], v[208:211]
    ds_read_b64_tr_b16 a[42:43], v4 offset:8960
    v_mul_f32 v168, v168, v184
    v_mul_f32 v169, v169, v185
    v_mul_f32 v170, v170, v186
    v_mfma_f32_16x16x32_bf16 v[212:215], a[44:47], a[156:159], v[212:215]
    v_mul_f32 v171, v171, v187
    v_fma_f32 v24, v24, v19, v19
    v_mfma_f32_16x16x32_bf16 v[216:219], a[44:47], a[160:163], v[216:219]
    v_fma_f32 v25, v25, v19, v19
    v_fma_f32 v26, v26, v19, v19
    v_fma_f32 v27, v27, v19, v19
    v_mfma_f32_16x16x32_bf16 v[220:223], a[44:47], a[164:167], v[220:223]
    ds_read_b64_tr_b16 a[44:45], v4 offset:1792
    v_rcp_f32 v24, v24
    v_mfma_f32_16x16x32_bf16 v[192:195], a[48:51], a[168:171], v[192:195]
    ds_read_b64_tr_b16 a[46:47], v4 offset:9984
    v_rcp_f32 v25, v25
    v_rcp_f32 v26, v26
    v_mfma_f32_16x16x32_bf16 v[196:199], a[48:51], a[172:175], v[196:199]
    v_rcp_f32 v27, v27
    v_mfma_f32_16x16x32_bf16 v[200:203], a[48:51], a[176:179], v[200:203]
    v_mul_f32 v168, v168, v24
    v_mul_f32 v169, v169, v25
    v_mfma_f32_16x16x32_bf16 v[204:207], a[48:51], a[180:183], v[204:207]
    ds_read_b64_tr_b16 a[48:49], v4 offset:17152
    v_mul_f32 v170, v170, v26
    v_mul_f32 v171, v171, v27
    v_cvt_pk_bf16_f32 v184, v168, v169
    v_mfma_f32_16x16x32_bf16 v[208:211], a[52:55], a[168:171], v[208:211]
    ds_read_b64_tr_b16 a[50:51], v4 offset:25344
    v_cvt_pk_bf16_f32 v185, v170, v171
    v_mul_f32 v28, v172, v23
    v_mfma_f32_16x16x32_bf16 v[212:215], a[52:55], a[172:175], v[212:215]
    v_mul_f32 v29, v173, v23
    v_mul_f32 v30, v174, v23
    v_mul_f32 v31, v175, v23
    v_mfma_f32_16x16x32_bf16 v[216:219], a[52:55], a[176:179], v[216:219]
    v_exp_f32 v28, v28
    v_mfma_f32_16x16x32_bf16 v[220:223], a[52:55], a[180:183], v[220:223]
    ds_read_b64_tr_b16 a[52:53], v4 offset:18176
    v_exp_f32 v29, v29
    v_exp_f32 v30, v30
    v_mfma_f32_16x16x32_bf16 v[224:227], a[0:3], a[72:75], v[224:227]
    ds_read_b64_tr_b16 a[54:55], v4 offset:26368
    v_exp_f32 v31, v31
    v_mfma_f32_16x16x32_bf16 v[228:231], a[0:3], a[76:79], v[228:231]
    s_waitcnt vmcnt(0)
    v_cmp_gt_i32 vcc, 1, v13
    v_mul_f32 v172, v172, v188
    v_mul_f32 v173, v173, v189
    v_mfma_f32_16x16x32_bf16 v[232:235], a[0:3], a[80:83], v[232:235]
    s_cbranch_vccnz L_up_slow1
L_up_back1:
    v_mul_f32 v174, v174, v190
    v_mul_f32 v175, v175, v191
    v_fma_f32 v28, v28, v20, v20
    v_mfma_f32_16x16x32_bf16 v[236:239], a[0:3], a[84:87], v[236:239]
    buffer_load_dwordx4 a[240:243], v1, s[36:39], s35 offen offset:0 sc1
    v_fma_f32 v29, v29, v20, v20
    v_fma_f32 v30, v30, v20, v20
    v_mfma_f32_16x16x32_bf16 v[240:243], a[4:7], a[72:75], v[240:243]
    v_fma_f32 v31, v31, v20, v20
    v_rcp_f32 v28, v28
    v_mfma_f32_16x16x32_bf16 v[244:247], a[4:7], a[76:79], v[244:247]
    v_rcp_f32 v29, v29
    v_mfma_f32_16x16x32_bf16 v[248:251], a[4:7], a[80:83], v[248:251]
    v_rcp_f32 v30, v30
    v_rcp_f32 v31, v31
    v_mfma_f32_16x16x32_bf16 v[252:255], a[4:7], a[84:87], v[252:255]
    buffer_load_dwordx4 a[244:247], v1, s[36:39], s35 offen offset:1024 sc1
    v_mul_f32 v172, v172, v28
    v_mfma_f32_16x16x32_bf16 v[224:227], a[8:11], a[88:91], v[224:227]
    v_mul_f32 v173, v173, v29
    v_mul_f32 v174, v174, v30
    v_mul_f32 v175, v175, v31
    v_mfma_f32_16x16x32_bf16 v[228:231], a[8:11], a[92:95], v[228:231]
    v_cvt_pk_bf16_f32 v188, v172, v173
    v_cvt_pk_bf16_f32 v189, v174, v175
    v_mfma_f32_16x16x32_bf16 v[232:235], a[8:11], a[96:99], v[232:235]
    v_mfma_f32_16x16x32_bf16 v[236:239], a[8:11], a[100:103], v[236:239]
    v_mfma_f32_16x16x32_bf16 v[240:243], a[12:15], a[88:91], v[240:243]
    buffer_load_dwordx4 a[248:251], v1, s[36:39], s35 offen offset:2048 sc1
    v_mfma_f32_16x16x32_bf16 v[244:247], a[12:15], a[92:95], v[244:247]
    v_mul_f32 v24, v192, v17
    v_mul_f32 v25, v193, v17
    v_mfma_f32_16x16x32_bf16 v[248:251], a[12:15], a[96:99], v[248:251]
    v_mul_f32 v26, v194, v17
    v_mul_f32 v27, v195, v17
    v_mfma_f32_16x16x32_bf16 v[252:255], a[12:15], a[100:103], v[252:255]
    s_waitcnt lgkmcnt(0)
    s_barrier
    v_mfma_f32_16x16x32_bf16 v[224:227], a[16:19], a[104:107], v[224:227]
    v_exp_f32 v24, v24
    v_exp_f32 v25, v25
    v_mfma_f32_16x16x32_bf16 v[228:231], a[16:19], a[108:111], v[228:231]
    buffer_load_dwordx4 a[252:255], v1, s[36:39], s35 offen offset:3072 sc1
    v_exp_f32 v26, v26
    v_mfma_f32_16x16x32_bf16 v[232:235], a[16:19], a[112:115], v[232:235]
    s_add_u32 s35, s75, 0
    v_exp_f32 v27, v27
    v_mul_f32 v192, v192, v208
    v_mfma_f32_16x16x32_bf16 v[236:239], a[16:19], a[116:119], v[236:239]
    v_mul_f32 v193, v193, v209
    v_mul_f32 v194, v194, v210
    v_mul_f32 v195, v195, v211
    v_mfma_f32_16x16x32_bf16 v[240:243], a[20:23], a[104:107], v[240:243]
    v_fma_f32 v24, v24, v16, v16
    v_fma_f32 v25, v25, v16, v16
    v_fma_f32 v26, v26, v16, v16
    v_mfma_f32_16x16x32_bf16 v[244:247], a[20:23], a[108:111], v[244:247]
    buffer_load_dwordx4 a[56:59], v1, s[36:39], s35 offen offset:0 sc1
    v_fma_f32 v27, v27, v16, v16
    v_rcp_f32 v24, v24
    v_mfma_f32_16x16x32_bf16 v[248:251], a[20:23], a[112:115], v[248:251]
    v_rcp_f32 v25, v25
    v_rcp_f32 v26, v26
    v_mfma_f32_16x16x32_bf16 v[252:255], a[20:23], a[116:119], v[252:255]
    v_mov_b32 v14, 2
    v_rcp_f32 v27, v27
    v_mfma_f32_16x16x32_bf16 v[224:227], a[24:27], a[120:123], v[224:227]
    buffer_store_dword v14, v15, s[44:47], s56 offen sc1
    v_mul_f32 v192, v192, v24
    v_mul_f32 v193, v193, v25
    v_mul_f32 v194, v194, v26
    v_mfma_f32_16x16x32_bf16 v[228:231], a[24:27], a[124:127], v[228:231]
    v_mul_f32 v195, v195, v27
    v_cvt_pk_bf16_f32 v178, v192, v193
    v_cvt_pk_bf16_f32 v179, v194, v195
    v_mfma_f32_16x16x32_bf16 v[232:235], a[24:27], a[128:131], v[232:235]
    buffer_store_dwordx4 v[176:179], v1, s[36:39], s34 offen offset:0 sc1
    v_accvgpr_write_b32 a224, v176
    v_mfma_f32_16x16x32_bf16 v[236:239], a[24:27], a[132:135], v[236:239]
    v_accvgpr_write_b32 a225, v177
    v_accvgpr_write_b32 a226, v178
    v_accvgpr_write_b32 a227, v179
    v_mfma_f32_16x16x32_bf16 v[240:243], a[28:31], a[120:123], v[240:243]
    v_mul_f32 v28, v196, v21
    v_mul_f32 v29, v197, v21
    v_mul_f32 v30, v198, v21
    v_mfma_f32_16x16x32_bf16 v[244:247], a[28:31], a[124:127], v[244:247]
    v_mul_f32 v31, v199, v21
    v_exp_f32 v28, v28
    v_mfma_f32_16x16x32_bf16 v[248:251], a[28:31], a[128:131], v[248:251]
    buffer_load_dwordx4 a[60:63], v1, s[36:39], s35 offen offset:1024 sc1
    v_exp_f32 v29, v29
    v_exp_f32 v30, v30
    v_mfma_f32_16x16x32_bf16 v[252:255], a[28:31], a[132:135], v[252:255]
    v_exp_f32 v31, v31
    v_mfma_f32_16x16x32_bf16 v[224:227], a[32:35], a[136:139], v[224:227]
    v_mul_f32 v196, v196, v212
    v_mul_f32 v197, v197, v213
    v_mul_f32 v198, v198, v214
    v_mfma_f32_16x16x32_bf16 v[228:231], a[32:35], a[140:143], v[228:231]
    v_mul_f32 v199, v199, v215
    v_fma_f32 v28, v28, v18, v18
    v_fma_f32 v29, v29, v18, v18
    v_mfma_f32_16x16x32_bf16 v[232:235], a[32:35], a[144:147], v[232:235]
    buffer_load_dwordx4 a[64:67], v1, s[36:39], s35 offen offset:2048 sc1
    v_fma_f32 v30, v30, v18, v18
    v_fma_f32 v31, v31, v18, v18
    v_rcp_f32 v28, v28
    v_mfma_f32_16x16x32_bf16 v[236:239], a[32:35], a[148:151], v[236:239]
    s_barrier
    v_rcp_f32 v29, v29
    v_mfma_f32_16x16x32_bf16 v[240:243], a[36:39], a[136:139], v[240:243]
    ds_read_b64_tr_b16 v[32:33], v64 offset:32768
    v_rcp_f32 v30, v30
    v_rcp_f32 v31, v31
    v_mfma_f32_16x16x32_bf16 v[244:247], a[36:39], a[140:143], v[244:247]
    ds_read_b64_tr_b16 v[34:35], v64 offset:34816
    v_mul_f32 v196, v196, v28
    v_mul_f32 v197, v197, v29
    v_mfma_f32_16x16x32_bf16 v[248:251], a[36:39], a[144:147], v[248:251]
    buffer_load_dwordx4 a[68:71], v1, s[36:39], s35 offen offset:3072 sc1
    v_mul_f32 v198, v198, v30
    v_mul_f32 v199, v199, v31
    v_cvt_pk_bf16_f32 v182, v196, v197
    v_mfma_f32_16x16x32_bf16 v[252:255], a[36:39], a[148:151], v[252:255]
    s_add_u32 s35, s76, 0
    v_cvt_pk_bf16_f32 v183, v198, v199
    v_mfma_f32_16x16x32_bf16 v[224:227], a[40:43], a[152:155], v[224:227]
    buffer_store_dwordx4 v[180:183], v1, s[36:39], s34 offen offset:1024 sc1
    v_accvgpr_write_b32 a228, v180
    v_accvgpr_write_b32 a229, v181
    v_accvgpr_write_b32 a230, v182
    v_mfma_f32_16x16x32_bf16 v[228:231], a[40:43], a[156:159], v[228:231]
    ds_read_b64_tr_b16 v[36:37], v65 offset:32768
    v_accvgpr_write_b32 a231, v183
    v_mul_f32 v24, v200, v22
    v_mul_f32 v25, v201, v22
    v_mfma_f32_16x16x32_bf16 v[232:235], a[40:43], a[160:163], v[232:235]
    ds_read_b64_tr_b16 v[38:39], v65 offset:34816
    v_mul_f32 v26, v202, v22
    v_mul_f32 v27, v203, v22
    v_exp_f32 v24, v24
    v_mfma_f32_16x16x32_bf16 v[236:239], a[40:43], a[164:167], v[236:239]
    buffer_load_dwordx4 v11, s[40:43], s55 offen lds
    v_exp_f32 v25, v25
    v_mfma_f32_16x16x32_bf16 v[240:243], a[44:47], a[152:155], v[240:243]
    s_add_u32 m0, s54, 86016
    s_add_u32 s55, s7, 0
    s_sub_u32 s30, s55, 917504
    v_exp_f32 v26, v26
    v_exp_f32 v27, v27
    v_mfma_f32_16x16x32_bf16 v[244:247], a[44:47], a[156:159], v[244:247]
    s_min_u32 s55, s55, s30
    ds_read_b64_tr_b16 v[40:41], v66 offset:32768
    v_mul_f32 v200, v200, v216
    v_mul_f32 v201, v201, v217
    v_mfma_f32_16x16x32_bf16 v[248:251], a[44:47], a[160:163], v[248:251]
    ds_read_b64_tr_b16 v[42:43], v66 offset:34816
    v_mul_f32 v202, v202, v218
    v_mul_f32 v203, v203, v219
    v_fma_f32 v24, v24, v19, v19
    v_mfma_f32_16x16x32_bf16 v[252:255], a[44:47], a[164:167], v[252:255]
    buffer_load_dwordx4 v11, s[40:43], s55 offen lds
    v_fma_f32 v25, v25, v19, v19
    v_fma_f32 v26, v26, v19, v19
    v_fma_f32 v27, v27, v19, v19
    v_mfma_f32_16x16x32_bf16 v[224:227], a[48:51], a[168:171], v[224:227]
    s_add_u32 m0, s54, 90112
    s_add_u32 s55, s6, 262144
    s_sub_u32 s30, s55, 917504
    v_rcp_f32 v24, v24
    v_rcp_f32 v25, v25
    v_mfma_f32_16x16x32_bf16 v[228:231], a[48:51], a[172:175], v[228:231]
    s_min_u32 s55, s55, s30
    ds_read_b64_tr_b16 v[44:45], v67 offset:32768
    v_rcp_f32 v26, v26
    v_mfma_f32_16x16x32_bf16 v[232:235], a[48:51], a[176:179], v[232:235]
    buffer_load_dwordx4 v11, s[40:43], s55 offen lds
    v_rcp_f32 v27, v27
    v_mul_f32 v200, v200, v24
    v_mfma_f32_16x16x32_bf16 v[236:239], a[48:51], a[180:183], v[236:239]
    s_add_u32 m0, s54, 94208
    s_add_u32 s55, s7, 262144
    s_sub_u32 s30, s55, 917504
    v_mul_f32 v201, v201, v25
    v_mul_f32 v202, v202, v26
    v_mul_f32 v203, v203, v27
    v_mfma_f32_16x16x32_bf16 v[240:243], a[52:55], a[168:171], v[240:243]
    s_min_u32 s55, s55, s30
    ds_read_b64_tr_b16 v[46:47], v67 offset:34816
    v_cvt_pk_bf16_f32 v186, v200, v201
    v_cvt_pk_bf16_f32 v187, v202, v203
    v_mfma_f32_16x16x32_bf16 v[244:247], a[52:55], a[172:175], v[244:247]
    buffer_store_dwordx4 v[184:187], v1, s[36:39], s34 offen offset:2048 sc1
    v_accvgpr_write_b32 a232, v184
    v_accvgpr_write_b32 a233, v185
    v_mfma_f32_16x16x32_bf16 v[248:251], a[52:55], a[176:179], v[248:251]
    ds_read_b64_tr_b16 v[48:49], v64 offset:36864
    v_accvgpr_write_b32 a234, v186
    v_accvgpr_write_b32 a235, v187
    v_mul_f32 v28, v204, v23
    v_mfma_f32_16x16x32_bf16 v[252:255], a[52:55], a[180:183], v[252:255]
    s_waitcnt lgkmcnt(2)
    ds_read_b64_tr_b16 v[50:51], v64 offset:38912
    v_mul_f32 v29, v205, v23
    v_mul_f32 v30, v206, v23
    v_mul_f32 v31, v207, v23
    v_mfma_f32_16x16x32_bf16 v[96:99], v[32:35], a[192:195], 0
    ds_read_b64_tr_b16 v[52:53], v65 offset:36864
    v_exp_f32 v28, v28
    v_exp_f32 v29, v29
    v_mfma_f32_16x16x32_bf16 v[100:103], v[32:35], a[196:199], 0
    buffer_load_dwordx4 a[0:3], v1, s[36:39], s35 offen offset:0 sc1
    v_exp_f32 v30, v30
    v_mfma_f32_16x16x32_bf16 v[104:107], v[32:35], a[200:203], 0
    ds_read_b64_tr_b16 v[54:55], v65 offset:38912
    v_exp_f32 v31, v31
    v_mul_f32 v204, v204, v220
    v_mfma_f32_16x16x32_bf16 v[108:111], v[32:35], a[204:207], 0
    v_mul_f32 v205, v205, v221
    v_mul_f32 v206, v206, v222
    v_mul_f32 v207, v207, v223
    v_mfma_f32_16x16x32_bf16 v[112:115], v[36:39], a[192:195], 0
    ds_read_b64_tr_b16 v[56:57], v66 offset:36864
    v_fma_f32 v28, v28, v20, v20
    v_fma_f32 v29, v29, v20, v20
    v_fma_f32 v30, v30, v20, v20
    v_mfma_f32_16x16x32_bf16 v[116:119], v[36:39], a[196:199], 0
    buffer_load_dwordx4 a[4:7], v1, s[36:39], s35 offen offset:1024 sc1
    v_fma_f32 v31, v31, v20, v20
    v_rcp_f32 v28, v28
    v_mfma_f32_16x16x32_bf16 v[120:123], v[36:39], a[200:203], 0
    ds_read_b64_tr_b16 v[58:59], v66 offset:38912
    v_rcp_f32 v29, v29
    v_rcp_f32 v30, v30
    v_mfma_f32_16x16x32_bf16 v[124:127], v[36:39], a[204:207], 0
    v_rcp_f32 v31, v31
    v_mfma_f32_16x16x32_bf16 v[128:131], v[40:43], a[192:195], 0
    ds_read_b64_tr_b16 v[60:61], v67 offset:36864
    v_mul_f32 v204, v204, v28
    v_mul_f32 v205, v205, v29
    v_mul_f32 v206, v206, v30
    v_mfma_f32_16x16x32_bf16 v[132:135], v[40:43], a[196:199], 0
    buffer_load_dwordx4 a[8:11], v1, s[36:39], s35 offen offset:2048 sc1
    v_mul_f32 v207, v207, v31
    v_cvt_pk_bf16_f32 v190, v204, v205
    v_cvt_pk_bf16_f32 v191, v206, v207
    v_mfma_f32_16x16x32_bf16 v[136:139], v[40:43], a[200:203], 0
    buffer_store_dwordx4 v[188:191], v1, s[36:39], s34 offen offset:3072 sc1
    v_accvgpr_write_b32 a236, v188
    v_mfma_f32_16x16x32_bf16 v[140:143], v[40:43], a[204:207], 0
    s_waitcnt lgkmcnt(2)
    ds_read_b64_tr_b16 v[62:63], v67 offset:38912
    v_accvgpr_write_b32 a237, v189
    v_accvgpr_write_b32 a238, v190
    v_accvgpr_write_b32 a239, v191
    v_mfma_f32_16x16x32_bf16 v[144:147], v[44:47], a[192:195], 0
    ds_read_b64_tr_b16 v[32:33], v64 offset:40960
    v_mfma_f32_16x16x32_bf16 v[148:151], v[44:47], a[196:199], 0
    ds_read_b64_tr_b16 v[34:35], v64 offset:43008
    v_mfma_f32_16x16x32_bf16 v[152:155], v[44:47], a[200:203], 0
    v_mfma_f32_16x16x32_bf16 v[156:159], v[44:47], a[204:207], 0
    buffer_load_dwordx4 a[12:15], v1, s[36:39], s35 offen offset:3072 sc1
    v_mfma_f32_16x16x32_bf16 v[160:163], v[48:51], a[192:195], 0
    s_add_u32 s35, s65, 0
    ds_read_b64_tr_b16 v[36:37], v65 offset:40960
    v_mul_f32 v24, v224, v17
    v_mfma_f32_16x16x32_bf16 v[164:167], v[48:51], a[196:199], 0
    buffer_load_dword v13, v12, s[44:47], s57 offen sc1
    v_mfma_f32_16x16x32_bf16 v[168:171], v[48:51], a[200:203], 0
    ds_read_b64_tr_b16 v[38:39], v65 offset:43008
    v_mul_f32 v25, v225, v17
    v_mfma_f32_16x16x32_bf16 v[172:175], v[48:51], a[204:207], 0
    v_mul_f32 v26, v226, v17
    v_mul_f32 v27, v227, v17
    v_mfma_f32_16x16x32_bf16 v[176:179], v[52:55], a[192:195], 0
    ds_read_b64_tr_b16 v[40:41], v66 offset:40960
    v_mfma_f32_16x16x32_bf16 v[180:183], v[52:55], a[196:199], 0
    ds_read_b64_tr_b16 v[42:43], v66 offset:43008
    v_exp_f32 v24, v24
    v_mfma_f32_16x16x32_bf16 v[184:187], v[52:55], a[200:203], 0
    buffer_load_dwordx4 v11, s[40:43], s55 offen lds
    v_mfma_f32_16x16x32_bf16 v[188:191], v[52:55], a[204:207], 0
    s_waitcnt lgkmcnt(3)
    s_add_u32 m0, s54, 98304
    s_add_u32 s55, s6, 458752
    v_exp_f32 v25, v25
    v_mfma_f32_16x16x32_bf16 v[192:195], v[56:59], a[192:195], 0
    s_sub_u32 s30, s55, 917504
    s_min_u32 s55, s55, s30
    ds_read_b64_tr_b16 v[44:45], v67 offset:40960
    v_mfma_f32_16x16x32_bf16 v[196:199], v[56:59], a[196:199], 0
    ds_read_b64_tr_b16 v[46:47], v67 offset:43008
    v_exp_f32 v26, v26
    v_mfma_f32_16x16x32_bf16 v[200:203], v[56:59], a[200:203], 0
    v_exp_f32 v27, v27
    v_mfma_f32_16x16x32_bf16 v[204:207], v[56:59], a[204:207], 0
    buffer_load_dwordx4 a[16:19], v1, s[36:39], s35 offen offset:0 sc1
    v_mfma_f32_16x16x32_bf16 v[208:211], v[60:63], a[192:195], 0
    ds_read_b64_tr_b16 v[48:49], v64 offset:45056
    v_mul_f32 v224, v224, v240
    v_mfma_f32_16x16x32_bf16 v[212:215], v[60:63], a[196:199], 0
    ds_read_b64_tr_b16 v[50:51], v64 offset:47104
    v_mul_f32 v225, v225, v241
    v_mfma_f32_16x16x32_bf16 v[216:219], v[60:63], a[200:203], 0
    v_mul_f32 v226, v226, v242
    v_mul_f32 v227, v227, v243
    v_mfma_f32_16x16x32_bf16 v[220:223], v[60:63], a[204:207], 0
    v_fma_f32 v24, v24, v16, v16
    v_mfma_f32_16x16x32_bf16 v[96:99], v[32:35], a[208:211], v[96:99]
    buffer_load_dwordx4 a[20:23], v1, s[36:39], s35 offen offset:1024 sc1
    v_mfma_f32_16x16x32_bf16 v[100:103], v[32:35], a[212:215], v[100:103]
    ds_read_b64_tr_b16 v[52:53], v65 offset:45056
    v_fma_f32 v25, v25, v16, v16
    v_mfma_f32_16x16x32_bf16 v[104:107], v[32:35], a[216:219], v[104:107]
    ds_read_b64_tr_b16 v[54:55], v65 offset:47104
    v_fma_f32 v26, v26, v16, v16
    v_mfma_f32_16x16x32_bf16 v[108:111], v[32:35], a[220:223], v[108:111]
    s_waitcnt lgkmcnt(2)
    v_fma_f32 v27, v27, v16, v16
    v_mfma_f32_16x16x32_bf16 v[112:115], v[36:39], a[208:211], v[112:115]
    ds_read_b64_tr_b16 v[56:57], v66 offset:45056
    v_mfma_f32_16x16x32_bf16 v[116:119], v[36:39], a[212:215], v[116:119]
    buffer_load_dwordx4 a[24:27], v1, s[36:39], s35 offen offset:2048 sc1
    v_rcp_f32 v24, v24
    v_mfma_f32_16x16x32_bf16 v[120:123], v[36:39], a[216:219], v[120:123]
    ds_read_b64_tr_b16 v[58:59], v66 offset:47104
    v_mfma_f32_16x16x32_bf16 v[124:127], v[36:39], a[220:223], v[124:127]
    v_rcp_f32 v25, v25
    v_mfma_f32_16x16x32_bf16 v[128:131], v[40:43], a[208:211], v[128:131]
    ds_read_b64_tr_b16 v[60:61], v67 offset:45056
    v_mfma_f32_16x16x32_bf16 v[132:135], v[40:43], a[212:215], v[132:135]
    ds_read_b64_tr_b16 v[62:63], v67 offset:47104
    v_rcp_f32 v26, v26
    v_mfma_f32_16x16x32_bf16 v[136:139], v[40:43], a[216:219], v[136:139]
    buffer_load_dwordx4 a[28:31], v1, s[36:39], s35 offen offset:3072 sc1
    v_mfma_f32_16x16x32_bf16 v[140:143], v[40:43], a[220:223], v[140:143]
    s_waitcnt lgkmcnt(3)
    s_barrier
    s_add_u32 s35, s65, 16384
    v_mfma_f32_16x16x32_bf16 v[144:147], v[44:47], a[208:211], v[144:147]
    ds_read_b64_tr_b16 v[32:33], v64 offset:49152
    v_rcp_f32 v27, v27
    v_mfma_f32_16x16x32_bf16 v[148:151], v[44:47], a[212:215], v[148:151]
    ds_read_b64_tr_b16 v[34:35], v64 offset:51200
    v_mul_f32 v224, v224, v24
    v_mfma_f32_16x16x32_bf16 v[152:155], v[44:47], a[216:219], v[152:155]
    v_mul_f32 v225, v225, v25
    v_mul_f32 v226, v226, v26
    v_mfma_f32_16x16x32_bf16 v[156:159], v[44:47], a[220:223], v[156:159]
    buffer_load_dwordx4 a[32:35], v1, s[36:39], s35 offen offset:0 sc1
    v_mfma_f32_16x16x32_bf16 v[160:163], v[48:51], a[208:211], v[160:163]
    ds_read_b64_tr_b16 v[36:37], v65 offset:49152
    v_mul_f32 v227, v227, v27
    v_mfma_f32_16x16x32_bf16 v[164:167], v[48:51], a[212:215], v[164:167]
    ds_read_b64_tr_b16 v[38:39], v65 offset:51200
    v_cvt_pk_bf16_f32 v240, v224, v225
    v_mfma_f32_16x16x32_bf16 v[168:171], v[48:51], a[216:219], v[168:171]
    v_cvt_pk_bf16_f32 v241, v226, v227
    v_mul_f32 v28, v228, v21
    v_mfma_f32_16x16x32_bf16 v[172:175], v[48:51], a[220:223], v[172:175]
    v_mul_f32 v29, v229, v21
    v_mfma_f32_16x16x32_bf16 v[176:179], v[52:55], a[208:211], v[176:179]
    buffer_load_dwordx4 a[36:39], v1, s[36:39], s35 offen offset:1024 sc1
    v_mfma_f32_16x16x32_bf16 v[180:183], v[52:55], a[212:215], v[180:183]
    ds_read_b64_tr_b16 v[40:41], v66 offset:49152
    v_mul_f32 v30, v230, v21
    v_mfma_f32_16x16x32_bf16 v[184:187], v[52:55], a[216:219], v[184:187]
    ds_read_b64_tr_b16 v[42:43], v66 offset:51200
    v_mul_f32 v31, v231, v21
    v_mfma_f32_16x16x32_bf16 v[188:191], v[52:55], a[220:223], v[188:191]
    s_waitcnt lgkmcnt(2)
    v_exp_f32 v28, v28
    v_mfma_f32_16x16x32_bf16 v[192:195], v[56:59], a[208:211], v[192:195]
    ds_read_b64_tr_b16 v[44:45], v67 offset:49152
    v_mfma_f32_16x16x32_bf16 v[196:199], v[56:59], a[212:215], v[196:199]
    buffer_load_dwordx4 a[40:43], v1, s[36:39], s35 offen offset:2048 sc1
    v_mfma_f32_16x16x32_bf16 v[200:203], v[56:59], a[216:219], v[200:203]
    ds_read_b64_tr_b16 v[46:47], v67 offset:51200
    v_exp_f32 v29, v29
    v_mfma_f32_16x16x32_bf16 v[204:207], v[56:59], a[220:223], v[204:207]
    s_waitcnt vmcnt(8)
    v_cmp_gt_i32 vcc, 2, v13
    v_mfma_f32_16x16x32_bf16 v[208:211], v[60:63], a[208:211], v[208:211]
    s_cbranch_vccnz L_up_slow2
L_up_back2:
    ds_read_b64_tr_b16 v[48:49], v64 offset:53248
    v_exp_f32 v30, v30
    v_mfma_f32_16x16x32_bf16 v[212:215], v[60:63], a[212:215], v[212:215]
    ds_read_b64_tr_b16 v[50:51], v64 offset:55296
    v_mfma_f32_16x16x32_bf16 v[216:219], v[60:63], a[216:219], v[216:219]
    buffer_load_dwordx4 a[44:47], v1, s[36:39], s35 offen offset:3072 sc1
    v_exp_f32 v31, v31
    v_mfma_f32_16x16x32_bf16 v[220:223], v[60:63], a[220:223], v[220:223]
    s_add_u32 s35, s65, 28672
    v_mul_f32 v228, v228, v244
    v_mul_f32 v229, v229, v245
    v_mfma_f32_16x16x32_bf16 v[96:99], v[32:35], a[224:227], v[96:99]
    ds_read_b64_tr_b16 v[52:53], v65 offset:53248
    v_mul_f32 v230, v230, v246
    v_mfma_f32_16x16x32_bf16 v[100:103], v[32:35], a[228:231], v[100:103]
    ds_read_b64_tr_b16 v[54:55], v65 offset:55296
    v_mul_f32 v231, v231, v247
    v_mfma_f32_16x16x32_bf16 v[104:107], v[32:35], a[232:235], v[104:107]
    v_mfma_f32_16x16x32_bf16 v[108:111], v[32:35], a[236:239], v[108:111]
    buffer_load_dwordx4 v11, s[40:43], s55 offen lds
    v_mfma_f32_16x16x32_bf16 v[112:115], v[36:39], a[224:227], v[112:115]
    s_add_u32 m0, s54, 102400
    s_add_u32 s55, s7, 458752
    s_sub_u32 s30, s55, 917504
    v_mfma_f32_16x16x32_bf16 v[116:119], v[36:39], a[228:231], v[116:119]
    s_min_u32 s55, s55, s30
    ds_read_b64_tr_b16 v[56:57], v66 offset:53248
    v_fma_f32 v28, v28, v18, v18
    v_mfma_f32_16x16x32_bf16 v[120:123], v[36:39], a[232:235], v[120:123]
    ds_read_b64_tr_b16 v[58:59], v66 offset:55296
    v_fma_f32 v29, v29, v18, v18
    v_mfma_f32_16x16x32_bf16 v[124:127], v[36:39], a[236:239], v[124:127]
    s_waitcnt lgkmcnt(2)
    v_fma_f32 v30, v30, v18, v18
    v_fma_f32 v31, v31, v18, v18
    v_mfma_f32_16x16x32_bf16 v[128:131], v[40:43], a[224:227], v[128:131]
    buffer_load_dwordx4 v11, s[40:43], s55 offen lds
    v_mfma_f32_16x16x32_bf16 v[132:135], v[40:43], a[228:231], v[132:135]
    s_add_u32 m0, s54, 106496
    s_add_u32 s55, s6, 720896
    s_sub_u32 s30, s55, 917504
    v_rcp_f32 v28, v28
    v_mfma_f32_16x16x32_bf16 v[136:139], v[40:43], a[232:235], v[136:139]
    s_min_u32 s55, s55, s30
    ds_read_b64_tr_b16 v[60:61], v67 offset:53248
    v_mfma_f32_16x16x32_bf16 v[140:143], v[40:43], a[236:239], v[140:143]
    ds_read_b64_tr_b16 v[62:63], v67 offset:55296
    v_rcp_f32 v29, v29
    v_mfma_f32_16x16x32_bf16 v[144:147], v[44:47], a[224:227], v[144:147]
    ds_read_b64_tr_b16 v[32:33], v64 offset:57344
    v_mfma_f32_16x16x32_bf16 v[148:151], v[44:47], a[228:231], v[148:151]
    buffer_load_dwordx4 v11, s[40:43], s55 offen lds
    v_rcp_f32 v30, v30
    v_mfma_f32_16x16x32_bf16 v[152:155], v[44:47], a[232:235], v[152:155]
    s_add_u32 m0, s54, 110592
    s_add_u32 s55, s7, 720896
    s_sub_u32 s30, s55, 917504
    v_mfma_f32_16x16x32_bf16 v[156:159], v[44:47], a[236:239], v[156:159]
    s_min_u32 s55, s55, s30
    ds_read_b64_tr_b16 v[34:35], v64 offset:59392
    v_rcp_f32 v31, v31
    v_mfma_f32_16x16x32_bf16 v[160:163], v[48:51], a[224:227], v[160:163]
    ds_read_b64_tr_b16 v[36:37], v65 offset:57344
    v_mul_f32 v228, v228, v28
    v_mfma_f32_16x16x32_bf16 v[164:167], v[48:51], a[228:231], v[164:167]
    ds_read_b64_tr_b16 v[38:39], v65 offset:59392
    v_mul_f32 v229, v229, v29
    v_mfma_f32_16x16x32_bf16 v[168:171], v[48:51], a[232:235], v[168:171]
    buffer_load_dwordx4 v11, s[40:43], s55 offen lds
    v_mfma_f32_16x16x32_bf16 v[172:175], v[48:51], a[236:239], v[172:175]
    s_add_u32 m0, s54, 114688
    s_add_u32 s55, s4, s77
    s_add_u32 s55, s55, 65536
    v_mul_f32 v230, v230, v30
    v_mfma_f32_16x16x32_bf16 v[176:179], v[52:55], a[224:227], v[176:179]
    s_sub_u32 s30, s55, 917504
    s_min_u32 s55, s55, s30
    ds_read_b64_tr_b16 v[40:41], v66 offset:57344
    v_mul_f32 v231, v231, v31
    v_mfma_f32_16x16x32_bf16 v[180:183], v[52:55], a[228:231], v[180:183]
    ds_read_b64_tr_b16 v[42:43], v66 offset:59392
    v_cvt_pk_bf16_f32 v242, v228, v229
    v_mfma_f32_16x16x32_bf16 v[184:187], v[52:55], a[232:235], v[184:187]
    v_cvt_pk_bf16_f32 v243, v230, v231
    s_nop 1
    v_mfma_f32_16x16x32_bf16 v[188:191], v[52:55], a[236:239], v[188:191]
    s_waitcnt lgkmcnt(2)
    v_permlane32_swap_b32 v240, v242
    v_mfma_f32_16x16x32_bf16 v[192:195], v[56:59], a[224:227], v[192:195]
    buffer_load_dwordx4 a[48:51], v1, s[36:39], s35 offen offset:0 sc1
    v_mfma_f32_16x16x32_bf16 v[196:199], v[56:59], a[228:231], v[196:199]
    ds_read_b64_tr_b16 v[44:45], v67 offset:57344
    v_mfma_f32_16x16x32_bf16 v[200:203], v[56:59], a[232:235], v[200:203]
    ds_read_b64_tr_b16 v[46:47], v67 offset:59392
    v_permlane32_swap_b32 v241, v243
    v_mfma_f32_16x16x32_bf16 v[204:207], v[56:59], a[236:239], v[204:207]
    buffer_store_dwordx4 v[240:243], v1, s[36:39], s53 offen offset:0 sc1
    v_mfma_f32_16x16x32_bf16 v[208:211], v[60:63], a[224:227], v[208:211]
    ds_read_b64_tr_b16 v[48:49], v64 offset:61440
    v_mul_f32 v24, v232, v22
    v_mfma_f32_16x16x32_bf16 v[212:215], v[60:63], a[228:231], v[212:215]
    ds_read_b64_tr_b16 v[50:51], v64 offset:63488
    v_mul_f32 v25, v233, v22
    v_mfma_f32_16x16x32_bf16 v[216:219], v[60:63], a[232:235], v[216:219]
    v_mov_b32 v14, 3
    v_mul_f32 v26, v234, v22
    v_mfma_f32_16x16x32_bf16 v[220:223], v[60:63], a[236:239], v[220:223]
    buffer_store_dword v14, v15, s[44:47], s56 offen sc1
    v_mfma_f32_16x16x32_bf16 v[96:99], v[32:35], a[240:243], v[96:99]
    ds_read_b64_tr_b16 v[52:53], v65 offset:61440
    v_mul_f32 v27, v235, v22
    v_mfma_f32_16x16x32_bf16 v[100:103], v[32:35], a[244:247], v[100:103]
    ds_read_b64_tr_b16 v[54:55], v65 offset:63488
    v_mfma_f32_16x16x32_bf16 v[104:107], v[32:35], a[248:251], v[104:107]
    v_exp_f32 v24, v24
    v_mfma_f32_16x16x32_bf16 v[108:111], v[32:35], a[252:255], v[108:111]
    v_exp_f32 v25, v25
    v_mfma_f32_16x16x32_bf16 v[112:115], v[36:39], a[240:243], v[112:115]
    buffer_load_dwordx4 a[52:55], v1, s[36:39], s35 offen offset:1024 sc1
    v_mfma_f32_16x16x32_bf16 v[116:119], v[36:39], a[244:247], v[116:119]
    ds_read_b64_tr_b16 v[56:57], v66 offset:61440
    v_and_b32 v74, 0x1f0, v1
    v_mfma_f32_16x16x32_bf16 v[120:123], v[36:39], a[248:251], v[120:123]
    ds_read_b64_tr_b16 v[58:59], v66 offset:63488
    v_exp_f32 v26, v26
    v_mfma_f32_16x16x32_bf16 v[124:127], v[36:39], a[252:255], v[124:127]
    s_waitcnt lgkmcnt(2)
    v_exp_f32 v27, v27
    v_mfma_f32_16x16x32_bf16 v[128:131], v[40:43], a[240:243], v[128:131]
    ds_read_b64_tr_b16 v[60:61], v67 offset:61440
    v_lshrrev_b32 v69, 5, v0
    v_mfma_f32_16x16x32_bf16 v[132:135], v[40:43], a[244:247], v[132:135]
    buffer_load_dwordx4 a[184:187], v1, s[36:39], s35 offen offset:2048 sc1
    v_mfma_f32_16x16x32_bf16 v[136:139], v[40:43], a[248:251], v[136:139]
    ds_read_b64_tr_b16 v[62:63], v67 offset:63488
    v_mul_f32 v232, v232, v248
    v_mfma_f32_16x16x32_bf16 v[140:143], v[40:43], a[252:255], v[140:143]
    s_waitcnt lgkmcnt(3)
    s_barrier
    v_add_u32 v64, 65536, v64
    v_mfma_f32_16x16x32_bf16 v[144:147], v[44:47], a[240:243], v[144:147]
    ds_read_b64_tr_b16 v[32:33], v64 offset:0
    v_mul_f32 v233, v233, v249
    v_lshl_add_u32 v74, v69, 3, v74
    v_mfma_f32_16x16x32_bf16 v[148:151], v[44:47], a[244:247], v[148:151]
    s_lshl_b32 s31, s29, 17
    ds_read_b64_tr_b16 v[34:35], v64 offset:2048
    v_mul_f32 v234, v234, v250
    v_mfma_f32_16x16x32_bf16 v[152:155], v[44:47], a[248:251], v[152:155]
    buffer_load_dwordx4 a[188:191], v1, s[36:39], s35 offen offset:3072 sc1
    v_mul_f32 v235, v235, v251
    v_mfma_f32_16x16x32_bf16 v[156:159], v[44:47], a[252:255], v[156:159]
    s_add_u32 s35, s65, 45056
    s_lshl_b32 s62, s24, 14
    v_fma_f32 v24, v24, v19, v19
    v_mfma_f32_16x16x32_bf16 v[160:163], v[48:51], a[240:243], v[160:163]
    s_add_u32 s31, s31, s62
    v_add_u32 v65, 65536, v65
    v_fma_f32 v25, v25, v19, v19
    v_mfma_f32_16x16x32_bf16 v[164:167], v[48:51], a[244:247], v[164:167]
    ds_read_b64_tr_b16 v[36:37], v65 offset:0
    v_fma_f32 v26, v26, v19, v19
    v_mfma_f32_16x16x32_bf16 v[168:171], v[48:51], a[248:251], v[168:171]
    s_lshl_b32 s62, s60, 12
    ds_read_b64_tr_b16 v[38:39], v65 offset:2048
    v_fma_f32 v27, v27, v19, v19
    v_mfma_f32_16x16x32_bf16 v[172:175], v[48:51], a[252:255], v[172:175]
    buffer_load_dwordx4 a[72:75], v1, s[36:39], s35 offen offset:0 sc1
    v_rcp_f32 v24, v24
    v_mfma_f32_16x16x32_bf16 v[176:179], v[52:55], a[240:243], v[176:179]
    s_add_u32 s31, s31, s62
    v_add_u32 v66, 65536, v66
    v_mfma_f32_16x16x32_bf16 v[180:183], v[52:55], a[244:247], v[180:183]
    s_lshl_b32 s62, s29, 6
    ds_read_b64_tr_b16 v[40:41], v66 offset:0
    v_rcp_f32 v25, v25
    v_mfma_f32_16x16x32_bf16 v[184:187], v[52:55], a[248:251], v[184:187]
    ds_read_b64_tr_b16 v[42:43], v66 offset:2048
    v_add_u32 v67, 65536, v67
    v_mfma_f32_16x16x32_bf16 v[188:191], v[52:55], a[252:255], v[188:191]
    s_waitcnt lgkmcnt(3)
    v_rcp_f32 v26, v26
    v_mfma_f32_16x16x32_bf16 v[192:195], v[56:59], a[240:243], v[192:195]
    buffer_load_dwordx4 a[76:79], v1, s[36:39], s35 offen offset:1024 sc1
    v_mfma_f32_16x16x32_bf16 v[196:199], v[56:59], a[244:247], v[196:199]
    ds_read_b64_tr_b16 v[44:45], v67 offset:0
    v_rcp_f32 v27, v27
    v_and_b32 v68, 15, v0
    v_mfma_f32_16x16x32_bf16 v[200:203], v[56:59], a[248:251], v[200:203]
    ds_read_b64_tr_b16 v[46:47], v67 offset:2048
    v_mul_f32 v232, v232, v24
    v_mfma_f32_16x16x32_bf16 v[204:207], v[56:59], a[252:255], v[204:207]
    v_mul_f32 v233, v233, v25
    v_add_u32 v68, s62, v68
    v_mfma_f32_16x16x32_bf16 v[208:211], v[60:63], a[240:243], v[208:211]
    ds_read_b64_tr_b16 v[48:49], v64 offset:4096
    v_mul_f32 v234, v234, v26
    v_mfma_f32_16x16x32_bf16 v[212:215], v[60:63], a[244:247], v[212:215]
    buffer_load_dwordx4 a[80:83], v1, s[36:39], s35 offen offset:2048 sc1
    v_mfma_f32_16x16x32_bf16 v[216:219], v[60:63], a[248:251], v[216:219]
    ds_read_b64_tr_b16 v[50:51], v64 offset:6144
    v_mul_f32 v235, v235, v27
    v_mfma_f32_16x16x32_bf16 v[220:223], v[60:63], a[252:255], v[220:223]
    v_cvt_pk_bf16_f32 v248, v232, v233
    v_lshlrev_b32 v75, 2, v68
    v_mfma_f32_16x16x32_bf16 v[96:99], v[32:35], a[56:59], v[96:99]
    s_mov_b32 s62, 24576
    ds_read_b64_tr_b16 v[52:53], v65 offset:4096
    v_cvt_pk_bf16_f32 v249, v234, v235
    v_mfma_f32_16x16x32_bf16 v[100:103], v[32:35], a[60:63], v[100:103]
    ds_read_b64_tr_b16 v[54:55], v65 offset:6144
    v_mul_f32 v28, v236, v23
    v_mfma_f32_16x16x32_bf16 v[104:107], v[32:35], a[64:67], v[104:107]
    buffer_load_dwordx4 a[84:87], v1, s[36:39], s35 offen offset:3072 sc1
    v_mul_f32 v29, v237, v23
    v_mfma_f32_16x16x32_bf16 v[108:111], v[32:35], a[68:71], v[108:111]
    s_waitcnt lgkmcnt(3)
    s_add_u32 s35, s74, 4096
    v_mul_f32 v30, v238, v23
    v_mfma_f32_16x16x32_bf16 v[112:115], v[36:39], a[56:59], v[112:115]
    buffer_load_dword v70, v75, s[44:47], s62 offen offset:0 sc1
    v_mul_f32 v31, v239, v23
    v_mfma_f32_16x16x32_bf16 v[116:119], v[36:39], a[60:63], v[116:119]
    ds_read_b64_tr_b16 v[56:57], v66 offset:4096
    v_mfma_f32_16x16x32_bf16 v[120:123], v[36:39], a[64:67], v[120:123]
    ds_read_b64_tr_b16 v[58:59], v66 offset:6144
    v_exp_f32 v28, v28
    v_mfma_f32_16x16x32_bf16 v[124:127], v[36:39], a[68:71], v[124:127]
    v_exp_f32 v29, v29
    v_mfma_f32_16x16x32_bf16 v[128:131], v[40:43], a[56:59], v[128:131]
    buffer_load_dword v71, v75, s[44:47], s62 offen offset:64 sc1
    v_mfma_f32_16x16x32_bf16 v[132:135], v[40:43], a[60:63], v[132:135]
    ds_read_b64_tr_b16 v[60:61], v67 offset:4096
    v_mfma_f32_16x16x32_bf16 v[136:139], v[40:43], a[64:67], v[136:139]
    ds_read_b64_tr_b16 v[62:63], v67 offset:6144
    v_exp_f32 v30, v30
    v_mfma_f32_16x16x32_bf16 v[140:143], v[40:43], a[68:71], v[140:143]
    v_exp_f32 v31, v31
    v_mfma_f32_16x16x32_bf16 v[144:147], v[44:47], a[56:59], v[144:147]
    ds_read_b64_tr_b16 v[32:33], v64 offset:8192
    v_mul_f32 v236, v236, v252
    v_mfma_f32_16x16x32_bf16 v[148:151], v[44:47], a[60:63], v[148:151]
    buffer_load_dwordx4 v10, s[40:43], s55 offen lds
    v_mfma_f32_16x16x32_bf16 v[152:155], v[44:47], a[64:67], v[152:155]
    buffer_load_dword v72, v75, s[44:47], s62 offen offset:128 sc1
    v_mfma_f32_16x16x32_bf16 v[156:159], v[44:47], a[68:71], v[156:159]
    s_waitcnt lgkmcnt(2)
    s_add_u32 m0, s54, 118784
    s_add_u32 s55, s5, s77
    v_mul_f32 v237, v237, v253
    v_mfma_f32_16x16x32_bf16 v[160:163], v[48:51], a[56:59], v[160:163]
    s_add_u32 s55, s55, 65536
    s_sub_u32 s30, s55, 917504
    s_min_u32 s55, s55, s30
    v_mul_f32 v238, v238, v254
    v_mfma_f32_16x16x32_bf16 v[164:167], v[48:51], a[60:63], v[164:167]
    ds_read_b64_tr_b16 v[34:35], v64 offset:10240
    v_mul_f32 v239, v239, v255
    v_mfma_f32_16x16x32_bf16 v[168:171], v[48:51], a[64:67], v[168:171]
    ds_read_b64_tr_b16 v[36:37], v65 offset:8192
    v_fma_f32 v28, v28, v20, v20
    v_mfma_f32_16x16x32_bf16 v[172:175], v[48:51], a[68:71], v[172:175]
    buffer_load_dwordx4 v10, s[40:43], s55 offen lds
    v_fma_f32 v29, v29, v20, v20
    v_mfma_f32_16x16x32_bf16 v[176:179], v[52:55], a[56:59], v[176:179]
    s_add_u32 m0, s54, 122880
    s_add_u32 s55, s4, s78
    s_add_u32 s55, s55, 65536
    v_fma_f32 v30, v30, v20, v20
    v_mfma_f32_16x16x32_bf16 v[180:183], v[52:55], a[60:63], v[180:183]
    buffer_load_dword v73, v75, s[44:47], s62 offen offset:192 sc1
    v_fma_f32 v31, v31, v20, v20
    v_mfma_f32_16x16x32_bf16 v[184:187], v[52:55], a[64:67], v[184:187]
    s_sub_u32 s30, s55, 917504
    s_min_u32 s55, s55, s30
    ds_read_b64_tr_b16 v[38:39], v65 offset:10240
    v_rcp_f32 v28, v28
    v_mfma_f32_16x16x32_bf16 v[188:191], v[52:55], a[68:71], v[188:191]
    ds_read_b64_tr_b16 v[40:41], v66 offset:8192
    v_mfma_f32_16x16x32_bf16 v[192:195], v[56:59], a[56:59], v[192:195]
    ds_read_b64_tr_b16 v[42:43], v66 offset:10240
    v_rcp_f32 v29, v29
    v_mfma_f32_16x16x32_bf16 v[196:199], v[56:59], a[60:63], v[196:199]
    buffer_load_dwordx4 v10, s[40:43], s55 offen lds
    v_mfma_f32_16x16x32_bf16 v[200:203], v[56:59], a[64:67], v[200:203]
    s_add_u32 m0, s54, 126976
    s_add_u32 s55, s5, s78
    s_add_u32 s55, s55, 65536
    v_rcp_f32 v30, v30
    v_mfma_f32_16x16x32_bf16 v[204:207], v[56:59], a[68:71], v[204:207]
    s_waitcnt lgkmcnt(3)
    s_sub_u32 s30, s55, 917504
    s_min_u32 s55, s55, s30
    v_mfma_f32_16x16x32_bf16 v[208:211], v[60:63], a[56:59], v[208:211]
    ds_read_b64_tr_b16 v[44:45], v67 offset:8192
    v_rcp_f32 v31, v31
    v_mfma_f32_16x16x32_bf16 v[212:215], v[60:63], a[60:63], v[212:215]
    ds_read_b64_tr_b16 v[46:47], v67 offset:10240
    v_lshlrev_b32 v68, 11, v68
    v_mfma_f32_16x16x32_bf16 v[216:219], v[60:63], a[64:67], v[216:219]
    buffer_load_dwordx4 v10, s[40:43], s55 offen lds
    v_mul_f32 v236, v236, v28
    v_mfma_f32_16x16x32_bf16 v[220:223], v[60:63], a[68:71], v[220:223]
    s_add_u32 m0, s54, 135168
    s_add_u32 s55, s5, s79
    s_add_u32 s55, s55, 65536
    v_mfma_f32_16x16x32_bf16 v[96:99], v[32:35], a[0:3], v[96:99]
    s_sub_u32 s30, s55, 917504
    s_min_u32 s55, s55, s30
    ds_read_b64_tr_b16 v[48:49], v64 offset:12288
    v_mul_f32 v237, v237, v29
    v_lshl_add_u32 v68, v69, 4, v68
    v_mfma_f32_16x16x32_bf16 v[100:103], v[32:35], a[4:7], v[100:103]
    ds_read_b64_tr_b16 v[50:51], v64 offset:14336
    v_mul_f32 v238, v238, v30
    v_mfma_f32_16x16x32_bf16 v[104:107], v[32:35], a[8:11], v[104:107]
    ds_read_b64_tr_b16 v[52:53], v65 offset:12288
    v_mul_f32 v239, v239, v31
    v_mfma_f32_16x16x32_bf16 v[108:111], v[32:35], a[12:15], v[108:111]
    s_waitcnt lgkmcnt(3)
    ds_read_b64_tr_b16 v[54:55], v65 offset:14336
    v_cvt_pk_bf16_f32 v250, v236, v237
    v_bfe_u32 v69, v0, 4, 1
    v_mfma_f32_16x16x32_bf16 v[112:115], v[36:39], a[0:3], v[112:115]
    buffer_load_dwordx4 a[88:91], v1, s[36:39], s35 offen offset:0 sc1
    v_cvt_pk_bf16_f32 v251, v238, v239
    v_mfma_f32_16x16x32_bf16 v[116:119], v[36:39], a[4:7], v[116:119]
    s_nop 1
    ds_read_b64_tr_b16 v[56:57], v66 offset:12288
    v_permlane32_swap_b32 v248, v250
    v_mfma_f32_16x16x32_bf16 v[120:123], v[36:39], a[8:11], v[120:123]
    ds_read_b64_tr_b16 v[58:59], v66 offset:14336
    v_lshl_add_u32 v68, v69, 5, v68
    v_mfma_f32_16x16x32_bf16 v[124:127], v[36:39], a[12:15], v[124:127]
    v_permlane32_swap_b32 v249, v251
    v_mfma_f32_16x16x32_bf16 v[128:131], v[40:43], a[0:3], v[128:131]
    buffer_store_dwordx4 v[248:251], v1, s[36:39], s53 offen offset:2048 sc1
    v_mfma_f32_16x16x32_bf16 v[132:135], v[40:43], a[4:7], v[132:135]
    s_lshl_b32 s62, s24, 8
    s_lshl_b32 s59, s60, 6
    ds_read_b64_tr_b16 v[60:61], v67 offset:12288
    v_mfma_f32_16x16x32_bf16 v[136:139], v[40:43], a[8:11], v[136:139]
    ds_read_b64_tr_b16 v[62:63], v67 offset:14336
    v_mfma_f32_16x16x32_bf16 v[140:143], v[40:43], a[12:15], v[140:143]
    s_waitcnt vmcnt(32) lgkmcnt(3)
    s_barrier
    s_add_u32 s62, s62, s59
    v_mfma_f32_16x16x32_bf16 v[144:147], v[44:47], a[0:3], v[144:147]
    ds_read_b64_tr_b16 v[32:33], v64 offset:16384
    v_mfma_f32_16x16x32_bf16 v[148:151], v[44:47], a[4:7], v[148:151]
    buffer_load_dwordx4 a[92:95], v1, s[36:39], s35 offen offset:1024 sc1
    v_mfma_f32_16x16x32_bf16 v[152:155], v[44:47], a[8:11], v[152:155]
    ds_read_b64_tr_b16 v[34:35], v64 offset:18432
    v_add_u32 v68, s62, v68
    v_mfma_f32_16x16x32_bf16 v[156:159], v[44:47], a[12:15], v[156:159]
    v_mfma_f32_16x16x32_bf16 v[160:163], v[48:51], a[0:3], v[160:163]
    ds_read_b64_tr_b16 v[36:37], v65 offset:16384
    v_lshrrev_b32 v76, 4, v0
    v_mfma_f32_16x16x32_bf16 v[164:167], v[48:51], a[4:7], v[164:167]
    ds_read_b64_tr_b16 v[38:39], v65 offset:18432
    v_mfma_f32_16x16x32_bf16 v[168:171], v[48:51], a[8:11], v[168:171]
    buffer_load_dwordx4 a[96:99], v1, s[36:39], s35 offen offset:2048 sc1
    v_mfma_f32_16x16x32_bf16 v[172:175], v[48:51], a[12:15], v[172:175]
    v_bfe_u32 v77, v0, 2, 2
    v_mfma_f32_16x16x32_bf16 v[176:179], v[52:55], a[0:3], v[176:179]
    ds_read_b64_tr_b16 v[40:41], v66 offset:16384
    v_mfma_f32_16x16x32_bf16 v[180:183], v[52:55], a[4:7], v[180:183]
    ds_read_b64_tr_b16 v[42:43], v66 offset:18432
    v_mfma_f32_16x16x32_bf16 v[184:187], v[52:55], a[8:11], v[184:187]
    v_cmp_eq_u32 s[22:23], v76, v77
    v_mfma_f32_16x16x32_bf16 v[188:191], v[52:55], a[12:15], v[188:191]
    s_waitcnt lgkmcnt(2)
    v_mfma_f32_16x16x32_bf16 v[192:195], v[56:59], a[0:3], v[192:195]
    buffer_load_dwordx4 a[100:103], v1, s[36:39], s35 offen offset:3072 sc1
    v_mfma_f32_16x16x32_bf16 v[196:199], v[56:59], a[4:7], v[196:199]
    s_add_u32 s35, s75, 4096
    ds_read_b64_tr_b16 v[44:45], v67 offset:16384
    v_and_b32 v76, 1, v0
    v_mfma_f32_16x16x32_bf16 v[200:203], v[56:59], a[8:11], v[200:203]
    ds_read_b64_tr_b16 v[46:47], v67 offset:18432
    v_mfma_f32_16x16x32_bf16 v[204:207], v[56:59], a[12:15], v[204:207]
    v_mfma_f32_16x16x32_bf16 v[208:211], v[60:63], a[0:3], v[208:211]
    ds_read_b64_tr_b16 v[48:49], v64 offset:20480
    v_lshlrev_b32 v76, 4, v76
    v_mfma_f32_16x16x32_bf16 v[212:215], v[60:63], a[4:7], v[212:215]
    buffer_load_dwordx4 a[104:107], v1, s[36:39], s35 offen offset:0 sc1
    v_mfma_f32_16x16x32_bf16 v[216:219], v[60:63], a[8:11], v[216:219]
    ds_read_b64_tr_b16 v[50:51], v64 offset:22528
    v_mfma_f32_16x16x32_bf16 v[220:223], v[60:63], a[12:15], v[220:223]
    s_waitcnt vmcnt(32)
    v_mfma_f32_16x16x32_bf16 v[96:99], v[32:35], a[16:19], v[96:99]
    ds_read_b64_tr_b16 v[52:53], v65 offset:20480
    v_mov_b32 v77, 0x3f80
    v_mfma_f32_16x16x32_bf16 v[100:103], v[32:35], a[20:23], v[100:103]
    ds_read_b64_tr_b16 v[54:55], v65 offset:22528
    v_mfma_f32_16x16x32_bf16 v[104:107], v[32:35], a[24:27], v[104:107]
    buffer_load_dwordx4 a[108:111], v1, s[36:39], s35 offen offset:1024 sc1
    v_mfma_f32_16x16x32_bf16 v[108:111], v[32:35], a[28:31], v[108:111]
    v_lshlrev_b32 v76, v76, v77
    v_mfma_f32_16x16x32_bf16 v[112:115], v[36:39], a[16:19], v[112:115]
    ds_read_b64_tr_b16 v[56:57], v66 offset:20480
    v_mfma_f32_16x16x32_bf16 v[116:119], v[36:39], a[20:23], v[116:119]
    ds_read_b64_tr_b16 v[58:59], v66 offset:22528
    v_mfma_f32_16x16x32_bf16 v[120:123], v[36:39], a[24:27], v[120:123]
    buffer_load_dword v13, v12, s[44:47], s57 offen sc1
    v_mfma_f32_16x16x32_bf16 v[124:127], v[36:39], a[28:31], v[124:127]
    s_waitcnt lgkmcnt(2)
    v_cndmask_b32 v76, 0, v76, s[22:23]
    v_mfma_f32_16x16x32_bf16 v[128:131], v[40:43], a[16:19], v[128:131]
    ds_read_b64_tr_b16 v[60:61], v67 offset:20480
    v_mfma_f32_16x16x32_bf16 v[132:135], v[40:43], a[20:23], v[132:135]
    ds_read_b64_tr_b16 v[62:63], v67 offset:22528
    v_bfe_i32 v77, v0, 1, 1
    v_mfma_f32_16x16x32_bf16 v[136:139], v[40:43], a[24:27], v[136:139]
    v_mfma_f32_16x16x32_bf16 v[140:143], v[40:43], a[28:31], v[140:143]
    buffer_load_dwordx4 a[112:115], v1, s[36:39], s35 offen offset:2048 sc1
    v_mfma_f32_16x16x32_bf16 v[144:147], v[44:47], a[16:19], v[144:147]
    ds_read_b64_tr_b16 v[32:33], v64 offset:24576
    v_and_b32 v79, v77, v76
    v_mfma_f32_16x16x32_bf16 v[148:151], v[44:47], a[20:23], v[148:151]
    ds_read_b64_tr_b16 v[34:35], v64 offset:26624
    v_mfma_f32_16x16x32_bf16 v[152:155], v[44:47], a[24:27], v[152:155]
    v_mfma_f32_16x16x32_bf16 v[156:159], v[44:47], a[28:31], v[156:159]
    v_mfma_f32_16x16x32_bf16 v[160:163], v[48:51], a[16:19], v[160:163]
    buffer_load_dwordx4 a[116:119], v1, s[36:39], s35 offen offset:3072 sc1
    v_mfma_f32_16x16x32_bf16 v[164:167], v[48:51], a[20:23], v[164:167]
    s_add_u32 s35, s76, 4096
    ds_read_b64_tr_b16 v[36:37], v65 offset:24576
    v_xor_b32 v78, v79, v76
    v_mfma_f32_16x16x32_bf16 v[168:171], v[48:51], a[24:27], v[168:171]
    ds_read_b64_tr_b16 v[38:39], v65 offset:26624
    v_mfma_f32_16x16x32_bf16 v[172:175], v[48:51], a[28:31], v[172:175]
    v_mov_b32 v76, 0
    v_mfma_f32_16x16x32_bf16 v[176:179], v[52:55], a[16:19], v[176:179]
    ds_read_b64_tr_b16 v[40:41], v66 offset:24576
    v_mfma_f32_16x16x32_bf16 v[180:183], v[52:55], a[20:23], v[180:183]
    buffer_load_dwordx4 v10, s[40:43], s55 offen lds
    v_mfma_f32_16x16x32_bf16 v[184:187], v[52:55], a[24:27], v[184:187]
    s_add_u32 m0, s54, 143360
    s_add_u32 s55, s7, 65536
    s_sub_u32 s30, s55, 917504
    v_mfma_f32_16x16x32_bf16 v[188:191], v[52:55], a[28:31], v[188:191]
    s_waitcnt lgkmcnt(2)
    s_min_u32 s55, s55, s30
    ds_read_b64_tr_b16 v[42:43], v66 offset:26624
    v_mfma_f32_16x16x32_bf16 v[192:195], v[56:59], a[16:19], v[192:195]
    ds_read_b64_tr_b16 v[44:45], v67 offset:24576
    v_mov_b32 v77, 0
    v_mfma_f32_16x16x32_bf16 v[196:199], v[56:59], a[20:23], v[196:199]
    ds_read_b64_tr_b16 v[46:47], v67 offset:26624
    v_mov_b32 v80, 0
    v_mfma_f32_16x16x32_bf16 v[200:203], v[56:59], a[24:27], v[200:203]
    buffer_load_dwordx4 v11, s[40:43], s55 offen lds
    v_mfma_f32_16x16x32_bf16 v[204:207], v[56:59], a[28:31], v[204:207]
    s_add_u32 m0, s54, 151552
    s_add_u32 s55, s7, 327680
    s_sub_u32 s30, s55, 917504
    v_mfma_f32_16x16x32_bf16 v[208:211], v[60:63], a[16:19], v[208:211]
    s_min_u32 s55, s55, s30
    ds_read_b64_tr_b16 v[48:49], v64 offset:28672
    v_mov_b32 v81, 0
    v_mfma_f32_16x16x32_bf16 v[212:215], v[60:63], a[20:23], v[212:215]
    ds_read_b64_tr_b16 v[50:51], v64 offset:30720
    v_mfma_f32_16x16x32_bf16 v[216:219], v[60:63], a[24:27], v[216:219]
    v_mfma_f32_16x16x32_bf16 v[220:223], v[60:63], a[28:31], v[220:223]
    s_waitcnt vmcnt(34)
    v_and_b32 v69, 3, v0
    v_mfma_f32_16x16x32_bf16 v[96:99], v[32:35], a[32:35], v[96:99]
    buffer_load_dwordx4 v11, s[40:43], s55 offen lds
    v_mfma_f32_16x16x32_bf16 v[100:103], v[32:35], a[36:39], v[100:103]
    s_add_u32 m0, s54, 159744
    s_add_u32 s55, s7, 524288
    s_sub_u32 s30, s55, 917504
    v_mfma_f32_16x16x32_bf16 v[104:107], v[32:35], a[40:43], v[104:107]
    s_min_u32 s55, s55, s30
    ds_read_b64_tr_b16 v[52:53], v65 offset:28672
    v_mfma_f32_16x16x32_bf16 v[108:111], v[32:35], a[44:47], v[108:111]
    s_waitcnt lgkmcnt(1)
    ds_read_b64_tr_b16 v[54:55], v65 offset:30720
    v_lshlrev_b32 v69, 10, v69
    v_mfma_f32_16x16x32_bf16 v[112:115], v[36:39], a[32:35], v[112:115]
    ds_read_b64_tr_b16 v[56:57], v66 offset:28672
    v_mfma_f32_16x16x32_bf16 v[116:119], v[36:39], a[36:39], v[116:119]
    buffer_load_dwordx4 v11, s[40:43], s55 offen lds
    v_mfma_f32_16x16x32_bf16 v[120:123], v[36:39], a[40:43], v[120:123]
    s_add_u32 m0, s54, 4096
    s_add_u32 s55, s7, 786432
    s_sub_u32 s30, s55, 917504
    v_mfma_f32_16x16x32_bf16 v[124:127], v[36:39], a[44:47], v[124:127]
    s_min_u32 s55, s55, s30
    s_xor_b32 s12, s61, 131072
    s_add_u32 s12, s12, 14680064
    v_mfma_f32_16x16x32_bf16 v[128:131], v[40:43], a[32:35], v[128:131]
    ds_read_b64_tr_b16 v[58:59], v66 offset:30720
    v_mfma_f32_16x16x32_bf16 v[132:135], v[40:43], a[36:39], v[132:135]
    s_xor_b32 s13, s61, 266240
    ds_read_b64_tr_b16 v[60:61], v67 offset:28672
    v_mfma_f32_16x16x32_bf16 v[136:139], v[40:43], a[40:43], v[136:139]
    buffer_load_dwordx4 a[120:123], v1, s[36:39], s35 offen offset:0 sc1
    v_mfma_f32_16x16x32_bf16 v[140:143], v[40:43], a[44:47], v[140:143]
    s_waitcnt vmcnt(33) lgkmcnt(2)
    s_barrier
    s_add_u32 s13, s13, 14680064
    v_mfma_f32_16x16x32_bf16 v[144:147], v[44:47], a[32:35], v[144:147]
    s_xor_b32 s14, s61, 401408
    ds_read_b64_tr_b16 v[62:63], v67 offset:30720
    v_mfma_f32_16x16x32_bf16 v[148:151], v[44:47], a[36:39], v[148:151]
    ds_read_b64_tr_b16 v[32:33], v64 offset:32768
    v_mfma_f32_16x16x32_bf16 v[152:155], v[44:47], a[40:43], v[152:155]
    s_add_u32 s14, s14, 14680064
    ds_read_b64_tr_b16 v[34:35], v64 offset:34816
    v_mfma_f32_16x16x32_bf16 v[156:159], v[44:47], a[44:47], v[156:159]
    buffer_load_dwordx4 a[124:127], v1, s[36:39], s35 offen offset:1024 sc1
    v_mfma_f32_16x16x32_bf16 v[160:163], v[48:51], a[32:35], v[160:163]
    s_xor_b32 s15, s56, 1024
    ds_read_b64_tr_b16 v[36:37], v65 offset:32768
    v_mfma_f32_16x16x32_bf16 v[164:167], v[48:51], a[36:39], v[164:167]
    s_add_u32 s16, s64, 4096
    ds_read_b64_tr_b16 v[38:39], v65 offset:34816
    v_mfma_f32_16x16x32_bf16 v[168:171], v[48:51], a[40:43], v[168:171]
    s_waitcnt vmcnt(8)
    v_cmp_gt_i32 vcc, 3, v13
    s_add_u32 s17, s64, 8192
    v_mfma_f32_16x16x32_bf16 v[172:175], v[48:51], a[44:47], v[172:175]
    s_cbranch_vccnz L_up_slow3
L_up_back3:
    v_mfma_f32_16x16x32_bf16 v[176:179], v[52:55], a[32:35], v[176:179]
    buffer_load_dwordx4 a[128:131], v1, s[36:39], s35 offen offset:2048 sc1
    v_mfma_f32_16x16x32_bf16 v[180:183], v[52:55], a[36:39], v[180:183]
    buffer_load_dwordx4 v[224:227], v1, s[8:11], s31 offen offset:0 sc1
    v_mfma_f32_16x16x32_bf16 v[184:187], v[52:55], a[40:43], v[184:187]
    ds_read_b64_tr_b16 v[40:41], v66 offset:32768
    v_mfma_f32_16x16x32_bf16 v[188:191], v[52:55], a[44:47], v[188:191]
    s_waitcnt lgkmcnt(1)
    ds_read_b64_tr_b16 v[42:43], v66 offset:34816
    v_mfma_f32_16x16x32_bf16 v[192:195], v[56:59], a[32:35], v[192:195]
    ds_read_b64_tr_b16 v[44:45], v67 offset:32768
    v_mfma_f32_16x16x32_bf16 v[196:199], v[56:59], a[36:39], v[196:199]
    ds_read_b64_tr_b16 v[46:47], v67 offset:34816
    v_mfma_f32_16x16x32_bf16 v[200:203], v[56:59], a[40:43], v[200:203]
    buffer_load_dwordx4 a[132:135], v1, s[36:39], s35 offen offset:3072 sc1
    v_mfma_f32_16x16x32_bf16 v[204:207], v[56:59], a[44:47], v[204:207]
    buffer_load_dwordx4 v[228:231], v1, s[8:11], s31 offen offset:1024 sc1
    v_mfma_f32_16x16x32_bf16 v[208:211], v[60:63], a[32:35], v[208:211]
    s_add_u32 s35, s65, 4096
    ds_read_b64_tr_b16 v[48:49], v64 offset:36864
    v_mfma_f32_16x16x32_bf16 v[212:215], v[60:63], a[36:39], v[212:215]
    ds_read_b64_tr_b16 v[50:51], v64 offset:38912
    v_mfma_f32_16x16x32_bf16 v[216:219], v[60:63], a[40:43], v[216:219]
    v_mfma_f32_16x16x32_bf16 v[220:223], v[60:63], a[44:47], v[220:223]
    v_mfma_f32_16x16x32_bf16 v[96:99], v[32:35], a[48:51], v[96:99]
    buffer_load_dwordx4 a[136:139], v1, s[36:39], s35 offen offset:0 sc1
    v_mfma_f32_16x16x32_bf16 v[100:103], v[32:35], a[52:55], v[100:103]
    buffer_load_dwordx4 v[232:235], v1, s[8:11], s31 offen offset:2048 sc1
    v_mfma_f32_16x16x32_bf16 v[104:107], v[32:35], a[184:187], v[104:107]
    ds_read_b64_tr_b16 v[52:53], v65 offset:36864
    v_mov_b32 v14, 4
    v_mfma_f32_16x16x32_bf16 v[108:111], v[32:35], a[188:191], v[108:111]
    buffer_store_dword v14, v15, s[44:47], s56 offen sc1
    v_mfma_f32_16x16x32_bf16 v[112:115], v[36:39], a[48:51], v[112:115]
    ds_read_b64_tr_b16 v[54:55], v65 offset:38912
    v_mfma_f32_16x16x32_bf16 v[116:119], v[36:39], a[52:55], v[116:119]
    ds_read_b64_tr_b16 v[56:57], v66 offset:36864
    v_mfma_f32_16x16x32_bf16 v[120:123], v[36:39], a[184:187], v[120:123]
    ds_read_b64_tr_b16 v[58:59], v66 offset:38912
    v_mfma_f32_16x16x32_bf16 v[124:127], v[36:39], a[188:191], v[124:127]
    s_waitcnt lgkmcnt(4)
    v_mfma_f32_16x16x32_bf16 v[128:131], v[40:43], a[48:51], v[128:131]
    buffer_load_dwordx4 a[140:143], v1, s[36:39], s35 offen offset:1024 sc1
    v_mfma_f32_16x16x32_bf16 v[132:135], v[40:43], a[52:55], v[132:135]
    buffer_load_dwordx4 v[236:239], v1, s[8:11], s31 offen offset:3072 sc1
    v_mfma_f32_16x16x32_bf16 v[136:139], v[40:43], a[184:187], v[136:139]
    ds_read_b64_tr_b16 v[60:61], v67 offset:36864
    v_mfma_f32_16x16x32_bf16 v[140:143], v[40:43], a[188:191], v[140:143]
    ds_read_b64_tr_b16 v[62:63], v67 offset:38912
    v_mfma_f32_16x16x32_bf16 v[144:147], v[44:47], a[48:51], v[144:147]
    ds_read_b64_tr_b16 v[32:33], v64 offset:40960
    v_mfma_f32_16x16x32_bf16 v[148:151], v[44:47], a[52:55], v[148:151]
    ds_read_b64_tr_b16 v[34:35], v64 offset:43008
    v_mfma_f32_16x16x32_bf16 v[152:155], v[44:47], a[184:187], v[152:155]
    buffer_load_dwordx4 a[144:147], v1, s[36:39], s35 offen offset:2048 sc1
    v_mfma_f32_16x16x32_bf16 v[156:159], v[44:47], a[188:191], v[156:159]
    v_mfma_f32_16x16x32_bf16 v[160:163], v[48:51], a[48:51], v[160:163]
    ds_read_b64_tr_b16 v[36:37], v65 offset:40960
    v_mfma_f32_16x16x32_bf16 v[164:167], v[48:51], a[52:55], v[164:167]
    ds_read_b64_tr_b16 v[38:39], v65 offset:43008
    v_mfma_f32_16x16x32_bf16 v[168:171], v[48:51], a[184:187], v[168:171]
    v_mfma_f32_16x16x32_bf16 v[172:175], v[48:51], a[188:191], v[172:175]
    s_waitcnt lgkmcnt(2)
    v_mfma_f32_16x16x32_bf16 v[176:179], v[52:55], a[48:51], v[176:179]
    buffer_load_dwordx4 a[148:151], v1, s[36:39], s35 offen offset:3072 sc1
    v_mfma_f32_16x16x32_bf16 v[180:183], v[52:55], a[52:55], v[180:183]
    s_add_u32 s35, s65, 20480
    ds_read_b64_tr_b16 v[40:41], v66 offset:40960
    v_mfma_f32_16x16x32_bf16 v[184:187], v[52:55], a[184:187], v[184:187]
    ds_read_b64_tr_b16 v[42:43], v66 offset:43008
    v_mfma_f32_16x16x32_bf16 v[188:191], v[52:55], a[188:191], v[188:191]
    v_mfma_f32_16x16x32_bf16 v[192:195], v[56:59], a[48:51], v[192:195]
    ds_read_b64_tr_b16 v[44:45], v67 offset:40960
    v_mfma_f32_16x16x32_bf16 v[196:199], v[56:59], a[52:55], v[196:199]
    buffer_load_dwordx4 a[152:155], v1, s[36:39], s35 offen offset:0 sc1
    v_mfma_f32_16x16x32_bf16 v[200:203], v[56:59], a[184:187], v[200:203]
    ds_read_b64_tr_b16 v[46:47], v67 offset:43008
    v_mfma_f32_16x16x32_bf16 v[204:207], v[56:59], a[188:191], v[204:207]
    v_mfma_f32_16x16x32_bf16 v[208:211], v[60:63], a[48:51], v[208:211]
    ds_read_b64_tr_b16 v[48:49], v64 offset:45056
    v_mfma_f32_16x16x32_bf16 v[212:215], v[60:63], a[52:55], v[212:215]
    ds_read_b64_tr_b16 v[50:51], v64 offset:47104
    v_mfma_f32_16x16x32_bf16 v[216:219], v[60:63], a[184:187], v[216:219]
    buffer_load_dwordx4 a[156:159], v1, s[36:39], s35 offen offset:1024 sc1
    v_mfma_f32_16x16x32_bf16 v[220:223], v[60:63], a[188:191], v[220:223]
    v_mfma_f32_16x16x32_bf16 v[96:99], v[32:35], a[72:75], v[96:99]
    ds_read_b64_tr_b16 v[52:53], v65 offset:45056
    v_mfma_f32_16x16x32_bf16 v[100:103], v[32:35], a[76:79], v[100:103]
    ds_read_b64_tr_b16 v[54:55], v65 offset:47104
    v_mfma_f32_16x16x32_bf16 v[104:107], v[32:35], a[80:83], v[104:107]
    v_mfma_f32_16x16x32_bf16 v[108:111], v[32:35], a[84:87], v[108:111]
    s_waitcnt lgkmcnt(2)
    v_mfma_f32_16x16x32_bf16 v[112:115], v[36:39], a[72:75], v[112:115]
    buffer_load_dwordx4 a[160:163], v1, s[36:39], s35 offen offset:2048 sc1
    v_mfma_f32_16x16x32_bf16 v[116:119], v[36:39], a[76:79], v[116:119]
    ds_read_b64_tr_b16 v[56:57], v66 offset:45056
    v_mfma_f32_16x16x32_bf16 v[120:123], v[36:39], a[80:83], v[120:123]
    ds_read_b64_tr_b16 v[58:59], v66 offset:47104
    v_mfma_f32_16x16x32_bf16 v[124:127], v[36:39], a[84:87], v[124:127]
    v_mfma_f32_16x16x32_bf16 v[128:131], v[40:43], a[72:75], v[128:131]
    ds_read_b64_tr_b16 v[60:61], v67 offset:45056
    v_mfma_f32_16x16x32_bf16 v[132:135], v[40:43], a[76:79], v[132:135]
    buffer_load_dwordx4 a[164:167], v1, s[36:39], s35 offen offset:3072 sc1
    v_mfma_f32_16x16x32_bf16 v[136:139], v[40:43], a[80:83], v[136:139]
    s_add_u32 s35, s65, 32768
    ds_read_b64_tr_b16 v[62:63], v67 offset:47104
    v_mfma_f32_16x16x32_bf16 v[140:143], v[40:43], a[84:87], v[140:143]
    s_waitcnt lgkmcnt(3)
    s_barrier
    v_mfma_f32_16x16x32_bf16 v[144:147], v[44:47], a[72:75], v[144:147]
    ds_read_b64_tr_b16 v[32:33], v64 offset:49152
    v_mfma_f32_16x16x32_bf16 v[148:151], v[44:47], a[76:79], v[148:151]
    ds_read_b64_tr_b16 v[34:35], v64 offset:51200
    v_mfma_f32_16x16x32_bf16 v[152:155], v[44:47], a[80:83], v[152:155]
    buffer_load_dwordx4 v11, s[40:43], s55 offen lds
    v_mfma_f32_16x16x32_bf16 v[156:159], v[44:47], a[84:87], v[156:159]
    s_add_u32 m0, s54, 12288
    s_add_u32 s55, s5, s77
    s_add_u32 s55, s55, 131072
    v_mfma_f32_16x16x32_bf16 v[160:163], v[48:51], a[72:75], v[160:163]
    s_sub_u32 s30, s55, 917504
    s_min_u32 s55, s55, s30
    ds_read_b64_tr_b16 v[36:37], v65 offset:49152
    v_mfma_f32_16x16x32_bf16 v[164:167], v[48:51], a[76:79], v[164:167]
    ds_read_b64_tr_b16 v[38:39], v65 offset:51200
    v_mfma_f32_16x16x32_bf16 v[168:171], v[48:51], a[80:83], v[168:171]
    v_mfma_f32_16x16x32_bf16 v[172:175], v[48:51], a[84:87], v[172:175]
    buffer_load_dwordx4 v10, s[40:43], s55 offen lds
    v_mfma_f32_16x16x32_bf16 v[176:179], v[52:55], a[72:75], v[176:179]
    s_add_u32 m0, s54, 20480
    s_add_u32 s55, s5, s78
    s_add_u32 s55, s55, 131072
    v_mfma_f32_16x16x32_bf16 v[180:183], v[52:55], a[76:79], v[180:183]
    s_sub_u32 s30, s55, 917504
    s_min_u32 s55, s55, s30
    ds_read_b64_tr_b16 v[40:41], v66 offset:49152
    v_mfma_f32_16x16x32_bf16 v[184:187], v[52:55], a[80:83], v[184:187]
    ds_read_b64_tr_b16 v[42:43], v66 offset:51200
    v_mfma_f32_16x16x32_bf16 v[188:191], v[52:55], a[84:87], v[188:191]
    s_waitcnt lgkmcnt(2)
    v_mfma_f32_16x16x32_bf16 v[192:195], v[56:59], a[72:75], v[192:195]
    buffer_load_dwordx4 v10, s[40:43], s55 offen lds
    v_mfma_f32_16x16x32_bf16 v[196:199], v[56:59], a[76:79], v[196:199]
    s_add_u32 m0, s54, 28672
    s_add_u32 s55, s5, s79
    s_add_u32 s55, s55, 131072
    v_mfma_f32_16x16x32_bf16 v[200:203], v[56:59], a[80:83], v[200:203]
    s_sub_u32 s30, s55, 917504
    s_min_u32 s55, s55, s30
    ds_read_b64_tr_b16 v[44:45], v67 offset:49152
    v_mfma_f32_16x16x32_bf16 v[204:207], v[56:59], a[84:87], v[204:207]
    ds_read_b64_tr_b16 v[46:47], v67 offset:51200
    v_mfma_f32_16x16x32_bf16 v[208:211], v[60:63], a[72:75], v[208:211]
    ds_read_b64_tr_b16 v[48:49], v64 offset:53248
    v_mfma_f32_16x16x32_bf16 v[212:215], v[60:63], a[76:79], v[212:215]
    buffer_load_dwordx4 v10, s[40:43], s55 offen lds
    v_mfma_f32_16x16x32_bf16 v[216:219], v[60:63], a[80:83], v[216:219]
    s_add_u32 m0, s54, 36864
    s_add_u32 s55, s7, 131072
    s_sub_u32 s30, s55, 917504
    v_mfma_f32_16x16x32_bf16 v[220:223], v[60:63], a[84:87], v[220:223]
    s_min_u32 s55, s55, s30
    ds_read_b64_tr_b16 v[50:51], v64 offset:55296
    v_mfma_f32_16x16x32_bf16 v[96:99], v[32:35], a[88:91], v[96:99]
    ds_read_b64_tr_b16 v[52:53], v65 offset:53248
    v_mfma_f32_16x16x32_bf16 v[100:103], v[32:35], a[92:95], v[100:103]
    ds_read_b64_tr_b16 v[54:55], v65 offset:55296
    v_mfma_f32_16x16x32_bf16 v[104:107], v[32:35], a[96:99], v[104:107]
    buffer_load_dwordx4 a[168:171], v1, s[36:39], s35 offen offset:0 sc1
    v_mfma_f32_16x16x32_bf16 v[108:111], v[32:35], a[100:103], v[108:111]
    buffer_load_dwordx4 a[172:175], v1, s[36:39], s35 offen offset:1024 sc1
    v_mfma_f32_16x16x32_bf16 v[112:115], v[36:39], a[88:91], v[112:115]
    buffer_load_dwordx4 a[176:179], v1, s[36:39], s35 offen offset:2048 sc1
    v_mfma_f32_16x16x32_bf16 v[116:119], v[36:39], a[92:95], v[116:119]
    buffer_load_dwordx4 a[180:183], v1, s[36:39], s35 offen offset:3072 sc1
    v_mfma_f32_16x16x32_bf16 v[120:123], v[36:39], a[96:99], v[120:123]
    s_add_u32 s35, s65, 49152
    ds_read_b64_tr_b16 v[56:57], v66 offset:53248
    v_mfma_f32_16x16x32_bf16 v[124:127], v[36:39], a[100:103], v[124:127]
    s_waitcnt lgkmcnt(1)
    ds_read_b64_tr_b16 v[58:59], v66 offset:55296
    v_mfma_f32_16x16x32_bf16 v[128:131], v[40:43], a[88:91], v[128:131]
    ds_read_b64_tr_b16 v[60:61], v67 offset:53248
    v_mfma_f32_16x16x32_bf16 v[132:135], v[40:43], a[92:95], v[132:135]
    ds_read_b64_tr_b16 v[62:63], v67 offset:55296
    v_mfma_f32_16x16x32_bf16 v[136:139], v[40:43], a[96:99], v[136:139]
    buffer_load_dwordx4 a[192:195], v1, s[36:39], s35 offen offset:0 sc1
    v_mfma_f32_16x16x32_bf16 v[140:143], v[40:43], a[100:103], v[140:143]
    v_mfma_f32_16x16x32_bf16 v[144:147], v[44:47], a[88:91], v[144:147]
    ds_read_b64_tr_b16 v[32:33], v64 offset:57344
    v_mfma_f32_16x16x32_bf16 v[148:151], v[44:47], a[92:95], v[148:151]
    ds_read_b64_tr_b16 v[34:35], v64 offset:59392
    v_mfma_f32_16x16x32_bf16 v[152:155], v[44:47], a[96:99], v[152:155]
    v_mfma_f32_16x16x32_bf16 v[156:159], v[44:47], a[100:103], v[156:159]
    buffer_load_dwordx4 a[196:199], v1, s[36:39], s35 offen offset:1024 sc1
    v_mfma_f32_16x16x32_bf16 v[160:163], v[48:51], a[88:91], v[160:163]
    ds_read_b64_tr_b16 v[36:37], v65 offset:57344
    v_mfma_f32_16x16x32_bf16 v[164:167], v[48:51], a[92:95], v[164:167]
    ds_read_b64_tr_b16 v[38:39], v65 offset:59392
    v_mfma_f32_16x16x32_bf16 v[168:171], v[48:51], a[96:99], v[168:171]
    buffer_load_dwordx4 a[200:203], v1, s[36:39], s35 offen offset:2048 sc1
    v_mfma_f32_16x16x32_bf16 v[172:175], v[48:51], a[100:103], v[172:175]
    buffer_load_dwordx4 a[204:207], v1, s[36:39], s35 offen offset:3072 sc1
    v_mfma_f32_16x16x32_bf16 v[176:179], v[52:55], a[88:91], v[176:179]
    s_add_u32 s35, s74, 8192
    ds_read_b64_tr_b16 v[40:41], v66 offset:57344
    v_mfma_f32_16x16x32_bf16 v[180:183], v[52:55], a[92:95], v[180:183]
    ds_read_b64_tr_b16 v[42:43], v66 offset:59392
    v_mfma_f32_16x16x32_bf16 v[184:187], v[52:55], a[96:99], v[184:187]
    v_mfma_f32_16x16x32_bf16 v[188:191], v[52:55], a[100:103], v[188:191]
    s_waitcnt lgkmcnt(2)
    v_mfma_f32_16x16x32_bf16 v[192:195], v[56:59], a[88:91], v[192:195]
    buffer_load_dwordx4 a[208:211], v1, s[36:39], s35 offen offset:0 sc1
    v_mfma_f32_16x16x32_bf16 v[196:199], v[56:59], a[92:95], v[196:199]
    ds_read_b64_tr_b16 v[44:45], v67 offset:57344
    v_mfma_f32_16x16x32_bf16 v[200:203], v[56:59], a[96:99], v[200:203]
    ds_read_b64_tr_b16 v[46:47], v67 offset:59392
    v_mfma_f32_16x16x32_bf16 v[204:207], v[56:59], a[100:103], v[204:207]
    v_mfma_f32_16x16x32_bf16 v[208:211], v[60:63], a[88:91], v[208:211]
    ds_read_b64_tr_b16 v[48:49], v64 offset:61440
    v_mfma_f32_16x16x32_bf16 v[212:215], v[60:63], a[92:95], v[212:215]
    buffer_load_dwordx4 a[212:215], v1, s[36:39], s35 offen offset:1024 sc1
    v_mfma_f32_16x16x32_bf16 v[216:219], v[60:63], a[96:99], v[216:219]
    ds_read_b64_tr_b16 v[50:51], v64 offset:63488
    v_mfma_f32_16x16x32_bf16 v[220:223], v[60:63], a[100:103], v[220:223]
    s_waitcnt vmcnt(35)
    v_mfma_f32_16x16x32_bf16 v[96:99], v[32:35], a[104:107], v[96:99]
    ds_read_b64_tr_b16 v[52:53], v65 offset:61440
    v_mfma_f32_16x16x32_bf16 v[100:103], v[32:35], a[108:111], v[100:103]
    ds_read_b64_tr_b16 v[54:55], v65 offset:63488
    v_mfma_f32_16x16x32_bf16 v[104:107], v[32:35], a[112:115], v[104:107]
    buffer_load_dwordx4 a[216:219], v1, s[36:39], s35 offen offset:2048 sc1
    v_mfma_f32_16x16x32_bf16 v[108:111], v[32:35], a[116:119], v[108:111]
    buffer_load_dwordx4 a[220:223], v1, s[36:39], s35 offen offset:3072 sc1
    v_mfma_f32_16x16x32_bf16 v[112:115], v[36:39], a[104:107], v[112:115]
    s_add_u32 s35, s75, 8192
    ds_read_b64_tr_b16 v[56:57], v66 offset:61440
    v_mfma_f32_16x16x32_bf16 v[116:119], v[36:39], a[108:111], v[116:119]
    ds_read_b64_tr_b16 v[58:59], v66 offset:63488
    v_mfma_f32_16x16x32_bf16 v[120:123], v[36:39], a[112:115], v[120:123]
    v_mfma_f32_16x16x32_bf16 v[124:127], v[36:39], a[116:119], v[124:127]
    s_waitcnt lgkmcnt(2)
    v_mfma_f32_16x16x32_bf16 v[128:131], v[40:43], a[104:107], v[128:131]
    buffer_load_dwordx4 a[224:227], v1, s[36:39], s35 offen offset:0 sc1
    v_mfma_f32_16x16x32_bf16 v[132:135], v[40:43], a[108:111], v[132:135]
    ds_read_b64_tr_b16 v[60:61], v67 offset:61440
    v_mfma_f32_16x16x32_bf16 v[136:139], v[40:43], a[112:115], v[136:139]
    ds_read_b64_tr_b16 v[62:63], v67 offset:63488
    v_add_u32 v64, 65536, v64
    v_mfma_f32_16x16x32_bf16 v[140:143], v[40:43], a[116:119], v[140:143]
    s_waitcnt vmcnt(34) lgkmcnt(2)
    s_barrier
    v_mfma_f32_16x16x32_bf16 v[144:147], v[44:47], a[104:107], v[144:147]
    ds_read_b64_tr_b16 v[32:33], v64 offset:4096
    v_mfma_f32_16x16x32_bf16 v[148:151], v[44:47], a[108:111], v[148:151]
    buffer_load_dwordx4 a[228:231], v1, s[36:39], s35 offen offset:1024 sc1
    v_mfma_f32_16x16x32_bf16 v[152:155], v[44:47], a[112:115], v[152:155]
    ds_read_b64_tr_b16 v[34:35], v64 offset:6144
    v_add_u32 v65, 65536, v65
    v_mfma_f32_16x16x32_bf16 v[156:159], v[44:47], a[116:119], v[156:159]
    v_mfma_f32_16x16x32_bf16 v[160:163], v[48:51], a[104:107], v[160:163]
    ds_read_b64_tr_b16 v[36:37], v65 offset:4096
    v_mfma_f32_16x16x32_bf16 v[164:167], v[48:51], a[108:111], v[164:167]
    ds_read_b64_tr_b16 v[38:39], v65 offset:6144
    v_mfma_f32_16x16x32_bf16 v[168:171], v[48:51], a[112:115], v[168:171]
    buffer_load_dwordx4 a[232:235], v1, s[36:39], s35 offen offset:2048 sc1
    v_mfma_f32_16x16x32_bf16 v[172:175], v[48:51], a[116:119], v[172:175]
    buffer_load_dwordx4 a[236:239], v1, s[36:39], s35 offen offset:3072 sc1
    v_mfma_f32_16x16x32_bf16 v[176:179], v[52:55], a[104:107], v[176:179]
    s_add_u32 s35, s76, 8192
    v_add_u32 v66, 65536, v66
    v_mfma_f32_16x16x32_bf16 v[180:183], v[52:55], a[108:111], v[180:183]
    ds_read_b64_tr_b16 v[40:41], v66 offset:4096
    v_mfma_f32_16x16x32_bf16 v[184:187], v[52:55], a[112:115], v[184:187]
    ds_read_b64_tr_b16 v[42:43], v66 offset:6144
    v_add_u32 v67, 65536, v67
    v_mfma_f32_16x16x32_bf16 v[188:191], v[52:55], a[116:119], v[188:191]
    v_mfma_f32_16x16x32_bf16 v[192:195], v[56:59], a[104:107], v[192:195]
    buffer_load_dwordx4 v11, s[40:43], s55 offen lds
    v_mfma_f32_16x16x32_bf16 v[196:199], v[56:59], a[108:111], v[196:199]
    s_add_u32 m0, s54, 45056
    s_add_u32 s55, s7, 393216
    s_sub_u32 s30, s55, 917504
    v_mfma_f32_16x16x32_bf16 v[200:203], v[56:59], a[112:115], v[200:203]
    s_min_u32 s55, s55, s30
    ds_read_b64_tr_b16 v[44:45], v67 offset:4096
    v_mfma_f32_16x16x32_bf16 v[204:207], v[56:59], a[116:119], v[204:207]
    s_waitcnt lgkmcnt(2)
    ds_read_b64_tr_b16 v[46:47], v67 offset:6144
    v_mfma_f32_16x16x32_bf16 v[208:211], v[60:63], a[104:107], v[208:211]
    ds_read_b64_tr_b16 v[48:49], v64 offset:12288
    v_mfma_f32_16x16x32_bf16 v[212:215], v[60:63], a[108:111], v[212:215]
    buffer_load_dwordx4 v11, s[40:43], s55 offen lds
    v_mfma_f32_16x16x32_bf16 v[216:219], v[60:63], a[112:115], v[216:219]
    s_add_u32 m0, s54, 53248
    s_add_u32 s55, s7, 589824
    s_sub_u32 s30, s55, 917504
    v_mfma_f32_16x16x32_bf16 v[220:223], v[60:63], a[116:119], v[220:223]
    s_waitcnt vmcnt(34)
    s_min_u32 s55, s55, s30
    ds_read_b64_tr_b16 v[50:51], v64 offset:14336
    v_mfma_f32_16x16x32_bf16 v[160:163], v[32:35], a[120:123], v[160:163]
    buffer_load_dwordx4 v11, s[40:43], s55 offen lds
    v_mfma_f32_16x16x32_bf16 v[164:167], v[32:35], a[124:127], v[164:167]
    s_add_u32 m0, s54, 61440
    s_add_u32 s55, s7, 851968
    s_sub_u32 s30, s55, 917504
    v_mfma_f32_16x16x32_bf16 v[168:171], v[32:35], a[128:131], v[168:171]
    buffer_load_dwordx4 a[240:243], v1, s[36:39], s35 offen offset:0 sc1
    v_mfma_f32_16x16x32_bf16 v[172:175], v[32:35], a[132:135], v[172:175]
    buffer_load_dwordx4 a[244:247], v1, s[36:39], s35 offen offset:1024 sc1
    v_mfma_f32_16x16x32_bf16 v[176:179], v[36:39], a[120:123], v[176:179]
    buffer_load_dwordx4 a[248:251], v1, s[36:39], s35 offen offset:2048 sc1
    v_mfma_f32_16x16x32_bf16 v[180:183], v[36:39], a[124:127], v[180:183]
    buffer_load_dwordx4 a[252:255], v1, s[36:39], s35 offen offset:3072 sc1
    v_mfma_f32_16x16x32_bf16 v[184:187], v[36:39], a[128:131], v[184:187]
    buffer_load_dword v13, v12, s[44:47], s57 offen sc1
    ds_read_b64_tr_b16 v[52:53], v65 offset:12288
    v_mfma_f32_16x16x32_bf16 v[188:191], v[36:39], a[132:135], v[188:191]
    s_waitcnt lgkmcnt(1)
    s_min_u32 s55, s55, s30
    s_add_u32 s35, s65, 8192
    ds_read_b64_tr_b16 v[54:55], v65 offset:14336
    v_mfma_f32_16x16x32_bf16 v[192:195], v[40:43], a[120:123], v[192:195]
    buffer_load_dwordx4 v11, s[40:43], s55 offen lds
    v_mfma_f32_16x16x32_bf16 v[196:199], v[40:43], a[124:127], v[196:199]
    s_add_u32 m0, s54, 69632
    s_add_u32 s55, s5, 196608
    s_sub_u32 s30, s55, 917504
    v_mfma_f32_16x16x32_bf16 v[200:203], v[40:43], a[128:131], v[200:203]
    s_min_u32 s55, s55, s30
    v_add_f32 v96, v96, v70
    v_mfma_f32_16x16x32_bf16 v[204:207], v[40:43], a[132:135], v[204:207]
    ds_read_b64_tr_b16 v[56:57], v66 offset:12288
    ds_read_b64_tr_b16 v[58:59], v66 offset:14336
    v_mfma_f32_16x16x32_bf16 v[208:211], v[44:47], a[120:123], v[208:211]
    ds_read_b64_tr_b16 v[60:61], v67 offset:12288
    v_mfma_f32_16x16x32_bf16 v[212:215], v[44:47], a[124:127], v[212:215]
    buffer_load_dwordx4 a[56:59], v1, s[36:39], s35 offen offset:0 sc1
    v_mfma_f32_16x16x32_bf16 v[216:219], v[44:47], a[128:131], v[216:219]
    ds_read_b64_tr_b16 v[62:63], v67 offset:14336
    v_mfma_f32_16x16x32_bf16 v[220:223], v[44:47], a[132:135], v[220:223]
    s_waitcnt vmcnt(34)
    ds_read_b64_tr_b16 v[32:33], v64 offset:20480
    v_add_f32 v97, v97, v70
    v_mfma_f32_16x16x32_bf16 v[160:163], v[48:51], a[136:139], v[160:163]
    ds_read_b64_tr_b16 v[34:35], v64 offset:22528
    v_mfma_f32_16x16x32_bf16 v[164:167], v[48:51], a[140:143], v[164:167]
    ds_read_b64_tr_b16 v[36:37], v65 offset:20480
    v_mfma_f32_16x16x32_bf16 v[168:171], v[48:51], a[144:147], v[168:171]
    buffer_load_dwordx4 a[60:63], v1, s[36:39], s35 offen offset:1024 sc1
    v_mfma_f32_16x16x32_bf16 v[172:175], v[48:51], a[148:151], v[172:175]
    s_waitcnt lgkmcnt(4)
    ds_read_b64_tr_b16 v[38:39], v65 offset:22528
    v_mfma_f32_16x16x32_bf16 v[176:179], v[52:55], a[136:139], v[176:179]
    buffer_load_dwordx4 a[64:67], v1, s[36:39], s35 offen offset:2048 sc1
    v_mfma_f32_16x16x32_bf16 v[180:183], v[52:55], a[140:143], v[180:183]
    buffer_load_dwordx4 a[68:71], v1, s[36:39], s35 offen offset:3072 sc1
    v_mfma_f32_16x16x32_bf16 v[184:187], v[52:55], a[144:147], v[184:187]
    s_add_u32 s35, s65, 24576
    ds_read_b64_tr_b16 v[40:41], v66 offset:20480
    v_add_f32 v98, v98, v70
    v_mfma_f32_16x16x32_bf16 v[188:191], v[52:55], a[148:151], v[188:191]
    ds_read_b64_tr_b16 v[42:43], v66 offset:22528
    v_mfma_f32_16x16x32_bf16 v[192:195], v[56:59], a[136:139], v[192:195]
    ds_read_b64_tr_b16 v[44:45], v67 offset:20480
    v_mfma_f32_16x16x32_bf16 v[196:199], v[56:59], a[140:143], v[196:199]
    ds_read_b64_tr_b16 v[46:47], v67 offset:22528
    v_mfma_f32_16x16x32_bf16 v[200:203], v[56:59], a[144:147], v[200:203]
    buffer_load_dwordx4 a[0:3], v1, s[36:39], s35 offen offset:0 sc1
    v_mfma_f32_16x16x32_bf16 v[204:207], v[56:59], a[148:151], v[204:207]
    s_waitcnt lgkmcnt(4)
    v_mfma_f32_16x16x32_bf16 v[208:211], v[60:63], a[136:139], v[208:211]
    ds_read_b64_tr_b16 v[48:49], v64 offset:28672
    v_add_f32 v99, v99, v70
    v_mfma_f32_16x16x32_bf16 v[212:215], v[60:63], a[140:143], v[212:215]
    ds_read_b64_tr_b16 v[50:51], v64 offset:30720
    v_mfma_f32_16x16x32_bf16 v[216:219], v[60:63], a[144:147], v[216:219]
    v_mfma_f32_16x16x32_bf16 v[220:223], v[60:63], a[148:151], v[220:223]
    s_waitcnt vmcnt(34)
    v_mfma_f32_16x16x32_bf16 v[160:163], v[32:35], a[152:155], v[160:163]
    buffer_load_dwordx4 a[4:7], v1, s[36:39], s35 offen offset:1024 sc1
    v_mfma_f32_16x16x32_bf16 v[164:167], v[32:35], a[156:159], v[164:167]
    ds_read_b64_tr_b16 v[52:53], v65 offset:28672
    v_mfma_f32_16x16x32_bf16 v[168:171], v[32:35], a[160:163], v[168:171]
    buffer_load_dwordx4 a[8:11], v1, s[36:39], s35 offen offset:2048 sc1
    v_mfma_f32_16x16x32_bf16 v[172:175], v[32:35], a[164:167], v[172:175]
    buffer_load_dwordx4 a[12:15], v1, s[36:39], s35 offen offset:3072 sc1
    v_mfma_f32_16x16x32_bf16 v[176:179], v[36:39], a[152:155], v[176:179]
    s_add_u32 s35, s65, 36864
    ds_read_b64_tr_b16 v[54:55], v65 offset:30720
    v_add_f32 v112, v112, v70
    v_mfma_f32_16x16x32_bf16 v[180:183], v[36:39], a[156:159], v[180:183]
    ds_read_b64_tr_b16 v[56:57], v66 offset:28672
    v_mfma_f32_16x16x32_bf16 v[184:187], v[36:39], a[160:163], v[184:187]
    ds_read_b64_tr_b16 v[58:59], v66 offset:30720
    v_mfma_f32_16x16x32_bf16 v[188:191], v[36:39], a[164:167], v[188:191]
    s_waitcnt lgkmcnt(3)
    v_mfma_f32_16x16x32_bf16 v[192:195], v[40:43], a[152:155], v[192:195]
    buffer_load_dwordx4 a[16:19], v1, s[36:39], s35 offen offset:0 sc1
    v_mfma_f32_16x16x32_bf16 v[196:199], v[40:43], a[156:159], v[196:199]
    ds_read_b64_tr_b16 v[60:61], v67 offset:28672
    v_add_f32 v113, v113, v70
    v_mfma_f32_16x16x32_bf16 v[200:203], v[40:43], a[160:163], v[200:203]
    ds_read_b64_tr_b16 v[62:63], v67 offset:30720
    v_add_u32 v64, 4294836224, v64
    v_mfma_f32_16x16x32_bf16 v[204:207], v[40:43], a[164:167], v[204:207]
    s_waitcnt vmcnt(34) lgkmcnt(3)
    s_barrier
    v_mfma_f32_16x16x32_bf16 v[208:211], v[44:47], a[152:155], v[208:211]
    ds_read_b64_tr_b16 v[32:33], v64 offset:4096
    v_mfma_f32_16x16x32_bf16 v[212:215], v[44:47], a[156:159], v[212:215]
    buffer_load_dwordx4 a[20:23], v1, s[36:39], s35 offen offset:1024 sc1
    v_mfma_f32_16x16x32_bf16 v[216:219], v[44:47], a[160:163], v[216:219]
    ds_read_b64_tr_b16 v[34:35], v64 offset:6144
    v_add_u32 v65, 4294836224, v65
    v_mfma_f32_16x16x32_bf16 v[220:223], v[44:47], a[164:167], v[220:223]
    s_waitcnt vmcnt(31)
    v_mfma_f32_16x16x32_bf16 v[160:163], v[48:51], a[168:171], v[160:163]
    ds_read_b64_tr_b16 v[36:37], v65 offset:4096
    v_add_f32 v114, v114, v70
    v_mfma_f32_16x16x32_bf16 v[164:167], v[48:51], a[172:175], v[164:167]
    ds_read_b64_tr_b16 v[38:39], v65 offset:6144
    v_mfma_f32_16x16x32_bf16 v[168:171], v[48:51], a[176:179], v[168:171]
    buffer_load_dwordx4 a[24:27], v1, s[36:39], s35 offen offset:2048 sc1
    v_mfma_f32_16x16x32_bf16 v[172:175], v[48:51], a[180:183], v[172:175]
    buffer_load_dwordx4 a[28:31], v1, s[36:39], s35 offen offset:3072 sc1
    v_mfma_f32_16x16x32_bf16 v[176:179], v[52:55], a[168:171], v[176:179]
    s_add_u32 s35, s65, 53248
    s_waitcnt vmcnt(13)
    v_cmp_gt_i32 vcc, 4, v13
    v_add_u32 v66, 4294836224, v66
    v_mfma_f32_16x16x32_bf16 v[180:183], v[52:55], a[172:175], v[180:183]
    s_cbranch_vccnz L_up_slow4
L_up_back4:
    ds_read_b64_tr_b16 v[40:41], v66 offset:4096
    v_mfma_f32_16x16x32_bf16 v[184:187], v[52:55], a[176:179], v[184:187]
    ds_read_b64_tr_b16 v[42:43], v66 offset:6144
    v_add_u32 v67, 4294836224, v67
    v_mfma_f32_16x16x32_bf16 v[188:191], v[52:55], a[180:183], v[188:191]
    s_waitcnt lgkmcnt(2)
    v_add_f32 v115, v115, v70
    v_mfma_f32_16x16x32_bf16 v[192:195], v[56:59], a[168:171], v[192:195]
    buffer_load_dwordx4 v10, s[40:43], s55 offen lds
    v_mfma_f32_16x16x32_bf16 v[196:199], v[56:59], a[172:175], v[196:199]
    s_add_u32 m0, s54, 77824
    s_add_u32 s55, s5, 655360
    s_sub_u32 s30, s55, 917504
    v_mfma_f32_16x16x32_bf16 v[200:203], v[56:59], a[176:179], v[200:203]
    s_min_u32 s55, s55, s30
    ds_read_b64_tr_b16 v[44:45], v67 offset:4096
    v_mfma_f32_16x16x32_bf16 v[204:207], v[56:59], a[180:183], v[204:207]
    ds_read_b64_tr_b16 v[46:47], v67 offset:6144
    v_mfma_f32_16x16x32_bf16 v[208:211], v[60:63], a[168:171], v[208:211]
    ds_read_b64_tr_b16 v[48:49], v64 offset:12288
    v_add_f32 v100, v100, v71
    v_mfma_f32_16x16x32_bf16 v[212:215], v[60:63], a[172:175], v[212:215]
    buffer_load_dwordx4 v10, s[40:43], s55 offen lds
    v_mfma_f32_16x16x32_bf16 v[216:219], v[60:63], a[176:179], v[216:219]
    s_add_u32 m0, s54, 86016
    s_add_u32 s55, s7, 196608
    s_sub_u32 s30, s55, 917504
    v_mfma_f32_16x16x32_bf16 v[220:223], v[60:63], a[180:183], v[220:223]
    s_min_u32 s55, s55, s30
    ds_read_b64_tr_b16 v[50:51], v64 offset:14336
    v_mfma_f32_16x16x32_bf16 v[160:163], v[32:35], a[192:195], v[160:163]
    buffer_load_dwordx4 v11, s[40:43], s55 offen lds
    v_mfma_f32_16x16x32_bf16 v[164:167], v[32:35], a[196:199], v[164:167]
    s_add_u32 m0, s54, 94208
    s_add_u32 s55, s7, 655360
    s_sub_u32 s30, s55, 917504
    v_mfma_f32_16x16x32_bf16 v[168:171], v[32:35], a[200:203], v[168:171]
    buffer_load_dwordx4 a[32:35], v1, s[36:39], s35 offen offset:0 sc1
    v_mfma_f32_16x16x32_bf16 v[172:175], v[32:35], a[204:207], v[172:175]
    buffer_load_dwordx4 a[36:39], v1, s[36:39], s35 offen offset:1024 sc1
    v_mfma_f32_16x16x32_bf16 v[176:179], v[36:39], a[192:195], v[176:179]
    buffer_load_dwordx4 a[40:43], v1, s[36:39], s35 offen offset:2048 sc1
    v_mfma_f32_16x16x32_bf16 v[180:183], v[36:39], a[196:199], v[180:183]
    buffer_load_dwordx4 a[44:47], v1, s[36:39], s35 offen offset:3072 sc1
    v_add_f32 v101, v101, v71
    v_mfma_f32_16x16x32_bf16 v[184:187], v[36:39], a[200:203], v[184:187]
    s_min_u32 s55, s55, s30
    s_add_u32 s35, s52, 12288
    ds_read_b64_tr_b16 v[52:53], v65 offset:12288
    v_mfma_f32_16x16x32_bf16 v[188:191], v[36:39], a[204:207], v[188:191]
    s_waitcnt lgkmcnt(1)
    ds_read_b64_tr_b16 v[54:55], v65 offset:14336
    v_mfma_f32_16x16x32_bf16 v[192:195], v[40:43], a[192:195], v[192:195]
    buffer_load_dwordx4 v11, s[40:43], s55 offen lds
    v_mfma_f32_16x16x32_bf16 v[196:199], v[40:43], a[196:199], v[196:199]
    s_add_u32 m0, s54, 131072
    s_add_u32 s55, s4, s79
    s_add_u32 s55, s55, 65536
    v_mfma_f32_16x16x32_bf16 v[200:203], v[40:43], a[200:203], v[200:203]
    s_sub_u32 s30, s55, 917504
    s_min_u32 s55, s55, s30
    ds_read_b64_tr_b16 v[56:57], v66 offset:12288
    v_mfma_f32_16x16x32_bf16 v[204:207], v[40:43], a[204:207], v[204:207]
    ds_read_b64_tr_b16 v[58:59], v66 offset:14336
    v_add_f32 v102, v102, v71
    v_mfma_f32_16x16x32_bf16 v[208:211], v[44:47], a[192:195], v[208:211]
    ds_read_b64_tr_b16 v[60:61], v67 offset:12288
    v_mfma_f32_16x16x32_bf16 v[212:215], v[44:47], a[196:199], v[212:215]
    buffer_load_dwordx2 a[48:49], v74, s[36:39], s35 offen offset:0 sc1
    v_mfma_f32_16x16x32_bf16 v[216:219], v[44:47], a[200:203], v[216:219]
    ds_read_b64_tr_b16 v[62:63], v67 offset:14336
    v_mfma_f32_16x16x32_bf16 v[220:223], v[44:47], a[204:207], v[220:223]
    ds_read_b64_tr_b16 v[32:33], v64 offset:20480
    v_mfma_f32_16x16x32_bf16 v[160:163], v[48:51], a[208:211], v[160:163]
    ds_read_b64_tr_b16 v[34:35], v64 offset:22528
    v_add_f32 v103, v103, v71
    v_mfma_f32_16x16x32_bf16 v[164:167], v[48:51], a[212:215], v[164:167]
    ds_read_b64_tr_b16 v[36:37], v65 offset:20480
    v_mfma_f32_16x16x32_bf16 v[168:171], v[48:51], a[216:219], v[168:171]
    buffer_load_dwordx2 a[50:51], v74, s[36:39], s35 offen offset:1024 sc1
    v_mfma_f32_16x16x32_bf16 v[172:175], v[48:51], a[220:223], v[172:175]
    s_waitcnt lgkmcnt(4)
    ds_read_b64_tr_b16 v[38:39], v65 offset:22528
    v_mfma_f32_16x16x32_bf16 v[176:179], v[52:55], a[208:211], v[176:179]
    buffer_load_dwordx2 a[52:53], v74, s[36:39], s35 offen offset:512 sc1
    v_mfma_f32_16x16x32_bf16 v[180:183], v[52:55], a[212:215], v[180:183]
    buffer_load_dwordx2 a[54:55], v74, s[36:39], s35 offen offset:1536 sc1
    v_mfma_f32_16x16x32_bf16 v[184:187], v[52:55], a[216:219], v[184:187]
    buffer_load_dwordx2 a[184:185], v74, s[36:39], s35 offen offset:2048 sc1
    v_mfma_f32_16x16x32_bf16 v[188:191], v[52:55], a[220:223], v[188:191]
    buffer_load_dwordx2 a[186:187], v74, s[36:39], s35 offen offset:3072 sc1
    v_mfma_f32_16x16x32_bf16 v[192:195], v[56:59], a[208:211], v[192:195]
    buffer_load_dwordx2 a[188:189], v74, s[36:39], s35 offen offset:2560 sc1
    v_add_f32 v116, v116, v71
    v_mfma_f32_16x16x32_bf16 v[196:199], v[56:59], a[212:215], v[196:199]
    buffer_load_dwordx2 a[190:191], v74, s[36:39], s35 offen offset:3584 sc1
    v_mfma_f32_16x16x32_bf16 v[200:203], v[56:59], a[216:219], v[200:203]
    s_add_u32 s35, s52, 40960
    ds_read_b64_tr_b16 v[40:41], v66 offset:20480
    v_mfma_f32_16x16x32_bf16 v[204:207], v[56:59], a[220:223], v[204:207]
    s_waitcnt lgkmcnt(1)
    ds_read_b64_tr_b16 v[42:43], v66 offset:22528
    v_mfma_f32_16x16x32_bf16 v[208:211], v[60:63], a[208:211], v[208:211]
    ds_read_b64_tr_b16 v[44:45], v67 offset:20480
    v_mfma_f32_16x16x32_bf16 v[212:215], v[60:63], a[212:215], v[212:215]
    ds_read_b64_tr_b16 v[46:47], v67 offset:22528
    v_add_f32 v117, v117, v71
    v_mfma_f32_16x16x32_bf16 v[216:219], v[60:63], a[216:219], v[216:219]
    buffer_load_dwordx2 a[72:73], v74, s[36:39], s35 offen offset:0 sc1
    v_mfma_f32_16x16x32_bf16 v[220:223], v[60:63], a[220:223], v[220:223]
    ds_read_b64_tr_b16 v[48:49], v64 offset:28672
    v_mfma_f32_16x16x32_bf16 v[160:163], v[32:35], a[224:227], v[160:163]
    ds_read_b64_tr_b16 v[50:51], v64 offset:30720
    v_mfma_f32_16x16x32_bf16 v[164:167], v[32:35], a[228:231], v[164:167]
    ds_read_b64_tr_b16 v[52:53], v65 offset:28672
    v_mfma_f32_16x16x32_bf16 v[168:171], v[32:35], a[232:235], v[168:171]
    buffer_load_dwordx2 a[74:75], v74, s[36:39], s35 offen offset:1024 sc1
    v_mfma_f32_16x16x32_bf16 v[172:175], v[32:35], a[236:239], v[172:175]
    buffer_load_dwordx2 a[76:77], v74, s[36:39], s35 offen offset:512 sc1
    v_mfma_f32_16x16x32_bf16 v[176:179], v[36:39], a[224:227], v[176:179]
    buffer_load_dwordx2 a[78:79], v74, s[36:39], s35 offen offset:1536 sc1
    v_mfma_f32_16x16x32_bf16 v[180:183], v[36:39], a[228:231], v[180:183]
    buffer_load_dwordx2 a[80:81], v74, s[36:39], s35 offen offset:2048 sc1
    v_add_f32 v118, v118, v71
    v_mfma_f32_16x16x32_bf16 v[184:187], v[36:39], a[232:235], v[184:187]
    buffer_load_dwordx2 a[82:83], v74, s[36:39], s35 offen offset:3072 sc1
    v_mfma_f32_16x16x32_bf16 v[188:191], v[36:39], a[236:239], v[188:191]
    s_waitcnt lgkmcnt(0)
    ds_read_b64_tr_b16 v[54:55], v65 offset:30720
    v_mfma_f32_16x16x32_bf16 v[192:195], v[40:43], a[224:227], v[192:195]
    buffer_load_dwordx2 a[84:85], v74, s[36:39], s35 offen offset:2560 sc1
    v_mfma_f32_16x16x32_bf16 v[196:199], v[40:43], a[228:231], v[196:199]
    buffer_load_dwordx2 a[86:87], v74, s[36:39], s35 offen offset:3584 sc1
    v_mfma_f32_16x16x32_bf16 v[200:203], v[40:43], a[232:235], v[200:203]
    s_add_u32 s35, s65, 12288
    ds_read_b64_tr_b16 v[56:57], v66 offset:28672
    v_add_f32 v119, v119, v71
    v_mfma_f32_16x16x32_bf16 v[204:207], v[40:43], a[236:239], v[204:207]
    s_waitcnt vmcnt(36)
    s_barrier
    ds_read_b64_tr_b16 v[58:59], v66 offset:30720
    v_mfma_f32_16x16x32_bf16 v[208:211], v[44:47], a[224:227], v[208:211]
    ds_read_b64_tr_b16 v[60:61], v67 offset:28672
    v_mfma_f32_16x16x32_bf16 v[212:215], v[44:47], a[228:231], v[212:215]
    ds_read_b64_tr_b16 v[62:63], v67 offset:30720
    v_mfma_f32_16x16x32_bf16 v[216:219], v[44:47], a[232:235], v[216:219]
    buffer_load_dwordx2 a[88:89], v74, s[36:39], s35 offen offset:0 sc1
    v_mfma_f32_16x16x32_bf16 v[220:223], v[44:47], a[236:239], v[220:223]
    ds_read_b64_tr_b16 v[32:33], v64 offset:36864
    v_mfma_f32_16x16x32_bf16 v[160:163], v[48:51], a[240:243], v[160:163]
    ds_read_b64_tr_b16 v[34:35], v64 offset:38912
    v_add_f32 v104, v104, v72
    v_mfma_f32_16x16x32_bf16 v[164:167], v[48:51], a[244:247], v[164:167]
    ds_read_b64_tr_b16 v[36:37], v65 offset:36864
    v_mfma_f32_16x16x32_bf16 v[168:171], v[48:51], a[248:251], v[168:171]
    buffer_load_dwordx2 a[90:91], v74, s[36:39], s35 offen offset:1024 sc1
    v_mfma_f32_16x16x32_bf16 v[172:175], v[48:51], a[252:255], v[172:175]
    s_waitcnt lgkmcnt(3)
    ds_read_b64_tr_b16 v[38:39], v65 offset:38912
    v_mfma_f32_16x16x32_bf16 v[176:179], v[52:55], a[240:243], v[176:179]
    buffer_load_dwordx2 a[92:93], v74, s[36:39], s35 offen offset:512 sc1
    v_mfma_f32_16x16x32_bf16 v[180:183], v[52:55], a[244:247], v[180:183]
    buffer_load_dwordx2 a[94:95], v74, s[36:39], s35 offen offset:1536 sc1
    v_mfma_f32_16x16x32_bf16 v[184:187], v[52:55], a[248:251], v[184:187]
    buffer_load_dwordx2 a[96:97], v74, s[36:39], s35 offen offset:2048 sc1
    v_mfma_f32_16x16x32_bf16 v[188:191], v[52:55], a[252:255], v[188:191]
    buffer_load_dwordx2 a[98:99], v74, s[36:39], s35 offen offset:3072 sc1
    v_mfma_f32_16x16x32_bf16 v[192:195], v[56:59], a[240:243], v[192:195]
    buffer_load_dwordx2 a[100:101], v74, s[36:39], s35 offen offset:2560 sc1
    v_mfma_f32_16x16x32_bf16 v[196:199], v[56:59], a[244:247], v[196:199]
    buffer_load_dwordx2 a[102:103], v74, s[36:39], s35 offen offset:3584 sc1
    v_add_f32 v105, v105, v72
    v_mfma_f32_16x16x32_bf16 v[200:203], v[56:59], a[248:251], v[200:203]
    s_add_u32 s35, s65, 40960
    ds_read_b64_tr_b16 v[40:41], v66 offset:36864
    v_mfma_f32_16x16x32_bf16 v[204:207], v[56:59], a[252:255], v[204:207]
    ds_read_b64_tr_b16 v[42:43], v66 offset:38912
    v_mfma_f32_16x16x32_bf16 v[208:211], v[60:63], a[240:243], v[208:211]
    ds_read_b64_tr_b16 v[44:45], v67 offset:36864
    v_mfma_f32_16x16x32_bf16 v[212:215], v[60:63], a[244:247], v[212:215]
    ds_read_b64_tr_b16 v[46:47], v67 offset:38912
    v_add_f32 v106, v106, v72
    v_mfma_f32_16x16x32_bf16 v[216:219], v[60:63], a[248:251], v[216:219]
    buffer_load_dwordx4 v10, s[40:43], s55 offen lds
    v_mfma_f32_16x16x32_bf16 v[220:223], v[60:63], a[252:255], v[220:223]
    s_waitcnt vmcnt(41) lgkmcnt(4)
    s_add_u32 m0, s54, 139264
    s_add_u32 s55, s6, 65536
    v_mfma_f32_16x16x32_bf16 v[160:163], v[32:35], a[56:59], v[160:163]
    s_sub_u32 s30, s55, 917504
    s_min_u32 s55, s55, s30
    ds_read_b64_tr_b16 v[48:49], v64 offset:45056
    v_mfma_f32_16x16x32_bf16 v[164:167], v[32:35], a[60:63], v[164:167]
    buffer_load_dwordx4 v11, s[40:43], s55 offen lds
    v_mfma_f32_16x16x32_bf16 v[168:171], v[32:35], a[64:67], v[168:171]
    buffer_load_dwordx2 a[104:105], v74, s[36:39], s35 offen offset:0 sc1
    v_mfma_f32_16x16x32_bf16 v[172:175], v[32:35], a[68:71], v[172:175]
    buffer_load_dwordx2 a[106:107], v74, s[36:39], s35 offen offset:1024 sc1
    ds_read_b64_tr_b16 v[50:51], v64 offset:47104
    v_mfma_f32_16x16x32_bf16 v[176:179], v[36:39], a[56:59], v[176:179]
    buffer_load_dwordx2 a[108:109], v74, s[36:39], s35 offen offset:512 sc1
    v_mfma_f32_16x16x32_bf16 v[180:183], v[36:39], a[60:63], v[180:183]
    buffer_load_dwordx2 a[110:111], v74, s[36:39], s35 offen offset:1536 sc1
    v_mfma_f32_16x16x32_bf16 v[184:187], v[36:39], a[64:67], v[184:187]
    buffer_load_dwordx2 a[112:113], v74, s[36:39], s35 offen offset:2048 sc1
    ds_read_b64_tr_b16 v[52:53], v65 offset:45056
    v_add_f32 v107, v107, v72
    v_mfma_f32_16x16x32_bf16 v[188:191], v[36:39], a[68:71], v[188:191]
    s_waitcnt lgkmcnt(2)
    s_add_u32 m0, s54, 147456
    s_add_u32 s55, s6, 327680
    ds_read_b64_tr_b16 v[54:55], v65 offset:47104
    v_mfma_f32_16x16x32_bf16 v[192:195], v[40:43], a[56:59], v[192:195]
    buffer_load_dwordx2 a[114:115], v74, s[36:39], s35 offen offset:3072 sc1
    v_mfma_f32_16x16x32_bf16 v[196:199], v[40:43], a[60:63], v[196:199]
    buffer_load_dwordx2 a[116:117], v74, s[36:39], s35 offen offset:2560 sc1
    v_mfma_f32_16x16x32_bf16 v[200:203], v[40:43], a[64:67], v[200:203]
    buffer_load_dwordx2 a[118:119], v74, s[36:39], s35 offen offset:3584 sc1
    ds_read_b64_tr_b16 v[56:57], v66 offset:45056
    v_mfma_f32_16x16x32_bf16 v[204:207], v[40:43], a[68:71], v[204:207]
    s_sub_u32 s30, s55, 917504
    s_min_u32 s55, s55, s30
    ds_read_b64_tr_b16 v[58:59], v66 offset:47104
    v_mfma_f32_16x16x32_bf16 v[208:211], v[44:47], a[56:59], v[208:211]
    buffer_load_dwordx4 v11, s[40:43], s55 offen lds
    v_add_f32 v120, v120, v72
    v_mfma_f32_16x16x32_bf16 v[212:215], v[44:47], a[60:63], v[212:215]
    s_add_u32 m0, s54, 155648
    s_add_u32 s55, s6, 524288
    s_sub_u32 s30, s55, 917504
    v_mfma_f32_16x16x32_bf16 v[216:219], v[44:47], a[64:67], v[216:219]
    s_min_u32 s55, s55, s30
    ds_read_b64_tr_b16 v[60:61], v67 offset:45056
    v_mfma_f32_16x16x32_bf16 v[220:223], v[44:47], a[68:71], v[220:223]
    s_waitcnt vmcnt(47) lgkmcnt(3)
    ds_read_b64_tr_b16 v[62:63], v67 offset:47104
    v_mfma_f32_16x16x32_bf16 v[160:163], v[48:51], a[0:3], v[160:163]
    buffer_load_dwordx4 v11, s[40:43], s55 offen lds
    v_mfma_f32_16x16x32_bf16 v[164:167], v[48:51], a[4:7], v[164:167]
    s_add_u32 m0, s54, 0
    s_add_u32 s55, s6, 786432
    s_sub_u32 s30, s55, 917504
    v_mfma_f32_16x16x32_bf16 v[168:171], v[48:51], a[8:11], v[168:171]
    s_min_u32 s55, s55, s30
    ds_read_b64_tr_b16 v[32:33], v64 offset:53248
    v_add_f32 v121, v121, v72
    v_mfma_f32_16x16x32_bf16 v[172:175], v[48:51], a[12:15], v[172:175]
    buffer_load_dwordx4 v11, s[40:43], s55 offen lds
    ds_read_b64_tr_b16 v[34:35], v64 offset:55296
    v_mfma_f32_16x16x32_bf16 v[176:179], v[52:55], a[0:3], v[176:179]
    s_add_u32 m0, s54, 8192
    s_add_u32 s55, s4, s77
    s_add_u32 s55, s55, 131072
    v_mfma_f32_16x16x32_bf16 v[180:183], v[52:55], a[4:7], v[180:183]
    s_sub_u32 s30, s55, 917504
    s_min_u32 s55, s55, s30
    ds_read_b64_tr_b16 v[36:37], v65 offset:53248
    v_mfma_f32_16x16x32_bf16 v[184:187], v[52:55], a[8:11], v[184:187]
    buffer_load_dwordx4 v10, s[40:43], s55 offen lds
    v_mfma_f32_16x16x32_bf16 v[188:191], v[52:55], a[12:15], v[188:191]
    s_waitcnt lgkmcnt(3)
    s_add_u32 m0, s54, 16384
    s_add_u32 s55, s4, s78
    ds_read_b64_tr_b16 v[38:39], v65 offset:55296
    v_mfma_f32_16x16x32_bf16 v[192:195], v[56:59], a[0:3], v[192:195]
    s_add_u32 s55, s55, 131072
    s_sub_u32 s30, s55, 917504
    s_min_u32 s55, s55, s30
    v_mfma_f32_16x16x32_bf16 v[196:199], v[56:59], a[4:7], v[196:199]
    buffer_load_dwordx4 v10, s[40:43], s55 offen lds
    v_add_f32 v122, v122, v72
    v_mfma_f32_16x16x32_bf16 v[200:203], v[56:59], a[8:11], v[200:203]
    s_add_u32 m0, s54, 24576
    s_add_u32 s55, s4, s79
    s_add_u32 s55, s55, 131072
    ds_read_b64_tr_b16 v[40:41], v66 offset:53248
    v_mfma_f32_16x16x32_bf16 v[204:207], v[56:59], a[12:15], v[204:207]
    s_sub_u32 s30, s55, 917504
    s_min_u32 s55, s55, s30
    ds_read_b64_tr_b16 v[42:43], v66 offset:55296
    v_mfma_f32_16x16x32_bf16 v[208:211], v[60:63], a[0:3], v[208:211]
    buffer_load_dwordx4 v10, s[40:43], s55 offen lds
    v_mfma_f32_16x16x32_bf16 v[212:215], v[60:63], a[4:7], v[212:215]
    s_add_u32 m0, s54, 32768
    s_add_u32 s55, s6, 131072
    s_sub_u32 s30, s55, 917504
    v_mfma_f32_16x16x32_bf16 v[216:219], v[60:63], a[8:11], v[216:219]
    s_min_u32 s55, s55, s30
    ds_read_b64_tr_b16 v[44:45], v67 offset:53248
    v_add_f32 v123, v123, v72
    v_mfma_f32_16x16x32_bf16 v[220:223], v[60:63], a[12:15], v[220:223]
    s_waitcnt vmcnt(48) lgkmcnt(3)
    ds_read_b64_tr_b16 v[46:47], v67 offset:55296
    v_mfma_f32_16x16x32_bf16 v[160:163], v[32:35], a[16:19], v[160:163]
    ds_read_b64_tr_b16 v[48:49], v64 offset:61440
    v_mfma_f32_16x16x32_bf16 v[164:167], v[32:35], a[20:23], v[164:167]
    ds_read_b64_tr_b16 v[50:51], v64 offset:63488
    v_mfma_f32_16x16x32_bf16 v[168:171], v[32:35], a[24:27], v[168:171]
    buffer_load_dwordx4 v11, s[40:43], s55 offen lds
    v_mfma_f32_16x16x32_bf16 v[172:175], v[32:35], a[28:31], v[172:175]
    s_add_u32 m0, s54, 40960
    s_add_u32 s55, s6, 393216
    s_sub_u32 s30, s55, 917504
    v_mfma_f32_16x16x32_bf16 v[176:179], v[36:39], a[16:19], v[176:179]
    s_min_u32 s55, s55, s30
    ds_read_b64_tr_b16 v[52:53], v65 offset:61440
    v_add_f32 v108, v108, v73
    v_mfma_f32_16x16x32_bf16 v[180:183], v[36:39], a[20:23], v[180:183]
    ds_read_b64_tr_b16 v[54:55], v65 offset:63488
    v_mfma_f32_16x16x32_bf16 v[184:187], v[36:39], a[24:27], v[184:187]
    ds_read_b64_tr_b16 v[56:57], v66 offset:61440
    v_mfma_f32_16x16x32_bf16 v[188:191], v[36:39], a[28:31], v[188:191]
    s_waitcnt lgkmcnt(3)
    ds_read_b64_tr_b16 v[58:59], v66 offset:63488
    v_mfma_f32_16x16x32_bf16 v[192:195], v[40:43], a[16:19], v[192:195]
    buffer_load_dwordx4 v11, s[40:43], s55 offen lds
    v_mfma_f32_16x16x32_bf16 v[196:199], v[40:43], a[20:23], v[196:199]
    s_add_u32 m0, s54, 49152
    s_add_u32 s55, s6, 589824
    s_sub_u32 s30, s55, 917504
    v_mfma_f32_16x16x32_bf16 v[200:203], v[40:43], a[24:27], v[200:203]
    s_min_u32 s55, s55, s30
    ds_read_b64_tr_b16 v[60:61], v67 offset:61440
    v_add_f32 v109, v109, v73
    v_mfma_f32_16x16x32_bf16 v[204:207], v[40:43], a[28:31], v[204:207]
    s_waitcnt vmcnt(42) lgkmcnt(3)
    s_barrier
    ds_read_b64_tr_b16 v[62:63], v67 offset:63488
    v_mfma_f32_16x16x32_bf16 v[208:211], v[44:47], a[16:19], v[208:211]
    v_add_u32 v64, 65536, v64
    v_mfma_f32_16x16x32_bf16 v[212:215], v[44:47], a[20:23], v[212:215]
    ds_read_b64_tr_b16 v[32:33], v64 offset:4096
    v_mfma_f32_16x16x32_bf16 v[216:219], v[44:47], a[24:27], v[216:219]
    buffer_load_dwordx4 v11, s[40:43], s55 offen lds
    v_mfma_f32_16x16x32_bf16 v[220:223], v[44:47], a[28:31], v[220:223]
    s_add_u32 m0, s54, 57344
    s_add_u32 s55, s6, 851968
    s_sub_u32 s30, s55, 917504
    v_mfma_f32_16x16x32_bf16 v[160:163], v[48:51], a[32:35], v[160:163]
    s_min_u32 s55, s55, s30
    ds_read_b64_tr_b16 v[34:35], v64 offset:6144
    v_add_u32 v65, 65536, v65
    v_mfma_f32_16x16x32_bf16 v[164:167], v[48:51], a[36:39], v[164:167]
    ds_read_b64_tr_b16 v[36:37], v65 offset:4096
    v_add_f32 v110, v110, v73
    v_mfma_f32_16x16x32_bf16 v[168:171], v[48:51], a[40:43], v[168:171]
    ds_read_b64_tr_b16 v[38:39], v65 offset:6144
    v_add_u32 v66, 65536, v66
    v_mfma_f32_16x16x32_bf16 v[172:175], v[48:51], a[44:47], v[172:175]
    v_mfma_f32_16x16x32_bf16 v[176:179], v[52:55], a[32:35], v[176:179]
    buffer_load_dwordx4 v11, s[40:43], s55 offen lds
    v_mfma_f32_16x16x32_bf16 v[180:183], v[52:55], a[36:39], v[180:183]
    s_add_u32 m0, s54, 65536
    s_add_u32 s55, s4, 196608
    s_sub_u32 s30, s55, 917504
    v_mfma_f32_16x16x32_bf16 v[184:187], v[52:55], a[40:43], v[184:187]
    s_min_u32 s55, s55, s30
    ds_read_b64_tr_b16 v[40:41], v66 offset:4096
    v_mfma_f32_16x16x32_bf16 v[188:191], v[52:55], a[44:47], v[188:191]
    s_waitcnt lgkmcnt(2)
    ds_read_b64_tr_b16 v[42:43], v66 offset:6144
    v_add_u32 v67, 65536, v67
    v_mfma_f32_16x16x32_bf16 v[192:195], v[56:59], a[32:35], v[192:195]
    ds_read_b64_tr_b16 v[44:45], v67 offset:4096
    v_add_f32 v111, v111, v73
    v_mfma_f32_16x16x32_bf16 v[196:199], v[56:59], a[36:39], v[196:199]
    ds_read_b64_tr_b16 v[46:47], v67 offset:6144
    v_mfma_f32_16x16x32_bf16 v[200:203], v[56:59], a[40:43], v[200:203]
    buffer_load_dwordx4 v10, s[40:43], s55 offen lds
    v_mfma_f32_16x16x32_bf16 v[204:207], v[56:59], a[44:47], v[204:207]
    s_add_u32 m0, s54, 73728
    s_add_u32 s55, s4, 655360
    s_sub_u32 s30, s55, 917504
    v_mfma_f32_16x16x32_bf16 v[208:211], v[60:63], a[32:35], v[208:211]
    s_min_u32 s55, s55, s30
    ds_read_b64_tr_b16 v[48:49], v64 offset:12288
    v_mfma_f32_16x16x32_bf16 v[212:215], v[60:63], a[36:39], v[212:215]
    ds_read_b64_tr_b16 v[50:51], v64 offset:14336
    v_mfma_f32_16x16x32_bf16 v[216:219], v[60:63], a[40:43], v[216:219]
    buffer_load_dwordx4 v10, s[40:43], s55 offen lds
    v_mfma_f32_16x16x32_bf16 v[220:223], v[60:63], a[44:47], v[220:223]
    s_waitcnt vmcnt(38)
    s_add_u32 m0, s54, 81920
    s_add_u32 s55, s6, 196608
    v_mfma_f32_16x16x32_bf16 v[160:163], v[32:35], a[48:51], v[160:163]
    s_sub_u32 s30, s55, 917504
    s_min_u32 s55, s55, s30
    ds_read_b64_tr_b16 v[52:53], v65 offset:12288
    v_add_f32 v124, v124, v73
    v_mfma_f32_16x16x32_bf16 v[164:167], v[32:35], a[52:55], v[164:167]
    buffer_load_dwordx4 v11, s[40:43], s55 offen lds
    v_mfma_f32_16x16x32_bf16 v[168:171], v[32:35], a[184:187], v[168:171]
    s_add_u32 m0, s54, 90112
    s_add_u32 s55, s6, 655360
    s_sub_u32 s30, s55, 917504
    v_mfma_f32_16x16x32_bf16 v[172:175], v[32:35], a[188:191], v[172:175]
    s_waitcnt lgkmcnt(1)
    s_min_u32 s55, s55, s30
    ds_read_b64_tr_b16 v[54:55], v65 offset:14336
    v_mfma_f32_16x16x32_bf16 v[176:179], v[36:39], a[48:51], v[176:179]
    buffer_load_dwordx4 v11, s[40:43], s55 offen lds
    v_mfma_f32_16x16x32_bf16 v[180:183], v[36:39], a[52:55], v[180:183]
    ds_read_b64_tr_b16 v[56:57], v66 offset:12288
    v_add_f32 v125, v125, v73
    v_mfma_f32_16x16x32_bf16 v[184:187], v[36:39], a[184:187], v[184:187]
    ds_read_b64_tr_b16 v[58:59], v66 offset:14336
    v_mfma_f32_16x16x32_bf16 v[188:191], v[36:39], a[188:191], v[188:191]
    v_mfma_f32_16x16x32_bf16 v[192:195], v[40:43], a[48:51], v[192:195]
    ds_read_b64_tr_b16 v[60:61], v67 offset:12288
    v_mfma_f32_16x16x32_bf16 v[196:199], v[40:43], a[52:55], v[196:199]
    ds_read_b64_tr_b16 v[62:63], v67 offset:14336
    v_mfma_f32_16x16x32_bf16 v[200:203], v[40:43], a[184:187], v[200:203]
    v_mfma_f32_16x16x32_bf16 v[204:207], v[40:43], a[188:191], v[204:207]
    v_add_f32 v126, v126, v73
    v_mfma_f32_16x16x32_bf16 v[208:211], v[44:47], a[48:51], v[208:211]
    ds_read_b64_tr_b16 v[32:33], v64 offset:20480
    v_mfma_f32_16x16x32_bf16 v[212:215], v[44:47], a[52:55], v[212:215]
    ds_read_b64_tr_b16 v[34:35], v64 offset:22528
    v_mfma_f32_16x16x32_bf16 v[216:219], v[44:47], a[184:187], v[216:219]
    v_mfma_f32_16x16x32_bf16 v[220:223], v[44:47], a[188:191], v[220:223]
    s_waitcnt vmcnt(32)
    v_mfma_f32_16x16x32_bf16 v[160:163], v[48:51], a[72:75], v[160:163]
    ds_read_b64_tr_b16 v[36:37], v65 offset:20480
    v_mfma_f32_16x16x32_bf16 v[164:167], v[48:51], a[76:79], v[164:167]
    ds_read_b64_tr_b16 v[38:39], v65 offset:22528
    v_add_f32 v127, v127, v73
    v_mfma_f32_16x16x32_bf16 v[168:171], v[48:51], a[80:83], v[168:171]
    v_mfma_f32_16x16x32_bf16 v[172:175], v[48:51], a[84:87], v[172:175]
    s_waitcnt lgkmcnt(2)
    v_mfma_f32_16x16x32_bf16 v[176:179], v[52:55], a[72:75], v[176:179]
    ds_read_b64_tr_b16 v[40:41], v66 offset:20480
    v_mfma_f32_16x16x32_bf16 v[180:183], v[52:55], a[76:79], v[180:183]
    ds_read_b64_tr_b16 v[42:43], v66 offset:22528
    v_mfma_f32_16x16x32_bf16 v[184:187], v[52:55], a[80:83], v[184:187]
    v_mfma_f32_16x16x32_bf16 v[188:191], v[52:55], a[84:87], v[188:191]
    v_mfma_f32_16x16x32_bf16 v[192:195], v[56:59], a[72:75], v[192:195]
    ds_read_b64_tr_b16 v[44:45], v67 offset:20480
    v_mfma_f32_16x16x32_bf16 v[196:199], v[56:59], a[76:79], v[196:199]
    ds_read_b64_tr_b16 v[46:47], v67 offset:22528
    v_mfma_f32_16x16x32_bf16 v[200:203], v[56:59], a[80:83], v[200:203]
    v_mfma_f32_16x16x32_bf16 v[204:207], v[56:59], a[84:87], v[204:207]
    v_mfma_f32_16x16x32_bf16 v[208:211], v[60:63], a[72:75], v[208:211]
    ds_read_b64_tr_b16 v[48:49], v64 offset:28672
    v_mfma_f32_16x16x32_bf16 v[212:215], v[60:63], a[76:79], v[212:215]
    ds_read_b64_tr_b16 v[50:51], v64 offset:30720
    v_mfma_f32_16x16x32_bf16 v[216:219], v[60:63], a[80:83], v[216:219]
    v_mfma_f32_16x16x32_bf16 v[220:223], v[60:63], a[84:87], v[220:223]
    s_waitcnt vmcnt(24)
    v_mfma_f32_16x16x32_bf16 v[160:163], v[32:35], a[88:91], v[160:163]
    ds_read_b64_tr_b16 v[52:53], v65 offset:28672
    v_mfma_f32_16x16x32_bf16 v[164:167], v[32:35], a[92:95], v[164:167]
    ds_read_b64_tr_b16 v[54:55], v65 offset:30720
    v_mfma_f32_16x16x32_bf16 v[168:171], v[32:35], a[96:99], v[168:171]
    v_mfma_f32_16x16x32_bf16 v[172:175], v[32:35], a[100:103], v[172:175]
    s_waitcnt lgkmcnt(2)
    v_mfma_f32_16x16x32_bf16 v[176:179], v[36:39], a[88:91], v[176:179]
    ds_read_b64_tr_b16 v[56:57], v66 offset:28672
    v_mfma_f32_16x16x32_bf16 v[180:183], v[36:39], a[92:95], v[180:183]
    ds_read_b64_tr_b16 v[58:59], v66 offset:30720
    v_mfma_f32_16x16x32_bf16 v[184:187], v[36:39], a[96:99], v[184:187]
    v_mfma_f32_16x16x32_bf16 v[188:191], v[36:39], a[100:103], v[188:191]
    v_mfma_f32_16x16x32_bf16 v[192:195], v[40:43], a[88:91], v[192:195]
    ds_read_b64_tr_b16 v[60:61], v67 offset:28672
    v_mfma_f32_16x16x32_bf16 v[196:199], v[40:43], a[92:95], v[196:199]
    ds_read_b64_tr_b16 v[62:63], v67 offset:30720
    v_mfma_f32_16x16x32_bf16 v[200:203], v[40:43], a[96:99], v[200:203]
    v_add_u32 v66, 65536, v66
    v_mfma_f32_16x16x32_bf16 v[204:207], v[40:43], a[100:103], v[204:207]
    s_waitcnt vmcnt(8) lgkmcnt(2)
    s_barrier
    v_mfma_f32_16x16x32_bf16 v[208:211], v[44:47], a[88:91], v[208:211]
    ds_read_b64_tr_b16 v[32:33], v66 offset:0
    v_mfma_f32_16x16x32_bf16 v[212:215], v[44:47], a[92:95], v[212:215]
    ds_read_b64_tr_b16 v[34:35], v66 offset:2048
    v_mfma_f32_16x16x32_bf16 v[216:219], v[44:47], a[96:99], v[216:219]
    v_add_u32 v67, 65536, v67
    v_mfma_f32_16x16x32_bf16 v[220:223], v[44:47], a[100:103], v[220:223]
    v_mfma_f32_16x16x32_bf16 v[160:163], v[48:51], a[104:107], v[160:163]
    ds_read_b64_tr_b16 v[36:37], v67 offset:0
    v_mfma_f32_16x16x32_bf16 v[164:167], v[48:51], a[108:111], v[164:167]
    ds_read_b64_tr_b16 v[38:39], v67 offset:2048
    v_mfma_f32_16x16x32_bf16 v[168:171], v[48:51], a[112:115], v[168:171]
    v_mfma_f32_16x16x32_bf16 v[172:175], v[48:51], a[116:119], v[172:175]
    v_mfma_f32_16x16x32_bf16 v[176:179], v[52:55], a[104:107], v[176:179]
    ds_read_b64_tr_b16 v[40:41], v66 offset:8192
    v_mfma_f32_16x16x32_bf16 v[180:183], v[52:55], a[108:111], v[180:183]
    ds_read_b64_tr_b16 v[42:43], v66 offset:10240
    v_mfma_f32_16x16x32_bf16 v[184:187], v[52:55], a[112:115], v[184:187]
    v_mfma_f32_16x16x32_bf16 v[188:191], v[52:55], a[116:119], v[188:191]
    v_mfma_f32_16x16x32_bf16 v[192:195], v[56:59], a[104:107], v[192:195]
    ds_read_b64_tr_b16 v[44:45], v67 offset:8192
    v_mfma_f32_16x16x32_bf16 v[196:199], v[56:59], a[108:111], v[196:199]
    ds_read_b64_tr_b16 v[46:47], v67 offset:10240
    v_mfma_f32_16x16x32_bf16 v[200:203], v[56:59], a[112:115], v[200:203]
    v_mfma_f32_16x16x32_bf16 v[204:207], v[56:59], a[116:119], v[204:207]
    s_waitcnt lgkmcnt(2)
    v_mfma_f32_16x16x32_bf16 v[208:211], v[60:63], a[104:107], v[208:211]
    ds_read_b64_tr_b16 v[48:49], v66 offset:16384
    v_cvt_pk_bf16_f32 v160, v160, v161
    v_mfma_f32_16x16x32_bf16 v[212:215], v[60:63], a[108:111], v[212:215]
    ds_read_b64_tr_b16 v[50:51], v66 offset:18432
    v_cvt_pk_bf16_f32 v161, v162, v163
    v_mfma_f32_16x16x32_bf16 v[216:219], v[60:63], a[112:115], v[216:219]
    v_cvt_pk_bf16_f32 v162, v176, v177
    v_cvt_pk_bf16_f32 v163, v178, v179
    v_mfma_f32_16x16x32_bf16 v[220:223], v[60:63], a[116:119], v[220:223]
    buffer_store_dwordx4 v[160:163], v1, s[44:47], s16 offen offset:0 sc1
    v_cvt_pk_bf16_f32 v164, v164, v165
    v_cvt_pk_bf16_f32 v165, v166, v167
    v_cvt_pk_bf16_f32 v166, v180, v181
    v_cvt_pk_bf16_f32 v167, v182, v183
    v_mfma_f32_16x16x32_bf16 v[128:131], v[32:35], a[120:123], v[128:131]
    buffer_store_dwordx4 v[164:167], v1, s[44:47], s16 offen offset:1024 sc1
    v_cvt_pk_bf16_f32 v168, v168, v169
    v_cvt_pk_bf16_f32 v169, v170, v171
    v_cvt_pk_bf16_f32 v170, v184, v185
    v_cvt_pk_bf16_f32 v171, v186, v187
    v_mfma_f32_16x16x32_bf16 v[132:135], v[32:35], a[124:127], v[132:135]
    buffer_store_dwordx4 v[168:171], v1, s[44:47], s16 offen offset:2048 sc1
    v_cvt_pk_bf16_f32 v172, v172, v173
    v_cvt_pk_bf16_f32 v173, v174, v175
    v_cvt_pk_bf16_f32 v174, v188, v189
    v_cvt_pk_bf16_f32 v175, v190, v191
    v_mfma_f32_16x16x32_bf16 v[136:139], v[32:35], a[128:131], v[136:139]
    buffer_store_dwordx4 v[172:175], v1, s[44:47], s16 offen offset:3072 sc1
    v_mfma_f32_16x16x32_bf16 v[140:143], v[32:35], a[132:135], v[140:143]
    ds_read_b64_tr_b16 v[52:53], v67 offset:16384
    v_mfma_f32_16x16x32_bf16 v[144:147], v[36:39], a[120:123], v[144:147]
    ds_read_b64_tr_b16 v[54:55], v67 offset:18432
    v_cvt_pk_bf16_f32 v192, v192, v193
    v_mfma_f32_16x16x32_bf16 v[148:151], v[36:39], a[124:127], v[148:151]
    ds_read_b64_tr_b16 v[56:57], v66 offset:24576
    v_cvt_pk_bf16_f32 v193, v194, v195
    v_mfma_f32_16x16x32_bf16 v[152:155], v[36:39], a[128:131], v[152:155]
    ds_read_b64_tr_b16 v[58:59], v66 offset:26624
    v_cvt_pk_bf16_f32 v194, v208, v209
    v_cvt_pk_bf16_f32 v195, v210, v211
    v_mfma_f32_16x16x32_bf16 v[156:159], v[36:39], a[132:135], v[156:159]
    buffer_store_dwordx4 v[192:195], v1, s[44:47], s17 offen offset:0 sc1
    v_cvt_pk_bf16_f32 v196, v196, v197
    v_cvt_pk_bf16_f32 v197, v198, v199
    v_cvt_pk_bf16_f32 v198, v212, v213
    v_cvt_pk_bf16_f32 v199, v214, v215
    v_mfma_f32_16x16x32_bf16 v[128:131], v[40:43], a[136:139], v[128:131]
    buffer_store_dwordx4 v[196:199], v1, s[44:47], s17 offen offset:1024 sc1
    v_cvt_pk_bf16_f32 v200, v200, v201
    v_cvt_pk_bf16_f32 v201, v202, v203
    v_cvt_pk_bf16_f32 v202, v216, v217
    v_cvt_pk_bf16_f32 v203, v218, v219
    v_mfma_f32_16x16x32_bf16 v[132:135], v[40:43], a[140:143], v[132:135]
    buffer_store_dwordx4 v[200:203], v1, s[44:47], s17 offen offset:2048 sc1
    v_cvt_pk_bf16_f32 v204, v204, v205
    v_cvt_pk_bf16_f32 v205, v206, v207
    v_cvt_pk_bf16_f32 v206, v220, v221
    v_cvt_pk_bf16_f32 v207, v222, v223
    v_mfma_f32_16x16x32_bf16 v[136:139], v[40:43], a[144:147], v[136:139]
    buffer_store_dwordx4 v[204:207], v1, s[44:47], s17 offen offset:3072 sc1
    v_mfma_f32_16x16x32_bf16 v[140:143], v[40:43], a[148:151], v[140:143]
    s_waitcnt lgkmcnt(1)
    ds_read_b64_tr_b16 v[60:61], v67 offset:24576
    v_mfma_f32_16x16x32_bf16 v[144:147], v[44:47], a[136:139], v[144:147]
    ds_read_b64_tr_b16 v[62:63], v67 offset:26624
    v_add_u32 v66, 4294836224, v66
    v_mfma_f32_16x16x32_bf16 v[148:151], v[44:47], a[140:143], v[148:151]
    ds_read_b64_tr_b16 v[32:33], v66 offset:0
    v_mfma_f32_16x16x32_bf16 v[152:155], v[44:47], a[144:147], v[152:155]
    ds_read_b64_tr_b16 v[34:35], v66 offset:2048
    v_add_u32 v67, 4294836224, v67
    v_mfma_f32_16x16x32_bf16 v[156:159], v[44:47], a[148:151], v[156:159]
    v_mfma_f32_16x16x32_bf16 v[128:131], v[48:51], a[152:155], v[128:131]
    ds_read_b64_tr_b16 v[36:37], v67 offset:0
    v_mfma_f32_16x16x32_bf16 v[132:135], v[48:51], a[156:159], v[132:135]
    ds_read_b64_tr_b16 v[38:39], v67 offset:2048
    v_mfma_f32_16x16x32_bf16 v[136:139], v[48:51], a[160:163], v[136:139]
    v_mfma_f32_16x16x32_bf16 v[140:143], v[48:51], a[164:167], v[140:143]
    v_mfma_f32_16x16x32_bf16 v[144:147], v[52:55], a[152:155], v[144:147]
    ds_read_b64_tr_b16 v[40:41], v66 offset:8192
    v_mfma_f32_16x16x32_bf16 v[148:151], v[52:55], a[156:159], v[148:151]
    ds_read_b64_tr_b16 v[42:43], v66 offset:10240
    v_mfma_f32_16x16x32_bf16 v[152:155], v[52:55], a[160:163], v[152:155]
    v_mfma_f32_16x16x32_bf16 v[156:159], v[52:55], a[164:167], v[156:159]
    s_waitcnt lgkmcnt(2)
    v_mfma_f32_16x16x32_bf16 v[128:131], v[56:59], a[168:171], v[128:131]
    ds_read_b64_tr_b16 v[44:45], v67 offset:8192
    v_mfma_f32_16x16x32_bf16 v[132:135], v[56:59], a[172:175], v[132:135]
    ds_read_b64_tr_b16 v[46:47], v67 offset:10240
    v_mfma_f32_16x16x32_bf16 v[136:139], v[56:59], a[176:179], v[136:139]
    v_mfma_f32_16x16x32_bf16 v[140:143], v[56:59], a[180:183], v[140:143]
    v_mfma_f32_16x16x32_bf16 v[144:147], v[60:63], a[168:171], v[144:147]
    ds_read_b64_tr_b16 v[48:49], v66 offset:16384
    v_mfma_f32_16x16x32_bf16 v[148:151], v[60:63], a[172:175], v[148:151]
    ds_read_b64_tr_b16 v[50:51], v66 offset:18432
    v_mfma_f32_16x16x32_bf16 v[152:155], v[60:63], a[176:179], v[152:155]
    v_mfma_f32_16x16x32_bf16 v[156:159], v[60:63], a[180:183], v[156:159]
    v_mfma_f32_16x16x32_bf16 v[128:131], v[32:35], a[192:195], v[128:131]
    ds_read_b64_tr_b16 v[52:53], v67 offset:16384
    v_mfma_f32_16x16x32_bf16 v[132:135], v[32:35], a[196:199], v[132:135]
    ds_read_b64_tr_b16 v[54:55], v67 offset:18432
    v_mfma_f32_16x16x32_bf16 v[136:139], v[32:35], a[200:203], v[136:139]
    v_mfma_f32_16x16x32_bf16 v[140:143], v[32:35], a[204:207], v[140:143]
    v_mfma_f32_16x16x32_bf16 v[144:147], v[36:39], a[192:195], v[144:147]
    ds_read_b64_tr_b16 v[56:57], v66 offset:24576
    v_mfma_f32_16x16x32_bf16 v[148:151], v[36:39], a[196:199], v[148:151]
    ds_read_b64_tr_b16 v[58:59], v66 offset:26624
    v_mfma_f32_16x16x32_bf16 v[152:155], v[36:39], a[200:203], v[152:155]
    v_mfma_f32_16x16x32_bf16 v[156:159], v[36:39], a[204:207], v[156:159]
    s_waitcnt lgkmcnt(2)
    v_mfma_f32_16x16x32_bf16 v[128:131], v[40:43], a[208:211], v[128:131]
    ds_read_b64_tr_b16 v[60:61], v67 offset:24576
    v_mfma_f32_16x16x32_bf16 v[132:135], v[40:43], a[212:215], v[132:135]
    ds_read_b64_tr_b16 v[62:63], v67 offset:26624
    v_mfma_f32_16x16x32_bf16 v[136:139], v[40:43], a[216:219], v[136:139]
    v_mfma_f32_16x16x32_bf16 v[140:143], v[40:43], a[220:223], v[140:143]
    s_waitcnt vmcnt(8) lgkmcnt(2)
    s_barrier
    v_mfma_f32_16x16x32_bf16 v[144:147], v[44:47], a[208:211], v[144:147]
    ds_read_b64_tr_b16 v[32:33], v66 offset:32768
    v_mfma_f32_16x16x32_bf16 v[148:151], v[44:47], a[212:215], v[148:151]
    ds_read_b64_tr_b16 v[34:35], v66 offset:34816
    v_mfma_f32_16x16x32_bf16 v[152:155], v[44:47], a[216:219], v[152:155]
    v_mfma_f32_16x16x32_bf16 v[156:159], v[44:47], a[220:223], v[156:159]
    v_mfma_f32_16x16x32_bf16 v[128:131], v[48:51], a[224:227], v[128:131]
    ds_read_b64_tr_b16 v[36:37], v67 offset:32768
    v_mfma_f32_16x16x32_bf16 v[132:135], v[48:51], a[228:231], v[132:135]
    ds_read_b64_tr_b16 v[38:39], v67 offset:34816
    v_mfma_f32_16x16x32_bf16 v[136:139], v[48:51], a[232:235], v[136:139]
    v_mfma_f32_16x16x32_bf16 v[140:143], v[48:51], a[236:239], v[140:143]
    v_mfma_f32_16x16x32_bf16 v[144:147], v[52:55], a[224:227], v[144:147]
    ds_read_b64_tr_b16 v[40:41], v66 offset:40960
    v_mfma_f32_16x16x32_bf16 v[148:151], v[52:55], a[228:231], v[148:151]
    ds_read_b64_tr_b16 v[42:43], v66 offset:43008
    v_mfma_f32_16x16x32_bf16 v[152:155], v[52:55], a[232:235], v[152:155]
    v_mfma_f32_16x16x32_bf16 v[156:159], v[52:55], a[236:239], v[156:159]
    v_mfma_f32_16x16x32_bf16 v[128:131], v[56:59], a[240:243], v[128:131]
    ds_read_b64_tr_b16 v[44:45], v67 offset:40960
    v_mfma_f32_16x16x32_bf16 v[132:135], v[56:59], a[244:247], v[132:135]
    ds_read_b64_tr_b16 v[46:47], v67 offset:43008
    v_mfma_f32_16x16x32_bf16 v[136:139], v[56:59], a[248:251], v[136:139]
    v_mfma_f32_16x16x32_bf16 v[140:143], v[56:59], a[252:255], v[140:143]
    s_waitcnt lgkmcnt(2)
    v_mfma_f32_16x16x32_bf16 v[144:147], v[60:63], a[240:243], v[144:147]
    ds_read_b64_tr_b16 v[48:49], v66 offset:49152
    v_mfma_f32_16x16x32_bf16 v[148:151], v[60:63], a[244:247], v[148:151]
    ds_read_b64_tr_b16 v[50:51], v66 offset:51200
    v_mfma_f32_16x16x32_bf16 v[152:155], v[60:63], a[248:251], v[152:155]
    v_mfma_f32_16x16x32_bf16 v[156:159], v[60:63], a[252:255], v[156:159]
    v_mfma_f32_16x16x32_bf16 v[128:131], v[32:35], a[56:59], v[128:131]
    ds_read_b64_tr_b16 v[52:53], v67 offset:49152
    v_mfma_f32_16x16x32_bf16 v[132:135], v[32:35], a[60:63], v[132:135]
    ds_read_b64_tr_b16 v[54:55], v67 offset:51200
    v_mfma_f32_16x16x32_bf16 v[136:139], v[32:35], a[64:67], v[136:139]
    v_mfma_f32_16x16x32_bf16 v[140:143], v[32:35], a[68:71], v[140:143]
    v_mfma_f32_16x16x32_bf16 v[144:147], v[36:39], a[56:59], v[144:147]
    ds_read_b64_tr_b16 v[56:57], v66 offset:57344
    v_mfma_f32_16x16x32_bf16 v[148:151], v[36:39], a[60:63], v[148:151]
    ds_read_b64_tr_b16 v[58:59], v66 offset:59392
    v_mfma_f32_16x16x32_bf16 v[152:155], v[36:39], a[64:67], v[152:155]
    v_mfma_f32_16x16x32_bf16 v[156:159], v[36:39], a[68:71], v[156:159]
    v_mfma_f32_16x16x32_bf16 v[128:131], v[40:43], a[0:3], v[128:131]
    ds_read_b64_tr_b16 v[60:61], v67 offset:57344
    v_mfma_f32_16x16x32_bf16 v[132:135], v[40:43], a[4:7], v[132:135]
    ds_read_b64_tr_b16 v[62:63], v67 offset:59392
    v_mfma_f32_16x16x32_bf16 v[136:139], v[40:43], a[8:11], v[136:139]
    v_add_u32 v66, 65536, v66
    v_mfma_f32_16x16x32_bf16 v[140:143], v[40:43], a[12:15], v[140:143]
    s_waitcnt lgkmcnt(2)
    v_mfma_f32_16x16x32_bf16 v[144:147], v[44:47], a[0:3], v[144:147]
    ds_read_b64_tr_b16 v[32:33], v66 offset:0
    v_mfma_f32_16x16x32_bf16 v[148:151], v[44:47], a[4:7], v[148:151]
    ds_read_b64_tr_b16 v[34:35], v66 offset:2048
    v_mfma_f32_16x16x32_bf16 v[152:155], v[44:47], a[8:11], v[152:155]
    v_add_u32 v67, 65536, v67
    v_mfma_f32_16x16x32_bf16 v[156:159], v[44:47], a[12:15], v[156:159]
    v_mfma_f32_16x16x32_bf16 v[128:131], v[48:51], a[16:19], v[128:131]
    ds_read_b64_tr_b16 v[36:37], v67 offset:0
    v_mfma_f32_16x16x32_bf16 v[132:135], v[48:51], a[20:23], v[132:135]
    ds_read_b64_tr_b16 v[38:39], v67 offset:2048
    v_mfma_f32_16x16x32_bf16 v[136:139], v[48:51], a[24:27], v[136:139]
    v_mfma_f32_16x16x32_bf16 v[140:143], v[48:51], a[28:31], v[140:143]
    v_mfma_f32_16x16x32_bf16 v[144:147], v[52:55], a[16:19], v[144:147]
    ds_read_b64_tr_b16 v[40:41], v66 offset:8192
    v_mfma_f32_16x16x32_bf16 v[148:151], v[52:55], a[20:23], v[148:151]
    ds_read_b64_tr_b16 v[42:43], v66 offset:10240
    v_mfma_f32_16x16x32_bf16 v[152:155], v[52:55], a[24:27], v[152:155]
    v_mfma_f32_16x16x32_bf16 v[156:159], v[52:55], a[28:31], v[156:159]
    v_mfma_f32_16x16x32_bf16 v[128:131], v[56:59], a[32:35], v[128:131]
    ds_read_b64_tr_b16 v[44:45], v67 offset:8192
    v_mfma_f32_16x16x32_bf16 v[132:135], v[56:59], a[36:39], v[132:135]
    ds_read_b64_tr_b16 v[46:47], v67 offset:10240
    v_mfma_f32_16x16x32_bf16 v[136:139], v[56:59], a[40:43], v[136:139]
    v_mfma_f32_16x16x32_bf16 v[140:143], v[56:59], a[44:47], v[140:143]
    s_waitcnt lgkmcnt(2)
    v_mfma_f32_16x16x32_bf16 v[144:147], v[60:63], a[32:35], v[144:147]
    ds_read_b64_tr_b16 v[48:49], v66 offset:16384
    v_mfma_f32_16x16x32_bf16 v[148:151], v[60:63], a[36:39], v[148:151]
    ds_read_b64_tr_b16 v[50:51], v66 offset:18432
    v_mfma_f32_16x16x32_bf16 v[152:155], v[60:63], a[40:43], v[152:155]
    v_mfma_f32_16x16x32_bf16 v[156:159], v[60:63], a[44:47], v[156:159]
    v_mfma_f32_16x16x32_bf16 v[128:131], v[32:35], a[48:51], v[128:131]
    ds_read_b64_tr_b16 v[52:53], v67 offset:16384
    v_mfma_f32_16x16x32_bf16 v[132:135], v[32:35], a[52:55], v[132:135]
    ds_read_b64_tr_b16 v[54:55], v67 offset:18432
    v_mfma_f32_16x16x32_bf16 v[136:139], v[32:35], a[184:187], v[136:139]
    v_mfma_f32_16x16x32_bf16 v[140:143], v[32:35], a[188:191], v[140:143]
    v_mfma_f32_16x16x32_bf16 v[144:147], v[36:39], a[48:51], v[144:147]
    ds_read_b64_tr_b16 v[56:57], v66 offset:24576
    v_mov_b32 v14, 5
    v_mfma_f32_16x16x32_bf16 v[148:151], v[36:39], a[52:55], v[148:151]
    s_waitcnt vmcnt(0)
    buffer_store_dword v14, v15, s[44:47], s56 offen sc1
    v_mfma_f32_16x16x32_bf16 v[152:155], v[36:39], a[184:187], v[152:155]
    ds_read_b64_tr_b16 v[58:59], v66 offset:26624
    v_mfma_f32_16x16x32_bf16 v[156:159], v[36:39], a[188:191], v[156:159]
    v_mfma_f32_16x16x32_bf16 v[128:131], v[40:43], a[72:75], v[128:131]
    ds_read_b64_tr_b16 v[60:61], v67 offset:24576
    v_mfma_f32_16x16x32_bf16 v[132:135], v[40:43], a[76:79], v[132:135]
    ds_read_b64_tr_b16 v[62:63], v67 offset:26624
    v_mfma_f32_16x16x32_bf16 v[136:139], v[40:43], a[80:83], v[136:139]
    v_add_u32 v64, 65536, v64
    v_mfma_f32_16x16x32_bf16 v[140:143], v[40:43], a[84:87], v[140:143]
    s_waitcnt lgkmcnt(3)
    v_mfma_f32_16x16x32_bf16 v[144:147], v[44:47], a[72:75], v[144:147]
    ds_read_b64_tr_b16 v[32:33], v64 offset:0
    v_mfma_f32_16x16x32_bf16 v[148:151], v[44:47], a[76:79], v[148:151]
    ds_read_b64_tr_b16 v[34:35], v64 offset:2048
    v_mfma_f32_16x16x32_bf16 v[152:155], v[44:47], a[80:83], v[152:155]
    v_add_u32 v65, 65536, v65
    v_mfma_f32_16x16x32_bf16 v[156:159], v[44:47], a[84:87], v[156:159]
    v_mfma_f32_16x16x32_bf16 v[128:131], v[48:51], a[88:91], v[128:131]
    ds_read_b64_tr_b16 v[36:37], v65 offset:0
    v_mfma_f32_16x16x32_bf16 v[132:135], v[48:51], a[92:95], v[132:135]
    ds_read_b64_tr_b16 v[38:39], v65 offset:2048
    v_mfma_f32_16x16x32_bf16 v[136:139], v[48:51], a[96:99], v[136:139]
    v_mfma_f32_16x16x32_bf16 v[140:143], v[48:51], a[100:103], v[140:143]
    v_mfma_f32_16x16x32_bf16 v[144:147], v[52:55], a[88:91], v[144:147]
    ds_read_b64_tr_b16 v[40:41], v64 offset:8192
    v_mfma_f32_16x16x32_bf16 v[148:151], v[52:55], a[92:95], v[148:151]
    ds_read_b64_tr_b16 v[42:43], v64 offset:10240
    v_mfma_f32_16x16x32_bf16 v[152:155], v[52:55], a[96:99], v[152:155]
    v_mfma_f32_16x16x32_bf16 v[156:159], v[52:55], a[100:103], v[156:159]
    s_waitcnt lgkmcnt(2)
    v_mfma_f32_16x16x32_bf16 v[128:131], v[56:59], a[104:107], v[128:131]
    ds_read_b64_tr_b16 v[44:45], v65 offset:8192
    v_mfma_f32_16x16x32_bf16 v[132:135], v[56:59], a[108:111], v[132:135]
    ds_read_b64_tr_b16 v[46:47], v65 offset:10240
    v_mfma_f32_16x16x32_bf16 v[136:139], v[56:59], a[112:115], v[136:139]
    v_mfma_f32_16x16x32_bf16 v[140:143], v[56:59], a[116:119], v[140:143]
    v_mfma_f32_16x16x32_bf16 v[144:147], v[60:63], a[104:107], v[144:147]
    ds_read_b64_tr_b16 v[48:49], v64 offset:16384
    v_mfma_f32_16x16x32_bf16 v[148:151], v[60:63], a[108:111], v[148:151]
    ds_read_b64_tr_b16 v[50:51], v64 offset:18432
    v_mfma_f32_16x16x32_bf16 v[152:155], v[60:63], a[112:115], v[152:155]
    v_mfma_f32_16x16x32_bf16 v[156:159], v[60:63], a[116:119], v[156:159]
    v_mfma_f32_16x16x32_bf16 v[96:99], v[32:35], a[120:123], v[96:99]
    ds_read_b64_tr_b16 v[52:53], v65 offset:16384
    v_mfma_f32_16x16x32_bf16 v[100:103], v[32:35], a[124:127], v[100:103]
    ds_read_b64_tr_b16 v[54:55], v65 offset:18432
    v_mfma_f32_16x16x32_bf16 v[104:107], v[32:35], a[128:131], v[104:107]
    v_mfma_f32_16x16x32_bf16 v[108:111], v[32:35], a[132:135], v[108:111]
    v_mfma_f32_16x16x32_bf16 v[112:115], v[36:39], a[120:123], v[112:115]
    ds_read_b64_tr_b16 v[56:57], v64 offset:24576
    v_cvt_pk_bf16_f32 v128, v128, v129
    v_mfma_f32_16x16x32_bf16 v[116:119], v[36:39], a[124:127], v[116:119]
    ds_read_b64_tr_b16 v[58:59], v64 offset:26624
    v_cvt_pk_bf16_f32 v129, v130, v131
    v_mfma_f32_16x16x32_bf16 v[120:123], v[36:39], a[128:131], v[120:123]
    v_cvt_pk_bf16_f32 v130, v144, v145
    v_cvt_pk_bf16_f32 v131, v146, v147
    v_min_u32 v128, -2, v128
    v_min_u32 v129, -2, v129
    v_min_u32 v130, -2, v130
    v_min_u32 v131, -2, v131
    v_mfma_f32_16x16x32_bf16 v[124:127], v[36:39], a[132:135], v[124:127]
    s_waitcnt lgkmcnt(2)
    v_mfma_f32_16x16x32_bf16 v[96:99], v[40:43], a[136:139], v[96:99]
    buffer_store_dwordx4 v[128:131], v1, s[44:47], s64 offen offset:0 sc1
    v_cvt_pk_bf16_f32 v132, v132, v133
    v_cvt_pk_bf16_f32 v133, v134, v135
    v_cvt_pk_bf16_f32 v134, v148, v149
    v_cvt_pk_bf16_f32 v135, v150, v151
    v_min_u32 v132, -2, v132
    v_min_u32 v133, -2, v133
    v_min_u32 v134, -2, v134
    v_min_u32 v135, -2, v135
    v_mfma_f32_16x16x32_bf16 v[100:103], v[40:43], a[140:143], v[100:103]
    buffer_store_dwordx4 v[132:135], v1, s[44:47], s64 offen offset:1024 sc1
    v_cvt_pk_bf16_f32 v136, v136, v137
    v_cvt_pk_bf16_f32 v137, v138, v139
    v_cvt_pk_bf16_f32 v138, v152, v153
    v_cvt_pk_bf16_f32 v139, v154, v155
    v_min_u32 v136, -2, v136
    v_min_u32 v137, -2, v137
    v_min_u32 v138, -2, v138
    v_min_u32 v139, -2, v139
    v_mfma_f32_16x16x32_bf16 v[104:107], v[40:43], a[144:147], v[104:107]
    buffer_store_dwordx4 v[136:139], v1, s[44:47], s64 offen offset:2048 sc1
    v_cvt_pk_bf16_f32 v140, v140, v141
    v_cvt_pk_bf16_f32 v141, v142, v143
    v_cvt_pk_bf16_f32 v142, v156, v157
    v_cvt_pk_bf16_f32 v143, v158, v159
    v_min_u32 v140, -2, v140
    v_min_u32 v141, -2, v141
    v_min_u32 v142, -2, v142
    v_min_u32 v143, -2, v143
    v_mfma_f32_16x16x32_bf16 v[108:111], v[40:43], a[148:151], v[108:111]
    buffer_store_dwordx4 v[140:143], v1, s[44:47], s64 offen offset:3072 sc1
    v_mfma_f32_16x16x32_bf16 v[112:115], v[44:47], a[136:139], v[112:115]
    ds_read_b64_tr_b16 v[60:61], v65 offset:24576
    v_mov_b32 v14, 6
    v_mfma_f32_16x16x32_bf16 v[116:119], v[44:47], a[140:143], v[116:119]
    buffer_store_dword v14, v15, s[44:47], s56 offen sc1
    v_mfma_f32_16x16x32_bf16 v[120:123], v[44:47], a[144:147], v[120:123]
    ds_read_b64_tr_b16 v[62:63], v65 offset:26624
    v_add_u32 v64, 4294836224, v64
    v_mfma_f32_16x16x32_bf16 v[124:127], v[44:47], a[148:151], v[124:127]
    ds_read_b64_tr_b16 v[32:33], v64 offset:0
    v_mfma_f32_16x16x32_bf16 v[96:99], v[48:51], a[152:155], v[96:99]
    ds_read_b64_tr_b16 v[34:35], v64 offset:2048
    v_add_u32 v65, 4294836224, v65
    v_mfma_f32_16x16x32_bf16 v[100:103], v[48:51], a[156:159], v[100:103]
    ds_read_b64_tr_b16 v[36:37], v65 offset:0
    v_mfma_f32_16x16x32_bf16 v[104:107], v[48:51], a[160:163], v[104:107]
    ds_read_b64_tr_b16 v[38:39], v65 offset:2048
    v_mfma_f32_16x16x32_bf16 v[108:111], v[48:51], a[164:167], v[108:111]
    v_mfma_f32_16x16x32_bf16 v[112:115], v[52:55], a[152:155], v[112:115]
    ds_read_b64_tr_b16 v[40:41], v64 offset:8192
    v_mfma_f32_16x16x32_bf16 v[116:119], v[52:55], a[156:159], v[116:119]
    ds_read_b64_tr_b16 v[42:43], v64 offset:10240
    v_mfma_f32_16x16x32_bf16 v[120:123], v[52:55], a[160:163], v[120:123]
    v_mfma_f32_16x16x32_bf16 v[124:127], v[52:55], a[164:167], v[124:127]
    s_waitcnt lgkmcnt(3)
    v_mfma_f32_16x16x32_bf16 v[96:99], v[56:59], a[168:171], v[96:99]
    ds_read_b64_tr_b16 v[44:45], v65 offset:8192
    v_mfma_f32_16x16x32_bf16 v[100:103], v[56:59], a[172:175], v[100:103]
    ds_read_b64_tr_b16 v[46:47], v65 offset:10240
    v_mfma_f32_16x16x32_bf16 v[104:107], v[56:59], a[176:179], v[104:107]
    v_mfma_f32_16x16x32_bf16 v[108:111], v[56:59], a[180:183], v[108:111]
    v_mfma_f32_16x16x32_bf16 v[112:115], v[60:63], a[168:171], v[112:115]
    ds_read_b64_tr_b16 v[48:49], v64 offset:16384
    v_mfma_f32_16x16x32_bf16 v[116:119], v[60:63], a[172:175], v[116:119]
    ds_read_b64_tr_b16 v[50:51], v64 offset:18432
    v_mfma_f32_16x16x32_bf16 v[120:123], v[60:63], a[176:179], v[120:123]
    v_mfma_f32_16x16x32_bf16 v[124:127], v[60:63], a[180:183], v[124:127]
    v_mfma_f32_16x16x32_bf16 v[96:99], v[32:35], a[192:195], v[96:99]
    ds_read_b64_tr_b16 v[52:53], v65 offset:16384
    v_mfma_f32_16x16x32_bf16 v[100:103], v[32:35], a[196:199], v[100:103]
    ds_read_b64_tr_b16 v[54:55], v65 offset:18432
    v_mfma_f32_16x16x32_bf16 v[104:107], v[32:35], a[200:203], v[104:107]
    v_mfma_f32_16x16x32_bf16 v[108:111], v[32:35], a[204:207], v[108:111]
    s_waitcnt lgkmcnt(2)
    v_mfma_f32_16x16x32_bf16 v[112:115], v[36:39], a[192:195], v[112:115]
    ds_read_b64_tr_b16 v[56:57], v64 offset:24576
    v_mfma_f32_16x16x32_bf16 v[116:119], v[36:39], a[196:199], v[116:119]
    ds_read_b64_tr_b16 v[58:59], v64 offset:26624
    v_mfma_f32_16x16x32_bf16 v[120:123], v[36:39], a[200:203], v[120:123]
    v_mfma_f32_16x16x32_bf16 v[124:127], v[36:39], a[204:207], v[124:127]
    v_mfma_f32_16x16x32_bf16 v[96:99], v[40:43], a[208:211], v[96:99]
    ds_read_b64_tr_b16 v[60:61], v65 offset:24576
    v_mfma_f32_16x16x32_bf16 v[100:103], v[40:43], a[212:215], v[100:103]
    buffer_load_dword v13, v69, s[44:47], s58 offen sc1
    v_mfma_f32_16x16x32_bf16 v[104:107], v[40:43], a[216:219], v[104:107]
    ds_read_b64_tr_b16 v[62:63], v65 offset:26624
    v_mfma_f32_16x16x32_bf16 v[108:111], v[40:43], a[220:223], v[108:111]
    v_mfma_f32_16x16x32_bf16 v[112:115], v[44:47], a[208:211], v[112:115]
    ds_read_b64_tr_b16 v[32:33], v64 offset:32768
    v_mfma_f32_16x16x32_bf16 v[116:119], v[44:47], a[212:215], v[116:119]
    ds_read_b64_tr_b16 v[34:35], v64 offset:34816
    v_mfma_f32_16x16x32_bf16 v[120:123], v[44:47], a[216:219], v[120:123]
    v_mfma_f32_16x16x32_bf16 v[124:127], v[44:47], a[220:223], v[124:127]
    v_mfma_f32_16x16x32_bf16 v[96:99], v[48:51], a[224:227], v[96:99]
    ds_read_b64_tr_b16 v[36:37], v65 offset:32768
    v_mfma_f32_16x16x32_bf16 v[100:103], v[48:51], a[228:231], v[100:103]
    ds_read_b64_tr_b16 v[38:39], v65 offset:34816
    v_mfma_f32_16x16x32_bf16 v[104:107], v[48:51], a[232:235], v[104:107]
    v_mfma_f32_16x16x32_bf16 v[108:111], v[48:51], a[236:239], v[108:111]
    s_waitcnt lgkmcnt(2)
    v_mfma_f32_16x16x32_bf16 v[112:115], v[52:55], a[224:227], v[112:115]
    ds_read_b64_tr_b16 v[40:41], v64 offset:40960
    v_mfma_f32_16x16x32_bf16 v[116:119], v[52:55], a[228:231], v[116:119]
    ds_read_b64_tr_b16 v[42:43], v64 offset:43008
    v_mfma_f32_16x16x32_bf16 v[120:123], v[52:55], a[232:235], v[120:123]
    v_mfma_f32_16x16x32_bf16 v[124:127], v[52:55], a[236:239], v[124:127]
    v_mfma_f32_16x16x32_bf16 v[96:99], v[56:59], a[240:243], v[96:99]
    ds_read_b64_tr_b16 v[44:45], v65 offset:40960
    v_mfma_f32_16x16x32_bf16 v[100:103], v[56:59], a[244:247], v[100:103]
    ds_read_b64_tr_b16 v[46:47], v65 offset:43008
    v_mfma_f32_16x16x32_bf16 v[104:107], v[56:59], a[248:251], v[104:107]
    v_mfma_f32_16x16x32_bf16 v[108:111], v[56:59], a[252:255], v[108:111]
    v_mfma_f32_16x16x32_bf16 v[112:115], v[60:63], a[240:243], v[112:115]
    ds_read_b64_tr_b16 v[48:49], v64 offset:49152
    v_mfma_f32_16x16x32_bf16 v[116:119], v[60:63], a[244:247], v[116:119]
    ds_read_b64_tr_b16 v[50:51], v64 offset:51200
    v_mfma_f32_16x16x32_bf16 v[120:123], v[60:63], a[248:251], v[120:123]
    v_mfma_f32_16x16x32_bf16 v[124:127], v[60:63], a[252:255], v[124:127]
    v_mfma_f32_16x16x32_bf16 v[96:99], v[32:35], a[56:59], v[96:99]
    ds_read_b64_tr_b16 v[52:53], v65 offset:49152
    v_mfma_f32_16x16x32_bf16 v[100:103], v[32:35], a[60:63], v[100:103]
    ds_read_b64_tr_b16 v[54:55], v65 offset:51200
    v_mfma_f32_16x16x32_bf16 v[104:107], v[32:35], a[64:67], v[104:107]
    v_mfma_f32_16x16x32_bf16 v[108:111], v[32:35], a[68:71], v[108:111]
    s_waitcnt lgkmcnt(2)
    v_mfma_f32_16x16x32_bf16 v[112:115], v[36:39], a[56:59], v[112:115]
    ds_read_b64_tr_b16 v[56:57], v64 offset:57344
    v_mfma_f32_16x16x32_bf16 v[116:119], v[36:39], a[60:63], v[116:119]
    ds_read_b64_tr_b16 v[58:59], v64 offset:59392
    v_mfma_f32_16x16x32_bf16 v[120:123], v[36:39], a[64:67], v[120:123]
    v_mfma_f32_16x16x32_bf16 v[124:127], v[36:39], a[68:71], v[124:127]
    v_mfma_f32_16x16x32_bf16 v[96:99], v[40:43], a[0:3], v[96:99]
    ds_read_b64_tr_b16 v[60:61], v65 offset:57344
    v_mfma_f32_16x16x32_bf16 v[100:103], v[40:43], a[4:7], v[100:103]
    ds_read_b64_tr_b16 v[62:63], v65 offset:59392
    v_mfma_f32_16x16x32_bf16 v[104:107], v[40:43], a[8:11], v[104:107]
    v_add_u32 v64, 65536, v64
    v_mfma_f32_16x16x32_bf16 v[108:111], v[40:43], a[12:15], v[108:111]
    v_mfma_f32_16x16x32_bf16 v[112:115], v[44:47], a[0:3], v[112:115]
    ds_read_b64_tr_b16 v[32:33], v64 offset:0
    v_mfma_f32_16x16x32_bf16 v[116:119], v[44:47], a[4:7], v[116:119]
    ds_read_b64_tr_b16 v[34:35], v64 offset:2048
    v_mfma_f32_16x16x32_bf16 v[120:123], v[44:47], a[8:11], v[120:123]
    v_add_u32 v65, 65536, v65
    v_mfma_f32_16x16x32_bf16 v[124:127], v[44:47], a[12:15], v[124:127]
    v_mfma_f32_16x16x32_bf16 v[96:99], v[48:51], a[16:19], v[96:99]
    ds_read_b64_tr_b16 v[36:37], v65 offset:0
    v_mfma_f32_16x16x32_bf16 v[100:103], v[48:51], a[20:23], v[100:103]
    ds_read_b64_tr_b16 v[38:39], v65 offset:2048
    v_mfma_f32_16x16x32_bf16 v[104:107], v[48:51], a[24:27], v[104:107]
    v_mfma_f32_16x16x32_bf16 v[108:111], v[48:51], a[28:31], v[108:111]
    s_waitcnt lgkmcnt(2)
    v_mfma_f32_16x16x32_bf16 v[112:115], v[52:55], a[16:19], v[112:115]
    ds_read_b64_tr_b16 v[40:41], v64 offset:8192
    v_mfma_f32_16x16x32_bf16 v[116:119], v[52:55], a[20:23], v[116:119]
    s_waitcnt vmcnt(0)
    v_cmp_gt_i32 vcc, 5, v13
    v_mfma_f32_16x16x32_bf16 v[120:123], v[52:55], a[24:27], v[120:123]
    s_cbranch_vccnz L_up_slow5
L_up_back5:
    ds_read_b64_tr_b16 v[42:43], v64 offset:10240
    v_mfma_f32_16x16x32_bf16 v[124:127], v[52:55], a[28:31], v[124:127]
    buffer_load_dwordx4 v[176:179], v1, s[44:47], s13 offen offset:0 sc1
    v_mfma_f32_16x16x32_bf16 v[96:99], v[56:59], a[32:35], v[96:99]
    buffer_load_dwordx4 v[180:183], v1, s[44:47], s13 offen offset:1024 sc1
    v_mfma_f32_16x16x32_bf16 v[100:103], v[56:59], a[36:39], v[100:103]
    buffer_load_dwordx4 v[184:187], v1, s[44:47], s13 offen offset:2048 sc1
    v_mfma_f32_16x16x32_bf16 v[104:107], v[56:59], a[40:43], v[104:107]
    buffer_load_dwordx4 v[188:191], v1, s[44:47], s13 offen offset:3072 sc1
    v_mfma_f32_16x16x32_bf16 v[108:111], v[56:59], a[44:47], v[108:111]
    buffer_load_dwordx4 v[208:211], v1, s[44:47], s14 offen offset:0 sc1
    v_mfma_f32_16x16x32_bf16 v[112:115], v[60:63], a[32:35], v[112:115]
    buffer_load_dwordx4 v[212:215], v1, s[44:47], s14 offen offset:1024 sc1
    v_mfma_f32_16x16x32_bf16 v[116:119], v[60:63], a[36:39], v[116:119]
    buffer_load_dwordx4 v[216:219], v1, s[44:47], s14 offen offset:2048 sc1
    v_mfma_f32_16x16x32_bf16 v[120:123], v[60:63], a[40:43], v[120:123]
    buffer_load_dwordx4 v[220:223], v1, s[44:47], s14 offen offset:3072 sc1
    ds_read_b64_tr_b16 v[44:45], v65 offset:8192
    v_mfma_f32_16x16x32_bf16 v[124:127], v[60:63], a[44:47], v[124:127]
    ds_read_b64_tr_b16 v[46:47], v65 offset:10240
    v_mfma_f32_16x16x32_bf16 v[96:99], v[32:35], a[48:51], v[96:99]
    ds_read_b64_tr_b16 v[48:49], v64 offset:16384
    v_mfma_f32_16x16x32_bf16 v[100:103], v[32:35], a[52:55], v[100:103]
    ds_read_b64_tr_b16 v[50:51], v64 offset:18432
    v_mfma_f32_16x16x32_bf16 v[104:107], v[32:35], a[184:187], v[104:107]
    ds_read_b64_tr_b16 v[52:53], v65 offset:16384
    v_mfma_f32_16x16x32_bf16 v[108:111], v[32:35], a[188:191], v[108:111]
    s_waitcnt lgkmcnt(5)
    ds_read_b64_tr_b16 v[54:55], v65 offset:18432
    v_mfma_f32_16x16x32_bf16 v[112:115], v[36:39], a[48:51], v[112:115]
    ds_read_b64_tr_b16 v[56:57], v64 offset:24576
    v_mfma_f32_16x16x32_bf16 v[116:119], v[36:39], a[52:55], v[116:119]
    ds_read_b64_tr_b16 v[58:59], v64 offset:26624
    v_mfma_f32_16x16x32_bf16 v[120:123], v[36:39], a[184:187], v[120:123]
    v_mfma_f32_16x16x32_bf16 v[124:127], v[36:39], a[188:191], v[124:127]
    v_mfma_f32_16x16x32_bf16 v[96:99], v[40:43], a[72:75], v[96:99]
    ds_read_b64_tr_b16 v[60:61], v65 offset:24576
    v_mfma_f32_16x16x32_bf16 v[100:103], v[40:43], a[76:79], v[100:103]
    ds_read_b64_tr_b16 v[62:63], v65 offset:26624
    v_mfma_f32_16x16x32_bf16 v[104:107], v[40:43], a[80:83], v[104:107]
    v_mfma_f32_16x16x32_bf16 v[108:111], v[40:43], a[84:87], v[108:111]
    s_waitcnt lgkmcnt(2)
    v_mfma_f32_16x16x32_bf16 v[112:115], v[44:47], a[72:75], v[112:115]
    v_mfma_f32_16x16x32_bf16 v[116:119], v[44:47], a[76:79], v[116:119]
    v_mfma_f32_16x16x32_bf16 v[120:123], v[44:47], a[80:83], v[120:123]
    v_mfma_f32_16x16x32_bf16 v[124:127], v[44:47], a[84:87], v[124:127]
    v_mfma_f32_16x16x32_bf16 v[96:99], v[48:51], a[88:91], v[96:99]
    v_mfma_f32_16x16x32_bf16 v[100:103], v[48:51], a[92:95], v[100:103]
    v_mfma_f32_16x16x32_bf16 v[104:107], v[48:51], a[96:99], v[104:107]
    v_mfma_f32_16x16x32_bf16 v[108:111], v[48:51], a[100:103], v[108:111]
    v_mfma_f32_16x16x32_bf16 v[112:115], v[52:55], a[88:91], v[112:115]
    v_mfma_f32_16x16x32_bf16 v[116:119], v[52:55], a[92:95], v[116:119]
    v_mfma_f32_16x16x32_bf16 v[120:123], v[52:55], a[96:99], v[120:123]
    v_mfma_f32_16x16x32_bf16 v[124:127], v[52:55], a[100:103], v[124:127]
    v_mfma_f32_16x16x32_bf16 v[96:99], v[56:59], a[104:107], v[96:99]
    v_mfma_f32_16x16x32_bf16 v[100:103], v[56:59], a[108:111], v[100:103]
    v_mfma_f32_16x16x32_bf16 v[104:107], v[56:59], a[112:115], v[104:107]
    buffer_load_dwordx4 v[144:147], v1, s[44:47], s12 offen offset:0 sc1
    v_mfma_f32_16x16x32_bf16 v[108:111], v[56:59], a[116:119], v[108:111]
    s_waitcnt lgkmcnt(0)
    v_mfma_f32_16x16x32_bf16 v[112:115], v[60:63], a[104:107], v[112:115]
    buffer_load_dwordx4 v[148:151], v1, s[44:47], s12 offen offset:1024 sc1
    v_mfma_f32_16x16x32_bf16 v[116:119], v[60:63], a[108:111], v[116:119]
    buffer_load_dwordx4 v[152:155], v1, s[44:47], s12 offen offset:2048 sc1
    v_mfma_f32_16x16x32_bf16 v[120:123], v[60:63], a[112:115], v[120:123]
    buffer_load_dwordx4 v[156:159], v1, s[44:47], s12 offen offset:3072 sc1
    v_mfma_f32_16x16x32_bf16 v[124:127], v[60:63], a[116:119], v[124:127]
    v_mfma_f32_16x16x32_bf16 v[96:99], v[78:81], v[224:227], v[96:99]
    v_mfma_f32_16x16x32_bf16 v[100:103], v[78:81], v[228:231], v[100:103]
    v_mfma_f32_16x16x32_bf16 v[104:107], v[78:81], v[232:235], v[104:107]
    v_mfma_f32_16x16x32_bf16 v[108:111], v[78:81], v[236:239], v[108:111]
    v_mfma_f32_16x16x32_bf16 v[112:115], v[76:79], v[224:227], v[112:115]
    v_mfma_f32_16x16x32_bf16 v[116:119], v[76:79], v[228:231], v[116:119]
    v_mfma_f32_16x16x32_bf16 v[120:123], v[76:79], v[232:235], v[120:123]
    v_mfma_f32_16x16x32_bf16 v[124:127], v[76:79], v[236:239], v[124:127]
    s_mov_b32 s4, 0
    s_mov_b32 s5, 32768
    s_mov_b32 s6, 65536
    s_mov_b32 s7, 98304
    s_waitcnt vmcnt(8)
    v_mfma_f32_16x16x32_bf16 v[96:99], v[78:81], v[176:179], v[96:99]
    v_mfma_f32_16x16x32_bf16 v[100:103], v[78:81], v[180:183], v[100:103]
    v_mfma_f32_16x16x32_bf16 v[104:107], v[78:81], v[184:187], v[104:107]
    v_mfma_f32_16x16x32_bf16 v[108:111], v[78:81], v[188:191], v[108:111]
    v_mfma_f32_16x16x32_bf16 v[112:115], v[76:79], v[176:179], v[112:115]
    v_mfma_f32_16x16x32_bf16 v[116:119], v[76:79], v[180:183], v[116:119]
    v_mfma_f32_16x16x32_bf16 v[120:123], v[76:79], v[184:187], v[120:123]
    v_mfma_f32_16x16x32_bf16 v[124:127], v[76:79], v[188:191], v[124:127]
    s_waitcnt vmcnt(4)
    v_mfma_f32_16x16x32_bf16 v[96:99], v[78:81], v[208:211], v[96:99]
    v_mfma_f32_16x16x32_bf16 v[100:103], v[78:81], v[212:215], v[100:103]
    v_mfma_f32_16x16x32_bf16 v[104:107], v[78:81], v[216:219], v[104:107]
    v_mfma_f32_16x16x32_bf16 v[108:111], v[78:81], v[220:223], v[108:111]
    v_mfma_f32_16x16x32_bf16 v[112:115], v[76:79], v[208:211], v[112:115]
    v_mfma_f32_16x16x32_bf16 v[116:119], v[76:79], v[212:215], v[116:119]
    v_mfma_f32_16x16x32_bf16 v[120:123], v[76:79], v[216:219], v[120:123]
    v_mfma_f32_16x16x32_bf16 v[124:127], v[76:79], v[220:223], v[124:127]
    s_mov_b32 s3, 0
L_up_chk:
    s_waitcnt vmcnt(0)
    v_max3_u32 v24, v144, v145, v146
    v_max3_u32 v25, v147, v148, v149
    v_max3_u32 v26, v150, v151, v152
    v_max3_u32 v27, v153, v154, v155
    v_max3_u32 v28, v156, v157, v158
    v_max3_u32 v24, v24, v25, v159
    v_max3_u32 v26, v26, v27, v28
    v_max_u32 v24, v24, v26
    v_cmp_eq_u32 vcc, -1, v24
    s_nop 0
    s_cbranch_vccnz L_up_retry
L_up_ok:
    v_mfma_f32_16x16x32_bf16 v[96:99], v[78:81], v[144:147], v[96:99]
    v_mfma_f32_16x16x32_bf16 v[112:115], v[76:79], v[144:147], v[112:115]
    v_mfma_f32_16x16x32_bf16 v[100:103], v[78:81], v[148:151], v[100:103]
    v_mfma_f32_16x16x32_bf16 v[116:119], v[76:79], v[148:151], v[116:119]
    v_mfma_f32_16x16x32_bf16 v[104:107], v[78:81], v[152:155], v[104:107]
    v_mfma_f32_16x16x32_bf16 v[120:123], v[76:79], v[152:155], v[120:123]
    v_mfma_f32_16x16x32_bf16 v[108:111], v[78:81], v[156:159], v[108:111]
    v_mfma_f32_16x16x32_bf16 v[124:127], v[76:79], v[156:159], v[124:127]
    s_nop 1
    v_cvt_pk_bf16_f32 v32, v96, v97
    v_cvt_pk_bf16_f32 v33, v98, v99
    v_cvt_pk_bf16_f32 v34, v112, v113
    v_cvt_pk_bf16_f32 v35, v114, v115
    s_nop 1
    v_permlane16_swap_b32 v32, v34
    v_permlane16_swap_b32 v33, v35
    buffer_store_dwordx4 v[32:35], v68, s[48:51], s4 offen sc1
    v_cvt_pk_bf16_f32 v36, v100, v101
    v_cvt_pk_bf16_f32 v37, v102, v103
    v_cvt_pk_bf16_f32 v38, v116, v117
    v_cvt_pk_bf16_f32 v39, v118, v119
    s_nop 1
    v_permlane16_swap_b32 v36, v38
    v_permlane16_swap_b32 v37, v39
    buffer_store_dwordx4 v[36:39], v68, s[48:51], s5 offen sc1
    v_cvt_pk_bf16_f32 v40, v104, v105
    v_cvt_pk_bf16_f32 v41, v106, v107
    v_cvt_pk_bf16_f32 v42, v120, v121
    v_cvt_pk_bf16_f32 v43, v122, v123
    s_nop 1
    v_permlane16_swap_b32 v40, v42
    v_permlane16_swap_b32 v41, v43
    buffer_store_dwordx4 v[40:43], v68, s[48:51], s6 offen sc1
    v_cvt_pk_bf16_f32 v44, v108, v109
    v_cvt_pk_bf16_f32 v45, v110, v111
    v_cvt_pk_bf16_f32 v46, v124, v125
    v_cvt_pk_bf16_f32 v47, v126, v127
    s_nop 1
    v_permlane16_swap_b32 v44, v46
    v_permlane16_swap_b32 v45, v47
    buffer_store_dwordx4 v[44:47], v68, s[48:51], s7 offen sc1
L_up_end:
    s_endpgm
L_up_retry:
    buffer_load_dword v13, v15, s[44:47], s15 offen sc1
    s_add_u32 s3, s3, 1
    s_waitcnt vmcnt(0)
    v_cmp_gt_i32 vcc, 6, v13
    s_cmp_ge_u32 s3, 0x40000
    s_cbranch_scc1 L_up_ok
    s_sleep 1
    s_cbranch_vccnz L_up_retry
    buffer_load_dwordx4 v[144:147], v1, s[44:47], s12 offen offset:0 sc1
    buffer_load_dwordx4 v[148:151], v1, s[44:47], s12 offen offset:1024 sc1
    buffer_load_dwordx4 v[152:155], v1, s[44:47], s12 offen offset:2048 sc1
    buffer_load_dwordx4 v[156:159], v1, s[44:47], s12 offen offset:3072 sc1
    s_branch L_up_chk
L_up_slow1:
    s_mov_b32 s3, 0
L_up_spin1:
    buffer_load_dword v13, v12, s[44:47], s57 offen sc1
    s_add_u32 s3, s3, 1
    s_waitcnt vmcnt(0)
    v_cmp_gt_i32 vcc, 1, v13
    s_cmp_ge_u32 s3, 0x40000
    s_cbranch_scc1 L_up_back1
    s_cbranch_vccz L_up_back1
    s_sleep 1
    s_branch L_up_spin1
L_up_slow2:
    s_mov_b32 s3, 0
L_up_spin2:
    buffer_load_dword v13, v12, s[44:47], s57 offen sc1
    s_add_u32 s3, s3, 1
    s_waitcnt vmcnt(0)
    v_cmp_gt_i32 vcc, 2, v13
    s_cmp_ge_u32 s3, 0x40000
    s_cbranch_scc1 L_up_back2
    s_cbranch_vccz L_up_back2
    s_sleep 1
    s_branch L_up_spin2
L_up_slow3:
    s_mov_b32 s3, 0
L_up_spin3:
    buffer_load_dword v13, v12, s[44:47], s57 offen sc1
    s_add_u32 s3, s3, 1
    s_waitcnt vmcnt(0)
    v_cmp_gt_i32 vcc, 3, v13
    s_cmp_ge_u32 s3, 0x40000
    s_cbranch_scc1 L_up_back3
    s_cbranch_vccz L_up_back3
    s_sleep 1
    s_branch L_up_spin3
L_up_slow4:
    s_mov_b32 s3, 0
L_up_spin4:
    buffer_load_dword v13, v12, s[44:47], s57 offen sc1
    s_add_u32 s3, s3, 1
    s_waitcnt vmcnt(0)
    v_cmp_gt_i32 vcc, 4, v13
    s_cmp_ge_u32 s3, 0x40000
    s_cbranch_scc1 L_up_back4
    s_cbranch_vccz L_up_back4
    s_sleep 1
    s_branch L_up_spin4
L_up_slow5:
    s_mov_b32 s3, 0
L_up_spin5:
    buffer_load_dword v13, v69, s[44:47], s58 offen sc1
    s_add_u32 s3, s3, 1
    s_waitcnt vmcnt(0)
    v_cmp_gt_i32 vcc, 5, v13
    s_cmp_ge_u32 s3, 0x40000
    s_cbranch_scc1 L_up_back5
    s_cbranch_vccz L_up_back5
    s_sleep 1
    s_branch L_up_spin5
L_qkv_slow0:
    s_mov_b32 s3, 0
L_qkv_spin0:
    buffer_load_dword v14, v15, s[4:7], 0 offen offset:128 sc1
    s_add_u32 s3, s3, 1
    s_waitcnt vmcnt(0)
    v_cmp_ne_u32 vcc, 1, v14
    s_cmp_ge_u32 s3, 0x40000
    s_cbranch_scc1 L_qkv_back0
    s_cbranch_vccz L_qkv_back0
    s_sleep 1
    s_branch L_qkv_spin0
L_qkv_slow3:
    s_mov_b32 s3, 0
L_qkv_spin3:
    buffer_load_dword v14, v15, s[36:39], s51 offen offset:64 sc1
    s_add_u32 s3, s3, 1
    s_waitcnt vmcnt(0)
    v_cmp_eq_u32 vcc, -1, v14
    s_cmp_ge_u32 s3, 0x40000
    s_cbranch_scc1 L_qkv_back3
    s_cbranch_vccz L_qkv_back3
    s_sleep 1
    s_branch L_qkv_spin3
L_qkv_slow1:
    s_mov_b32 s3, 0
L_qkv_spin1:
    buffer_load_dwordx4 v[232:235], v30, s[36:39], s50 offen sc1
    buffer_load_dwordx4 v[236:239], v30, s[36:39], s89 offen sc1
    buffer_load_dwordx4 v[48:51], v42, s[36:39], s51 offen sc1
    s_add_u32 s3, s3, 1
    s_waitcnt vmcnt(0)
    v_max3_u32 v240, v232, v236, v48
    v_cmp_eq_u32 vcc, -1, v240
    s_cmp_ge_u32 s3, 0x40000
    s_cbranch_scc1 L_qkv_back1
    s_cbranch_vccz L_qkv_back1
    s_sleep 1
    s_branch L_qkv_spin1
L_qkv_slow2:
    s_mov_b32 s3, 0
L_qkv_spin2:
    buffer_load_dwordx4 v[128:131], v1, s[36:39], s51 offen offset:0 sc1
    buffer_load_dwordx4 v[132:135], v1, s[36:39], s51 offen offset:1024 sc1
    s_add_u32 s3, s3, 1
    s_waitcnt vmcnt(0)
    v_max3_u32 v136, v128, v129, v130
    v_max3_u32 v137, v131, v132, v133
    v_max3_u32 v136, v136, v134, v135
    v_max_u32 v136, v136, v137
    v_cmp_eq_u32 vcc, -1, v136
    s_cmp_ge_u32 s3, 0x40000
    s_cbranch_scc1 L_qkv_back2
    s_cbranch_vccz L_qkv_back2
    s_sleep 1
    s_branch L_qkv_spin2
L_qkv_slow1w:
    s_mov_b32 s3, 0
L_qkv_spin1w:
    buffer_load_dword v16, v28, s[36:39], s57 offen sc1
    s_add_u32 s3, s3, 1
    s_waitcnt vmcnt(0)
    v_cmp_gt_i32 vcc, 1, v16
    s_cmp_ge_u32 s3, 0x40000
    s_cbranch_scc1 L_qkv_back1w
    s_cbranch_vccz L_qkv_back1w
    s_sleep 1
    s_branch L_qkv_spin1w
L_qkv_slow2w:
    s_mov_b32 s3, 0
L_qkv_spin2w:
    buffer_load_dword v16, v28, s[36:39], s57 offen sc1
    s_add_u32 s3, s3, 1
    s_waitcnt vmcnt(0)
    v_cmp_gt_i32 vcc, 2, v16
    s_cmp_ge_u32 s3, 0x40000
    s_cbranch_scc1 L_qkv_back2w
    s_cbranch_vccz L_qkv_back2w
    s_sleep 1
    s_branch L_qkv_spin2w
L_qkv_slow3w:
    s_mov_b32 s3, 0
L_qkv_spin3w:
    buffer_load_dword v16, v28, s[36:39], s57 offen sc1
    s_add_u32 s3, s3, 1
    s_waitcnt vmcnt(0)
    v_cmp_gt_i32 vcc, 3, v16
    s_cmp_ge_u32 s3, 0x40000
    s_cbranch_scc1 L_qkv_back3w
    s_cbranch_vccz L_qkv_back3w
    s_sleep 1
    s_branch L_qkv_spin3w
L_qkv_slow4w:
    s_mov_b32 s3, 0
L_qkv_spin4w:
    buffer_load_dword v16, v28, s[36:39], s57 offen sc1
    s_add_u32 s3, s3, 1
    s_waitcnt vmcnt(0)
    v_cmp_gt_i32 vcc, 4, v16
    s_cmp_ge_u32 s3, 0x40000
    s_cbranch_scc1 L_qkv_back4w
    s_cbranch_vccz L_qkv_back4w
    s_sleep 1
    s_branch L_qkv_spin4w
L_code_end:

.section .rodata,"a"
.p2align 6
.amdhsa_kernel qkv_kernel
  .amdhsa_next_free_vgpr 512
  .amdhsa_next_free_sgpr 102
  .amdhsa_accum_offset 256
  .amdhsa_group_segment_fixed_size 0
  .amdhsa_kernarg_size 88
  .amdhsa_user_sgpr_count 2
  .amdhsa_user_sgpr_kernarg_segment_ptr 1
  .amdhsa_system_sgpr_workgroup_id_x 1

  .amdhsa_float_denorm_mode_32 3
  .amdhsa_float_denorm_mode_16_64 3
.end_amdhsa_kernel
```
